```python
import torch

def _softmax(x, axis=-1):
    return torch.softmax(x, dim=axis)

def _gelu(x):
    return torch.nn.functional.gelu(x, approximate='tanh')

def _silu(x):
    return torch.nn.functional.silu(x)

def _sigmoid(x):
    return torch.sigmoid(x)

def _layernorm(x, axis=-1, eps=1e-05):
    m = x.mean(dim=axis, keepdim=True)
    v = x.var(dim=axis, keepdim=True, unbiased=False)
    return (x - m) / torch.sqrt(v + eps)

def _scatter_add(tgt, idx, src, axis=0):
    return tgt.clone().index_add_(axis, idx, src)

def _segment_sum(src, seg, n):
    out = torch.zeros((n,) + src.shape[1:], dtype=src.dtype)
    return out.index_add_(0, seg, src)

def _pad(x, pw):
    flat = tuple((v for pair in reversed(pw) for v in pair))
    return torch.nn.functional.pad(x, flat)
kernel_name = 'interleave_layers__memory_aug_recurrent_mem_tr__grouped_kv_mqa__prompt'

def setup_inputs():

    _w = lambda a: (lambda t: t.to(torch.bfloat16) if t.is_floating_point() else t)(torch.as_tensor(a))

    def _A_setup():
        B, S, Dm = (1, 2048, 448)
        H, Dh = (16, 256)
        M, seg = (8, 32)
        seg = min(seg, S)
        S = S // seg * seg
        return {'x': _w((lambda *s: torch.randn(*s, dtype=torch.bfloat16) * 0.05)(B, S, Dm)), 'mem0': _w((lambda *s: torch.randn(*s, dtype=torch.bfloat16) * 0.2)(B, M, Dm)), 'Wq': _w((lambda *s: torch.randn(*s, dtype=torch.bfloat16) * 1.6)(Dm, H, Dh) * Dm ** (-0.5)), 'Wk': _w((lambda *s: torch.randn(*s, dtype=torch.bfloat16) * 1.6)(Dm, H, Dh) * Dm ** (-0.5)), 'Wv': _w((lambda *s: torch.randn(*s, dtype=torch.bfloat16) * 0.2)(Dm, H, Dh) * Dm ** (-0.5)), 'Wo': _w((lambda *s: torch.randn(*s, dtype=torch.bfloat16) * 0.2)(H, Dh, Dm) * (H * Dh) ** (-0.5)), 'seg_len': seg}
    _A_in = _A_setup()

    def _B_setup():
        B, S, D, H = (1, 2048, 448, 16)
        Dh = D // H
        return {'x': _w((lambda *s: torch.randn(*s, dtype=torch.bfloat16) * 0.05)(B, S, D)), 'wq': _w((lambda *s: torch.randn(*s, dtype=torch.bfloat16) * 0.05)(D, H * Dh)), 'wk': _w((lambda *s: torch.randn(*s, dtype=torch.bfloat16) * 0.05)(D, Dh)), 'wv': _w((lambda *s: torch.randn(*s, dtype=torch.bfloat16) * 0.05)(D, Dh)), 'wo': _w((lambda *s: torch.randn(*s, dtype=torch.bfloat16) * 0.05)(H * Dh, D))}
    _B_in = _B_setup()
    return {'A_x': _A_in['x'], 'A_mem0': _A_in['mem0'], 'A_Wq': _A_in['Wq'], 'A_Wk': _A_in['Wk'], 'A_Wv': _A_in['Wv'], 'A_Wo': _A_in['Wo'], 'A_seg_len': _A_in['seg_len'], 'B_x': _B_in['x'], 'B_wq': _B_in['wq'], 'B_wk': _B_in['wk'], 'B_wv': _B_in['wv'], 'B_wo': _B_in['wo']}

def reference(A_x, A_mem0, A_Wq, A_Wk, A_Wv, A_Wo, A_seg_len, B_x, B_wq, B_wk, B_wv, B_wo):

    def _A_ref(x, mem0, Wq, Wk, Wv, Wo, seg_len):
        B, S, Dm = x.shape
        H, Dh = (Wq.shape[1], Wq.shape[2])
        M = mem0.shape[1]
        scale = Dh ** (-0.5)
        n_seg = S // seg_len
        L = M + seg_len
        idx = torch.arange(L)
        mask = (idx[:, None] < M) | (idx[:, None] >= idx[None, :])
        mem = mem0
        outs = []
        for s in range(n_seg):
            xs = x[:, s * seg_len:(s + 1) * seg_len, :].clone()
            h = torch.concatenate([mem, xs], axis=1)
            q = torch.einsum('btd,dhe->bhte', h, Wq)
            k = torch.einsum('btd,dhe->bhte', h, Wk)
            v = torch.einsum('btd,dhe->bhte', h, Wv)
            scores = torch.einsum('bhqe,bhke->bhqk', q, k) * scale
            scores = torch.where(mask[None, None], scores, -1000000000.0)
            p = _softmax(scores, axis=-1)
            o = torch.einsum('bhqk,bhke->bhqe', p, v)
            o = torch.einsum('bhte,hed->btd', o, Wo)
            mem = o[:, :M, :].clone()
            outs.append(o[:, M:, :])
        return torch.concatenate(outs, axis=1)

    def _B_ref(x, wq, wk, wv, wo):
        B, S, D = x.shape
        H = 16
        Dh = D // H
        q = (lambda x, *d: x.permute(*d))((x @ wq).reshape(B, S, H, Dh), 0, 2, 1, 3)
        k = x @ wk
        v = x @ wv
        scores = torch.einsum('bhqd,bkd->bhqk', q, k) * Dh ** (-0.5)
        p = _softmax(scores, axis=-1)
        o = torch.einsum('bhqk,bkd->bhqd', p, v)
        return (lambda x, *d: x.permute(*d))(o, 0, 2, 1, 3).reshape(B, S, H * Dh) @ wo
    x = A_x
    x = x + _A_ref(_layernorm(x, axis=-1), A_mem0, A_Wq, A_Wk, A_Wv, A_Wo, A_seg_len)
    x = x + _B_ref(_layernorm(x, axis=-1), B_wq, B_wk, B_wv, B_wo)
    x = x + _A_ref(_layernorm(x, axis=-1), A_mem0, A_Wq, A_Wk, A_Wv, A_Wo, A_seg_len)
    x = x + _B_ref(_layernorm(x, axis=-1), B_wq, B_wk, B_wv, B_wo)
    return x
```

```asm
; @launch kernel=prep_kernel grid=(256,1,1) block=(256,1,1) lds=136192
; @launch kernel=main_kernel grid=(256,1,1) block=(256,1,1) lds=163840
.amdgcn_target "amdgcn-amd-amdhsa--gfx950"
.text
    .globl prep_kernel
    .p2align 8
    .type prep_kernel,@function
prep_kernel:
    s_cmp_ge_u32 s2, 256
    s_cbranch_scc1 prep_end
    s_load_dwordx2 s[4:5], s[0:1], 112
    s_load_dwordx2 s[6:7], s[0:1], 0
    s_load_dwordx4 s[28:31], s[0:1], 16
    s_load_dwordx4 s[32:35], s[0:1], 32
    v_and_b32 v1, 63, v0
    v_lshrrev_b32 v2, 6, v0
    s_nop 0
    v_readfirstlane_b32 s3, v2
    s_and_b32 s45, s2, 7
    s_lshr_b32 s46, s2, 6
    s_lshl_b32 s46, s46, 3
    s_add_u32 s46, s46, s45
    s_lshr_b32 s48, s46, 4
    s_and_b32 s49, s46, 15
    s_bfe_u32 s47, s2, 0x10003
    s_bfe_u32 s50, s2, 0x20004
    s_and_b32 s66, s3, 1
    s_lshr_b32 s67, s3, 1
    s_waitcnt lgkmcnt(0)
    s_mov_b32 s8, s4
    s_and_b32 s9, s5, 0xffff
    s_mov_b32 s10, 0x10000000
    s_mov_b32 s11, 0x20000
    s_mov_b32 s12, s6
    s_and_b32 s13, s7, 0xffff
    s_mov_b32 s14, 0x1c0000
    s_mov_b32 s15, 0x20000
    s_cmp_eq_u32 s48, 0
    s_cselect_b32 s52, s28, s32
    s_cselect_b32 s53, s29, s33
    s_cselect_b32 s54, s30, s34
    s_cselect_b32 s55, s31, s35
    s_mov_b32 s16, s52
    s_and_b32 s17, s53, 0xffff
    s_mov_b32 s18, 0x380000
    s_mov_b32 s19, 0x20000
    s_mov_b32 s20, s54
    s_and_b32 s21, s55, 0xffff
    s_mov_b32 s22, 0x380000
    s_mov_b32 s23, 0x20000
    v_mov_b32 v3, 0x40000000
    s_lshl_b32 s40, s3, 2
    s_cmp_eq_u32 s3, 3
    s_cselect_b32 s40, 11, s40
    s_mov_b32 s24, s12
    s_mov_b32 s25, s13
    s_mov_b32 s27, s15
    s_cmp_lt_u32 s3, 2
    s_cselect_b32 s26, s14, 0
    s_cselect_b32 s39, 1.0, 0
    s_cselect_b32 s38, s10, 0
    s_mov_b32 s36, s8
    s_mov_b32 s37, s9
    s_mov_b32 s41, s39
    s_mov_b32 s39, s11
    v_bfe_u32 v8, v1, 0, 4
    v_mul_u32_u24 v8, 0x380, v8
    v_bfe_u32 v2, v1, 4, 2
    v_lshlrev_b32 v2, 4, v2
    v_add_u32 v8, v8, v2
    s_and_b32 s44, s2, 127
    s_mul_i32 s45, s44, 14336
    s_lshl_b32 s56, s40, 6
    s_add_u32 s45, s45, s56
    buffer_load_dwordx4 a[0:3], v8, s[12:15], s45 offen offset:0
    buffer_load_dwordx4 a[4:7], v8, s[12:15], s45 offen offset:64
    buffer_load_dwordx4 a[8:11], v8, s[12:15], s45 offen offset:128
    buffer_load_dwordx4 a[12:15], v8, s[24:27], s45 offen offset:192
    v_lshlrev_b32 v9, 3, v0
    v_cmp_gt_u32 vcc, 128, v0
    s_nop 1
    v_cndmask_b32 v14, v3, v9, vcc
    s_mul_i32 s42, s2, 7168
    buffer_load_dwordx2 a[16:17], v9, s[12:15], s42 offen offset:0
    buffer_load_dwordx2 a[18:19], v9, s[12:15], s42 offen offset:2048
    s_add_u32 s42, s42, 4096
    buffer_load_dwordx2 a[20:21], v9, s[12:15], s42 offen offset:0
    buffer_load_dwordx2 a[22:23], v14, s[12:15], s42 offen offset:2048
    v_lshrrev_b32 v10, 4, v1
    s_lshl_b32 s56, s66, 2
    v_add_u32 v10, s56, v10
    v_and_b32 v11, 7, v1
    v_xor_b32 v10, v10, v11
    v_lshlrev_b32 v10, 4, v10
    v_bfe_u32 v4, v1, 5, 1
    v_lshlrev_b32 v4, 16, v4
    v_bfe_u32 v2, v1, 3, 2
    v_lshlrev_b32 v2, 13, v2
    v_add_u32 v4, v4, v2
    v_add_u32 v4, v4, v10
    s_mul_i32 s56, s47, 224
    s_lshl_b32 s57, s66, 4
    s_add_u32 s56, s56, s57
    s_lshl_b32 s57, s67, 2
    s_add_u32 s56, s56, s57
    s_lshl_b32 s56, s56, 13
    s_lshl_b32 s58, s49, 9
    s_add_u32 s60, s56, s58
    s_cmp_eq_u32 s48, 0
    s_cbranch_scc0 prep_addr_b
    v_bfe_u32 v5, v1, 5, 1
    v_lshlrev_b32 v5, 16, v5
    v_bfe_u32 v2, v1, 3, 2
    v_lshlrev_b32 v2, 14, v2
    v_add_u32 v5, v5, v2
    v_add_u32 v5, v5, v10
    s_lshl_b32 s56, s50, 7
    s_lshl_b32 s57, s66, 4
    s_add_u32 s56, s56, s57
    s_add_u32 s56, s56, s67
    s_lshl_b32 s56, s56, 13
    s_add_u32 s61, s56, s58
    s_mov_b32 s62, 262144
    s_movk_i32 s63, 128
    s_cmp_eq_u32 s50, 3
    s_cselect_b32 s68, -262144, s62
    s_branch prep_addr_done
prep_addr_b:
    v_lshrrev_b32 v10, 4, v1
    s_lshl_b32 s56, s66, 2
    v_add_u32 v11, s56, v10
    v_lshlrev_b32 v11, 1, v11
    v_and_b32 v12, 15, v1
    v_xor_b32 v11, v11, v12
    s_cmp_eq_u32 s50, 3
    s_cselect_b32 s56, 8, 16
    v_cmp_gt_u32 vcc, s56, v11
    v_lshlrev_b32 v11, 4, v11
    v_mul_u32_u24 v5, 896, v10
    v_add_u32 v5, v5, v11
    v_cndmask_b32 v5, v3, v5, vcc
    s_lshl_b32 s56, s49, 8
    s_lshl_b32 s57, s3, 2
    s_add_u32 s56, s56, s57
    s_mul_i32 s56, s56, 896
    s_lshl_b32 s57, s50, 8
    s_add_u32 s61, s56, s57
    s_mov_b32 s62, 14336
    s_mov_b32 s63, 57344
    s_mov_b32 s68, s62
prep_addr_done:
    s_lshl_b32 s64, s3, 10
    s_add_u32 s56, s60, 0
    s_add_u32 m0, s64, 0
    s_nop 0
    buffer_load_dwordx4 v4, s[16:19], s56 offen lds
    s_add_u32 s56, s56, 262144
    s_add_u32 m0, s64, 4096
    s_nop 0
    buffer_load_dwordx4 v4, s[16:19], s56 offen lds
    s_add_u32 s56, s56, 262144
    s_add_u32 m0, s64, 8192
    s_nop 0
    buffer_load_dwordx4 v4, s[16:19], s56 offen lds
    s_add_u32 s56, s56, 262144
    s_add_u32 m0, s64, 12288
    s_nop 0
    buffer_load_dwordx4 v4, s[16:19], s56 offen lds
    s_add_u32 s56, s56, 262144
    s_add_u32 m0, s64, 16384
    s_nop 0
    buffer_load_dwordx4 v4, s[16:19], s56 offen lds
    s_add_u32 s56, s56, 262144
    s_add_u32 m0, s64, 20480
    s_nop 0
    buffer_load_dwordx4 v4, s[16:19], s56 offen lds
    s_add_u32 s56, s56, 262144
    s_add_u32 m0, s64, 24576
    s_nop 0
    buffer_load_dwordx4 v4, s[16:19], s56 offen lds
    s_mov_b32 s56, s61
    s_add_u32 m0, s64, 28672
    s_nop 0
    buffer_load_dwordx4 v5, s[20:23], s56 offen lds
    s_add_u32 s56, s56, s62
    s_add_u32 m0, s64, 32768
    s_nop 0
    buffer_load_dwordx4 v5, s[20:23], s56 offen lds
    s_add_u32 s56, s56, s68
    s_add_u32 m0, s64, 36864
    s_nop 0
    buffer_load_dwordx4 v5, s[20:23], s56 offen lds
    s_add_u32 s56, s56, s62
    s_add_u32 m0, s64, 40960
    s_nop 0
    buffer_load_dwordx4 v5, s[20:23], s56 offen lds
    s_add_u32 s61, s61, s63
    s_add_u32 s56, s60, 128
    s_add_u32 m0, s64, 45056
    s_nop 0
    buffer_load_dwordx4 v4, s[16:19], s56 offen lds
    s_add_u32 s56, s56, 262144
    s_add_u32 m0, s64, 49152
    s_nop 0
    buffer_load_dwordx4 v4, s[16:19], s56 offen lds
    s_add_u32 s56, s56, 262144
    s_add_u32 m0, s64, 53248
    s_nop 0
    buffer_load_dwordx4 v4, s[16:19], s56 offen lds
    s_add_u32 s56, s56, 262144
    s_add_u32 m0, s64, 57344
    s_nop 0
    buffer_load_dwordx4 v4, s[16:19], s56 offen lds
    s_add_u32 s56, s56, 262144
    s_add_u32 m0, s64, 61440
    s_nop 0
    buffer_load_dwordx4 v4, s[16:19], s56 offen lds
    s_add_u32 s56, s56, 262144
    s_add_u32 m0, s64, 65536
    s_nop 0
    buffer_load_dwordx4 v4, s[16:19], s56 offen lds
    s_add_u32 s56, s56, 262144
    s_add_u32 m0, s64, 69632
    s_nop 0
    buffer_load_dwordx4 v4, s[16:19], s56 offen lds
    s_mov_b32 s56, s61
    s_add_u32 m0, s64, 73728
    s_nop 0
    buffer_load_dwordx4 v5, s[20:23], s56 offen lds
    s_add_u32 s56, s56, s62
    s_add_u32 m0, s64, 77824
    s_nop 0
    buffer_load_dwordx4 v5, s[20:23], s56 offen lds
    s_add_u32 s56, s56, s68
    s_add_u32 m0, s64, 81920
    s_nop 0
    buffer_load_dwordx4 v5, s[20:23], s56 offen lds
    s_add_u32 s56, s56, s62
    s_add_u32 m0, s64, 86016
    s_nop 0
    buffer_load_dwordx4 v5, s[20:23], s56 offen lds
    s_add_u32 s61, s61, s63
    s_add_u32 s56, s60, 256
    s_add_u32 m0, s64, 90112
    s_nop 0
    buffer_load_dwordx4 v4, s[16:19], s56 offen lds
    s_add_u32 s56, s56, 262144
    s_add_u32 m0, s64, 94208
    s_nop 0
    buffer_load_dwordx4 v4, s[16:19], s56 offen lds
    s_add_u32 s56, s56, 262144
    s_add_u32 m0, s64, 98304
    s_nop 0
    buffer_load_dwordx4 v4, s[16:19], s56 offen lds
    s_add_u32 s56, s56, 262144
    s_add_u32 m0, s64, 102400
    s_nop 0
    buffer_load_dwordx4 v4, s[16:19], s56 offen lds
    s_add_u32 s56, s56, 262144
    s_add_u32 m0, s64, 106496
    s_nop 0
    buffer_load_dwordx4 v4, s[16:19], s56 offen lds
    s_add_u32 s56, s56, 262144
    s_add_u32 m0, s64, 110592
    s_nop 0
    buffer_load_dwordx4 v4, s[16:19], s56 offen lds
    s_add_u32 s56, s56, 262144
    s_add_u32 m0, s64, 114688
    s_nop 0
    buffer_load_dwordx4 v4, s[16:19], s56 offen lds
    s_mov_b32 s56, s61
    s_add_u32 m0, s64, 118784
    s_nop 0
    buffer_load_dwordx4 v5, s[20:23], s56 offen lds
    s_add_u32 s56, s56, s62
    s_add_u32 m0, s64, 122880
    s_nop 0
    buffer_load_dwordx4 v5, s[20:23], s56 offen lds
    s_add_u32 s56, s56, s68
    s_add_u32 m0, s64, 126976
    s_nop 0
    buffer_load_dwordx4 v5, s[20:23], s56 offen lds
    s_add_u32 s56, s56, s62
    s_add_u32 m0, s64, 131072
    s_nop 0
    buffer_load_dwordx4 v5, s[20:23], s56 offen lds
    s_add_u32 s61, s61, s63
    v_bfe_u32 v10, v1, 1, 3
    v_lshrrev_b32 v11, 4, v1
    v_xor_b32 v10, v10, v11
    v_lshlrev_b32 v10, 4, v10
    v_and_b32 v11, 15, v1
    v_lshlrev_b32 v11, 7, v11
    v_add_u32 v6, v10, v11
    v_xor_b32 v7, 64, v6
    s_cmp_eq_u32 s50, 3
    s_cselect_b32 s65, s67, 0
    s_cmp_eq_u32 s48, 0
    s_cbranch_scc0 prep_gemm_b
    s_lshl_b32 s56, s3, 12
    s_add_u32 s56, s56, 28672
    v_add_u32 v8, s56, v6
    v_add_u32 v9, s56, v7
    s_waitcnt vmcnt(22)
    s_barrier
    s_cmp_lg_u32 s65, 0
    s_cbranch_scc1 pg_1_idle
    ds_read_b128 v[240:243], v8 offset:0
    ds_read_b128 v[244:247], v8 offset:2048
    ds_read_b128 v[16:19], v6 offset:0
    ds_read_b128 v[20:23], v6 offset:2048
    ds_read_b128 v[24:27], v6 offset:4096
    ds_read_b128 v[28:31], v6 offset:6144
    ds_read_b128 v[32:35], v6 offset:8192
    ds_read_b128 v[36:39], v6 offset:10240
    ds_read_b128 v[40:43], v6 offset:12288
    ds_read_b128 v[44:47], v6 offset:14336
    ds_read_b128 v[48:51], v6 offset:16384
    ds_read_b128 v[52:55], v6 offset:18432
    ds_read_b128 v[56:59], v6 offset:20480
    ds_read_b128 v[60:63], v6 offset:22528
    ds_read_b128 v[64:67], v6 offset:24576
    ds_read_b128 v[68:71], v6 offset:26624
    s_waitcnt lgkmcnt(0)
    v_mfma_f32_16x16x32_bf16 v[128:131], v[16:19], v[240:243], 0
    ds_read_b128 v[248:251], v9 offset:0
    v_mfma_f32_16x16x32_bf16 v[132:135], v[16:19], v[244:247], 0
    ds_read_b128 v[252:255], v9 offset:2048
    v_mfma_f32_16x16x32_bf16 v[136:139], v[20:23], v[240:243], 0
    ds_read_b128 v[72:75], v7 offset:0
    v_mfma_f32_16x16x32_bf16 v[140:143], v[20:23], v[244:247], 0
    ds_read_b128 v[76:79], v7 offset:2048
    v_mfma_f32_16x16x32_bf16 v[144:147], v[24:27], v[240:243], 0
    ds_read_b128 v[80:83], v7 offset:4096
    v_mfma_f32_16x16x32_bf16 v[148:151], v[24:27], v[244:247], 0
    ds_read_b128 v[84:87], v7 offset:6144
    v_mfma_f32_16x16x32_bf16 v[152:155], v[28:31], v[240:243], 0
    ds_read_b128 v[88:91], v7 offset:8192
    v_mfma_f32_16x16x32_bf16 v[156:159], v[28:31], v[244:247], 0
    ds_read_b128 v[92:95], v7 offset:10240
    v_mfma_f32_16x16x32_bf16 v[160:163], v[32:35], v[240:243], 0
    ds_read_b128 v[96:99], v7 offset:12288
    v_mfma_f32_16x16x32_bf16 v[164:167], v[32:35], v[244:247], 0
    ds_read_b128 v[100:103], v7 offset:14336
    v_mfma_f32_16x16x32_bf16 v[168:171], v[36:39], v[240:243], 0
    ds_read_b128 v[104:107], v7 offset:16384
    v_mfma_f32_16x16x32_bf16 v[172:175], v[36:39], v[244:247], 0
    ds_read_b128 v[108:111], v7 offset:18432
    v_mfma_f32_16x16x32_bf16 v[176:179], v[40:43], v[240:243], 0
    ds_read_b128 v[112:115], v7 offset:20480
    v_mfma_f32_16x16x32_bf16 v[180:183], v[40:43], v[244:247], 0
    ds_read_b128 v[116:119], v7 offset:22528
    v_mfma_f32_16x16x32_bf16 v[184:187], v[44:47], v[240:243], 0
    ds_read_b128 v[120:123], v7 offset:24576
    v_mfma_f32_16x16x32_bf16 v[188:191], v[44:47], v[244:247], 0
    ds_read_b128 v[124:127], v7 offset:26624
    v_mfma_f32_16x16x32_bf16 v[192:195], v[48:51], v[240:243], 0
    v_mfma_f32_16x16x32_bf16 v[196:199], v[48:51], v[244:247], 0
    v_mfma_f32_16x16x32_bf16 v[200:203], v[52:55], v[240:243], 0
    v_mfma_f32_16x16x32_bf16 v[204:207], v[52:55], v[244:247], 0
    v_mfma_f32_16x16x32_bf16 v[208:211], v[56:59], v[240:243], 0
    v_mfma_f32_16x16x32_bf16 v[212:215], v[56:59], v[244:247], 0
    v_mfma_f32_16x16x32_bf16 v[216:219], v[60:63], v[240:243], 0
    v_mfma_f32_16x16x32_bf16 v[220:223], v[60:63], v[244:247], 0
    v_mfma_f32_16x16x32_bf16 v[224:227], v[64:67], v[240:243], 0
    v_mfma_f32_16x16x32_bf16 v[228:231], v[64:67], v[244:247], 0
    v_mfma_f32_16x16x32_bf16 v[232:235], v[68:71], v[240:243], 0
    v_mfma_f32_16x16x32_bf16 v[236:239], v[68:71], v[244:247], 0
    s_waitcnt lgkmcnt(0)
    s_waitcnt vmcnt(11)
    s_barrier
    s_add_u32 s56, s60, 384
    s_add_u32 m0, s64, 0
    s_nop 0
    buffer_load_dwordx4 v4, s[16:19], s56 offen lds
    s_add_u32 s56, s56, 262144
    s_add_u32 m0, s64, 4096
    s_nop 0
    buffer_load_dwordx4 v4, s[16:19], s56 offen lds
    s_add_u32 s56, s56, 262144
    s_add_u32 m0, s64, 8192
    s_nop 0
    buffer_load_dwordx4 v4, s[16:19], s56 offen lds
    s_add_u32 s56, s56, 262144
    s_add_u32 m0, s64, 12288
    s_nop 0
    buffer_load_dwordx4 v4, s[16:19], s56 offen lds
    s_add_u32 s56, s56, 262144
    s_add_u32 m0, s64, 16384
    s_nop 0
    buffer_load_dwordx4 v4, s[16:19], s56 offen lds
    s_add_u32 s56, s56, 262144
    s_add_u32 m0, s64, 20480
    s_nop 0
    buffer_load_dwordx4 v4, s[16:19], s56 offen lds
    s_add_u32 s56, s56, 262144
    s_add_u32 m0, s64, 24576
    s_nop 0
    buffer_load_dwordx4 v4, s[16:19], s56 offen lds
    s_mov_b32 s56, s61
    s_add_u32 m0, s64, 28672
    s_nop 0
    buffer_load_dwordx4 v5, s[20:23], s56 offen lds
    s_add_u32 s56, s56, s62
    s_add_u32 m0, s64, 32768
    s_nop 0
    buffer_load_dwordx4 v5, s[20:23], s56 offen lds
    s_add_u32 s56, s56, s68
    s_add_u32 m0, s64, 36864
    s_nop 0
    buffer_load_dwordx4 v5, s[20:23], s56 offen lds
    s_add_u32 s56, s56, s62
    s_add_u32 m0, s64, 40960
    s_nop 0
    buffer_load_dwordx4 v5, s[20:23], s56 offen lds
    s_add_u32 s61, s61, s63
    v_add_u32 v6, 0xb000, v6
    v_add_u32 v7, 0xb000, v7
    v_add_u32 v8, 0xb000, v8
    v_add_u32 v9, 0xb000, v9
    v_mfma_f32_16x16x32_bf16 v[128:131], v[72:75], v[248:251], v[128:131]
    ds_read_b128 v[240:243], v8 offset:0
    v_mfma_f32_16x16x32_bf16 v[132:135], v[72:75], v[252:255], v[132:135]
    ds_read_b128 v[244:247], v8 offset:2048
    v_mfma_f32_16x16x32_bf16 v[136:139], v[76:79], v[248:251], v[136:139]
    ds_read_b128 v[16:19], v6 offset:0
    v_mfma_f32_16x16x32_bf16 v[140:143], v[76:79], v[252:255], v[140:143]
    ds_read_b128 v[20:23], v6 offset:2048
    v_mfma_f32_16x16x32_bf16 v[144:147], v[80:83], v[248:251], v[144:147]
    ds_read_b128 v[24:27], v6 offset:4096
    v_mfma_f32_16x16x32_bf16 v[148:151], v[80:83], v[252:255], v[148:151]
    ds_read_b128 v[28:31], v6 offset:6144
    v_mfma_f32_16x16x32_bf16 v[152:155], v[84:87], v[248:251], v[152:155]
    ds_read_b128 v[32:35], v6 offset:8192
    v_mfma_f32_16x16x32_bf16 v[156:159], v[84:87], v[252:255], v[156:159]
    ds_read_b128 v[36:39], v6 offset:10240
    v_mfma_f32_16x16x32_bf16 v[160:163], v[88:91], v[248:251], v[160:163]
    ds_read_b128 v[40:43], v6 offset:12288
    v_mfma_f32_16x16x32_bf16 v[164:167], v[88:91], v[252:255], v[164:167]
    ds_read_b128 v[44:47], v6 offset:14336
    v_mfma_f32_16x16x32_bf16 v[168:171], v[92:95], v[248:251], v[168:171]
    ds_read_b128 v[48:51], v6 offset:16384
    v_mfma_f32_16x16x32_bf16 v[172:175], v[92:95], v[252:255], v[172:175]
    ds_read_b128 v[52:55], v6 offset:18432
    v_mfma_f32_16x16x32_bf16 v[176:179], v[96:99], v[248:251], v[176:179]
    ds_read_b128 v[56:59], v6 offset:20480
    v_mfma_f32_16x16x32_bf16 v[180:183], v[96:99], v[252:255], v[180:183]
    ds_read_b128 v[60:63], v6 offset:22528
    v_mfma_f32_16x16x32_bf16 v[184:187], v[100:103], v[248:251], v[184:187]
    ds_read_b128 v[64:67], v6 offset:24576
    v_mfma_f32_16x16x32_bf16 v[188:191], v[100:103], v[252:255], v[188:191]
    ds_read_b128 v[68:71], v6 offset:26624
    v_mfma_f32_16x16x32_bf16 v[192:195], v[104:107], v[248:251], v[192:195]
    v_mfma_f32_16x16x32_bf16 v[196:199], v[104:107], v[252:255], v[196:199]
    v_mfma_f32_16x16x32_bf16 v[200:203], v[108:111], v[248:251], v[200:203]
    v_mfma_f32_16x16x32_bf16 v[204:207], v[108:111], v[252:255], v[204:207]
    v_mfma_f32_16x16x32_bf16 v[208:211], v[112:115], v[248:251], v[208:211]
    v_mfma_f32_16x16x32_bf16 v[212:215], v[112:115], v[252:255], v[212:215]
    v_mfma_f32_16x16x32_bf16 v[216:219], v[116:119], v[248:251], v[216:219]
    v_mfma_f32_16x16x32_bf16 v[220:223], v[116:119], v[252:255], v[220:223]
    v_mfma_f32_16x16x32_bf16 v[224:227], v[120:123], v[248:251], v[224:227]
    v_mfma_f32_16x16x32_bf16 v[228:231], v[120:123], v[252:255], v[228:231]
    v_mfma_f32_16x16x32_bf16 v[232:235], v[124:127], v[248:251], v[232:235]
    v_mfma_f32_16x16x32_bf16 v[236:239], v[124:127], v[252:255], v[236:239]
    s_waitcnt lgkmcnt(0)
    v_mfma_f32_16x16x32_bf16 v[128:131], v[16:19], v[240:243], v[128:131]
    ds_read_b128 v[248:251], v9 offset:0
    v_mfma_f32_16x16x32_bf16 v[132:135], v[16:19], v[244:247], v[132:135]
    ds_read_b128 v[252:255], v9 offset:2048
    v_mfma_f32_16x16x32_bf16 v[136:139], v[20:23], v[240:243], v[136:139]
    ds_read_b128 v[72:75], v7 offset:0
    v_mfma_f32_16x16x32_bf16 v[140:143], v[20:23], v[244:247], v[140:143]
    ds_read_b128 v[76:79], v7 offset:2048
    v_mfma_f32_16x16x32_bf16 v[144:147], v[24:27], v[240:243], v[144:147]
    ds_read_b128 v[80:83], v7 offset:4096
    v_mfma_f32_16x16x32_bf16 v[148:151], v[24:27], v[244:247], v[148:151]
    ds_read_b128 v[84:87], v7 offset:6144
    v_mfma_f32_16x16x32_bf16 v[152:155], v[28:31], v[240:243], v[152:155]
    ds_read_b128 v[88:91], v7 offset:8192
    v_mfma_f32_16x16x32_bf16 v[156:159], v[28:31], v[244:247], v[156:159]
    ds_read_b128 v[92:95], v7 offset:10240
    v_mfma_f32_16x16x32_bf16 v[160:163], v[32:35], v[240:243], v[160:163]
    ds_read_b128 v[96:99], v7 offset:12288
    v_mfma_f32_16x16x32_bf16 v[164:167], v[32:35], v[244:247], v[164:167]
    ds_read_b128 v[100:103], v7 offset:14336
    v_mfma_f32_16x16x32_bf16 v[168:171], v[36:39], v[240:243], v[168:171]
    ds_read_b128 v[104:107], v7 offset:16384
    v_mfma_f32_16x16x32_bf16 v[172:175], v[36:39], v[244:247], v[172:175]
    ds_read_b128 v[108:111], v7 offset:18432
    v_mfma_f32_16x16x32_bf16 v[176:179], v[40:43], v[240:243], v[176:179]
    ds_read_b128 v[112:115], v7 offset:20480
    v_mfma_f32_16x16x32_bf16 v[180:183], v[40:43], v[244:247], v[180:183]
    ds_read_b128 v[116:119], v7 offset:22528
    v_mfma_f32_16x16x32_bf16 v[184:187], v[44:47], v[240:243], v[184:187]
    ds_read_b128 v[120:123], v7 offset:24576
    v_mfma_f32_16x16x32_bf16 v[188:191], v[44:47], v[244:247], v[188:191]
    ds_read_b128 v[124:127], v7 offset:26624
    v_mfma_f32_16x16x32_bf16 v[192:195], v[48:51], v[240:243], v[192:195]
    v_mfma_f32_16x16x32_bf16 v[196:199], v[48:51], v[244:247], v[196:199]
    v_mfma_f32_16x16x32_bf16 v[200:203], v[52:55], v[240:243], v[200:203]
    v_mfma_f32_16x16x32_bf16 v[204:207], v[52:55], v[244:247], v[204:207]
    v_mfma_f32_16x16x32_bf16 v[208:211], v[56:59], v[240:243], v[208:211]
    v_mfma_f32_16x16x32_bf16 v[212:215], v[56:59], v[244:247], v[212:215]
    v_mfma_f32_16x16x32_bf16 v[216:219], v[60:63], v[240:243], v[216:219]
    v_mfma_f32_16x16x32_bf16 v[220:223], v[60:63], v[244:247], v[220:223]
    v_mfma_f32_16x16x32_bf16 v[224:227], v[64:67], v[240:243], v[224:227]
    v_mfma_f32_16x16x32_bf16 v[228:231], v[64:67], v[244:247], v[228:231]
    v_mfma_f32_16x16x32_bf16 v[232:235], v[68:71], v[240:243], v[232:235]
    v_mfma_f32_16x16x32_bf16 v[236:239], v[68:71], v[244:247], v[236:239]
    s_waitcnt lgkmcnt(0)
    s_waitcnt vmcnt(11)
    s_barrier
    v_add_u32 v6, 0xb000, v6
    v_add_u32 v7, 0xb000, v7
    v_add_u32 v8, 0xb000, v8
    v_add_u32 v9, 0xb000, v9
    v_mfma_f32_16x16x32_bf16 v[128:131], v[72:75], v[248:251], v[128:131]
    ds_read_b128 v[240:243], v8 offset:0
    v_mfma_f32_16x16x32_bf16 v[132:135], v[72:75], v[252:255], v[132:135]
    ds_read_b128 v[244:247], v8 offset:2048
    v_mfma_f32_16x16x32_bf16 v[136:139], v[76:79], v[248:251], v[136:139]
    ds_read_b128 v[16:19], v6 offset:0
    v_mfma_f32_16x16x32_bf16 v[140:143], v[76:79], v[252:255], v[140:143]
    ds_read_b128 v[20:23], v6 offset:2048
    v_mfma_f32_16x16x32_bf16 v[144:147], v[80:83], v[248:251], v[144:147]
    ds_read_b128 v[24:27], v6 offset:4096
    v_mfma_f32_16x16x32_bf16 v[148:151], v[80:83], v[252:255], v[148:151]
    ds_read_b128 v[28:31], v6 offset:6144
    v_mfma_f32_16x16x32_bf16 v[152:155], v[84:87], v[248:251], v[152:155]
    ds_read_b128 v[32:35], v6 offset:8192
    v_mfma_f32_16x16x32_bf16 v[156:159], v[84:87], v[252:255], v[156:159]
    ds_read_b128 v[36:39], v6 offset:10240
    v_mfma_f32_16x16x32_bf16 v[160:163], v[88:91], v[248:251], v[160:163]
    ds_read_b128 v[40:43], v6 offset:12288
    v_mfma_f32_16x16x32_bf16 v[164:167], v[88:91], v[252:255], v[164:167]
    ds_read_b128 v[44:47], v6 offset:14336
    v_mfma_f32_16x16x32_bf16 v[168:171], v[92:95], v[248:251], v[168:171]
    ds_read_b128 v[48:51], v6 offset:16384
    v_mfma_f32_16x16x32_bf16 v[172:175], v[92:95], v[252:255], v[172:175]
    ds_read_b128 v[52:55], v6 offset:18432
    v_mfma_f32_16x16x32_bf16 v[176:179], v[96:99], v[248:251], v[176:179]
    ds_read_b128 v[56:59], v6 offset:20480
    v_mfma_f32_16x16x32_bf16 v[180:183], v[96:99], v[252:255], v[180:183]
    ds_read_b128 v[60:63], v6 offset:22528
    v_mfma_f32_16x16x32_bf16 v[184:187], v[100:103], v[248:251], v[184:187]
    ds_read_b128 v[64:67], v6 offset:24576
    v_mfma_f32_16x16x32_bf16 v[188:191], v[100:103], v[252:255], v[188:191]
    ds_read_b128 v[68:71], v6 offset:26624
    v_mfma_f32_16x16x32_bf16 v[192:195], v[104:107], v[248:251], v[192:195]
    v_mfma_f32_16x16x32_bf16 v[196:199], v[104:107], v[252:255], v[196:199]
    v_mfma_f32_16x16x32_bf16 v[200:203], v[108:111], v[248:251], v[200:203]
    v_mfma_f32_16x16x32_bf16 v[204:207], v[108:111], v[252:255], v[204:207]
    v_mfma_f32_16x16x32_bf16 v[208:211], v[112:115], v[248:251], v[208:211]
    v_mfma_f32_16x16x32_bf16 v[212:215], v[112:115], v[252:255], v[212:215]
    v_mfma_f32_16x16x32_bf16 v[216:219], v[116:119], v[248:251], v[216:219]
    v_mfma_f32_16x16x32_bf16 v[220:223], v[116:119], v[252:255], v[220:223]
    v_mfma_f32_16x16x32_bf16 v[224:227], v[120:123], v[248:251], v[224:227]
    v_mfma_f32_16x16x32_bf16 v[228:231], v[120:123], v[252:255], v[228:231]
    v_mfma_f32_16x16x32_bf16 v[232:235], v[124:127], v[248:251], v[232:235]
    v_mfma_f32_16x16x32_bf16 v[236:239], v[124:127], v[252:255], v[236:239]
    s_waitcnt lgkmcnt(0)
    v_mfma_f32_16x16x32_bf16 v[128:131], v[16:19], v[240:243], v[128:131]
    ds_read_b128 v[248:251], v9 offset:0
    v_mfma_f32_16x16x32_bf16 v[132:135], v[16:19], v[244:247], v[132:135]
    ds_read_b128 v[252:255], v9 offset:2048
    v_mfma_f32_16x16x32_bf16 v[136:139], v[20:23], v[240:243], v[136:139]
    ds_read_b128 v[72:75], v7 offset:0
    v_mfma_f32_16x16x32_bf16 v[140:143], v[20:23], v[244:247], v[140:143]
    ds_read_b128 v[76:79], v7 offset:2048
    v_mfma_f32_16x16x32_bf16 v[144:147], v[24:27], v[240:243], v[144:147]
    ds_read_b128 v[80:83], v7 offset:4096
    v_mfma_f32_16x16x32_bf16 v[148:151], v[24:27], v[244:247], v[148:151]
    ds_read_b128 v[84:87], v7 offset:6144
    v_mfma_f32_16x16x32_bf16 v[152:155], v[28:31], v[240:243], v[152:155]
    ds_read_b128 v[88:91], v7 offset:8192
    v_mfma_f32_16x16x32_bf16 v[156:159], v[28:31], v[244:247], v[156:159]
    ds_read_b128 v[92:95], v7 offset:10240
    v_mfma_f32_16x16x32_bf16 v[160:163], v[32:35], v[240:243], v[160:163]
    ds_read_b128 v[96:99], v7 offset:12288
    v_mfma_f32_16x16x32_bf16 v[164:167], v[32:35], v[244:247], v[164:167]
    ds_read_b128 v[100:103], v7 offset:14336
    v_mfma_f32_16x16x32_bf16 v[168:171], v[36:39], v[240:243], v[168:171]
    ds_read_b128 v[104:107], v7 offset:16384
    v_mfma_f32_16x16x32_bf16 v[172:175], v[36:39], v[244:247], v[172:175]
    ds_read_b128 v[108:111], v7 offset:18432
    v_mfma_f32_16x16x32_bf16 v[176:179], v[40:43], v[240:243], v[176:179]
    ds_read_b128 v[112:115], v7 offset:20480
    v_mfma_f32_16x16x32_bf16 v[180:183], v[40:43], v[244:247], v[180:183]
    ds_read_b128 v[116:119], v7 offset:22528
    v_mfma_f32_16x16x32_bf16 v[184:187], v[44:47], v[240:243], v[184:187]
    ds_read_b128 v[120:123], v7 offset:24576
    v_mfma_f32_16x16x32_bf16 v[188:191], v[44:47], v[244:247], v[188:191]
    ds_read_b128 v[124:127], v7 offset:26624
    v_mfma_f32_16x16x32_bf16 v[192:195], v[48:51], v[240:243], v[192:195]
    v_mfma_f32_16x16x32_bf16 v[196:199], v[48:51], v[244:247], v[196:199]
    v_mfma_f32_16x16x32_bf16 v[200:203], v[52:55], v[240:243], v[200:203]
    v_mfma_f32_16x16x32_bf16 v[204:207], v[52:55], v[244:247], v[204:207]
    v_mfma_f32_16x16x32_bf16 v[208:211], v[56:59], v[240:243], v[208:211]
    v_mfma_f32_16x16x32_bf16 v[212:215], v[56:59], v[244:247], v[212:215]
    v_mfma_f32_16x16x32_bf16 v[216:219], v[60:63], v[240:243], v[216:219]
    v_mfma_f32_16x16x32_bf16 v[220:223], v[60:63], v[244:247], v[220:223]
    v_mfma_f32_16x16x32_bf16 v[224:227], v[64:67], v[240:243], v[224:227]
    v_mfma_f32_16x16x32_bf16 v[228:231], v[64:67], v[244:247], v[228:231]
    v_mfma_f32_16x16x32_bf16 v[232:235], v[68:71], v[240:243], v[232:235]
    v_mfma_f32_16x16x32_bf16 v[236:239], v[68:71], v[244:247], v[236:239]
    s_waitcnt lgkmcnt(0)
    s_waitcnt vmcnt(0)
    s_barrier
    v_add_u32 v6, 0xfffea000, v6
    v_add_u32 v7, 0xfffea000, v7
    v_add_u32 v8, 0xfffea000, v8
    v_add_u32 v9, 0xfffea000, v9
    v_mfma_f32_16x16x32_bf16 v[128:131], v[72:75], v[248:251], v[128:131]
    ds_read_b128 v[240:243], v8 offset:0
    v_mfma_f32_16x16x32_bf16 v[132:135], v[72:75], v[252:255], v[132:135]
    ds_read_b128 v[244:247], v8 offset:2048
    v_mfma_f32_16x16x32_bf16 v[136:139], v[76:79], v[248:251], v[136:139]
    ds_read_b128 v[16:19], v6 offset:0
    v_mfma_f32_16x16x32_bf16 v[140:143], v[76:79], v[252:255], v[140:143]
    ds_read_b128 v[20:23], v6 offset:2048
    v_mfma_f32_16x16x32_bf16 v[144:147], v[80:83], v[248:251], v[144:147]
    ds_read_b128 v[24:27], v6 offset:4096
    v_mfma_f32_16x16x32_bf16 v[148:151], v[80:83], v[252:255], v[148:151]
    ds_read_b128 v[28:31], v6 offset:6144
    v_mfma_f32_16x16x32_bf16 v[152:155], v[84:87], v[248:251], v[152:155]
    ds_read_b128 v[32:35], v6 offset:8192
    v_mfma_f32_16x16x32_bf16 v[156:159], v[84:87], v[252:255], v[156:159]
    ds_read_b128 v[36:39], v6 offset:10240
    v_mfma_f32_16x16x32_bf16 v[160:163], v[88:91], v[248:251], v[160:163]
    ds_read_b128 v[40:43], v6 offset:12288
    v_mfma_f32_16x16x32_bf16 v[164:167], v[88:91], v[252:255], v[164:167]
    ds_read_b128 v[44:47], v6 offset:14336
    v_mfma_f32_16x16x32_bf16 v[168:171], v[92:95], v[248:251], v[168:171]
    ds_read_b128 v[48:51], v6 offset:16384
    v_mfma_f32_16x16x32_bf16 v[172:175], v[92:95], v[252:255], v[172:175]
    ds_read_b128 v[52:55], v6 offset:18432
    v_mfma_f32_16x16x32_bf16 v[176:179], v[96:99], v[248:251], v[176:179]
    ds_read_b128 v[56:59], v6 offset:20480
    v_mfma_f32_16x16x32_bf16 v[180:183], v[96:99], v[252:255], v[180:183]
    ds_read_b128 v[60:63], v6 offset:22528
    v_mfma_f32_16x16x32_bf16 v[184:187], v[100:103], v[248:251], v[184:187]
    ds_read_b128 v[64:67], v6 offset:24576
    v_mfma_f32_16x16x32_bf16 v[188:191], v[100:103], v[252:255], v[188:191]
    ds_read_b128 v[68:71], v6 offset:26624
    v_mfma_f32_16x16x32_bf16 v[192:195], v[104:107], v[248:251], v[192:195]
    v_mfma_f32_16x16x32_bf16 v[196:199], v[104:107], v[252:255], v[196:199]
    v_mfma_f32_16x16x32_bf16 v[200:203], v[108:111], v[248:251], v[200:203]
    v_mfma_f32_16x16x32_bf16 v[204:207], v[108:111], v[252:255], v[204:207]
    v_mfma_f32_16x16x32_bf16 v[208:211], v[112:115], v[248:251], v[208:211]
    v_mfma_f32_16x16x32_bf16 v[212:215], v[112:115], v[252:255], v[212:215]
    v_mfma_f32_16x16x32_bf16 v[216:219], v[116:119], v[248:251], v[216:219]
    v_mfma_f32_16x16x32_bf16 v[220:223], v[116:119], v[252:255], v[220:223]
    v_mfma_f32_16x16x32_bf16 v[224:227], v[120:123], v[248:251], v[224:227]
    v_mfma_f32_16x16x32_bf16 v[228:231], v[120:123], v[252:255], v[228:231]
    v_mfma_f32_16x16x32_bf16 v[232:235], v[124:127], v[248:251], v[232:235]
    v_mfma_f32_16x16x32_bf16 v[236:239], v[124:127], v[252:255], v[236:239]
    s_waitcnt lgkmcnt(0)
    v_mfma_f32_16x16x32_bf16 v[128:131], v[16:19], v[240:243], v[128:131]
    ds_read_b128 v[248:251], v9 offset:0
    v_mfma_f32_16x16x32_bf16 v[132:135], v[16:19], v[244:247], v[132:135]
    ds_read_b128 v[252:255], v9 offset:2048
    v_mfma_f32_16x16x32_bf16 v[136:139], v[20:23], v[240:243], v[136:139]
    ds_read_b128 v[72:75], v7 offset:0
    v_mfma_f32_16x16x32_bf16 v[140:143], v[20:23], v[244:247], v[140:143]
    ds_read_b128 v[76:79], v7 offset:2048
    v_mfma_f32_16x16x32_bf16 v[144:147], v[24:27], v[240:243], v[144:147]
    ds_read_b128 v[80:83], v7 offset:4096
    v_mfma_f32_16x16x32_bf16 v[148:151], v[24:27], v[244:247], v[148:151]
    ds_read_b128 v[84:87], v7 offset:6144
    v_mfma_f32_16x16x32_bf16 v[152:155], v[28:31], v[240:243], v[152:155]
    ds_read_b128 v[88:91], v7 offset:8192
    v_mfma_f32_16x16x32_bf16 v[156:159], v[28:31], v[244:247], v[156:159]
    ds_read_b128 v[92:95], v7 offset:10240
    v_mfma_f32_16x16x32_bf16 v[160:163], v[32:35], v[240:243], v[160:163]
    ds_read_b128 v[96:99], v7 offset:12288
    v_mfma_f32_16x16x32_bf16 v[164:167], v[32:35], v[244:247], v[164:167]
    ds_read_b128 v[100:103], v7 offset:14336
    v_mfma_f32_16x16x32_bf16 v[168:171], v[36:39], v[240:243], v[168:171]
    ds_read_b128 v[104:107], v7 offset:16384
    v_mfma_f32_16x16x32_bf16 v[172:175], v[36:39], v[244:247], v[172:175]
    ds_read_b128 v[108:111], v7 offset:18432
    v_mfma_f32_16x16x32_bf16 v[176:179], v[40:43], v[240:243], v[176:179]
    ds_read_b128 v[112:115], v7 offset:20480
    v_mfma_f32_16x16x32_bf16 v[180:183], v[40:43], v[244:247], v[180:183]
    ds_read_b128 v[116:119], v7 offset:22528
    v_mfma_f32_16x16x32_bf16 v[184:187], v[44:47], v[240:243], v[184:187]
    ds_read_b128 v[120:123], v7 offset:24576
    v_mfma_f32_16x16x32_bf16 v[188:191], v[44:47], v[244:247], v[188:191]
    ds_read_b128 v[124:127], v7 offset:26624
    v_mfma_f32_16x16x32_bf16 v[192:195], v[48:51], v[240:243], v[192:195]
    v_mfma_f32_16x16x32_bf16 v[196:199], v[48:51], v[244:247], v[196:199]
    v_mfma_f32_16x16x32_bf16 v[200:203], v[52:55], v[240:243], v[200:203]
    v_mfma_f32_16x16x32_bf16 v[204:207], v[52:55], v[244:247], v[204:207]
    v_mfma_f32_16x16x32_bf16 v[208:211], v[56:59], v[240:243], v[208:211]
    v_mfma_f32_16x16x32_bf16 v[212:215], v[56:59], v[244:247], v[212:215]
    v_mfma_f32_16x16x32_bf16 v[216:219], v[60:63], v[240:243], v[216:219]
    v_mfma_f32_16x16x32_bf16 v[220:223], v[60:63], v[244:247], v[220:223]
    v_mfma_f32_16x16x32_bf16 v[224:227], v[64:67], v[240:243], v[224:227]
    v_mfma_f32_16x16x32_bf16 v[228:231], v[64:67], v[244:247], v[228:231]
    v_mfma_f32_16x16x32_bf16 v[232:235], v[68:71], v[240:243], v[232:235]
    v_mfma_f32_16x16x32_bf16 v[236:239], v[68:71], v[244:247], v[236:239]
    s_waitcnt lgkmcnt(0)
    v_mfma_f32_16x16x32_bf16 v[128:131], v[72:75], v[248:251], v[128:131]
    v_mfma_f32_16x16x32_bf16 v[132:135], v[72:75], v[252:255], v[132:135]
    v_mfma_f32_16x16x32_bf16 v[136:139], v[76:79], v[248:251], v[136:139]
    v_mfma_f32_16x16x32_bf16 v[140:143], v[76:79], v[252:255], v[140:143]
    v_mfma_f32_16x16x32_bf16 v[144:147], v[80:83], v[248:251], v[144:147]
    v_mfma_f32_16x16x32_bf16 v[148:151], v[80:83], v[252:255], v[148:151]
    v_mfma_f32_16x16x32_bf16 v[152:155], v[84:87], v[248:251], v[152:155]
    v_mfma_f32_16x16x32_bf16 v[156:159], v[84:87], v[252:255], v[156:159]
    v_mfma_f32_16x16x32_bf16 v[160:163], v[88:91], v[248:251], v[160:163]
    v_mfma_f32_16x16x32_bf16 v[164:167], v[88:91], v[252:255], v[164:167]
    v_mfma_f32_16x16x32_bf16 v[168:171], v[92:95], v[248:251], v[168:171]
    v_mfma_f32_16x16x32_bf16 v[172:175], v[92:95], v[252:255], v[172:175]
    v_mfma_f32_16x16x32_bf16 v[176:179], v[96:99], v[248:251], v[176:179]
    v_mfma_f32_16x16x32_bf16 v[180:183], v[96:99], v[252:255], v[180:183]
    v_mfma_f32_16x16x32_bf16 v[184:187], v[100:103], v[248:251], v[184:187]
    v_mfma_f32_16x16x32_bf16 v[188:191], v[100:103], v[252:255], v[188:191]
    v_mfma_f32_16x16x32_bf16 v[192:195], v[104:107], v[248:251], v[192:195]
    v_mfma_f32_16x16x32_bf16 v[196:199], v[104:107], v[252:255], v[196:199]
    v_mfma_f32_16x16x32_bf16 v[200:203], v[108:111], v[248:251], v[200:203]
    v_mfma_f32_16x16x32_bf16 v[204:207], v[108:111], v[252:255], v[204:207]
    v_mfma_f32_16x16x32_bf16 v[208:211], v[112:115], v[248:251], v[208:211]
    v_mfma_f32_16x16x32_bf16 v[212:215], v[112:115], v[252:255], v[212:215]
    v_mfma_f32_16x16x32_bf16 v[216:219], v[116:119], v[248:251], v[216:219]
    v_mfma_f32_16x16x32_bf16 v[220:223], v[116:119], v[252:255], v[220:223]
    v_mfma_f32_16x16x32_bf16 v[224:227], v[120:123], v[248:251], v[224:227]
    v_mfma_f32_16x16x32_bf16 v[228:231], v[120:123], v[252:255], v[228:231]
    v_mfma_f32_16x16x32_bf16 v[232:235], v[124:127], v[248:251], v[232:235]
    v_mfma_f32_16x16x32_bf16 v[236:239], v[124:127], v[252:255], v[236:239]
    s_branch pg_1_done
pg_1_idle:
    s_waitcnt vmcnt(11)
    s_barrier
    s_add_u32 s56, s60, 384
    s_add_u32 m0, s64, 0
    s_nop 0
    buffer_load_dwordx4 v4, s[16:19], s56 offen lds
    s_add_u32 s56, s56, 262144
    s_add_u32 m0, s64, 4096
    s_nop 0
    buffer_load_dwordx4 v4, s[16:19], s56 offen lds
    s_add_u32 s56, s56, 262144
    s_add_u32 m0, s64, 8192
    s_nop 0
    buffer_load_dwordx4 v4, s[16:19], s56 offen lds
    s_add_u32 s56, s56, 262144
    s_add_u32 m0, s64, 12288
    s_nop 0
    buffer_load_dwordx4 v4, s[16:19], s56 offen lds
    s_add_u32 s56, s56, 262144
    s_add_u32 m0, s64, 16384
    s_nop 0
    buffer_load_dwordx4 v4, s[16:19], s56 offen lds
    s_add_u32 s56, s56, 262144
    s_add_u32 m0, s64, 20480
    s_nop 0
    buffer_load_dwordx4 v4, s[16:19], s56 offen lds
    s_add_u32 s56, s56, 262144
    s_add_u32 m0, s64, 24576
    s_nop 0
    buffer_load_dwordx4 v4, s[16:19], s56 offen lds
    s_mov_b32 s56, s61
    s_add_u32 m0, s64, 28672
    s_nop 0
    buffer_load_dwordx4 v5, s[20:23], s56 offen lds
    s_add_u32 s56, s56, s62
    s_add_u32 m0, s64, 32768
    s_nop 0
    buffer_load_dwordx4 v5, s[20:23], s56 offen lds
    s_add_u32 s56, s56, s68
    s_add_u32 m0, s64, 36864
    s_nop 0
    buffer_load_dwordx4 v5, s[20:23], s56 offen lds
    s_add_u32 s56, s56, s62
    s_add_u32 m0, s64, 40960
    s_nop 0
    buffer_load_dwordx4 v5, s[20:23], s56 offen lds
    s_add_u32 s61, s61, s63
    s_waitcnt vmcnt(11)
    s_barrier
    s_waitcnt vmcnt(0)
    s_barrier
pg_1_done:
    s_mov_b32 s58, 0x3db8aa3b
    s_mov_b32 s59, 0x620000
    s_branch prep_store
prep_gemm_b:
    s_lshl_b32 s56, s3, 2
    s_add_u32 s56, s56, 0
    v_bfe_u32 v12, v1, 1, 1
    v_add_u32 v12, s56, v12
    v_bfe_u32 v13, v1, 2, 2
    v_lshlrev_b32 v13, 1, v13
    v_add_u32 v13, 0, v13
    v_xor_b32 v12, v12, v13
    v_lshlrev_b32 v12, 4, v12
    v_bfe_u32 v8, v1, 4, 2
    v_lshlrev_b32 v8, 11, v8
    v_bfe_u32 v13, v1, 2, 2
    v_lshlrev_b32 v13, 8, v13
    v_add_u32 v8, v8, v13
    v_bfe_u32 v13, v1, 0, 1
    v_lshlrev_b32 v13, 3, v13
    v_add_u32 v8, v8, v13
    v_add_u32 v8, 0x7000, v8
    v_add_u32 v8, v8, v12
    s_lshl_b32 s56, s3, 2
    s_add_u32 s56, s56, 0
    v_bfe_u32 v12, v1, 1, 1
    v_add_u32 v12, s56, v12
    v_bfe_u32 v13, v1, 2, 2
    v_lshlrev_b32 v13, 1, v13
    v_add_u32 v13, 8, v13
    v_xor_b32 v12, v12, v13
    v_lshlrev_b32 v12, 4, v12
    v_bfe_u32 v9, v1, 4, 2
    v_lshlrev_b32 v9, 11, v9
    v_bfe_u32 v13, v1, 2, 2
    v_lshlrev_b32 v13, 8, v13
    v_add_u32 v9, v9, v13
    v_bfe_u32 v13, v1, 0, 1
    v_lshlrev_b32 v13, 3, v13
    v_add_u32 v9, v9, v13
    v_add_u32 v9, 0x7400, v9
    v_add_u32 v9, v9, v12
    s_lshl_b32 s56, s3, 2
    s_add_u32 s56, s56, 2
    v_bfe_u32 v12, v1, 1, 1
    v_add_u32 v12, s56, v12
    v_bfe_u32 v13, v1, 2, 2
    v_lshlrev_b32 v13, 1, v13
    v_add_u32 v13, 0, v13
    v_xor_b32 v12, v12, v13
    v_lshlrev_b32 v12, 4, v12
    v_bfe_u32 v10, v1, 4, 2
    v_lshlrev_b32 v10, 11, v10
    v_bfe_u32 v13, v1, 2, 2
    v_lshlrev_b32 v13, 8, v13
    v_add_u32 v10, v10, v13
    v_bfe_u32 v13, v1, 0, 1
    v_lshlrev_b32 v13, 3, v13
    v_add_u32 v10, v10, v13
    v_add_u32 v10, 0x7000, v10
    v_add_u32 v10, v10, v12
    s_lshl_b32 s56, s3, 2
    s_add_u32 s56, s56, 2
    v_bfe_u32 v12, v1, 1, 1
    v_add_u32 v12, s56, v12
    v_bfe_u32 v13, v1, 2, 2
    v_lshlrev_b32 v13, 1, v13
    v_add_u32 v13, 8, v13
    v_xor_b32 v12, v12, v13
    v_lshlrev_b32 v12, 4, v12
    v_bfe_u32 v11, v1, 4, 2
    v_lshlrev_b32 v11, 11, v11
    v_bfe_u32 v13, v1, 2, 2
    v_lshlrev_b32 v13, 8, v13
    v_add_u32 v11, v11, v13
    v_bfe_u32 v13, v1, 0, 1
    v_lshlrev_b32 v13, 3, v13
    v_add_u32 v11, v11, v13
    v_add_u32 v11, 0x7400, v11
    v_add_u32 v11, v11, v12
    s_waitcnt vmcnt(22)
    s_barrier
    s_cmp_lg_u32 s65, 0
    s_cbranch_scc1 pg_2_idle
    ds_read_b64_tr_b16 v[240:241], v8 offset:0
    ds_read_b64_tr_b16 v[242:243], v9 offset:0
    ds_read_b64_tr_b16 v[244:245], v10 offset:0
    ds_read_b64_tr_b16 v[246:247], v11 offset:0
    ds_read_b128 v[16:19], v6 offset:0
    ds_read_b128 v[20:23], v6 offset:2048
    ds_read_b128 v[24:27], v6 offset:4096
    ds_read_b128 v[28:31], v6 offset:6144
    ds_read_b128 v[32:35], v6 offset:8192
    ds_read_b128 v[36:39], v6 offset:10240
    ds_read_b128 v[40:43], v6 offset:12288
    ds_read_b128 v[44:47], v6 offset:14336
    ds_read_b128 v[48:51], v6 offset:16384
    ds_read_b128 v[52:55], v6 offset:18432
    ds_read_b128 v[56:59], v6 offset:20480
    ds_read_b128 v[60:63], v6 offset:22528
    ds_read_b128 v[64:67], v6 offset:24576
    ds_read_b128 v[68:71], v6 offset:26624
    s_waitcnt lgkmcnt(0)
    v_mfma_f32_16x16x32_bf16 v[128:131], v[16:19], v[240:243], 0
    ds_read_b64_tr_b16 v[248:249], v8 offset:8192
    v_mfma_f32_16x16x32_bf16 v[132:135], v[16:19], v[244:247], 0
    ds_read_b64_tr_b16 v[250:251], v9 offset:8192
    v_mfma_f32_16x16x32_bf16 v[136:139], v[20:23], v[240:243], 0
    ds_read_b64_tr_b16 v[252:253], v10 offset:8192
    v_mfma_f32_16x16x32_bf16 v[140:143], v[20:23], v[244:247], 0
    ds_read_b64_tr_b16 v[254:255], v11 offset:8192
    v_mfma_f32_16x16x32_bf16 v[144:147], v[24:27], v[240:243], 0
    ds_read_b128 v[72:75], v7 offset:0
    v_mfma_f32_16x16x32_bf16 v[148:151], v[24:27], v[244:247], 0
    ds_read_b128 v[76:79], v7 offset:2048
    v_mfma_f32_16x16x32_bf16 v[152:155], v[28:31], v[240:243], 0
    ds_read_b128 v[80:83], v7 offset:4096
    v_mfma_f32_16x16x32_bf16 v[156:159], v[28:31], v[244:247], 0
    ds_read_b128 v[84:87], v7 offset:6144
    v_mfma_f32_16x16x32_bf16 v[160:163], v[32:35], v[240:243], 0
    ds_read_b128 v[88:91], v7 offset:8192
    v_mfma_f32_16x16x32_bf16 v[164:167], v[32:35], v[244:247], 0
    ds_read_b128 v[92:95], v7 offset:10240
    v_mfma_f32_16x16x32_bf16 v[168:171], v[36:39], v[240:243], 0
    ds_read_b128 v[96:99], v7 offset:12288
    v_mfma_f32_16x16x32_bf16 v[172:175], v[36:39], v[244:247], 0
    ds_read_b128 v[100:103], v7 offset:14336
    v_mfma_f32_16x16x32_bf16 v[176:179], v[40:43], v[240:243], 0
    ds_read_b128 v[104:107], v7 offset:16384
    v_mfma_f32_16x16x32_bf16 v[180:183], v[40:43], v[244:247], 0
    ds_read_b128 v[108:111], v7 offset:18432
    v_mfma_f32_16x16x32_bf16 v[184:187], v[44:47], v[240:243], 0
    ds_read_b128 v[112:115], v7 offset:20480
    v_mfma_f32_16x16x32_bf16 v[188:191], v[44:47], v[244:247], 0
    ds_read_b128 v[116:119], v7 offset:22528
    v_mfma_f32_16x16x32_bf16 v[192:195], v[48:51], v[240:243], 0
    ds_read_b128 v[120:123], v7 offset:24576
    v_mfma_f32_16x16x32_bf16 v[196:199], v[48:51], v[244:247], 0
    ds_read_b128 v[124:127], v7 offset:26624
    v_mfma_f32_16x16x32_bf16 v[200:203], v[52:55], v[240:243], 0
    v_mfma_f32_16x16x32_bf16 v[204:207], v[52:55], v[244:247], 0
    v_mfma_f32_16x16x32_bf16 v[208:211], v[56:59], v[240:243], 0
    v_mfma_f32_16x16x32_bf16 v[212:215], v[56:59], v[244:247], 0
    v_mfma_f32_16x16x32_bf16 v[216:219], v[60:63], v[240:243], 0
    v_mfma_f32_16x16x32_bf16 v[220:223], v[60:63], v[244:247], 0
    v_mfma_f32_16x16x32_bf16 v[224:227], v[64:67], v[240:243], 0
    v_mfma_f32_16x16x32_bf16 v[228:231], v[64:67], v[244:247], 0
    v_mfma_f32_16x16x32_bf16 v[232:235], v[68:71], v[240:243], 0
    v_mfma_f32_16x16x32_bf16 v[236:239], v[68:71], v[244:247], 0
    s_waitcnt lgkmcnt(0)
    s_waitcnt vmcnt(11)
    s_barrier
    s_add_u32 s56, s60, 384
    s_add_u32 m0, s64, 0
    s_nop 0
    buffer_load_dwordx4 v4, s[16:19], s56 offen lds
    s_add_u32 s56, s56, 262144
    s_add_u32 m0, s64, 4096
    s_nop 0
    buffer_load_dwordx4 v4, s[16:19], s56 offen lds
    s_add_u32 s56, s56, 262144
    s_add_u32 m0, s64, 8192
    s_nop 0
    buffer_load_dwordx4 v4, s[16:19], s56 offen lds
    s_add_u32 s56, s56, 262144
    s_add_u32 m0, s64, 12288
    s_nop 0
    buffer_load_dwordx4 v4, s[16:19], s56 offen lds
    s_add_u32 s56, s56, 262144
    s_add_u32 m0, s64, 16384
    s_nop 0
    buffer_load_dwordx4 v4, s[16:19], s56 offen lds
    s_add_u32 s56, s56, 262144
    s_add_u32 m0, s64, 20480
    s_nop 0
    buffer_load_dwordx4 v4, s[16:19], s56 offen lds
    s_add_u32 s56, s56, 262144
    s_add_u32 m0, s64, 24576
    s_nop 0
    buffer_load_dwordx4 v4, s[16:19], s56 offen lds
    s_mov_b32 s56, s61
    s_add_u32 m0, s64, 28672
    s_nop 0
    buffer_load_dwordx4 v5, s[20:23], s56 offen lds
    s_add_u32 s56, s56, s62
    s_add_u32 m0, s64, 32768
    s_nop 0
    buffer_load_dwordx4 v5, s[20:23], s56 offen lds
    s_add_u32 s56, s56, s68
    s_add_u32 m0, s64, 36864
    s_nop 0
    buffer_load_dwordx4 v5, s[20:23], s56 offen lds
    s_add_u32 s56, s56, s62
    s_add_u32 m0, s64, 40960
    s_nop 0
    buffer_load_dwordx4 v5, s[20:23], s56 offen lds
    s_add_u32 s61, s61, s63
    v_add_u32 v6, 0xb000, v6
    v_add_u32 v7, 0xb000, v7
    v_add_u32 v8, 0xb000, v8
    v_add_u32 v9, 0xb000, v9
    v_add_u32 v10, 0xb000, v10
    v_add_u32 v11, 0xb000, v11
    v_mfma_f32_16x16x32_bf16 v[128:131], v[72:75], v[248:251], v[128:131]
    ds_read_b64_tr_b16 v[240:241], v8 offset:0
    v_mfma_f32_16x16x32_bf16 v[132:135], v[72:75], v[252:255], v[132:135]
    ds_read_b64_tr_b16 v[242:243], v9 offset:0
    v_mfma_f32_16x16x32_bf16 v[136:139], v[76:79], v[248:251], v[136:139]
    ds_read_b64_tr_b16 v[244:245], v10 offset:0
    v_mfma_f32_16x16x32_bf16 v[140:143], v[76:79], v[252:255], v[140:143]
    ds_read_b64_tr_b16 v[246:247], v11 offset:0
    v_mfma_f32_16x16x32_bf16 v[144:147], v[80:83], v[248:251], v[144:147]
    ds_read_b128 v[16:19], v6 offset:0
    v_mfma_f32_16x16x32_bf16 v[148:151], v[80:83], v[252:255], v[148:151]
    ds_read_b128 v[20:23], v6 offset:2048
    v_mfma_f32_16x16x32_bf16 v[152:155], v[84:87], v[248:251], v[152:155]
    ds_read_b128 v[24:27], v6 offset:4096
    v_mfma_f32_16x16x32_bf16 v[156:159], v[84:87], v[252:255], v[156:159]
    ds_read_b128 v[28:31], v6 offset:6144
    v_mfma_f32_16x16x32_bf16 v[160:163], v[88:91], v[248:251], v[160:163]
    ds_read_b128 v[32:35], v6 offset:8192
    v_mfma_f32_16x16x32_bf16 v[164:167], v[88:91], v[252:255], v[164:167]
    ds_read_b128 v[36:39], v6 offset:10240
    v_mfma_f32_16x16x32_bf16 v[168:171], v[92:95], v[248:251], v[168:171]
    ds_read_b128 v[40:43], v6 offset:12288
    v_mfma_f32_16x16x32_bf16 v[172:175], v[92:95], v[252:255], v[172:175]
    ds_read_b128 v[44:47], v6 offset:14336
    v_mfma_f32_16x16x32_bf16 v[176:179], v[96:99], v[248:251], v[176:179]
    ds_read_b128 v[48:51], v6 offset:16384
    v_mfma_f32_16x16x32_bf16 v[180:183], v[96:99], v[252:255], v[180:183]
    ds_read_b128 v[52:55], v6 offset:18432
    v_mfma_f32_16x16x32_bf16 v[184:187], v[100:103], v[248:251], v[184:187]
    ds_read_b128 v[56:59], v6 offset:20480
    v_mfma_f32_16x16x32_bf16 v[188:191], v[100:103], v[252:255], v[188:191]
    ds_read_b128 v[60:63], v6 offset:22528
    v_mfma_f32_16x16x32_bf16 v[192:195], v[104:107], v[248:251], v[192:195]
    ds_read_b128 v[64:67], v6 offset:24576
    v_mfma_f32_16x16x32_bf16 v[196:199], v[104:107], v[252:255], v[196:199]
    ds_read_b128 v[68:71], v6 offset:26624
    v_mfma_f32_16x16x32_bf16 v[200:203], v[108:111], v[248:251], v[200:203]
    v_mfma_f32_16x16x32_bf16 v[204:207], v[108:111], v[252:255], v[204:207]
    v_mfma_f32_16x16x32_bf16 v[208:211], v[112:115], v[248:251], v[208:211]
    v_mfma_f32_16x16x32_bf16 v[212:215], v[112:115], v[252:255], v[212:215]
    v_mfma_f32_16x16x32_bf16 v[216:219], v[116:119], v[248:251], v[216:219]
    v_mfma_f32_16x16x32_bf16 v[220:223], v[116:119], v[252:255], v[220:223]
    v_mfma_f32_16x16x32_bf16 v[224:227], v[120:123], v[248:251], v[224:227]
    v_mfma_f32_16x16x32_bf16 v[228:231], v[120:123], v[252:255], v[228:231]
    v_mfma_f32_16x16x32_bf16 v[232:235], v[124:127], v[248:251], v[232:235]
    v_mfma_f32_16x16x32_bf16 v[236:239], v[124:127], v[252:255], v[236:239]
    s_waitcnt lgkmcnt(0)
    v_mfma_f32_16x16x32_bf16 v[128:131], v[16:19], v[240:243], v[128:131]
    ds_read_b64_tr_b16 v[248:249], v8 offset:8192
    v_mfma_f32_16x16x32_bf16 v[132:135], v[16:19], v[244:247], v[132:135]
    ds_read_b64_tr_b16 v[250:251], v9 offset:8192
    v_mfma_f32_16x16x32_bf16 v[136:139], v[20:23], v[240:243], v[136:139]
    ds_read_b64_tr_b16 v[252:253], v10 offset:8192
    v_mfma_f32_16x16x32_bf16 v[140:143], v[20:23], v[244:247], v[140:143]
    ds_read_b64_tr_b16 v[254:255], v11 offset:8192
    v_mfma_f32_16x16x32_bf16 v[144:147], v[24:27], v[240:243], v[144:147]
    ds_read_b128 v[72:75], v7 offset:0
    v_mfma_f32_16x16x32_bf16 v[148:151], v[24:27], v[244:247], v[148:151]
    ds_read_b128 v[76:79], v7 offset:2048
    v_mfma_f32_16x16x32_bf16 v[152:155], v[28:31], v[240:243], v[152:155]
    ds_read_b128 v[80:83], v7 offset:4096
    v_mfma_f32_16x16x32_bf16 v[156:159], v[28:31], v[244:247], v[156:159]
    ds_read_b128 v[84:87], v7 offset:6144
    v_mfma_f32_16x16x32_bf16 v[160:163], v[32:35], v[240:243], v[160:163]
    ds_read_b128 v[88:91], v7 offset:8192
    v_mfma_f32_16x16x32_bf16 v[164:167], v[32:35], v[244:247], v[164:167]
    ds_read_b128 v[92:95], v7 offset:10240
    v_mfma_f32_16x16x32_bf16 v[168:171], v[36:39], v[240:243], v[168:171]
    ds_read_b128 v[96:99], v7 offset:12288
    v_mfma_f32_16x16x32_bf16 v[172:175], v[36:39], v[244:247], v[172:175]
    ds_read_b128 v[100:103], v7 offset:14336
    v_mfma_f32_16x16x32_bf16 v[176:179], v[40:43], v[240:243], v[176:179]
    ds_read_b128 v[104:107], v7 offset:16384
    v_mfma_f32_16x16x32_bf16 v[180:183], v[40:43], v[244:247], v[180:183]
    ds_read_b128 v[108:111], v7 offset:18432
    v_mfma_f32_16x16x32_bf16 v[184:187], v[44:47], v[240:243], v[184:187]
    ds_read_b128 v[112:115], v7 offset:20480
    v_mfma_f32_16x16x32_bf16 v[188:191], v[44:47], v[244:247], v[188:191]
    ds_read_b128 v[116:119], v7 offset:22528
    v_mfma_f32_16x16x32_bf16 v[192:195], v[48:51], v[240:243], v[192:195]
    ds_read_b128 v[120:123], v7 offset:24576
    v_mfma_f32_16x16x32_bf16 v[196:199], v[48:51], v[244:247], v[196:199]
    ds_read_b128 v[124:127], v7 offset:26624
    v_mfma_f32_16x16x32_bf16 v[200:203], v[52:55], v[240:243], v[200:203]
    v_mfma_f32_16x16x32_bf16 v[204:207], v[52:55], v[244:247], v[204:207]
    v_mfma_f32_16x16x32_bf16 v[208:211], v[56:59], v[240:243], v[208:211]
    v_mfma_f32_16x16x32_bf16 v[212:215], v[56:59], v[244:247], v[212:215]
    v_mfma_f32_16x16x32_bf16 v[216:219], v[60:63], v[240:243], v[216:219]
    v_mfma_f32_16x16x32_bf16 v[220:223], v[60:63], v[244:247], v[220:223]
    v_mfma_f32_16x16x32_bf16 v[224:227], v[64:67], v[240:243], v[224:227]
    v_mfma_f32_16x16x32_bf16 v[228:231], v[64:67], v[244:247], v[228:231]
    v_mfma_f32_16x16x32_bf16 v[232:235], v[68:71], v[240:243], v[232:235]
    v_mfma_f32_16x16x32_bf16 v[236:239], v[68:71], v[244:247], v[236:239]
    s_waitcnt lgkmcnt(0)
    s_waitcnt vmcnt(11)
    s_barrier
    v_add_u32 v6, 0xb000, v6
    v_add_u32 v7, 0xb000, v7
    v_add_u32 v8, 0xb000, v8
    v_add_u32 v9, 0xb000, v9
    v_add_u32 v10, 0xb000, v10
    v_add_u32 v11, 0xb000, v11
    v_mfma_f32_16x16x32_bf16 v[128:131], v[72:75], v[248:251], v[128:131]
    ds_read_b64_tr_b16 v[240:241], v8 offset:0
    v_mfma_f32_16x16x32_bf16 v[132:135], v[72:75], v[252:255], v[132:135]
    ds_read_b64_tr_b16 v[242:243], v9 offset:0
    v_mfma_f32_16x16x32_bf16 v[136:139], v[76:79], v[248:251], v[136:139]
    ds_read_b64_tr_b16 v[244:245], v10 offset:0
    v_mfma_f32_16x16x32_bf16 v[140:143], v[76:79], v[252:255], v[140:143]
    ds_read_b64_tr_b16 v[246:247], v11 offset:0
    v_mfma_f32_16x16x32_bf16 v[144:147], v[80:83], v[248:251], v[144:147]
    ds_read_b128 v[16:19], v6 offset:0
    v_mfma_f32_16x16x32_bf16 v[148:151], v[80:83], v[252:255], v[148:151]
    ds_read_b128 v[20:23], v6 offset:2048
    v_mfma_f32_16x16x32_bf16 v[152:155], v[84:87], v[248:251], v[152:155]
    ds_read_b128 v[24:27], v6 offset:4096
    v_mfma_f32_16x16x32_bf16 v[156:159], v[84:87], v[252:255], v[156:159]
    ds_read_b128 v[28:31], v6 offset:6144
    v_mfma_f32_16x16x32_bf16 v[160:163], v[88:91], v[248:251], v[160:163]
    ds_read_b128 v[32:35], v6 offset:8192
    v_mfma_f32_16x16x32_bf16 v[164:167], v[88:91], v[252:255], v[164:167]
    ds_read_b128 v[36:39], v6 offset:10240
    v_mfma_f32_16x16x32_bf16 v[168:171], v[92:95], v[248:251], v[168:171]
    ds_read_b128 v[40:43], v6 offset:12288
    v_mfma_f32_16x16x32_bf16 v[172:175], v[92:95], v[252:255], v[172:175]
    ds_read_b128 v[44:47], v6 offset:14336
    v_mfma_f32_16x16x32_bf16 v[176:179], v[96:99], v[248:251], v[176:179]
    ds_read_b128 v[48:51], v6 offset:16384
    v_mfma_f32_16x16x32_bf16 v[180:183], v[96:99], v[252:255], v[180:183]
    ds_read_b128 v[52:55], v6 offset:18432
    v_mfma_f32_16x16x32_bf16 v[184:187], v[100:103], v[248:251], v[184:187]
    ds_read_b128 v[56:59], v6 offset:20480
    v_mfma_f32_16x16x32_bf16 v[188:191], v[100:103], v[252:255], v[188:191]
    ds_read_b128 v[60:63], v6 offset:22528
    v_mfma_f32_16x16x32_bf16 v[192:195], v[104:107], v[248:251], v[192:195]
    ds_read_b128 v[64:67], v6 offset:24576
    v_mfma_f32_16x16x32_bf16 v[196:199], v[104:107], v[252:255], v[196:199]
    ds_read_b128 v[68:71], v6 offset:26624
    v_mfma_f32_16x16x32_bf16 v[200:203], v[108:111], v[248:251], v[200:203]
    v_mfma_f32_16x16x32_bf16 v[204:207], v[108:111], v[252:255], v[204:207]
    v_mfma_f32_16x16x32_bf16 v[208:211], v[112:115], v[248:251], v[208:211]
    v_mfma_f32_16x16x32_bf16 v[212:215], v[112:115], v[252:255], v[212:215]
    v_mfma_f32_16x16x32_bf16 v[216:219], v[116:119], v[248:251], v[216:219]
    v_mfma_f32_16x16x32_bf16 v[220:223], v[116:119], v[252:255], v[220:223]
    v_mfma_f32_16x16x32_bf16 v[224:227], v[120:123], v[248:251], v[224:227]
    v_mfma_f32_16x16x32_bf16 v[228:231], v[120:123], v[252:255], v[228:231]
    v_mfma_f32_16x16x32_bf16 v[232:235], v[124:127], v[248:251], v[232:235]
    v_mfma_f32_16x16x32_bf16 v[236:239], v[124:127], v[252:255], v[236:239]
    s_waitcnt lgkmcnt(0)
    v_mfma_f32_16x16x32_bf16 v[128:131], v[16:19], v[240:243], v[128:131]
    ds_read_b64_tr_b16 v[248:249], v8 offset:8192
    v_mfma_f32_16x16x32_bf16 v[132:135], v[16:19], v[244:247], v[132:135]
    ds_read_b64_tr_b16 v[250:251], v9 offset:8192
    v_mfma_f32_16x16x32_bf16 v[136:139], v[20:23], v[240:243], v[136:139]
    ds_read_b64_tr_b16 v[252:253], v10 offset:8192
    v_mfma_f32_16x16x32_bf16 v[140:143], v[20:23], v[244:247], v[140:143]
    ds_read_b64_tr_b16 v[254:255], v11 offset:8192
    v_mfma_f32_16x16x32_bf16 v[144:147], v[24:27], v[240:243], v[144:147]
    ds_read_b128 v[72:75], v7 offset:0
    v_mfma_f32_16x16x32_bf16 v[148:151], v[24:27], v[244:247], v[148:151]
    ds_read_b128 v[76:79], v7 offset:2048
    v_mfma_f32_16x16x32_bf16 v[152:155], v[28:31], v[240:243], v[152:155]
    ds_read_b128 v[80:83], v7 offset:4096
    v_mfma_f32_16x16x32_bf16 v[156:159], v[28:31], v[244:247], v[156:159]
    ds_read_b128 v[84:87], v7 offset:6144
    v_mfma_f32_16x16x32_bf16 v[160:163], v[32:35], v[240:243], v[160:163]
    ds_read_b128 v[88:91], v7 offset:8192
    v_mfma_f32_16x16x32_bf16 v[164:167], v[32:35], v[244:247], v[164:167]
    ds_read_b128 v[92:95], v7 offset:10240
    v_mfma_f32_16x16x32_bf16 v[168:171], v[36:39], v[240:243], v[168:171]
    ds_read_b128 v[96:99], v7 offset:12288
    v_mfma_f32_16x16x32_bf16 v[172:175], v[36:39], v[244:247], v[172:175]
    ds_read_b128 v[100:103], v7 offset:14336
    v_mfma_f32_16x16x32_bf16 v[176:179], v[40:43], v[240:243], v[176:179]
    ds_read_b128 v[104:107], v7 offset:16384
    v_mfma_f32_16x16x32_bf16 v[180:183], v[40:43], v[244:247], v[180:183]
    ds_read_b128 v[108:111], v7 offset:18432
    v_mfma_f32_16x16x32_bf16 v[184:187], v[44:47], v[240:243], v[184:187]
    ds_read_b128 v[112:115], v7 offset:20480
    v_mfma_f32_16x16x32_bf16 v[188:191], v[44:47], v[244:247], v[188:191]
    ds_read_b128 v[116:119], v7 offset:22528
    v_mfma_f32_16x16x32_bf16 v[192:195], v[48:51], v[240:243], v[192:195]
    ds_read_b128 v[120:123], v7 offset:24576
    v_mfma_f32_16x16x32_bf16 v[196:199], v[48:51], v[244:247], v[196:199]
    ds_read_b128 v[124:127], v7 offset:26624
    v_mfma_f32_16x16x32_bf16 v[200:203], v[52:55], v[240:243], v[200:203]
    v_mfma_f32_16x16x32_bf16 v[204:207], v[52:55], v[244:247], v[204:207]
    v_mfma_f32_16x16x32_bf16 v[208:211], v[56:59], v[240:243], v[208:211]
    v_mfma_f32_16x16x32_bf16 v[212:215], v[56:59], v[244:247], v[212:215]
    v_mfma_f32_16x16x32_bf16 v[216:219], v[60:63], v[240:243], v[216:219]
    v_mfma_f32_16x16x32_bf16 v[220:223], v[60:63], v[244:247], v[220:223]
    v_mfma_f32_16x16x32_bf16 v[224:227], v[64:67], v[240:243], v[224:227]
    v_mfma_f32_16x16x32_bf16 v[228:231], v[64:67], v[244:247], v[228:231]
    v_mfma_f32_16x16x32_bf16 v[232:235], v[68:71], v[240:243], v[232:235]
    v_mfma_f32_16x16x32_bf16 v[236:239], v[68:71], v[244:247], v[236:239]
    s_waitcnt lgkmcnt(0)
    s_waitcnt vmcnt(0)
    s_barrier
    v_add_u32 v6, 0xfffea000, v6
    v_add_u32 v7, 0xfffea000, v7
    v_add_u32 v8, 0xfffea000, v8
    v_add_u32 v9, 0xfffea000, v9
    v_add_u32 v10, 0xfffea000, v10
    v_add_u32 v11, 0xfffea000, v11
    v_mfma_f32_16x16x32_bf16 v[128:131], v[72:75], v[248:251], v[128:131]
    ds_read_b64_tr_b16 v[240:241], v8 offset:0
    v_mfma_f32_16x16x32_bf16 v[132:135], v[72:75], v[252:255], v[132:135]
    ds_read_b64_tr_b16 v[242:243], v9 offset:0
    v_mfma_f32_16x16x32_bf16 v[136:139], v[76:79], v[248:251], v[136:139]
    ds_read_b64_tr_b16 v[244:245], v10 offset:0
    v_mfma_f32_16x16x32_bf16 v[140:143], v[76:79], v[252:255], v[140:143]
    ds_read_b64_tr_b16 v[246:247], v11 offset:0
    v_mfma_f32_16x16x32_bf16 v[144:147], v[80:83], v[248:251], v[144:147]
    ds_read_b128 v[16:19], v6 offset:0
    v_mfma_f32_16x16x32_bf16 v[148:151], v[80:83], v[252:255], v[148:151]
    ds_read_b128 v[20:23], v6 offset:2048
    v_mfma_f32_16x16x32_bf16 v[152:155], v[84:87], v[248:251], v[152:155]
    ds_read_b128 v[24:27], v6 offset:4096
    v_mfma_f32_16x16x32_bf16 v[156:159], v[84:87], v[252:255], v[156:159]
    ds_read_b128 v[28:31], v6 offset:6144
    v_mfma_f32_16x16x32_bf16 v[160:163], v[88:91], v[248:251], v[160:163]
    ds_read_b128 v[32:35], v6 offset:8192
    v_mfma_f32_16x16x32_bf16 v[164:167], v[88:91], v[252:255], v[164:167]
    ds_read_b128 v[36:39], v6 offset:10240
    v_mfma_f32_16x16x32_bf16 v[168:171], v[92:95], v[248:251], v[168:171]
    ds_read_b128 v[40:43], v6 offset:12288
    v_mfma_f32_16x16x32_bf16 v[172:175], v[92:95], v[252:255], v[172:175]
    ds_read_b128 v[44:47], v6 offset:14336
    v_mfma_f32_16x16x32_bf16 v[176:179], v[96:99], v[248:251], v[176:179]
    ds_read_b128 v[48:51], v6 offset:16384
    v_mfma_f32_16x16x32_bf16 v[180:183], v[96:99], v[252:255], v[180:183]
    ds_read_b128 v[52:55], v6 offset:18432
    v_mfma_f32_16x16x32_bf16 v[184:187], v[100:103], v[248:251], v[184:187]
    ds_read_b128 v[56:59], v6 offset:20480
    v_mfma_f32_16x16x32_bf16 v[188:191], v[100:103], v[252:255], v[188:191]
    ds_read_b128 v[60:63], v6 offset:22528
    v_mfma_f32_16x16x32_bf16 v[192:195], v[104:107], v[248:251], v[192:195]
    ds_read_b128 v[64:67], v6 offset:24576
    v_mfma_f32_16x16x32_bf16 v[196:199], v[104:107], v[252:255], v[196:199]
    ds_read_b128 v[68:71], v6 offset:26624
    v_mfma_f32_16x16x32_bf16 v[200:203], v[108:111], v[248:251], v[200:203]
    v_mfma_f32_16x16x32_bf16 v[204:207], v[108:111], v[252:255], v[204:207]
    v_mfma_f32_16x16x32_bf16 v[208:211], v[112:115], v[248:251], v[208:211]
    v_mfma_f32_16x16x32_bf16 v[212:215], v[112:115], v[252:255], v[212:215]
    v_mfma_f32_16x16x32_bf16 v[216:219], v[116:119], v[248:251], v[216:219]
    v_mfma_f32_16x16x32_bf16 v[220:223], v[116:119], v[252:255], v[220:223]
    v_mfma_f32_16x16x32_bf16 v[224:227], v[120:123], v[248:251], v[224:227]
    v_mfma_f32_16x16x32_bf16 v[228:231], v[120:123], v[252:255], v[228:231]
    v_mfma_f32_16x16x32_bf16 v[232:235], v[124:127], v[248:251], v[232:235]
    v_mfma_f32_16x16x32_bf16 v[236:239], v[124:127], v[252:255], v[236:239]
    s_waitcnt lgkmcnt(0)
    v_mfma_f32_16x16x32_bf16 v[128:131], v[16:19], v[240:243], v[128:131]
    ds_read_b64_tr_b16 v[248:249], v8 offset:8192
    v_mfma_f32_16x16x32_bf16 v[132:135], v[16:19], v[244:247], v[132:135]
    ds_read_b64_tr_b16 v[250:251], v9 offset:8192
    v_mfma_f32_16x16x32_bf16 v[136:139], v[20:23], v[240:243], v[136:139]
    ds_read_b64_tr_b16 v[252:253], v10 offset:8192
    v_mfma_f32_16x16x32_bf16 v[140:143], v[20:23], v[244:247], v[140:143]
    ds_read_b64_tr_b16 v[254:255], v11 offset:8192
    v_mfma_f32_16x16x32_bf16 v[144:147], v[24:27], v[240:243], v[144:147]
    ds_read_b128 v[72:75], v7 offset:0
    v_mfma_f32_16x16x32_bf16 v[148:151], v[24:27], v[244:247], v[148:151]
    ds_read_b128 v[76:79], v7 offset:2048
    v_mfma_f32_16x16x32_bf16 v[152:155], v[28:31], v[240:243], v[152:155]
    ds_read_b128 v[80:83], v7 offset:4096
    v_mfma_f32_16x16x32_bf16 v[156:159], v[28:31], v[244:247], v[156:159]
    ds_read_b128 v[84:87], v7 offset:6144
    v_mfma_f32_16x16x32_bf16 v[160:163], v[32:35], v[240:243], v[160:163]
    ds_read_b128 v[88:91], v7 offset:8192
    v_mfma_f32_16x16x32_bf16 v[164:167], v[32:35], v[244:247], v[164:167]
    ds_read_b128 v[92:95], v7 offset:10240
    v_mfma_f32_16x16x32_bf16 v[168:171], v[36:39], v[240:243], v[168:171]
    ds_read_b128 v[96:99], v7 offset:12288
    v_mfma_f32_16x16x32_bf16 v[172:175], v[36:39], v[244:247], v[172:175]
    ds_read_b128 v[100:103], v7 offset:14336
    v_mfma_f32_16x16x32_bf16 v[176:179], v[40:43], v[240:243], v[176:179]
    ds_read_b128 v[104:107], v7 offset:16384
    v_mfma_f32_16x16x32_bf16 v[180:183], v[40:43], v[244:247], v[180:183]
    ds_read_b128 v[108:111], v7 offset:18432
    v_mfma_f32_16x16x32_bf16 v[184:187], v[44:47], v[240:243], v[184:187]
    ds_read_b128 v[112:115], v7 offset:20480
    v_mfma_f32_16x16x32_bf16 v[188:191], v[44:47], v[244:247], v[188:191]
    ds_read_b128 v[116:119], v7 offset:22528
    v_mfma_f32_16x16x32_bf16 v[192:195], v[48:51], v[240:243], v[192:195]
    ds_read_b128 v[120:123], v7 offset:24576
    v_mfma_f32_16x16x32_bf16 v[196:199], v[48:51], v[244:247], v[196:199]
    ds_read_b128 v[124:127], v7 offset:26624
    v_mfma_f32_16x16x32_bf16 v[200:203], v[52:55], v[240:243], v[200:203]
    v_mfma_f32_16x16x32_bf16 v[204:207], v[52:55], v[244:247], v[204:207]
    v_mfma_f32_16x16x32_bf16 v[208:211], v[56:59], v[240:243], v[208:211]
    v_mfma_f32_16x16x32_bf16 v[212:215], v[56:59], v[244:247], v[212:215]
    v_mfma_f32_16x16x32_bf16 v[216:219], v[60:63], v[240:243], v[216:219]
    v_mfma_f32_16x16x32_bf16 v[220:223], v[60:63], v[244:247], v[220:223]
    v_mfma_f32_16x16x32_bf16 v[224:227], v[64:67], v[240:243], v[224:227]
    v_mfma_f32_16x16x32_bf16 v[228:231], v[64:67], v[244:247], v[228:231]
    v_mfma_f32_16x16x32_bf16 v[232:235], v[68:71], v[240:243], v[232:235]
    v_mfma_f32_16x16x32_bf16 v[236:239], v[68:71], v[244:247], v[236:239]
    s_waitcnt lgkmcnt(0)
    v_mfma_f32_16x16x32_bf16 v[128:131], v[72:75], v[248:251], v[128:131]
    v_mfma_f32_16x16x32_bf16 v[132:135], v[72:75], v[252:255], v[132:135]
    v_mfma_f32_16x16x32_bf16 v[136:139], v[76:79], v[248:251], v[136:139]
    v_mfma_f32_16x16x32_bf16 v[140:143], v[76:79], v[252:255], v[140:143]
    v_mfma_f32_16x16x32_bf16 v[144:147], v[80:83], v[248:251], v[144:147]
    v_mfma_f32_16x16x32_bf16 v[148:151], v[80:83], v[252:255], v[148:151]
    v_mfma_f32_16x16x32_bf16 v[152:155], v[84:87], v[248:251], v[152:155]
    v_mfma_f32_16x16x32_bf16 v[156:159], v[84:87], v[252:255], v[156:159]
    v_mfma_f32_16x16x32_bf16 v[160:163], v[88:91], v[248:251], v[160:163]
    v_mfma_f32_16x16x32_bf16 v[164:167], v[88:91], v[252:255], v[164:167]
    v_mfma_f32_16x16x32_bf16 v[168:171], v[92:95], v[248:251], v[168:171]
    v_mfma_f32_16x16x32_bf16 v[172:175], v[92:95], v[252:255], v[172:175]
    v_mfma_f32_16x16x32_bf16 v[176:179], v[96:99], v[248:251], v[176:179]
    v_mfma_f32_16x16x32_bf16 v[180:183], v[96:99], v[252:255], v[180:183]
    v_mfma_f32_16x16x32_bf16 v[184:187], v[100:103], v[248:251], v[184:187]
    v_mfma_f32_16x16x32_bf16 v[188:191], v[100:103], v[252:255], v[188:191]
    v_mfma_f32_16x16x32_bf16 v[192:195], v[104:107], v[248:251], v[192:195]
    v_mfma_f32_16x16x32_bf16 v[196:199], v[104:107], v[252:255], v[196:199]
    v_mfma_f32_16x16x32_bf16 v[200:203], v[108:111], v[248:251], v[200:203]
    v_mfma_f32_16x16x32_bf16 v[204:207], v[108:111], v[252:255], v[204:207]
    v_mfma_f32_16x16x32_bf16 v[208:211], v[112:115], v[248:251], v[208:211]
    v_mfma_f32_16x16x32_bf16 v[212:215], v[112:115], v[252:255], v[212:215]
    v_mfma_f32_16x16x32_bf16 v[216:219], v[116:119], v[248:251], v[216:219]
    v_mfma_f32_16x16x32_bf16 v[220:223], v[116:119], v[252:255], v[220:223]
    v_mfma_f32_16x16x32_bf16 v[224:227], v[120:123], v[248:251], v[224:227]
    v_mfma_f32_16x16x32_bf16 v[228:231], v[120:123], v[252:255], v[228:231]
    v_mfma_f32_16x16x32_bf16 v[232:235], v[124:127], v[248:251], v[232:235]
    v_mfma_f32_16x16x32_bf16 v[236:239], v[124:127], v[252:255], v[236:239]
    s_branch pg_2_done
pg_2_idle:
    s_waitcnt vmcnt(11)
    s_barrier
    s_add_u32 s56, s60, 384
    s_add_u32 m0, s64, 0
    s_nop 0
    buffer_load_dwordx4 v4, s[16:19], s56 offen lds
    s_add_u32 s56, s56, 262144
    s_add_u32 m0, s64, 4096
    s_nop 0
    buffer_load_dwordx4 v4, s[16:19], s56 offen lds
    s_add_u32 s56, s56, 262144
    s_add_u32 m0, s64, 8192
    s_nop 0
    buffer_load_dwordx4 v4, s[16:19], s56 offen lds
    s_add_u32 s56, s56, 262144
    s_add_u32 m0, s64, 12288
    s_nop 0
    buffer_load_dwordx4 v4, s[16:19], s56 offen lds
    s_add_u32 s56, s56, 262144
    s_add_u32 m0, s64, 16384
    s_nop 0
    buffer_load_dwordx4 v4, s[16:19], s56 offen lds
    s_add_u32 s56, s56, 262144
    s_add_u32 m0, s64, 20480
    s_nop 0
    buffer_load_dwordx4 v4, s[16:19], s56 offen lds
    s_add_u32 s56, s56, 262144
    s_add_u32 m0, s64, 24576
    s_nop 0
    buffer_load_dwordx4 v4, s[16:19], s56 offen lds
    s_mov_b32 s56, s61
    s_add_u32 m0, s64, 28672
    s_nop 0
    buffer_load_dwordx4 v5, s[20:23], s56 offen lds
    s_add_u32 s56, s56, s62
    s_add_u32 m0, s64, 32768
    s_nop 0
    buffer_load_dwordx4 v5, s[20:23], s56 offen lds
    s_add_u32 s56, s56, s68
    s_add_u32 m0, s64, 36864
    s_nop 0
    buffer_load_dwordx4 v5, s[20:23], s56 offen lds
    s_add_u32 s56, s56, s62
    s_add_u32 m0, s64, 40960
    s_nop 0
    buffer_load_dwordx4 v5, s[20:23], s56 offen lds
    s_add_u32 s61, s61, s63
    s_waitcnt vmcnt(11)
    s_barrier
    s_waitcnt vmcnt(0)
    s_barrier
pg_2_done:
    s_mov_b32 s58, 1.0
    s_mov_b32 s59, 0x0
prep_store:
    s_cmp_lg_u32 s65, 0
    s_cbranch_scc1 prep_ln
    s_mul_i32 s44, s49, 28
    s_lshl_b32 s45, s50, 3
    s_add_u32 s44, s44, s45
    s_lshl_b32 s45, s3, 1
    s_add_u32 s44, s44, s45
    s_mul_i32 s44, s44, 14
    s_mul_i32 s45, s47, 7
    s_add_u32 s44, s44, s45
    s_lshl_b32 s44, s44, 10
    s_add_u32 s59, s59, s44
    v_lshlrev_b32 v5, 4, v1
    s_add_u32 s57, s59, 4096
    v_pk_mul_f32 v[128:129], v[128:129], s[58:59] op_sel_hi:[1,0]
    v_pk_mul_f32 v[130:131], v[130:131], s[58:59] op_sel_hi:[1,0]
    v_cvt_pk_bf16_f32 v64, v128, v129
    v_cvt_pk_bf16_f32 v65, v130, v131
    v_pk_mul_f32 v[136:137], v[136:137], s[58:59] op_sel_hi:[1,0]
    v_pk_mul_f32 v[138:139], v[138:139], s[58:59] op_sel_hi:[1,0]
    v_cvt_pk_bf16_f32 v66, v136, v137
    v_cvt_pk_bf16_f32 v67, v138, v139
    buffer_store_dwordx4 v[64:67], v5, s[8:11], s59 offen offset:0 sc1
    v_pk_mul_f32 v[144:145], v[144:145], s[58:59] op_sel_hi:[1,0]
    v_pk_mul_f32 v[146:147], v[146:147], s[58:59] op_sel_hi:[1,0]
    v_cvt_pk_bf16_f32 v68, v144, v145
    v_cvt_pk_bf16_f32 v69, v146, v147
    v_pk_mul_f32 v[152:153], v[152:153], s[58:59] op_sel_hi:[1,0]
    v_pk_mul_f32 v[154:155], v[154:155], s[58:59] op_sel_hi:[1,0]
    v_cvt_pk_bf16_f32 v70, v152, v153
    v_cvt_pk_bf16_f32 v71, v154, v155
    buffer_store_dwordx4 v[68:71], v5, s[8:11], s59 offen offset:1024 sc1
    v_pk_mul_f32 v[160:161], v[160:161], s[58:59] op_sel_hi:[1,0]
    v_pk_mul_f32 v[162:163], v[162:163], s[58:59] op_sel_hi:[1,0]
    v_cvt_pk_bf16_f32 v72, v160, v161
    v_cvt_pk_bf16_f32 v73, v162, v163
    v_pk_mul_f32 v[168:169], v[168:169], s[58:59] op_sel_hi:[1,0]
    v_pk_mul_f32 v[170:171], v[170:171], s[58:59] op_sel_hi:[1,0]
    v_cvt_pk_bf16_f32 v74, v168, v169
    v_cvt_pk_bf16_f32 v75, v170, v171
    buffer_store_dwordx4 v[72:75], v5, s[8:11], s59 offen offset:2048 sc1
    v_pk_mul_f32 v[176:177], v[176:177], s[58:59] op_sel_hi:[1,0]
    v_pk_mul_f32 v[178:179], v[178:179], s[58:59] op_sel_hi:[1,0]
    v_cvt_pk_bf16_f32 v76, v176, v177
    v_cvt_pk_bf16_f32 v77, v178, v179
    v_pk_mul_f32 v[184:185], v[184:185], s[58:59] op_sel_hi:[1,0]
    v_pk_mul_f32 v[186:187], v[186:187], s[58:59] op_sel_hi:[1,0]
    v_cvt_pk_bf16_f32 v78, v184, v185
    v_cvt_pk_bf16_f32 v79, v186, v187
    buffer_store_dwordx4 v[76:79], v5, s[8:11], s59 offen offset:3072 sc1
    v_pk_mul_f32 v[192:193], v[192:193], s[58:59] op_sel_hi:[1,0]
    v_pk_mul_f32 v[194:195], v[194:195], s[58:59] op_sel_hi:[1,0]
    v_cvt_pk_bf16_f32 v80, v192, v193
    v_cvt_pk_bf16_f32 v81, v194, v195
    v_pk_mul_f32 v[200:201], v[200:201], s[58:59] op_sel_hi:[1,0]
    v_pk_mul_f32 v[202:203], v[202:203], s[58:59] op_sel_hi:[1,0]
    v_cvt_pk_bf16_f32 v82, v200, v201
    v_cvt_pk_bf16_f32 v83, v202, v203
    buffer_store_dwordx4 v[80:83], v5, s[8:11], s57 offen offset:0 sc1
    v_pk_mul_f32 v[208:209], v[208:209], s[58:59] op_sel_hi:[1,0]
    v_pk_mul_f32 v[210:211], v[210:211], s[58:59] op_sel_hi:[1,0]
    v_cvt_pk_bf16_f32 v84, v208, v209
    v_cvt_pk_bf16_f32 v85, v210, v211
    v_pk_mul_f32 v[216:217], v[216:217], s[58:59] op_sel_hi:[1,0]
    v_pk_mul_f32 v[218:219], v[218:219], s[58:59] op_sel_hi:[1,0]
    v_cvt_pk_bf16_f32 v86, v216, v217
    v_cvt_pk_bf16_f32 v87, v218, v219
    buffer_store_dwordx4 v[84:87], v5, s[8:11], s57 offen offset:1024 sc1
    v_pk_mul_f32 v[224:225], v[224:225], s[58:59] op_sel_hi:[1,0]
    v_pk_mul_f32 v[226:227], v[226:227], s[58:59] op_sel_hi:[1,0]
    v_cvt_pk_bf16_f32 v88, v224, v225
    v_cvt_pk_bf16_f32 v89, v226, v227
    v_pk_mul_f32 v[232:233], v[232:233], s[58:59] op_sel_hi:[1,0]
    v_pk_mul_f32 v[234:235], v[234:235], s[58:59] op_sel_hi:[1,0]
    v_cvt_pk_bf16_f32 v90, v232, v233
    v_cvt_pk_bf16_f32 v91, v234, v235
    buffer_store_dwordx4 v[88:91], v5, s[8:11], s57 offen offset:2048 sc1
    s_add_u32 s59, s59, 14336
    s_add_u32 s57, s59, 4096
    v_pk_mul_f32 v[132:133], v[132:133], s[58:59] op_sel_hi:[1,0]
    v_pk_mul_f32 v[134:135], v[134:135], s[58:59] op_sel_hi:[1,0]
    v_cvt_pk_bf16_f32 v92, v132, v133
    v_cvt_pk_bf16_f32 v93, v134, v135
    v_pk_mul_f32 v[140:141], v[140:141], s[58:59] op_sel_hi:[1,0]
    v_pk_mul_f32 v[142:143], v[142:143], s[58:59] op_sel_hi:[1,0]
    v_cvt_pk_bf16_f32 v94, v140, v141
    v_cvt_pk_bf16_f32 v95, v142, v143
    buffer_store_dwordx4 v[92:95], v5, s[8:11], s59 offen offset:0 sc1
    v_pk_mul_f32 v[148:149], v[148:149], s[58:59] op_sel_hi:[1,0]
    v_pk_mul_f32 v[150:151], v[150:151], s[58:59] op_sel_hi:[1,0]
    v_cvt_pk_bf16_f32 v64, v148, v149
    v_cvt_pk_bf16_f32 v65, v150, v151
    v_pk_mul_f32 v[156:157], v[156:157], s[58:59] op_sel_hi:[1,0]
    v_pk_mul_f32 v[158:159], v[158:159], s[58:59] op_sel_hi:[1,0]
    v_cvt_pk_bf16_f32 v66, v156, v157
    v_cvt_pk_bf16_f32 v67, v158, v159
    buffer_store_dwordx4 v[64:67], v5, s[8:11], s59 offen offset:1024 sc1
    v_pk_mul_f32 v[164:165], v[164:165], s[58:59] op_sel_hi:[1,0]
    v_pk_mul_f32 v[166:167], v[166:167], s[58:59] op_sel_hi:[1,0]
    v_cvt_pk_bf16_f32 v68, v164, v165
    v_cvt_pk_bf16_f32 v69, v166, v167
    v_pk_mul_f32 v[172:173], v[172:173], s[58:59] op_sel_hi:[1,0]
    v_pk_mul_f32 v[174:175], v[174:175], s[58:59] op_sel_hi:[1,0]
    v_cvt_pk_bf16_f32 v70, v172, v173
    v_cvt_pk_bf16_f32 v71, v174, v175
    buffer_store_dwordx4 v[68:71], v5, s[8:11], s59 offen offset:2048 sc1
    v_pk_mul_f32 v[180:181], v[180:181], s[58:59] op_sel_hi:[1,0]
    v_pk_mul_f32 v[182:183], v[182:183], s[58:59] op_sel_hi:[1,0]
    v_cvt_pk_bf16_f32 v72, v180, v181
    v_cvt_pk_bf16_f32 v73, v182, v183
    v_pk_mul_f32 v[188:189], v[188:189], s[58:59] op_sel_hi:[1,0]
    v_pk_mul_f32 v[190:191], v[190:191], s[58:59] op_sel_hi:[1,0]
    v_cvt_pk_bf16_f32 v74, v188, v189
    v_cvt_pk_bf16_f32 v75, v190, v191
    buffer_store_dwordx4 v[72:75], v5, s[8:11], s59 offen offset:3072 sc1
    v_pk_mul_f32 v[196:197], v[196:197], s[58:59] op_sel_hi:[1,0]
    v_pk_mul_f32 v[198:199], v[198:199], s[58:59] op_sel_hi:[1,0]
    v_cvt_pk_bf16_f32 v76, v196, v197
    v_cvt_pk_bf16_f32 v77, v198, v199
    v_pk_mul_f32 v[204:205], v[204:205], s[58:59] op_sel_hi:[1,0]
    v_pk_mul_f32 v[206:207], v[206:207], s[58:59] op_sel_hi:[1,0]
    v_cvt_pk_bf16_f32 v78, v204, v205
    v_cvt_pk_bf16_f32 v79, v206, v207
    buffer_store_dwordx4 v[76:79], v5, s[8:11], s57 offen offset:0 sc1
    v_pk_mul_f32 v[212:213], v[212:213], s[58:59] op_sel_hi:[1,0]
    v_pk_mul_f32 v[214:215], v[214:215], s[58:59] op_sel_hi:[1,0]
    v_cvt_pk_bf16_f32 v80, v212, v213
    v_cvt_pk_bf16_f32 v81, v214, v215
    v_pk_mul_f32 v[220:221], v[220:221], s[58:59] op_sel_hi:[1,0]
    v_pk_mul_f32 v[222:223], v[222:223], s[58:59] op_sel_hi:[1,0]
    v_cvt_pk_bf16_f32 v82, v220, v221
    v_cvt_pk_bf16_f32 v83, v222, v223
    buffer_store_dwordx4 v[80:83], v5, s[8:11], s57 offen offset:1024 sc1
    v_pk_mul_f32 v[228:229], v[228:229], s[58:59] op_sel_hi:[1,0]
    v_pk_mul_f32 v[230:231], v[230:231], s[58:59] op_sel_hi:[1,0]
    v_cvt_pk_bf16_f32 v84, v228, v229
    v_cvt_pk_bf16_f32 v85, v230, v231
    v_pk_mul_f32 v[236:237], v[236:237], s[58:59] op_sel_hi:[1,0]
    v_pk_mul_f32 v[238:239], v[238:239], s[58:59] op_sel_hi:[1,0]
    v_cvt_pk_bf16_f32 v86, v236, v237
    v_cvt_pk_bf16_f32 v87, v238, v239
    buffer_store_dwordx4 v[84:87], v5, s[8:11], s57 offen offset:2048 sc1
prep_ln:
    v_mov_b32 v3, 0x40000000
    v_lshlrev_b32 v9, 3, v0
    v_cmp_gt_u32 vcc, 128, v0
    s_nop 1
    v_cndmask_b32 v14, v3, v9, vcc
    s_and_b32 s44, s2, 127
    v_accvgpr_read_b32 v16, a0
    v_accvgpr_read_b32 v17, a1
    v_accvgpr_read_b32 v18, a2
    v_accvgpr_read_b32 v19, a3
    v_accvgpr_read_b32 v20, a4
    v_accvgpr_read_b32 v21, a5
    v_accvgpr_read_b32 v22, a6
    v_accvgpr_read_b32 v23, a7
    v_accvgpr_read_b32 v24, a8
    v_accvgpr_read_b32 v25, a9
    v_accvgpr_read_b32 v26, a10
    v_accvgpr_read_b32 v27, a11
    v_accvgpr_read_b32 v28, a12
    v_accvgpr_read_b32 v29, a13
    v_accvgpr_read_b32 v30, a14
    v_accvgpr_read_b32 v31, a15
    v_accvgpr_read_b32 v96, a16
    v_accvgpr_read_b32 v97, a17
    v_accvgpr_read_b32 v100, a18
    v_accvgpr_read_b32 v101, a19
    v_accvgpr_read_b32 v104, a20
    v_accvgpr_read_b32 v105, a21
    v_accvgpr_read_b32 v108, a22
    v_accvgpr_read_b32 v109, a23
    v_and_b32 v99, 0xffff0000, v97
    v_lshlrev_b32 v98, 16, v97
    v_and_b32 v97, 0xffff0000, v96
    v_lshlrev_b32 v96, 16, v96
    v_and_b32 v103, 0xffff0000, v101
    v_lshlrev_b32 v102, 16, v101
    v_and_b32 v101, 0xffff0000, v100
    v_lshlrev_b32 v100, 16, v100
    v_and_b32 v107, 0xffff0000, v105
    v_lshlrev_b32 v106, 16, v105
    v_and_b32 v105, 0xffff0000, v104
    v_lshlrev_b32 v104, 16, v104
    v_and_b32 v111, 0xffff0000, v109
    v_lshlrev_b32 v110, 16, v109
    v_and_b32 v109, 0xffff0000, v108
    v_lshlrev_b32 v108, 16, v108
    v_lshlrev_b32 v9, 1, v9
    v_lshlrev_b32 v14, 1, v14
    s_mul_i32 s58, s2, 14336
    s_add_u32 s58, s58, 0xe00000
    buffer_store_dwordx4 v[96:99], v9, s[8:11], s58 offen sc1
    s_add_u32 s58, s58, 4096
    buffer_store_dwordx4 v[100:103], v9, s[8:11], s58 offen sc1
    s_add_u32 s58, s58, 4096
    buffer_store_dwordx4 v[104:107], v9, s[8:11], s58 offen sc1
    s_add_u32 s58, s58, 4096
    buffer_store_dwordx4 v[108:111], v14, s[8:11], s58 offen sc1
    s_add_u32 s58, s58, 4096
    v_lshlrev_b32 v32, 16, v16
    v_and_b32 v33, 0xffff0000, v16
    v_lshlrev_b32 v34, 16, v17
    v_and_b32 v35, 0xffff0000, v17
    v_lshlrev_b32 v36, 16, v18
    v_and_b32 v37, 0xffff0000, v18
    v_lshlrev_b32 v38, 16, v19
    v_and_b32 v39, 0xffff0000, v19
    v_lshlrev_b32 v40, 16, v20
    v_and_b32 v41, 0xffff0000, v20
    v_lshlrev_b32 v42, 16, v21
    v_and_b32 v43, 0xffff0000, v21
    v_lshlrev_b32 v44, 16, v22
    v_and_b32 v45, 0xffff0000, v22
    v_lshlrev_b32 v46, 16, v23
    v_and_b32 v47, 0xffff0000, v23
    v_lshlrev_b32 v48, 16, v24
    v_and_b32 v49, 0xffff0000, v24
    v_lshlrev_b32 v50, 16, v25
    v_and_b32 v51, 0xffff0000, v25
    v_lshlrev_b32 v52, 16, v26
    v_and_b32 v53, 0xffff0000, v26
    v_lshlrev_b32 v54, 16, v27
    v_and_b32 v55, 0xffff0000, v27
    v_lshlrev_b32 v56, 16, v28
    v_and_b32 v57, 0xffff0000, v28
    v_lshlrev_b32 v58, 16, v29
    v_and_b32 v59, 0xffff0000, v29
    v_lshlrev_b32 v60, 16, v30
    v_and_b32 v61, 0xffff0000, v30
    v_lshlrev_b32 v62, 16, v31
    v_and_b32 v63, 0xffff0000, v31
    v_bfe_u32 v12, v1, 0, 4
    v_lshlrev_b32 v12, 4, v12
    v_add_u32 v12, 0x21000, v12
    s_lshl_b32 s56, s3, 2
    v_add_u32 v13, s56, v12
    v_add_f32 v14, v32, v33
    v_add_f32 v15, v34, v35
    v_add_f32 v14, v14, v36
    v_add_f32 v15, v15, v37
    v_add_f32 v14, v14, v38
    v_add_f32 v15, v15, v39
    v_add_f32 v14, v14, v40
    v_add_f32 v15, v15, v41
    v_add_f32 v14, v14, v42
    v_add_f32 v15, v15, v43
    v_add_f32 v14, v14, v44
    v_add_f32 v15, v15, v45
    v_add_f32 v14, v14, v46
    v_add_f32 v15, v15, v47
    v_add_f32 v14, v14, v48
    v_add_f32 v15, v15, v49
    v_add_f32 v14, v14, v50
    v_add_f32 v15, v15, v51
    v_add_f32 v14, v14, v52
    v_add_f32 v15, v15, v53
    v_add_f32 v14, v14, v54
    v_add_f32 v15, v15, v55
    v_add_f32 v14, v14, v56
    v_add_f32 v15, v15, v57
    v_add_f32 v14, v14, v58
    v_add_f32 v15, v15, v59
    v_add_f32 v14, v14, v60
    v_add_f32 v15, v15, v61
    v_add_f32 v14, v14, v62
    v_add_f32 v15, v15, v63
    v_add_f32 v14, v14, v15
    v_mov_b32 v11, v14
    s_nop 1
    v_permlane16_swap_b32 v14, v11
    v_add_f32 v14, v14, v11
    v_mov_b32 v11, v14
    s_nop 1
    v_permlane32_swap_b32 v14, v11
    v_add_f32 v14, v14, v11
    ds_write_b32 v13, v14 offset:0
    s_waitcnt lgkmcnt(0)
    s_barrier
    ds_read_b128 v[16:19], v12 offset:0
    s_waitcnt lgkmcnt(0)
    v_add_f32 v16, v16, v17
    v_add_f32 v18, v18, v19
    v_add_f32 v14, v16, v18
    v_mul_f32 v14, 0x3b124925, v14
    v_sub_f32 v32, v32, v14
    v_sub_f32 v33, v33, v14
    v_sub_f32 v34, v34, v14
    v_sub_f32 v35, v35, v14
    v_sub_f32 v36, v36, v14
    v_sub_f32 v37, v37, v14
    v_sub_f32 v38, v38, v14
    v_sub_f32 v39, v39, v14
    v_sub_f32 v40, v40, v14
    v_sub_f32 v41, v41, v14
    v_sub_f32 v42, v42, v14
    v_sub_f32 v43, v43, v14
    v_sub_f32 v44, v44, v14
    v_sub_f32 v45, v45, v14
    v_sub_f32 v46, v46, v14
    v_sub_f32 v47, v47, v14
    v_sub_f32 v48, v48, v14
    v_sub_f32 v49, v49, v14
    v_sub_f32 v50, v50, v14
    v_sub_f32 v51, v51, v14
    v_sub_f32 v52, v52, v14
    v_sub_f32 v53, v53, v14
    v_sub_f32 v54, v54, v14
    v_sub_f32 v55, v55, v14
    v_sub_f32 v56, v56, v14
    v_sub_f32 v57, v57, v14
    v_sub_f32 v58, v58, v14
    v_sub_f32 v59, v59, v14
    v_sub_f32 v60, v60, v14
    v_sub_f32 v61, v61, v14
    v_sub_f32 v62, v62, v14
    v_sub_f32 v63, v63, v14
    v_mul_f32 v15, v32, v32
    v_mul_f32 v20, v56, v56
    v_fmac_f32 v15, v33, v33
    v_fmac_f32 v15, v34, v34
    v_fmac_f32 v15, v35, v35
    v_fmac_f32 v15, v36, v36
    v_fmac_f32 v15, v37, v37
    v_fmac_f32 v15, v38, v38
    v_fmac_f32 v15, v39, v39
    v_fmac_f32 v15, v40, v40
    v_fmac_f32 v15, v41, v41
    v_fmac_f32 v15, v42, v42
    v_fmac_f32 v15, v43, v43
    v_fmac_f32 v15, v44, v44
    v_fmac_f32 v15, v45, v45
    v_fmac_f32 v15, v46, v46
    v_fmac_f32 v15, v47, v47
    v_fmac_f32 v15, v48, v48
    v_fmac_f32 v15, v49, v49
    v_fmac_f32 v15, v50, v50
    v_fmac_f32 v15, v51, v51
    v_fmac_f32 v15, v52, v52
    v_fmac_f32 v15, v53, v53
    v_fmac_f32 v15, v54, v54
    v_fmac_f32 v15, v55, v55
    v_fmac_f32 v20, v57, v57
    v_fmac_f32 v20, v58, v58
    v_fmac_f32 v20, v59, v59
    v_fmac_f32 v20, v60, v60
    v_fmac_f32 v20, v61, v61
    v_fmac_f32 v20, v62, v62
    v_fmac_f32 v20, v63, v63
    v_fmac_f32 v15, s41, v20
    v_mov_b32 v11, v15
    s_nop 1
    v_permlane16_swap_b32 v15, v11
    v_add_f32 v15, v15, v11
    v_mov_b32 v11, v15
    s_nop 1
    v_permlane32_swap_b32 v15, v11
    v_add_f32 v15, v15, v11
    ds_write_b32 v13, v15 offset:256
    s_waitcnt lgkmcnt(0)
    s_barrier
    ds_read_b128 v[16:19], v12 offset:256
    s_waitcnt lgkmcnt(0)
    v_add_f32 v16, v16, v17
    v_add_f32 v18, v18, v19
    v_add_f32 v15, v16, v18
    v_mov_b32 v14, 0x3727c5ac
    v_fmac_f32 v14, 0x3b124925, v15
    v_rsq_f32 v14, v14
    s_nop 0
    v_mul_f32 v32, v32, v14
    v_mul_f32 v33, v33, v14
    v_mul_f32 v34, v34, v14
    v_mul_f32 v35, v35, v14
    v_mul_f32 v36, v36, v14
    v_mul_f32 v37, v37, v14
    v_mul_f32 v38, v38, v14
    v_mul_f32 v39, v39, v14
    v_mul_f32 v40, v40, v14
    v_mul_f32 v41, v41, v14
    v_mul_f32 v42, v42, v14
    v_mul_f32 v43, v43, v14
    v_mul_f32 v44, v44, v14
    v_mul_f32 v45, v45, v14
    v_mul_f32 v46, v46, v14
    v_mul_f32 v47, v47, v14
    v_mul_f32 v48, v48, v14
    v_mul_f32 v49, v49, v14
    v_mul_f32 v50, v50, v14
    v_mul_f32 v51, v51, v14
    v_mul_f32 v52, v52, v14
    v_mul_f32 v53, v53, v14
    v_mul_f32 v54, v54, v14
    v_mul_f32 v55, v55, v14
    v_mul_f32 v56, v56, v14
    v_mul_f32 v57, v57, v14
    v_mul_f32 v58, v58, v14
    v_mul_f32 v59, v59, v14
    v_mul_f32 v60, v60, v14
    v_mul_f32 v61, v61, v14
    v_mul_f32 v62, v62, v14
    v_mul_f32 v63, v63, v14
    v_cvt_pk_bf16_f32 v64, v32, v33
    v_cvt_pk_bf16_f32 v65, v34, v35
    v_cvt_pk_bf16_f32 v66, v36, v37
    v_cvt_pk_bf16_f32 v67, v38, v39
    v_cvt_pk_bf16_f32 v68, v40, v41
    v_cvt_pk_bf16_f32 v69, v42, v43
    v_cvt_pk_bf16_f32 v70, v44, v45
    v_cvt_pk_bf16_f32 v71, v46, v47
    v_cvt_pk_bf16_f32 v72, v48, v49
    v_cvt_pk_bf16_f32 v73, v50, v51
    v_cvt_pk_bf16_f32 v74, v52, v53
    v_cvt_pk_bf16_f32 v75, v54, v55
    v_cvt_pk_bf16_f32 v76, v56, v57
    v_cvt_pk_bf16_f32 v77, v58, v59
    v_cvt_pk_bf16_f32 v78, v60, v61
    v_cvt_pk_bf16_f32 v79, v62, v63
    s_cmp_lt_u32 s2, 128
    s_cselect_b32 s56, 0, 0x40000000
    v_lshlrev_b32 v15, 4, v1
    v_add_u32 v15, s56, v15
    v_bfe_u32 v14, v1, 0, 1
    v_mul_u32_u24 v14, 0x3800, v14
    v_bfe_u32 v2, v1, 4, 2
    v_lshlrev_b32 v2, 8, v2
    v_add_u32 v14, v14, v2
    v_bfe_u32 v2, v1, 1, 3
    v_lshlrev_b32 v2, 4, v2
    v_add_u32 v14, v14, v2
    v_add_u32 v14, s56, v14
    s_mul_i32 s58, s44, 14
    s_add_u32 s58, s58, s40
    s_lshl_b32 s58, s58, 10
    s_add_u32 s58, s58, 0x1800000
    buffer_store_dwordx4 v[64:67], v15, s[8:11], s58 offen offset:0 sc1
    buffer_store_dwordx4 v[68:71], v15, s[8:11], s58 offen offset:1024 sc1
    buffer_store_dwordx4 v[72:75], v15, s[8:11], s58 offen offset:2048 sc1
    buffer_store_dwordx4 v[76:79], v15, s[36:39], s58 offen offset:3072 sc1
    s_lshr_b32 s58, s44, 1
    s_mul_i32 s58, s58, 28672
    s_lshl_b32 s57, s40, 10
    s_add_u32 s58, s58, s57
    s_and_b32 s57, s44, 1
    s_lshl_b32 s57, s57, 7
    s_add_u32 s58, s58, s57
    s_add_u32 s58, s58, 0x1a00000
    buffer_store_dwordx4 v[64:67], v14, s[8:11], s58 offen offset:0 sc1
    buffer_store_dwordx4 v[68:71], v14, s[8:11], s58 offen offset:1024 sc1
    buffer_store_dwordx4 v[72:75], v14, s[8:11], s58 offen offset:2048 sc1
    buffer_store_dwordx4 v[76:79], v14, s[36:39], s58 offen offset:3072 sc1
    s_cmp_gt_u32 s2, 166
    s_cbranch_scc1 prep_noarm
    s_cmp_lt_u32 s2, 130
    s_cselect_b32 s58, -1, 0
    v_mov_b32 v24, s58
    v_mov_b32 v25, s58
    v_mov_b32 v26, s58
    v_mov_b32 v27, s58
    v_lshlrev_b32 v28, 4, v0
    s_lshl_b32 s58, s2, 12
    s_add_u32 s58, s58, 0x4200000
    s_cmp_eq_u32 s2, 166
    s_cselect_b32 s58, 0x1180000, s58
    s_cselect_b32 s57, 0, 0x3000000
    buffer_store_dwordx4 v[24:27], v28, s[8:11], s58 offen sc1
    s_add_u32 s58, s58, s57
    buffer_store_dwordx4 v[24:27], v28, s[8:11], s58 offen sc1
prep_noarm:
prep_end:
    s_endpgm
    .globl main_kernel
    .p2align 8
    .type main_kernel,@function
main_kernel:
    s_mov_b32 s89, 0
    s_mov_b32 s84, 0
    s_cmp_ge_u32 s2, 256
    s_cbranch_scc1 la_x
    s_load_dwordx2 s[4:5], s[0:1], 112
    s_load_dwordx2 s[6:7], s[0:1], 8
    s_getreg_b32 s21, hwreg(HW_REG_XCC_ID)
    v_and_b32 v1, 63, v0
    v_lshrrev_b32 v2, 6, v0
    s_nop 0
    v_readfirstlane_b32 s3, v2
    s_and_b32 s21, s21, 7
    s_mov_b32 s90, 32768
    s_mov_b32 s87, 0
    s_mov_b32 s86, -1
    s_mov_b32 s83, -1
    s_waitcnt lgkmcnt(0)
    s_mov_b32 s8, s4
    s_and_b32 s9, s5, 0xffff
    s_mov_b32 s10, 0x10000000
    s_mov_b32 s11, 0x20000
    s_mov_b32 s12, s6
    s_and_b32 s13, s7, 0xffff
    s_mov_b32 s14, 0x1c00
    s_mov_b32 s15, 0x20000
    s_cmp_lg_u32 s3, 0
    s_cbranch_scc1 la0_rank_wait
    s_lshl_b32 s22, s21, 8
    s_add_u32 s22, s22, 0x1180000
    v_mov_b32 v2, 1
    v_mov_b32 v3, 0
    s_mov_b64 exec, 1
    buffer_atomic_add v2, v3, s[8:11], s22 offen sc0
    v_mov_b32 v3, 0x27ff0
    s_waitcnt vmcnt(0)
    ds_write_b32 v3, v2
    s_mov_b64 exec, -1
    s_waitcnt lgkmcnt(0)
la0_rank_wait:
    s_barrier
    v_mov_b32 v3, 0x27ff0
    ds_read_b32 v2, v3
    s_waitcnt lgkmcnt(0)
    v_readfirstlane_b32 s20, v2
    s_barrier
    s_mov_b32 s100, s20
    s_mov_b32 s101, s21
    s_mov_b32 s77, 0
    s_cmp_lg_u32 s21, 0
    s_cbranch_scc1 la0_worker
la0_role:
    s_mov_b32 s100, s20
    s_mov_b32 s77, 1
    s_cmp_lt_u32 s20, 16
    s_cbranch_scc1 la0_A
    s_cmp_lt_u32 s20, 30
    s_cbranch_scc1 la0_B
    s_cmp_eq_u32 s20, 30
    s_cbranch_scc1 la0_pref
    s_cmp_eq_u32 s20, 31
    s_cbranch_scc1 la0_tr
    s_branch la0_worker
la0_pass2:
    s_load_dwordx2 s[6:7], s[0:1], 8
    s_mov_b32 s89, 1
    s_mov_b32 s84, 50331648
    s_mov_b32 s86, -1
    s_mov_b32 s20, s100
    s_mov_b32 s21, s101
    s_lshl_b32 s22, s3, 6
    v_add_u32 v0, s22, v1
    s_waitcnt vmcnt(0) lgkmcnt(0)
    s_barrier
    s_mov_b32 s12, s6
    s_and_b32 s13, s7, 0xffff
    s_mov_b32 s14, 0x1c00
    s_mov_b32 s15, 0x20000
    s_cmp_lg_u32 s77, 0
    s_cbranch_scc1 la0_role
    s_branch la0_worker
la0_A:
    v_bfe_u32 v2, v1, 1, 1
    v_mov_b32 v3, 0xaaaa
    v_mul_u32_u24 v2, v2, v3
    v_add_u32 v4, 0x4444, v2
    v_bfe_u32 v5, v1, 2, 2
    v_lshlrev_b32 v5, 7, v5
    v_bfe_u32 v2, v1, 0, 1
    v_lshlrev_b32 v2, 6, v2
    v_add_u32 v5, v5, v2
    v_bfe_u32 v2, v1, 5, 1
    v_lshlrev_b32 v2, 9, v2
    v_add_u32 v5, v5, v2
    v_bfe_u32 v2, v1, 4, 1
    v_lshlrev_b32 v2, 5, v2
    v_add_u32 v5, v5, v2
    v_bfe_u32 v2, v1, 1, 1
    v_lshlrev_b32 v2, 4, v2
    v_add_u32 v5, v5, v2
    v_mov_b32 v20, v1
    v_mov_b32 v21, v0
    s_lshr_b32 s38, s3, 1
    s_mul_i32 s38, s38, 7
    s_and_b32 s39, s3, 1
    s_lshl_b32 s37, s39, 2
    s_add_u32 s37, s37, s38
    s_add_u32 s38, s38, 3
    s_mul_i32 s22, s20, 28
    s_lshl_b32 s23, s37, 1
    s_add_u32 s23, s23, s22
    s_mul_i32 s23, s23, 14336
    s_add_u32 s24, s23, 0x620000
    s_lshl_b32 s23, s38, 1
    s_add_u32 s23, s23, s39
    s_add_u32 s23, s23, s22
    s_mul_i32 s23, s23, 14336
    s_add_u32 s25, s23, 0x620000
    v_lshlrev_b32 v16, 4, v20
    s_lshl_b32 s32, s3, 1
    s_add_u32 s33, s32, 0
    s_sub_u32 s34, s33, 7
    s_cmp_ge_u32 s33, 7
    s_cselect_b32 s33, s34, s33
    s_lshl_b32 s33, s33, 11
    s_add_u32 s34, s33, s24
    s_add_u32 s34, s34, 28672
    buffer_load_dwordx4 a[0:3], v16, s[8:11], s34 offen offset:0
    buffer_load_dwordx4 a[4:7], v16, s[8:11], s34 offen offset:1024
    s_add_u32 s34, s33, s24
    s_add_u32 s34, s34, 43008
    buffer_load_dwordx4 a[8:11], v16, s[8:11], s34 offen offset:0
    buffer_load_dwordx4 a[12:15], v16, s[8:11], s34 offen offset:1024
    s_add_u32 s34, s33, s24
    s_add_u32 s34, s34, 57344
    buffer_load_dwordx4 a[16:19], v16, s[8:11], s34 offen offset:0
    buffer_load_dwordx4 a[20:23], v16, s[8:11], s34 offen offset:1024
    s_add_u32 s34, s33, s24
    s_add_u32 s34, s34, 71680
    buffer_load_dwordx4 a[24:27], v16, s[8:11], s34 offen offset:0
    buffer_load_dwordx4 a[28:31], v16, s[8:11], s34 offen offset:1024
    s_add_u32 s34, s33, s25
    buffer_load_dwordx4 a[32:35], v16, s[8:11], s34 offen offset:0
    buffer_load_dwordx4 a[36:39], v16, s[8:11], s34 offen offset:1024
    s_add_u32 s33, s32, 1
    s_sub_u32 s34, s33, 7
    s_cmp_ge_u32 s33, 7
    s_cselect_b32 s33, s34, s33
    s_lshl_b32 s33, s33, 11
    s_add_u32 s34, s33, s24
    s_add_u32 s34, s34, 28672
    buffer_load_dwordx4 a[40:43], v16, s[8:11], s34 offen offset:0
    buffer_load_dwordx4 a[44:47], v16, s[8:11], s34 offen offset:1024
    s_add_u32 s34, s33, s24
    s_add_u32 s34, s34, 43008
    buffer_load_dwordx4 a[48:51], v16, s[8:11], s34 offen offset:0
    buffer_load_dwordx4 a[52:55], v16, s[8:11], s34 offen offset:1024
    s_add_u32 s34, s33, s24
    s_add_u32 s34, s34, 57344
    buffer_load_dwordx4 a[56:59], v16, s[8:11], s34 offen offset:0
    buffer_load_dwordx4 a[60:63], v16, s[8:11], s34 offen offset:1024
    s_add_u32 s34, s33, s24
    s_add_u32 s34, s34, 71680
    buffer_load_dwordx4 a[64:67], v16, s[8:11], s34 offen offset:0
    buffer_load_dwordx4 a[68:71], v16, s[8:11], s34 offen offset:1024
    s_add_u32 s34, s33, s25
    buffer_load_dwordx4 a[72:75], v16, s[8:11], s34 offen offset:0
    buffer_load_dwordx4 a[76:79], v16, s[8:11], s34 offen offset:1024
    s_add_u32 s33, s32, 2
    s_sub_u32 s34, s33, 7
    s_cmp_ge_u32 s33, 7
    s_cselect_b32 s33, s34, s33
    s_lshl_b32 s33, s33, 11
    s_add_u32 s34, s33, s24
    s_add_u32 s34, s34, 28672
    buffer_load_dwordx4 a[80:83], v16, s[8:11], s34 offen offset:0
    buffer_load_dwordx4 a[84:87], v16, s[8:11], s34 offen offset:1024
    s_add_u32 s34, s33, s24
    s_add_u32 s34, s34, 43008
    buffer_load_dwordx4 a[88:91], v16, s[8:11], s34 offen offset:0
    buffer_load_dwordx4 a[92:95], v16, s[8:11], s34 offen offset:1024
    s_add_u32 s34, s33, s24
    s_add_u32 s34, s34, 57344
    buffer_load_dwordx4 a[96:99], v16, s[8:11], s34 offen offset:0
    buffer_load_dwordx4 a[100:103], v16, s[8:11], s34 offen offset:1024
    s_add_u32 s34, s33, s24
    s_add_u32 s34, s34, 71680
    buffer_load_dwordx4 a[104:107], v16, s[8:11], s34 offen offset:0
    buffer_load_dwordx4 a[108:111], v16, s[8:11], s34 offen offset:1024
    s_add_u32 s34, s33, s25
    buffer_load_dwordx4 a[112:115], v16, s[8:11], s34 offen offset:0
    buffer_load_dwordx4 a[116:119], v16, s[8:11], s34 offen offset:1024
    s_add_u32 s33, s32, 3
    s_sub_u32 s34, s33, 7
    s_cmp_ge_u32 s33, 7
    s_cselect_b32 s33, s34, s33
    s_lshl_b32 s33, s33, 11
    s_add_u32 s34, s33, s24
    s_add_u32 s34, s34, 28672
    buffer_load_dwordx4 a[120:123], v16, s[8:11], s34 offen offset:0
    buffer_load_dwordx4 a[124:127], v16, s[8:11], s34 offen offset:1024
    s_add_u32 s34, s33, s24
    s_add_u32 s34, s34, 43008
    buffer_load_dwordx4 a[128:131], v16, s[8:11], s34 offen offset:0
    buffer_load_dwordx4 a[132:135], v16, s[8:11], s34 offen offset:1024
    s_add_u32 s34, s33, s24
    s_add_u32 s34, s34, 57344
    buffer_load_dwordx4 a[136:139], v16, s[8:11], s34 offen offset:0
    buffer_load_dwordx4 a[140:143], v16, s[8:11], s34 offen offset:1024
    s_add_u32 s34, s33, s24
    s_add_u32 s34, s34, 71680
    buffer_load_dwordx4 a[144:147], v16, s[8:11], s34 offen offset:0
    buffer_load_dwordx4 a[148:151], v16, s[8:11], s34 offen offset:1024
    s_add_u32 s34, s33, s25
    buffer_load_dwordx4 a[152:155], v16, s[8:11], s34 offen offset:0
    buffer_load_dwordx4 a[156:159], v16, s[8:11], s34 offen offset:1024
    s_add_u32 s33, s32, 4
    s_sub_u32 s34, s33, 7
    s_cmp_ge_u32 s33, 7
    s_cselect_b32 s33, s34, s33
    s_lshl_b32 s33, s33, 11
    s_add_u32 s34, s33, s24
    s_add_u32 s34, s34, 28672
    buffer_load_dwordx4 a[160:163], v16, s[8:11], s34 offen offset:0
    buffer_load_dwordx4 a[164:167], v16, s[8:11], s34 offen offset:1024
    s_add_u32 s34, s33, s24
    s_add_u32 s34, s34, 43008
    buffer_load_dwordx4 v[120:123], v16, s[8:11], s34 offen offset:0
    buffer_load_dwordx4 v[124:127], v16, s[8:11], s34 offen offset:1024
    s_add_u32 s34, s33, s24
    s_add_u32 s34, s34, 57344
    buffer_load_dwordx4 v[128:131], v16, s[8:11], s34 offen offset:0
    buffer_load_dwordx4 v[132:135], v16, s[8:11], s34 offen offset:1024
    s_add_u32 s34, s33, s24
    s_add_u32 s34, s34, 71680
    buffer_load_dwordx4 v[136:139], v16, s[8:11], s34 offen offset:0
    buffer_load_dwordx4 v[140:143], v16, s[8:11], s34 offen offset:1024
    s_add_u32 s34, s33, s25
    buffer_load_dwordx4 v[144:147], v16, s[8:11], s34 offen offset:0
    buffer_load_dwordx4 v[148:151], v16, s[8:11], s34 offen offset:1024
    s_add_u32 s33, s32, 5
    s_sub_u32 s34, s33, 7
    s_cmp_ge_u32 s33, 7
    s_cselect_b32 s33, s34, s33
    s_lshl_b32 s33, s33, 11
    s_add_u32 s34, s33, s24
    s_add_u32 s34, s34, 28672
    buffer_load_dwordx4 v[152:155], v16, s[8:11], s34 offen offset:0
    buffer_load_dwordx4 v[156:159], v16, s[8:11], s34 offen offset:1024
    s_add_u32 s34, s33, s24
    s_add_u32 s34, s34, 43008
    buffer_load_dwordx4 v[160:163], v16, s[8:11], s34 offen offset:0
    buffer_load_dwordx4 v[164:167], v16, s[8:11], s34 offen offset:1024
    s_add_u32 s34, s33, s24
    s_add_u32 s34, s34, 57344
    buffer_load_dwordx4 v[168:171], v16, s[8:11], s34 offen offset:0
    buffer_load_dwordx4 v[172:175], v16, s[8:11], s34 offen offset:1024
    s_add_u32 s34, s33, s24
    s_add_u32 s34, s34, 71680
    s_waitcnt vmcnt(20)
    buffer_load_dwordx4 v[176:179], v16, s[8:11], s34 offen offset:0
    buffer_load_dwordx4 v[180:183], v16, s[8:11], s34 offen offset:1024
    s_add_u32 s34, s33, s25
    buffer_load_dwordx4 v[184:187], v16, s[8:11], s34 offen offset:0
    buffer_load_dwordx4 v[188:191], v16, s[8:11], s34 offen offset:1024
    s_add_u32 s33, s32, 6
    s_sub_u32 s34, s33, 7
    s_cmp_ge_u32 s33, 7
    s_cselect_b32 s33, s34, s33
    s_lshl_b32 s33, s33, 11
    s_add_u32 s34, s33, s24
    s_add_u32 s34, s34, 28672
    buffer_load_dwordx4 v[192:195], v16, s[8:11], s34 offen offset:0
    buffer_load_dwordx4 v[196:199], v16, s[8:11], s34 offen offset:1024
    s_add_u32 s34, s33, s24
    s_add_u32 s34, s34, 43008
    buffer_load_dwordx4 v[224:227], v16, s[8:11], s34 offen offset:0
    buffer_load_dwordx4 v[228:231], v16, s[8:11], s34 offen offset:1024
    s_add_u32 s34, s33, s24
    s_add_u32 s34, s34, 57344
    buffer_load_dwordx4 v[232:235], v16, s[8:11], s34 offen offset:0
    buffer_load_dwordx4 v[236:239], v16, s[8:11], s34 offen offset:1024
    s_add_u32 s34, s33, s24
    s_add_u32 s34, s34, 71680
    buffer_load_dwordx4 v[240:243], v16, s[8:11], s34 offen offset:0
    buffer_load_dwordx4 v[244:247], v16, s[8:11], s34 offen offset:1024
    s_add_u32 s34, s33, s25
    buffer_load_dwordx4 v[248:251], v16, s[8:11], s34 offen offset:0
    buffer_load_dwordx4 v[252:255], v16, s[8:11], s34 offen offset:1024
    s_cmp_lg_u32 s89, 0
    s_cbranch_scc1 la0_A_pre
    s_waitcnt vmcnt(30)
    s_add_u32 s33, s32, 0
    s_sub_u32 s34, s33, 7
    s_cmp_ge_u32 s33, 7
    s_cselect_b32 s33, s34, s33
    s_lshl_b32 s33, s33, 11
    s_add_u32 s34, s33, s24
    s_add_u32 s34, s34, 0
    buffer_load_dwordx4 a[168:171], v16, s[8:11], s34 offen offset:0
    buffer_load_dwordx4 a[172:175], v16, s[8:11], s34 offen offset:1024
    s_add_u32 s34, s33, s24
    s_add_u32 s34, s34, 14336
    buffer_load_dwordx4 a[224:227], v16, s[8:11], s34 offen offset:0
    buffer_load_dwordx4 a[228:231], v16, s[8:11], s34 offen offset:1024
    s_add_u32 s33, s32, 1
    s_sub_u32 s34, s33, 7
    s_cmp_ge_u32 s33, 7
    s_cselect_b32 s33, s34, s33
    s_lshl_b32 s33, s33, 11
    s_add_u32 s34, s33, s24
    s_add_u32 s34, s34, 0
    buffer_load_dwordx4 a[176:179], v16, s[8:11], s34 offen offset:0
    buffer_load_dwordx4 a[180:183], v16, s[8:11], s34 offen offset:1024
    s_add_u32 s34, s33, s24
    s_add_u32 s34, s34, 14336
    buffer_load_dwordx4 a[232:235], v16, s[8:11], s34 offen offset:0
    buffer_load_dwordx4 a[236:239], v16, s[8:11], s34 offen offset:1024
    s_add_u32 s33, s32, 2
    s_sub_u32 s34, s33, 7
    s_cmp_ge_u32 s33, 7
    s_cselect_b32 s33, s34, s33
    s_lshl_b32 s33, s33, 11
    s_add_u32 s34, s33, s24
    s_add_u32 s34, s34, 0
    buffer_load_dwordx4 a[184:187], v16, s[8:11], s34 offen offset:0
    buffer_load_dwordx4 a[188:191], v16, s[8:11], s34 offen offset:1024
    s_add_u32 s34, s33, s24
    s_add_u32 s34, s34, 14336
    buffer_load_dwordx4 a[240:243], v16, s[8:11], s34 offen offset:0
    buffer_load_dwordx4 a[244:247], v16, s[8:11], s34 offen offset:1024
    s_add_u32 s33, s32, 3
    s_sub_u32 s34, s33, 7
    s_cmp_ge_u32 s33, 7
    s_cselect_b32 s33, s34, s33
    s_lshl_b32 s33, s33, 11
    s_add_u32 s34, s33, s24
    s_add_u32 s34, s34, 0
    buffer_load_dwordx4 a[192:195], v16, s[8:11], s34 offen offset:0
    buffer_load_dwordx4 a[196:199], v16, s[8:11], s34 offen offset:1024
    s_add_u32 s34, s33, s24
    s_add_u32 s34, s34, 14336
    buffer_load_dwordx4 a[248:251], v16, s[8:11], s34 offen offset:0
    buffer_load_dwordx4 a[252:255], v16, s[8:11], s34 offen offset:1024
    s_add_u32 s33, s32, 4
    s_sub_u32 s34, s33, 7
    s_cmp_ge_u32 s33, 7
    s_cselect_b32 s33, s34, s33
    s_lshl_b32 s33, s33, 11
    s_add_u32 s34, s33, s24
    s_add_u32 s34, s34, 0
    buffer_load_dwordx4 a[200:203], v16, s[8:11], s34 offen offset:0
    buffer_load_dwordx4 a[204:207], v16, s[8:11], s34 offen offset:1024
    s_add_u32 s34, s33, s24
    s_add_u32 s34, s34, 14336
    buffer_load_dwordx4 v[200:203], v16, s[8:11], s34 offen offset:0
    buffer_load_dwordx4 v[204:207], v16, s[8:11], s34 offen offset:1024
    s_add_u32 s33, s32, 5
    s_sub_u32 s34, s33, 7
    s_cmp_ge_u32 s33, 7
    s_cselect_b32 s33, s34, s33
    s_lshl_b32 s33, s33, 11
    s_add_u32 s34, s33, s24
    s_add_u32 s34, s34, 0
    buffer_load_dwordx4 a[208:211], v16, s[8:11], s34 offen offset:0
    buffer_load_dwordx4 a[212:215], v16, s[8:11], s34 offen offset:1024
    s_add_u32 s34, s33, s24
    s_add_u32 s34, s34, 14336
    buffer_load_dwordx4 v[208:211], v16, s[8:11], s34 offen offset:0
    buffer_load_dwordx4 v[212:215], v16, s[8:11], s34 offen offset:1024
    s_add_u32 s33, s32, 6
    s_sub_u32 s34, s33, 7
    s_cmp_ge_u32 s33, 7
    s_cselect_b32 s33, s34, s33
    s_lshl_b32 s33, s33, 11
    s_add_u32 s34, s33, s24
    s_add_u32 s34, s34, 0
    buffer_load_dwordx4 a[216:219], v16, s[8:11], s34 offen offset:0
    buffer_load_dwordx4 a[220:223], v16, s[8:11], s34 offen offset:1024
    s_add_u32 s34, s33, s24
    s_add_u32 s34, s34, 14336
    buffer_load_dwordx4 v[216:219], v16, s[8:11], s34 offen offset:0
    buffer_load_dwordx4 v[220:223], v16, s[8:11], s34 offen offset:1024
la0_A_pre:
    s_lshl_b32 s22, s37, 9
    v_bfe_u32 v6, v20, 5, 1
    v_lshlrev_b32 v6, 8, v6
    v_bfe_u32 v22, v20, 1, 2
    v_lshlrev_b32 v22, 6, v22
    v_add_u32 v6, v6, v22
    v_bfe_u32 v22, v20, 0, 1
    v_lshlrev_b32 v22, 4, v22
    v_add_u32 v6, v6, v22
    v_bfe_u32 v22, v20, 4, 1
    v_lshlrev_b32 v22, 3, v22
    v_add_u32 v6, v6, v22
    v_add_u32 v6, 0x6000, v6
    v_add_u32 v6, s22, v6
    s_sub_u32 s55, s38, s37
    s_lshl_b32 s55, s55, 9
    s_sub_u32 s56, s55, 1024
    s_mul_i32 s22, s3, 2560
    v_bfe_u32 v9, v20, 4, 2
    v_mul_u32_u24 v9, 0x280, v9
    v_bfe_u32 v22, v20, 3, 1
    v_lshlrev_b32 v22, 5, v22
    v_add_u32 v9, v9, v22
    v_bfe_u32 v22, v20, 0, 1
    v_lshlrev_b32 v22, 4, v22
    v_add_u32 v9, v9, v22
    v_bfe_u32 v22, v20, 2, 1
    v_lshlrev_b32 v22, 3, v22
    v_add_u32 v9, v9, v22
    v_bfe_u32 v22, v20, 1, 1
    v_lshlrev_b32 v22, 2, v22
    v_add_u32 v9, v9, v22
    v_add_u32 v9, s22, v9
    s_lshl_b32 s23, s39, 1
    s_add_u32 s23, s23, 192
    v_add_u32 v10, s23, v9
    v_bfe_u32 v11, v20, 2, 2
    v_mul_u32_u24 v11, 0x280, v11
    v_bfe_u32 v22, v20, 0, 1
    v_mul_u32_u24 v22, 0x140, v22
    v_add_u32 v11, v11, v22
    v_bfe_u32 v22, v20, 4, 2
    v_lshlrev_b32 v22, 5, v22
    v_add_u32 v11, v11, v22
    v_bfe_u32 v22, v20, 1, 1
    v_lshlrev_b32 v22, 4, v22
    v_add_u32 v11, v11, v22
    v_add_u32 v11, s22, v11
    s_lshr_b32 s22, s3, 1
    s_lshl_b32 s22, s22, 12
    s_and_b32 s23, s3, 1
    s_lshl_b32 s23, s23, 3
    s_add_u32 s22, s22, s23
    v_bfe_u32 v7, v20, 4, 2
    v_lshlrev_b32 v7, 10, v7
    v_bfe_u32 v22, v20, 0, 4
    v_lshlrev_b32 v22, 4, v22
    v_add_u32 v7, v7, v22
    v_add_u32 v7, 0x3000, v7
    v_add_u32 v7, s22, v7
    v_bfe_u32 v3, v20, 4, 2
    v_lshlrev_b32 v3, 10, v3
    v_bfe_u32 v22, v20, 1, 2
    v_lshlrev_b32 v22, 4, v22
    v_add_u32 v3, v3, v22
    v_bfe_u32 v22, v20, 0, 1
    v_lshlrev_b32 v22, 2, v22
    v_add_u32 v3, v3, v22
    v_add_u32 v3, 0x3100, v3
    v_add_u32 v3, s22, v3
    v_bfe_u32 v22, v20, 3, 1
    v_cmp_eq_u32 vcc, 1, v22
    v_lshlrev_b32 v23, 2, v20
    v_add_u32 v23, 0x5000, v23
    v_cndmask_b32 v3, v3, v23, vcc
    s_lshl_b32 s22, s3, 10
    v_bfe_u32 v2, v20, 0, 6
    v_lshlrev_b32 v2, 4, v2
    v_add_u32 v2, 0x3000, v2
    v_add_u32 v2, s22, v2
    s_lshl_b32 s22, s20, 9
    s_lshl_b32 s23, s3, 7
    s_add_u32 s22, s22, s23
    v_bfe_u32 v1, v20, 5, 1
    v_lshlrev_b32 v1, 6, v1
    v_bfe_u32 v22, v20, 0, 4
    v_lshlrev_b32 v22, 2, v22
    v_add_u32 v1, v1, v22
    v_add_u32 v1, s22, v1
    s_lshr_b32 s22, s20, 2
    s_lshl_b32 s22, s22, 9
    s_add_u32 s22, s22, s23
    s_and_b32 s31, s20, 1
    s_lshl_b32 s31, s31, 4
    s_add_u32 s22, s22, s31
    s_bfe_u32 s31, s20, 0x10001
    s_lshl_b32 s31, s31, 2
    s_add_u32 s22, s22, s31
    v_bfe_u32 v19, v20, 5, 1
    v_lshlrev_b32 v19, 6, v19
    v_bfe_u32 v22, v20, 1, 1
    v_lshlrev_b32 v22, 5, v22
    v_add_u32 v19, v19, v22
    v_bfe_u32 v22, v20, 0, 1
    v_lshlrev_b32 v22, 3, v22
    v_add_u32 v19, v19, v22
    v_add_u32 v19, 0x2000, v19
    v_add_u32 v19, s22, v19
    v_and_b32 v22, 31, v20
    v_cmp_le_u32 vcc, 16, v22
    s_nop 1
    v_cndmask_b32 v1, v1, v19, vcc
    v_cmp_le_u32 vcc, 20, v22
    v_mov_b32 v23, 0x40000000
    s_nop 0
    v_cndmask_b32 v1, v1, v23, vcc
    s_lshl_b32 s22, s3, 11
    v_add_u32 v5, s22, v5
    s_cmp_eq_u32 s3, 3
    s_movk_i32 s35, 1024
    s_cselect_b32 s35, -6144, s35
    s_lshl_b32 s36, s3, 11
    s_add_u32 s36, s36, 0x6000
    v_lshlrev_b32 v0, 4, v20
    v_add_u32 v0, s36, v0
    v_lshlrev_b32 v22, 4, v21
    v_mov_b32 v44, 0
    v_mov_b32 v48, 0xf149f2ca
    v_mov_b32 v45, 0
    v_mov_b32 v49, 0xf149f2ca
    v_mov_b32 v46, 0
    v_mov_b32 v50, 0xf149f2ca
    v_mov_b32 v47, 0
    v_mov_b32 v51, 0xf149f2ca
    ds_write_b128 v22, v[44:47] offset:0
    ds_write_b128 v22, v[44:47] offset:4096
    ds_write_b128 v22, v[44:47] offset:8192
    ds_write_b128 v22, v[48:51] offset:12288
    ds_write_b128 v22, v[48:51] offset:16384
    ds_write_b128 v22, v[44:47] offset:0x8000
    v_mov_b32 v72, 0
    v_mov_b32 v73, 0
    v_mov_b32 v74, 0
    v_mov_b32 v75, 0
    v_mov_b32 v76, 0
    v_mov_b32 v77, 0
    v_mov_b32 v78, 0
    v_mov_b32 v79, 0
    v_mov_b32 v80, 0
    v_mov_b32 v81, 0
    v_mov_b32 v82, 0
    v_mov_b32 v83, 0
    v_mov_b32 v84, 0
    v_mov_b32 v85, 0
    v_mov_b32 v86, 0
    v_mov_b32 v87, 0
    v_mov_b32 v88, 0
    v_mov_b32 v89, 0
    v_mov_b32 v90, 0
    v_mov_b32 v91, 0
    v_mov_b32 v92, 0
    v_mov_b32 v93, 0
    v_mov_b32 v94, 0
    v_mov_b32 v95, 0
    v_mov_b32 v96, 0
    v_mov_b32 v97, 0
    v_mov_b32 v98, 0
    v_mov_b32 v99, 0
    v_mov_b32 v100, 0
    v_mov_b32 v101, 0
    v_mov_b32 v102, 0
    v_mov_b32 v103, 0
    v_mov_b32 v104, 0
    v_mov_b32 v105, 0
    v_mov_b32 v106, 0
    v_mov_b32 v107, 0
    v_mov_b32 v108, 0
    v_mov_b32 v109, 0
    v_mov_b32 v110, 0
    v_mov_b32 v111, 0
    v_mov_b32 v112, 0
    v_mov_b32 v113, 0
    v_mov_b32 v114, 0
    v_mov_b32 v115, 0
    v_mov_b32 v116, 0
    v_mov_b32 v117, 0
    v_mov_b32 v118, 0
    v_mov_b32 v119, 0
    s_waitcnt lgkmcnt(0)
    s_barrier
    s_mov_b32 s40, 0
    s_mov_b32 s41, 0x4200000
    s_add_u32 s41, s41, s84
    s_add_u32 s42, s41, s35
    s_mov_b32 s43, 0x4208000
    s_add_u32 s43, s43, s84
    s_mov_b32 s45, 0x420d000
    s_add_u32 s45, s45, s84
    s_lshl_b32 s44, s37, 10
    s_sub_u32 s44, s44, s36
    s_add_u32 s44, s44, 0x1a00000
    s_add_u32 s44, s44, s84
    s_lshl_b32 s57, s55, 1
    s_mov_b32 s46, 0x12800000
    s_mov_b32 s47, 0x5f000000
    s_waitcnt vmcnt(0)
    v_mov_b32 v28, v2
    v_mov_b32 v29, v3
    s_mov_b32 s48, 0
    s_cmp_eq_u32 s89, 0
    s_cbranch_scc1 wt_3_ok
    s_mov_b32 s91, 0
    v_mbcnt_lo_u32_b32 v2, -1, 0
    v_mbcnt_hi_u32_b32 v2, -1, v2
    v_and_b32 v2, 7, v2
    v_lshlrev_b32 v2, 7, v2
    s_lshl_b32 s22, s48, 10
    s_add_u32 s22, s22, 0x428a000
    s_add_u32 s22, s22, s84
wt_3:
    buffer_load_dword v3, v2, s[8:11], s22 offen sc1
    s_waitcnt vmcnt(0)
    v_cmp_eq_u32 vcc, 0, v3
    s_cbranch_vccz wt_3_ok
    s_sleep 2
    s_add_u32 s91, s91, 1
    s_cmp_lt_u32 s91, s90
    s_cbranch_scc1 wt_3
    s_mov_b32 s90, 0
    s_branch wt_3_ok
wt_3_ok:
    v_mov_b32 v2, v28
    v_mov_b32 v3, v29
    s_mov_b32 s22, 0x1180800
    s_mov_b32 s91, 0
    v_mov_b32 v30, 0
ts_4:
    buffer_load_dword v28, v30, s[8:11], s22 offen sc1
    s_waitcnt vmcnt(0)
    v_readfirstlane_b32 s88, v28
    s_nop 0
    s_cmp_lg_u32 s88, 0
    s_cbranch_scc1 ts_4_ok
    s_sleep 8
    s_add_u32 s91, s91, 1
    s_cmp_lt_u32 s91, 100
    s_cbranch_scc1 ts_4
    v_mov_b32 v28, 2
    v_mov_b32 v29, 0
    s_mov_b64 exec, 1
    buffer_atomic_cmpswap v[28:29], v30, s[8:11], s22 offen
    s_mov_b64 exec, -1
    s_waitcnt vmcnt(0)
    s_mov_b32 s91, 0
    s_branch ts_4
ts_4_ok:
    s_cmp_eq_u32 s88, 2
    s_cselect_b32 s47, 0, s47
    v_mov_b32 v44, 0
    v_mov_b32 v45, 0
    v_mov_b32 v46, 0
    v_mov_b32 v47, 0
    v_mov_b32 v48, 0
    v_mov_b32 v49, 0
    v_mov_b32 v50, 0
    v_mov_b32 v51, 0
    v_mov_b32 v52, 0
    v_mov_b32 v53, 0
    v_mov_b32 v54, 0
    v_mov_b32 v55, 0
    v_mov_b32 v56, 0
    v_mov_b32 v57, 0
    v_mov_b32 v58, 0
    v_mov_b32 v59, 0
    v_mov_b32 v60, 0
    v_mov_b32 v61, 0
    v_mov_b32 v62, 0
    v_mov_b32 v63, 0
    v_mov_b32 v64, 0
    v_mov_b32 v65, 0
    v_mov_b32 v66, 0
    v_mov_b32 v67, 0
    v_mov_b32 v68, 0
    v_mov_b32 v69, 0
    v_mov_b32 v70, 0
    v_mov_b32 v71, 0
    s_lshl_b32 s58, s3, 2
    s_add_u32 s58, s58, 0x8800
    v_mov_b32 v8, 0x8800
    s_lshl_b32 s22, s3, 1
    s_add_u32 s22, s22, 2
    s_cmp_ge_u32 s22, 7
    s_movk_i32 s50, 2048
    s_cselect_b32 s50, -5120, s50
    s_lshl_b32 s22, s3, 1
    s_add_u32 s22, s22, 3
    s_cmp_ge_u32 s22, 7
    s_movk_i32 s51, 3072
    s_cselect_b32 s51, -4096, s51
    s_lshl_b32 s22, s3, 1
    s_add_u32 s22, s22, 4
    s_cmp_ge_u32 s22, 7
    s_movk_i32 s52, 4096
    s_cselect_b32 s52, -3072, s52
    s_lshl_b32 s22, s3, 1
    s_add_u32 s22, s22, 5
    s_cmp_ge_u32 s22, 7
    s_movk_i32 s53, 5120
    s_cselect_b32 s53, -2048, s53
    s_lshl_b32 s22, s3, 1
    s_add_u32 s22, s22, 6
    s_cmp_ge_u32 s22, 7
    s_movk_i32 s54, 6144
    s_cselect_b32 s54, -1024, s54
    .p2align 6
la0_A_loop:
    s_mov_b32 s91, 0
    v_mov_b32 v32, 0
    v_mov_b32 v33, 0
    v_mov_b32 v34, 0
    v_mov_b32 v35, 0
    v_mov_b32 v36, 0
    v_mov_b32 v37, 0
    v_mov_b32 v38, 0
    v_mov_b32 v39, 0
    v_mov_b32 v40, 0
    v_mov_b32 v41, 0
    v_mov_b32 v42, 0
    v_mov_b32 v43, 0
    v_mov_b32 v68, 0
    v_mov_b32 v69, 0
    v_mov_b32 v70, 0
    v_mov_b32 v71, 0
    v_add_u32 v12, s50, v0
    v_add_u32 v16, s51, v0
    v_add_u32 v20, s52, v0
    v_add_u32 v24, s53, v0
    v_add_u32 v28, s54, v0
    s_add_u32 s22, s44, 0
    s_add_u32 s23, s22, s57
    buffer_load_dwordx4 v[88:91], v0, s[8:11], s22 offen offset:0 sc1
    buffer_load_dwordx4 v[92:95], v0, s[8:11], s22 offen offset:1024 sc1
    buffer_load_dwordx4 v[96:99], v0, s[8:11], s22 offen offset:2048 sc1
    buffer_load_dwordx4 v[100:103], v0, s[8:11], s23 offen sc1
    s_add_u32 s22, s44, 14336
    s_add_u32 s23, s22, s57
    buffer_load_dwordx4 v[104:107], v0, s[8:11], s22 offen offset:0 sc1
    buffer_load_dwordx4 v[108:111], v0, s[8:11], s22 offen offset:1024 sc1
    buffer_load_dwordx4 v[112:115], v0, s[8:11], s22 offen offset:2048 sc1
    buffer_load_dwordx4 v[116:119], v0, s[8:11], s23 offen sc1
    s_waitcnt vmcnt(0)
    buffer_load_dwordx4 v[80:83], v5, s[8:11], s41 offen sc1
    buffer_load_dwordx4 v[84:87], v5, s[8:11], s42 offen sc1
    s_sleep 2
    s_nop 7
    .p2align 6
la0_A_poll:
    buffer_load_dwordx4 v[72:75], v5, s[8:11], s41 offen sc1
    buffer_load_dwordx4 v[76:79], v5, s[8:11], s42 offen sc1
    s_waitcnt vmcnt(3)
    ds_write_b128 v0, v[80:83]
    v_max3_u32 v13, v80, v81, v82
    v_max_u32 v13, v13, v83
    s_waitcnt vmcnt(2)
    ds_write_b128 v0, v[84:87] offset:1024
    v_max3_u32 v13, v13, v84, v85
    v_max3_u32 v13, v13, v86, v87
    v_cmp_eq_u32 vcc, -1, v13
    s_cbranch_vccnz la0_A_try0
la0_A_go:
    v_smfmac_f32_16x16x64_bf16 v[44:47], v[80:83], a[168:175], v4
    v_smfmac_f32_16x16x64_bf16 v[48:51], v[80:83], a[224:231], v4
    v_smfmac_f32_16x16x64_bf16 v[52:55], v[80:83], a[0:7], v4
    v_smfmac_f32_16x16x64_bf16 v[56:59], v[80:83], a[8:15], v4
    s_waitcnt lgkmcnt(0)
    s_barrier
    ds_read_b128 v[12:15], v12
    v_smfmac_f32_16x16x64_bf16 v[60:63], v[80:83], a[16:23], v4
    ds_read_b128 v[16:19], v16
    v_smfmac_f32_16x16x64_bf16 v[64:67], v[80:83], a[24:31], v4
    ds_read_b128 v[20:23], v20
    v_smfmac_f32_16x16x64_bf16 v[68:71], v[80:83], a[32:39], v4
    ds_read_b128 v[24:27], v24
    v_smfmac_f32_16x16x64_bf16 v[44:47], v[84:87], a[176:183], v4
    ds_read_b128 v[28:31], v28
    v_smfmac_f32_16x16x64_bf16 v[48:51], v[84:87], a[232:239], v4
    v_smfmac_f32_16x16x64_bf16 v[52:55], v[84:87], a[40:47], v4
    v_smfmac_f32_16x16x64_bf16 v[56:59], v[84:87], a[48:55], v4
    v_smfmac_f32_16x16x64_bf16 v[60:63], v[84:87], a[56:63], v4
    v_smfmac_f32_16x16x64_bf16 v[64:67], v[84:87], a[64:71], v4
    v_smfmac_f32_16x16x64_bf16 v[68:71], v[84:87], a[72:79], v4
    s_waitcnt vmcnt(0) lgkmcnt(4)
    v_smfmac_f32_16x16x64_bf16 v[44:47], v[12:15], a[184:191], v4
    ds_read2_b32 v[72:73], v6 offset0:0 offset1:8
    v_smfmac_f32_16x16x64_bf16 v[48:51], v[12:15], a[240:247], v4
    ds_read2_b32 v[74:75], v6 offset0:1 offset1:9
    v_smfmac_f32_16x16x64_bf16 v[52:55], v[12:15], a[80:87], v4
    ds_read2_b32 v[76:77], v6 offset0:128 offset1:136
    v_smfmac_f32_16x16x64_bf16 v[56:59], v[12:15], a[88:95], v4
    ds_read2_b32 v[78:79], v6 offset0:129 offset1:137
    v_smfmac_f32_16x16x64_bf16 v[60:63], v[12:15], a[96:103], v4
    v_add_u32 v6, 1024, v6
    v_smfmac_f32_16x16x64_bf16 v[64:67], v[12:15], a[104:111], v4
    s_waitcnt lgkmcnt(4)
    v_smfmac_f32_16x16x64_bf16 v[44:47], v[16:19], a[192:199], v4
    ds_read2_b32 v[80:81], v6 offset0:0 offset1:8
    v_smfmac_f32_16x16x64_bf16 v[44:47], v[20:23], a[200:207], v4
    ds_read2_b32 v[82:83], v6 offset0:1 offset1:9
    v_smfmac_f32_16x16x64_bf16 v[44:47], v[24:27], a[208:215], v4
    v_add_u32 v6, s56, v6
    v_smfmac_f32_16x16x64_bf16 v[44:47], v[28:31], a[216:223], v4
    ds_read2_b32 v[84:85], v6 offset0:0 offset1:8
    v_smfmac_f32_16x16x64_bf16 v[48:51], v[16:19], a[248:255], v4
    ds_read2_b32 v[86:87], v6 offset0:1 offset1:9
    v_smfmac_f32_16x16x64_bf16 v[48:51], v[20:23], v[200:207], v4
    v_subrev_u32 v6, s55, v6
    v_smfmac_f32_16x16x64_bf16 v[48:51], v[24:27], v[208:215], v4
    v_add_f32 v44, v44, v46
    v_smfmac_f32_16x16x64_bf16 v[48:51], v[28:31], v[216:223], v4
    v_add_f32 v45, v45, v47
    v_smfmac_f32_16x16x64_bf16 v[52:55], v[16:19], a[120:127], v4
    v_smfmac_f32_16x16x64_bf16 v[52:55], v[20:23], a[160:167], v4
    v_smfmac_f32_16x16x64_bf16 v[52:55], v[24:27], v[152:159], v4
    v_add_f32 v48, v48, v50
    v_smfmac_f32_16x16x64_bf16 v[52:55], v[28:31], v[192:199], v4
    v_add_f32 v49, v49, v51
    v_smfmac_f32_16x16x64_bf16 v[56:59], v[16:19], a[128:135], v4
    v_cvt_pk_bf16_f32 v46, v44, v48
    v_smfmac_f32_16x16x64_bf16 v[56:59], v[20:23], v[120:127], v4
    v_cvt_pk_bf16_f32 v47, v45, v49
    v_smfmac_f32_16x16x64_bf16 v[56:59], v[24:27], v[160:167], v4
    v_add_f32 v52, v52, v54
    ds_write_b32 v9, v46 offset:0
    v_smfmac_f32_16x16x64_bf16 v[56:59], v[28:31], v[224:231], v4
    v_add_f32 v53, v53, v55
    ds_write_b32 v9, v47 offset:320
    v_smfmac_f32_16x16x64_bf16 v[60:63], v[16:19], a[136:143], v4
    v_smfmac_f32_16x16x64_bf16 v[60:63], v[20:23], v[128:135], v4
    v_add_f32 v56, v56, v58
    v_smfmac_f32_16x16x64_bf16 v[60:63], v[24:27], v[168:175], v4
    v_add_f32 v57, v57, v59
    v_smfmac_f32_16x16x64_bf16 v[60:63], v[28:31], v[232:239], v4
    v_cvt_pk_bf16_f32 v54, v52, v56
    v_smfmac_f32_16x16x64_bf16 v[64:67], v[16:19], a[144:151], v4
    v_cvt_pk_bf16_f32 v55, v53, v57
    v_smfmac_f32_16x16x64_bf16 v[64:67], v[20:23], v[136:143], v4
    ds_write_b32 v9, v54 offset:64
    v_smfmac_f32_16x16x64_bf16 v[64:67], v[24:27], v[176:183], v4
    ds_write_b32 v9, v55 offset:384
    v_smfmac_f32_16x16x64_bf16 v[64:67], v[28:31], v[240:247], v4
    ds_read_b128 v[48:51], v11
    v_smfmac_f32_16x16x64_bf16 v[68:71], v[12:15], a[112:119], v4
    v_add_f32 v60, v60, v62
    v_smfmac_f32_16x16x64_bf16 v[68:71], v[16:19], a[152:159], v4
    v_add_f32 v61, v61, v63
    v_smfmac_f32_16x16x64_bf16 v[68:71], v[20:23], v[144:151], v4
    v_add_f32 v64, v64, v66
    v_smfmac_f32_16x16x64_bf16 v[68:71], v[24:27], v[184:191], v4
    v_add_f32 v65, v65, v67
    v_smfmac_f32_16x16x64_bf16 v[68:71], v[28:31], v[248:255], v4
    v_cvt_pk_bf16_f32 v62, v60, v64
    v_cvt_pk_bf16_f32 v63, v61, v65
    ds_write_b32 v9, v62 offset:128
    ds_write_b32 v9, v63 offset:448
    s_nop 3
    v_pk_add_f32 v[68:69], v[68:69], v[70:71]
    v_cvt_pk_bf16_f32 v70, v68, v69
    ds_write_b16 v10, v70
    ds_write_b16_d16_hi v10, v70 offset:320
    ds_read_b128 v[56:59], v11 offset:128
    s_waitcnt lgkmcnt(5)
    v_smfmac_f32_16x16x64_bf16 v[32:35], v[48:51], v[72:79], v4
    v_smfmac_f32_16x16x64_bf16 v[36:39], v[48:51], v[88:95], v4
    v_smfmac_f32_16x16x64_bf16 v[40:43], v[48:51], v[104:111], v4
    s_waitcnt lgkmcnt(0)
    v_smfmac_f32_16x16x64_bf16 v[32:35], v[56:59], v[80:87], v4
    v_smfmac_f32_16x16x64_bf16 v[36:39], v[56:59], v[96:103], v4
    v_smfmac_f32_16x16x64_bf16 v[40:43], v[56:59], v[112:119], v4
    v_mov_b32 v71, -1
    s_nop 0
    v_pk_add_f32 v[44:45], v[32:33], v[34:35]
    ds_write_b32 v3, v44
    ds_write_b32 v3, v45 offset:512
    v_add_f32 v46, v36, v38
    v_add_f32 v52, v37, v39
    s_nop 0
    v_add_f32 v47, v40, v42
    ds_write_b64 v7, v[46:47]
    v_add_f32 v53, v41, v43
    ds_write_b64 v7, v[52:53] offset:512
    s_waitcnt lgkmcnt(0)
    s_barrier
    ds_read_b128 v[60:63], v2
    ds_read_b128 v[64:67], v2 offset:4096
    s_waitcnt lgkmcnt(1)
    v_pk_add_f32 v[60:61], v[60:61], v[62:63]
    s_waitcnt lgkmcnt(0)
    v_pk_add_f32 v[64:65], v[64:65], v[66:67]
    v_pk_add_f32 v[60:61], v[60:61], v[64:65]
    v_exp_f32 v62, v60
    v_exp_f32 v63, v61
    s_nop 0
    v_add_f32 v68, v62, v63
    s_nop 1
    v_add_f32_dpp v68, v68, v68 quad_perm:[1,0,3,2] row_mask:0xf bank_mask:0xf
    s_nop 1
    v_add_f32_dpp v68, v68, v68 quad_perm:[2,3,0,1] row_mask:0xf bank_mask:0xf
    s_nop 1
    v_add_f32_dpp v68, v68, v68 row_half_mirror row_mask:0xf bank_mask:0xf
    s_nop 1
    v_add_f32_dpp v68, v68, v68 row_mirror row_mask:0xf bank_mask:0xf
    v_mov_b32 v69, v68
    s_nop 1
    v_permlane16_swap_b32 v68, v69
    v_add_f32 v68, v68, v69
    v_subrev_u32 v69, s46, v68
    v_rcp_f32 v68, v68
    v_cmp_le_u32 vcc, s47, v69
    v_pk_mul_f32 v[62:63], v[62:63], v[68:69] op_sel_hi:[1,0]
    v_cvt_pk_bf16_f32 v69, v62, v63
    s_cbranch_vccnz la0_A_slowb
la0_A_normb:
    buffer_store_dword v69, v1, s[8:11], s43 offen
    v_mov_b32 v44, 0
    v_mov_b32 v45, 0
    v_mov_b32 v46, 0
    v_mov_b32 v47, 0
    v_mov_b32 v48, 0
    v_mov_b32 v49, 0
    v_mov_b32 v50, 0
    v_mov_b32 v51, 0
    v_mov_b32 v52, 0
    v_mov_b32 v53, 0
    v_mov_b32 v54, 0
    v_mov_b32 v55, 0
    v_mov_b32 v56, 0
    v_mov_b32 v57, 0
    v_mov_b32 v58, 0
    v_mov_b32 v59, 0
    v_mov_b32 v60, 0
    v_mov_b32 v61, 0
    v_mov_b32 v62, 0
    v_mov_b32 v63, 0
    v_mov_b32 v64, 0
    v_mov_b32 v65, 0
    v_mov_b32 v66, 0
    v_mov_b32 v67, 0
    buffer_store_dword v71, v1, s[8:11], s45 offen
la0_A_cut:
    s_add_u32 s40, s40, 1
    s_add_u32 s44, s44, 28672
    s_and_b32 s22, s40, 3
    s_mul_i32 s41, s22, 7168
    s_add_u32 s41, s41, 0x4200000
    s_add_u32 s41, s41, s84
    s_add_u32 s42, s41, s35
    s_mul_i32 s43, s22, 10240
    s_add_u32 s43, s43, 0x4208000
    s_add_u32 s43, s43, s84
    s_xor_b32 s22, s22, 2
    s_mul_i32 s45, s22, 10240
    s_add_u32 s45, s45, 0x4208000
    s_add_u32 s45, s45, s84
    s_cmp_eq_u32 s40, 4
    s_cbranch_scc1 la0_A_all
    s_cmp_lt_u32 s40, 63
    s_cbranch_scc1 la0_A_loop
    s_branch la0_job
la0_A_all:
    v_mov_b32 v28, v2
    v_mov_b32 v29, v3
    s_cmp_eq_u32 s89, 0
    s_cbranch_scc1 wt_5_ok
    s_mov_b32 s91, 0
    v_mbcnt_lo_u32_b32 v2, -1, 0
    v_mbcnt_hi_u32_b32 v2, -1, v2
    v_lshlrev_b32 v2, 8, v2
    s_mov_b32 s22, 0x428a000
    s_add_u32 s22, s22, s84
wt_5:
    buffer_load_dword v30, v2, s[8:11], s22 offen sc1
    buffer_load_dword v31, v2, s[8:11], s22 offen offset:128 sc1
    s_waitcnt vmcnt(0)
    v_min_u32 v3, v30, v31
    v_cmp_eq_u32 vcc, 0, v3
    s_cbranch_vccz wt_5_ok
    s_sleep 2
    s_add_u32 s91, s91, 1
    s_cmp_lt_u32 s91, s90
    s_cbranch_scc1 wt_5
    s_mov_b32 s90, 0
    s_branch wt_5_ok
wt_5_ok:
    v_mov_b32 v2, v28
    v_mov_b32 v3, v29
    s_branch la0_A_loop
la0_A_again:
    s_add_u32 s91, s91, 1
    s_cmp_lt_u32 s91, s90
    s_cbranch_scc1 la0_A_poll
    s_mov_b32 s90, 0
    s_branch la0_A_go
    .p2align 6
la0_A_try0:
    buffer_load_dwordx4 v[80:83], v5, s[8:11], s41 offen sc1
    buffer_load_dwordx4 v[84:87], v5, s[8:11], s42 offen sc1
    s_waitcnt vmcnt(3)
    ds_write_b128 v0, v[72:75]
    v_max3_u32 v13, v72, v73, v74
    v_max_u32 v13, v13, v75
    s_waitcnt vmcnt(2)
    ds_write_b128 v0, v[76:79] offset:1024
    v_max3_u32 v13, v13, v76, v77
    v_max3_u32 v13, v13, v78, v79
    v_cmp_eq_u32 vcc, -1, v13
    s_cbranch_vccnz la0_A_again
    v_smfmac_f32_16x16x64_bf16 v[44:47], v[72:75], a[168:175], v4
    v_smfmac_f32_16x16x64_bf16 v[48:51], v[72:75], a[224:231], v4
    v_smfmac_f32_16x16x64_bf16 v[52:55], v[72:75], a[0:7], v4
    v_smfmac_f32_16x16x64_bf16 v[56:59], v[72:75], a[8:15], v4
    s_waitcnt lgkmcnt(0)
    s_barrier
    ds_read_b128 v[12:15], v12
    v_smfmac_f32_16x16x64_bf16 v[60:63], v[72:75], a[16:23], v4
    ds_read_b128 v[16:19], v16
    v_smfmac_f32_16x16x64_bf16 v[64:67], v[72:75], a[24:31], v4
    ds_read_b128 v[20:23], v20
    v_smfmac_f32_16x16x64_bf16 v[68:71], v[72:75], a[32:39], v4
    ds_read_b128 v[24:27], v24
    v_smfmac_f32_16x16x64_bf16 v[44:47], v[76:79], a[176:183], v4
    ds_read_b128 v[28:31], v28
    v_smfmac_f32_16x16x64_bf16 v[48:51], v[76:79], a[232:239], v4
    v_smfmac_f32_16x16x64_bf16 v[52:55], v[76:79], a[40:47], v4
    v_smfmac_f32_16x16x64_bf16 v[56:59], v[76:79], a[48:55], v4
    v_smfmac_f32_16x16x64_bf16 v[60:63], v[76:79], a[56:63], v4
    v_smfmac_f32_16x16x64_bf16 v[64:67], v[76:79], a[64:71], v4
    v_smfmac_f32_16x16x64_bf16 v[68:71], v[76:79], a[72:79], v4
    s_waitcnt vmcnt(0) lgkmcnt(4)
    v_smfmac_f32_16x16x64_bf16 v[44:47], v[12:15], a[184:191], v4
    ds_read2_b32 v[72:73], v6 offset0:0 offset1:8
    v_smfmac_f32_16x16x64_bf16 v[48:51], v[12:15], a[240:247], v4
    ds_read2_b32 v[74:75], v6 offset0:1 offset1:9
    v_smfmac_f32_16x16x64_bf16 v[52:55], v[12:15], a[80:87], v4
    ds_read2_b32 v[76:77], v6 offset0:128 offset1:136
    v_smfmac_f32_16x16x64_bf16 v[56:59], v[12:15], a[88:95], v4
    ds_read2_b32 v[78:79], v6 offset0:129 offset1:137
    v_smfmac_f32_16x16x64_bf16 v[60:63], v[12:15], a[96:103], v4
    v_add_u32 v6, 1024, v6
    v_smfmac_f32_16x16x64_bf16 v[64:67], v[12:15], a[104:111], v4
    s_waitcnt lgkmcnt(4)
    v_smfmac_f32_16x16x64_bf16 v[44:47], v[16:19], a[192:199], v4
    ds_read2_b32 v[80:81], v6 offset0:0 offset1:8
    v_smfmac_f32_16x16x64_bf16 v[44:47], v[20:23], a[200:207], v4
    ds_read2_b32 v[82:83], v6 offset0:1 offset1:9
    v_smfmac_f32_16x16x64_bf16 v[44:47], v[24:27], a[208:215], v4
    v_add_u32 v6, s56, v6
    v_smfmac_f32_16x16x64_bf16 v[44:47], v[28:31], a[216:223], v4
    ds_read2_b32 v[84:85], v6 offset0:0 offset1:8
    v_smfmac_f32_16x16x64_bf16 v[48:51], v[16:19], a[248:255], v4
    ds_read2_b32 v[86:87], v6 offset0:1 offset1:9
    v_smfmac_f32_16x16x64_bf16 v[48:51], v[20:23], v[200:207], v4
    v_subrev_u32 v6, s55, v6
    v_smfmac_f32_16x16x64_bf16 v[48:51], v[24:27], v[208:215], v4
    v_add_f32 v44, v44, v46
    v_smfmac_f32_16x16x64_bf16 v[48:51], v[28:31], v[216:223], v4
    v_add_f32 v45, v45, v47
    v_smfmac_f32_16x16x64_bf16 v[52:55], v[16:19], a[120:127], v4
    v_smfmac_f32_16x16x64_bf16 v[52:55], v[20:23], a[160:167], v4
    v_smfmac_f32_16x16x64_bf16 v[52:55], v[24:27], v[152:159], v4
    v_add_f32 v48, v48, v50
    v_smfmac_f32_16x16x64_bf16 v[52:55], v[28:31], v[192:199], v4
    v_add_f32 v49, v49, v51
    v_smfmac_f32_16x16x64_bf16 v[56:59], v[16:19], a[128:135], v4
    v_cvt_pk_bf16_f32 v46, v44, v48
    v_smfmac_f32_16x16x64_bf16 v[56:59], v[20:23], v[120:127], v4
    v_cvt_pk_bf16_f32 v47, v45, v49
    v_smfmac_f32_16x16x64_bf16 v[56:59], v[24:27], v[160:167], v4
    v_add_f32 v52, v52, v54
    ds_write_b32 v9, v46 offset:0
    v_smfmac_f32_16x16x64_bf16 v[56:59], v[28:31], v[224:231], v4
    v_add_f32 v53, v53, v55
    ds_write_b32 v9, v47 offset:320
    v_smfmac_f32_16x16x64_bf16 v[60:63], v[16:19], a[136:143], v4
    v_smfmac_f32_16x16x64_bf16 v[60:63], v[20:23], v[128:135], v4
    v_add_f32 v56, v56, v58
    v_smfmac_f32_16x16x64_bf16 v[60:63], v[24:27], v[168:175], v4
    v_add_f32 v57, v57, v59
    v_smfmac_f32_16x16x64_bf16 v[60:63], v[28:31], v[232:239], v4
    v_cvt_pk_bf16_f32 v54, v52, v56
    v_smfmac_f32_16x16x64_bf16 v[64:67], v[16:19], a[144:151], v4
    v_cvt_pk_bf16_f32 v55, v53, v57
    v_smfmac_f32_16x16x64_bf16 v[64:67], v[20:23], v[136:143], v4
    ds_write_b32 v9, v54 offset:64
    v_smfmac_f32_16x16x64_bf16 v[64:67], v[24:27], v[176:183], v4
    ds_write_b32 v9, v55 offset:384
    v_smfmac_f32_16x16x64_bf16 v[64:67], v[28:31], v[240:247], v4
    ds_read_b128 v[48:51], v11
    v_smfmac_f32_16x16x64_bf16 v[68:71], v[12:15], a[112:119], v4
    v_add_f32 v60, v60, v62
    v_smfmac_f32_16x16x64_bf16 v[68:71], v[16:19], a[152:159], v4
    v_add_f32 v61, v61, v63
    v_smfmac_f32_16x16x64_bf16 v[68:71], v[20:23], v[144:151], v4
    v_add_f32 v64, v64, v66
    v_smfmac_f32_16x16x64_bf16 v[68:71], v[24:27], v[184:191], v4
    v_add_f32 v65, v65, v67
    v_smfmac_f32_16x16x64_bf16 v[68:71], v[28:31], v[248:255], v4
    v_cvt_pk_bf16_f32 v62, v60, v64
    v_cvt_pk_bf16_f32 v63, v61, v65
    ds_write_b32 v9, v62 offset:128
    ds_write_b32 v9, v63 offset:448
    s_nop 3
    v_pk_add_f32 v[68:69], v[68:69], v[70:71]
    v_cvt_pk_bf16_f32 v70, v68, v69
    ds_write_b16 v10, v70
    ds_write_b16_d16_hi v10, v70 offset:320
    ds_read_b128 v[56:59], v11 offset:128
    s_waitcnt lgkmcnt(5)
    v_smfmac_f32_16x16x64_bf16 v[32:35], v[48:51], v[72:79], v4
    v_smfmac_f32_16x16x64_bf16 v[36:39], v[48:51], v[88:95], v4
    v_smfmac_f32_16x16x64_bf16 v[40:43], v[48:51], v[104:111], v4
    s_waitcnt lgkmcnt(0)
    v_smfmac_f32_16x16x64_bf16 v[32:35], v[56:59], v[80:87], v4
    v_smfmac_f32_16x16x64_bf16 v[36:39], v[56:59], v[96:103], v4
    v_smfmac_f32_16x16x64_bf16 v[40:43], v[56:59], v[112:119], v4
    v_mov_b32 v71, -1
    s_nop 0
    v_pk_add_f32 v[44:45], v[32:33], v[34:35]
    ds_write_b32 v3, v44
    ds_write_b32 v3, v45 offset:512
    v_add_f32 v46, v36, v38
    v_add_f32 v52, v37, v39
    s_nop 0
    v_add_f32 v47, v40, v42
    ds_write_b64 v7, v[46:47]
    v_add_f32 v53, v41, v43
    ds_write_b64 v7, v[52:53] offset:512
    s_waitcnt lgkmcnt(0)
    s_barrier
    ds_read_b128 v[60:63], v2
    ds_read_b128 v[64:67], v2 offset:4096
    s_waitcnt lgkmcnt(1)
    v_pk_add_f32 v[60:61], v[60:61], v[62:63]
    s_waitcnt lgkmcnt(0)
    v_pk_add_f32 v[64:65], v[64:65], v[66:67]
    v_pk_add_f32 v[60:61], v[60:61], v[64:65]
    v_exp_f32 v62, v60
    v_exp_f32 v63, v61
    s_nop 0
    v_add_f32 v68, v62, v63
    s_nop 1
    v_add_f32_dpp v68, v68, v68 quad_perm:[1,0,3,2] row_mask:0xf bank_mask:0xf
    s_nop 1
    v_add_f32_dpp v68, v68, v68 quad_perm:[2,3,0,1] row_mask:0xf bank_mask:0xf
    s_nop 1
    v_add_f32_dpp v68, v68, v68 row_half_mirror row_mask:0xf bank_mask:0xf
    s_nop 1
    v_add_f32_dpp v68, v68, v68 row_mirror row_mask:0xf bank_mask:0xf
    v_mov_b32 v69, v68
    s_nop 1
    v_permlane16_swap_b32 v68, v69
    v_add_f32 v68, v68, v69
    v_subrev_u32 v69, s46, v68
    v_rcp_f32 v68, v68
    v_cmp_le_u32 vcc, s47, v69
    v_pk_mul_f32 v[62:63], v[62:63], v[68:69] op_sel_hi:[1,0]
    v_cvt_pk_bf16_f32 v69, v62, v63
    s_cbranch_vccnz la0_A_slowa
la0_A_norma:
    buffer_store_dword v69, v1, s[8:11], s43 offen
    v_mov_b32 v44, 0
    v_mov_b32 v45, 0
    v_mov_b32 v46, 0
    v_mov_b32 v47, 0
    v_mov_b32 v48, 0
    v_mov_b32 v49, 0
    v_mov_b32 v50, 0
    v_mov_b32 v51, 0
    v_mov_b32 v52, 0
    v_mov_b32 v53, 0
    v_mov_b32 v54, 0
    v_mov_b32 v55, 0
    v_mov_b32 v56, 0
    v_mov_b32 v57, 0
    v_mov_b32 v58, 0
    v_mov_b32 v59, 0
    v_mov_b32 v60, 0
    v_mov_b32 v61, 0
    v_mov_b32 v62, 0
    v_mov_b32 v63, 0
    v_mov_b32 v64, 0
    v_mov_b32 v65, 0
    v_mov_b32 v66, 0
    v_mov_b32 v67, 0
    buffer_store_dword v71, v1, s[8:11], s45 offen
    s_branch la0_A_cut
la0_A_slowa:
    v_max_f32 v68, v60, v61
    s_nop 1
    v_max_f32_dpp v68, v68, v68 quad_perm:[1,0,3,2] row_mask:0xf bank_mask:0xf
    s_nop 1
    v_max_f32_dpp v68, v68, v68 quad_perm:[2,3,0,1] row_mask:0xf bank_mask:0xf
    s_nop 1
    v_max_f32_dpp v68, v68, v68 row_half_mirror row_mask:0xf bank_mask:0xf
    s_nop 1
    v_max_f32_dpp v68, v68, v68 row_mirror row_mask:0xf bank_mask:0xf
    v_mov_b32 v69, v68
    s_nop 1
    v_permlane16_swap_b32 v68, v69
    v_max_f32 v68, v68, v69
    v_sub_f32 v62, v60, v68
    v_sub_f32 v63, v61, v68
    v_exp_f32 v62, v62
    v_exp_f32 v63, v63
    s_nop 0
    v_add_f32 v68, v62, v63
    s_nop 1
    v_add_f32_dpp v68, v68, v68 quad_perm:[1,0,3,2] row_mask:0xf bank_mask:0xf
    s_nop 1
    v_add_f32_dpp v68, v68, v68 quad_perm:[2,3,0,1] row_mask:0xf bank_mask:0xf
    s_nop 1
    v_add_f32_dpp v68, v68, v68 row_half_mirror row_mask:0xf bank_mask:0xf
    s_nop 1
    v_add_f32_dpp v68, v68, v68 row_mirror row_mask:0xf bank_mask:0xf
    v_mov_b32 v69, v68
    s_nop 1
    v_permlane16_swap_b32 v68, v69
    v_add_f32 v68, v68, v69
    v_rcp_f32 v68, v68
    s_nop 0
    v_mul_f32 v62, v62, v68
    v_mul_f32 v63, v63, v68
    v_cvt_pk_bf16_f32 v69, v62, v63
    v_min_u32 v69, 0xfffffffe, v69
    s_cmp_lg_u32 s88, 2
    s_cbranch_scc1 la0_A_norma
    buffer_store_dword v69, v1, s[8:11], s43 offen sc1
    buffer_store_dword v71, v1, s[8:11], s45 offen sc1
    v_mov_b32 v44, 0
    v_mov_b32 v45, 0
    v_mov_b32 v46, 0
    v_mov_b32 v47, 0
    v_mov_b32 v48, 0
    v_mov_b32 v49, 0
    v_mov_b32 v50, 0
    v_mov_b32 v51, 0
    v_mov_b32 v52, 0
    v_mov_b32 v53, 0
    v_mov_b32 v54, 0
    v_mov_b32 v55, 0
    v_mov_b32 v56, 0
    v_mov_b32 v57, 0
    v_mov_b32 v58, 0
    v_mov_b32 v59, 0
    v_mov_b32 v60, 0
    v_mov_b32 v61, 0
    v_mov_b32 v62, 0
    v_mov_b32 v63, 0
    v_mov_b32 v64, 0
    v_mov_b32 v65, 0
    v_mov_b32 v66, 0
    v_mov_b32 v67, 0
    s_branch la0_A_cut
la0_A_slowb:
    v_max_f32 v68, v60, v61
    s_nop 1
    v_max_f32_dpp v68, v68, v68 quad_perm:[1,0,3,2] row_mask:0xf bank_mask:0xf
    s_nop 1
    v_max_f32_dpp v68, v68, v68 quad_perm:[2,3,0,1] row_mask:0xf bank_mask:0xf
    s_nop 1
    v_max_f32_dpp v68, v68, v68 row_half_mirror row_mask:0xf bank_mask:0xf
    s_nop 1
    v_max_f32_dpp v68, v68, v68 row_mirror row_mask:0xf bank_mask:0xf
    v_mov_b32 v69, v68
    s_nop 1
    v_permlane16_swap_b32 v68, v69
    v_max_f32 v68, v68, v69
    v_sub_f32 v62, v60, v68
    v_sub_f32 v63, v61, v68
    v_exp_f32 v62, v62
    v_exp_f32 v63, v63
    s_nop 0
    v_add_f32 v68, v62, v63
    s_nop 1
    v_add_f32_dpp v68, v68, v68 quad_perm:[1,0,3,2] row_mask:0xf bank_mask:0xf
    s_nop 1
    v_add_f32_dpp v68, v68, v68 quad_perm:[2,3,0,1] row_mask:0xf bank_mask:0xf
    s_nop 1
    v_add_f32_dpp v68, v68, v68 row_half_mirror row_mask:0xf bank_mask:0xf
    s_nop 1
    v_add_f32_dpp v68, v68, v68 row_mirror row_mask:0xf bank_mask:0xf
    v_mov_b32 v69, v68
    s_nop 1
    v_permlane16_swap_b32 v68, v69
    v_add_f32 v68, v68, v69
    v_rcp_f32 v68, v68
    s_nop 0
    v_mul_f32 v62, v62, v68
    v_mul_f32 v63, v63, v68
    v_cvt_pk_bf16_f32 v69, v62, v63
    v_min_u32 v69, 0xfffffffe, v69
    s_cmp_lg_u32 s88, 2
    s_cbranch_scc1 la0_A_normb
    buffer_store_dword v69, v1, s[8:11], s43 offen sc1
    buffer_store_dword v71, v1, s[8:11], s45 offen sc1
    v_mov_b32 v44, 0
    v_mov_b32 v45, 0
    v_mov_b32 v46, 0
    v_mov_b32 v47, 0
    v_mov_b32 v48, 0
    v_mov_b32 v49, 0
    v_mov_b32 v50, 0
    v_mov_b32 v51, 0
    v_mov_b32 v52, 0
    v_mov_b32 v53, 0
    v_mov_b32 v54, 0
    v_mov_b32 v55, 0
    v_mov_b32 v56, 0
    v_mov_b32 v57, 0
    v_mov_b32 v58, 0
    v_mov_b32 v59, 0
    v_mov_b32 v60, 0
    v_mov_b32 v61, 0
    v_mov_b32 v62, 0
    v_mov_b32 v63, 0
    v_mov_b32 v64, 0
    v_mov_b32 v65, 0
    v_mov_b32 v66, 0
    v_mov_b32 v67, 0
    s_branch la0_A_cut
la0_B:
    s_waitcnt vmcnt(0) lgkmcnt(0)
    v_bfe_u32 v2, v1, 1, 1
    v_mov_b32 v3, 0xaaaa
    v_mul_u32_u24 v2, v2, v3
    v_add_u32 v4, 0x4444, v2
    v_bfe_u32 v5, v1, 2, 2
    v_lshlrev_b32 v5, 7, v5
    v_bfe_u32 v2, v1, 0, 1
    v_lshlrev_b32 v2, 6, v2
    v_add_u32 v5, v5, v2
    v_bfe_u32 v2, v1, 5, 1
    v_lshlrev_b32 v2, 9, v2
    v_add_u32 v5, v5, v2
    v_bfe_u32 v2, v1, 4, 1
    v_lshlrev_b32 v2, 5, v2
    v_add_u32 v5, v5, v2
    v_bfe_u32 v2, v1, 1, 1
    v_lshlrev_b32 v2, 4, v2
    v_add_u32 v5, v5, v2
    s_sub_u32 s20, s20, 16
    s_mul_i32 s22, s3, 112
    s_lshl_b32 s23, s20, 1
    s_add_u32 s22, s22, s23
    s_mul_i32 s22, s22, 14336
    s_add_u32 s22, s22, 0x0
    s_add_u32 s24, s22, 0
    s_add_u32 s25, s22, 14336
    s_add_u32 s26, s22, 401408
    s_add_u32 s27, s22, 415744
    s_add_u32 s28, s22, 802816
    s_add_u32 s29, s22, 817152
    s_add_u32 s30, s22, 1204224
    s_add_u32 s31, s22, 1218560
    v_lshlrev_b32 v16, 4, v1
    s_mul_i32 s22, s3, 3584
    s_lshl_b32 s23, s20, 6
    s_add_u32 s22, s22, s23
    s_lshl_b32 s50, s20, 9
    s_lshl_b32 s23, s3, 8
    s_add_u32 s50, s50, s23
    v_bfe_u32 v11, v1, 4, 2
    v_lshlrev_b32 v11, 6, v11
    v_bfe_u32 v2, v1, 3, 1
    v_lshlrev_b32 v2, 5, v2
    v_add_u32 v11, v11, v2
    v_bfe_u32 v2, v1, 0, 1
    v_lshlrev_b32 v2, 4, v2
    v_add_u32 v11, v11, v2
    v_bfe_u32 v2, v1, 1, 2
    v_lshlrev_b32 v2, 2, v2
    v_add_u32 v11, v11, v2
    v_add_u32 v11, s50, v11
    v_bfe_u32 v12, v1, 4, 2
    v_mul_u32_u24 v12, 0x380, v12
    v_bfe_u32 v2, v1, 0, 4
    v_lshlrev_b32 v2, 2, v2
    v_add_u32 v12, v12, v2
    v_add_u32 v12, s22, v12
    s_mov_b32 s41, 0x4200000
    s_add_u32 s41, s41, s84
    s_cmp_ge_u32 s3, 2
    s_cbranch_scc1 la0_B_nopub0
    buffer_load_dword v15, v12, s[12:15], 0 offen
    s_waitcnt vmcnt(0)
    v_min_u32 v15, 0xfffffffe, v15
    buffer_store_dword v15, v11, s[8:11], s41 offen sc1
    s_mov_b32 s46, 0x4212000
    s_add_u32 s46, s46, s84
    buffer_store_dword v15, v12, s[8:11], s46 offen sc1
la0_B_nopub0:
    s_mul_i32 s33, s3, 28672
    s_lshl_b32 s22, s3, 1
    s_add_u32 s22, s22, 0
    s_sub_u32 s23, s22, 7
    s_cmp_ge_u32 s22, 7
    s_cselect_b32 s22, s23, s22
    s_lshl_b32 s60, s22, 11
    s_lshl_b32 s22, s3, 1
    s_add_u32 s22, s22, 1
    s_sub_u32 s23, s22, 7
    s_cmp_ge_u32 s22, 7
    s_cselect_b32 s22, s23, s22
    s_lshl_b32 s61, s22, 11
    s_lshl_b32 s22, s3, 1
    s_add_u32 s22, s22, 2
    s_sub_u32 s23, s22, 7
    s_cmp_ge_u32 s22, 7
    s_cselect_b32 s22, s23, s22
    s_lshl_b32 s62, s22, 11
    s_lshl_b32 s22, s3, 1
    s_add_u32 s22, s22, 3
    s_sub_u32 s23, s22, 7
    s_cmp_ge_u32 s22, 7
    s_cselect_b32 s22, s23, s22
    s_lshl_b32 s63, s22, 11
    s_lshl_b32 s22, s3, 1
    s_add_u32 s22, s22, 4
    s_sub_u32 s23, s22, 7
    s_cmp_ge_u32 s22, 7
    s_cselect_b32 s22, s23, s22
    s_lshl_b32 s64, s22, 11
    s_lshl_b32 s22, s3, 1
    s_add_u32 s22, s22, 5
    s_sub_u32 s23, s22, 7
    s_cmp_ge_u32 s22, 7
    s_cselect_b32 s22, s23, s22
    s_lshl_b32 s65, s22, 11
    s_lshl_b32 s22, s3, 1
    s_add_u32 s22, s22, 6
    s_sub_u32 s23, s22, 7
    s_cmp_ge_u32 s22, 7
    s_cselect_b32 s22, s23, s22
    s_lshl_b32 s66, s22, 11
    s_add_u32 s22, s30, s60
    s_add_u32 m0, s33, 0
    s_nop 0
    buffer_load_dwordx4 v16, s[8:11], s22 offen offset:0 lds
    buffer_load_dwordx4 v16, s[8:11], s22 offen offset:1024 lds
    s_add_u32 s22, s30, s61
    s_add_u32 m0, s33, 2048
    s_nop 0
    buffer_load_dwordx4 v16, s[8:11], s22 offen offset:0 lds
    buffer_load_dwordx4 v16, s[8:11], s22 offen offset:1024 lds
    s_add_u32 s22, s30, s62
    s_add_u32 m0, s33, 4096
    s_nop 0
    buffer_load_dwordx4 v16, s[8:11], s22 offen offset:0 lds
    buffer_load_dwordx4 v16, s[8:11], s22 offen offset:1024 lds
    s_add_u32 s22, s30, s63
    s_add_u32 m0, s33, 6144
    s_nop 0
    buffer_load_dwordx4 v16, s[8:11], s22 offen offset:0 lds
    buffer_load_dwordx4 v16, s[8:11], s22 offen offset:1024 lds
    s_add_u32 s22, s30, s64
    s_add_u32 m0, s33, 8192
    s_nop 0
    buffer_load_dwordx4 v16, s[8:11], s22 offen offset:0 lds
    buffer_load_dwordx4 v16, s[8:11], s22 offen offset:1024 lds
    s_add_u32 s22, s30, s65
    s_add_u32 m0, s33, 10240
    s_nop 0
    buffer_load_dwordx4 v16, s[8:11], s22 offen offset:0 lds
    buffer_load_dwordx4 v16, s[8:11], s22 offen offset:1024 lds
    s_add_u32 s22, s30, s66
    s_add_u32 m0, s33, 12288
    s_nop 0
    buffer_load_dwordx4 v16, s[8:11], s22 offen offset:0 lds
    buffer_load_dwordx4 v16, s[8:11], s22 offen offset:1024 lds
    s_add_u32 s22, s31, s60
    s_add_u32 m0, s33, 14336
    s_nop 0
    buffer_load_dwordx4 v16, s[8:11], s22 offen offset:0 lds
    buffer_load_dwordx4 v16, s[8:11], s22 offen offset:1024 lds
    s_add_u32 s22, s31, s61
    s_add_u32 m0, s33, 16384
    s_nop 0
    buffer_load_dwordx4 v16, s[8:11], s22 offen offset:0 lds
    buffer_load_dwordx4 v16, s[8:11], s22 offen offset:1024 lds
    s_add_u32 s22, s31, s62
    s_add_u32 m0, s33, 18432
    s_nop 0
    buffer_load_dwordx4 v16, s[8:11], s22 offen offset:0 lds
    buffer_load_dwordx4 v16, s[8:11], s22 offen offset:1024 lds
    s_add_u32 s22, s31, s63
    s_add_u32 m0, s33, 20480
    s_nop 0
    buffer_load_dwordx4 v16, s[8:11], s22 offen offset:0 lds
    buffer_load_dwordx4 v16, s[8:11], s22 offen offset:1024 lds
    s_add_u32 s22, s31, s64
    s_add_u32 m0, s33, 22528
    s_nop 0
    buffer_load_dwordx4 v16, s[8:11], s22 offen offset:0 lds
    buffer_load_dwordx4 v16, s[8:11], s22 offen offset:1024 lds
    s_add_u32 s22, s31, s65
    s_add_u32 m0, s33, 24576
    s_nop 0
    buffer_load_dwordx4 v16, s[8:11], s22 offen offset:0 lds
    buffer_load_dwordx4 v16, s[8:11], s22 offen offset:1024 lds
    s_add_u32 s22, s31, s66
    s_add_u32 m0, s33, 26624
    s_nop 0
    buffer_load_dwordx4 v16, s[8:11], s22 offen offset:0 lds
    buffer_load_dwordx4 v16, s[8:11], s22 offen offset:1024 lds
    v_lshlrev_b32 v8, 4, v1
    s_lshl_b32 s34, s3, 13
    s_add_u32 s34, s34, 0x1f000
    s_mul_i32 s44, s3, 112
    s_lshl_b32 s22, s20, 1
    s_add_u32 s44, s44, s22
    s_lshl_b32 s44, s44, 10
    s_add_u32 s44, s44, 0x1c00000
    s_add_u32 s44, s44, s84
    s_lshl_b32 s22, s3, 9
    s_add_u32 s22, s22, 0x428e000
    s_add_u32 s22, s22, s84
    s_add_u32 s56, s4, s22
    s_addc_u32 s57, s5, 0
    s_add_u32 s22, s26, s60
    buffer_load_dwordx4 a[0:3], v16, s[8:11], s22 offen offset:0
    buffer_load_dwordx4 a[4:7], v16, s[8:11], s22 offen offset:1024
    s_add_u32 s22, s27, s60
    buffer_load_dwordx4 a[8:11], v16, s[8:11], s22 offen offset:0
    buffer_load_dwordx4 a[12:15], v16, s[8:11], s22 offen offset:1024
    s_add_u32 s22, s28, s60
    buffer_load_dwordx4 a[16:19], v16, s[8:11], s22 offen offset:0
    buffer_load_dwordx4 a[20:23], v16, s[8:11], s22 offen offset:1024
    s_add_u32 s22, s29, s60
    buffer_load_dwordx4 a[24:27], v16, s[8:11], s22 offen offset:0
    buffer_load_dwordx4 a[28:31], v16, s[8:11], s22 offen offset:1024
    s_add_u32 s22, s26, s61
    buffer_load_dwordx4 a[32:35], v16, s[8:11], s22 offen offset:0
    buffer_load_dwordx4 a[36:39], v16, s[8:11], s22 offen offset:1024
    s_add_u32 s22, s27, s61
    buffer_load_dwordx4 a[40:43], v16, s[8:11], s22 offen offset:0
    buffer_load_dwordx4 a[44:47], v16, s[8:11], s22 offen offset:1024
    s_add_u32 s22, s28, s61
    buffer_load_dwordx4 a[48:51], v16, s[8:11], s22 offen offset:0
    buffer_load_dwordx4 a[52:55], v16, s[8:11], s22 offen offset:1024
    s_add_u32 s22, s29, s61
    buffer_load_dwordx4 a[56:59], v16, s[8:11], s22 offen offset:0
    buffer_load_dwordx4 a[60:63], v16, s[8:11], s22 offen offset:1024
    s_add_u32 s22, s26, s62
    buffer_load_dwordx4 a[64:67], v16, s[8:11], s22 offen offset:0
    buffer_load_dwordx4 a[68:71], v16, s[8:11], s22 offen offset:1024
    s_add_u32 s22, s27, s62
    buffer_load_dwordx4 a[72:75], v16, s[8:11], s22 offen offset:0
    buffer_load_dwordx4 a[76:79], v16, s[8:11], s22 offen offset:1024
    s_add_u32 s22, s28, s62
    buffer_load_dwordx4 a[80:83], v16, s[8:11], s22 offen offset:0
    buffer_load_dwordx4 a[84:87], v16, s[8:11], s22 offen offset:1024
    s_add_u32 s22, s29, s62
    buffer_load_dwordx4 a[88:91], v16, s[8:11], s22 offen offset:0
    buffer_load_dwordx4 a[92:95], v16, s[8:11], s22 offen offset:1024
    s_add_u32 s22, s26, s63
    buffer_load_dwordx4 a[96:99], v16, s[8:11], s22 offen offset:0
    buffer_load_dwordx4 a[100:103], v16, s[8:11], s22 offen offset:1024
    s_add_u32 s22, s27, s63
    buffer_load_dwordx4 a[104:107], v16, s[8:11], s22 offen offset:0
    s_waitcnt vmcnt(20)
    buffer_load_dwordx4 a[108:111], v16, s[8:11], s22 offen offset:1024
    s_add_u32 s22, s28, s63
    buffer_load_dwordx4 a[112:115], v16, s[8:11], s22 offen offset:0
    buffer_load_dwordx4 a[116:119], v16, s[8:11], s22 offen offset:1024
    s_add_u32 s22, s29, s63
    buffer_load_dwordx4 a[120:123], v16, s[8:11], s22 offen offset:0
    buffer_load_dwordx4 a[124:127], v16, s[8:11], s22 offen offset:1024
    s_add_u32 s22, s26, s64
    buffer_load_dwordx4 a[128:131], v16, s[8:11], s22 offen offset:0
    buffer_load_dwordx4 a[132:135], v16, s[8:11], s22 offen offset:1024
    s_add_u32 s22, s27, s64
    buffer_load_dwordx4 a[136:139], v16, s[8:11], s22 offen offset:0
    buffer_load_dwordx4 a[140:143], v16, s[8:11], s22 offen offset:1024
    s_add_u32 s22, s28, s64
    buffer_load_dwordx4 a[144:147], v16, s[8:11], s22 offen offset:0
    buffer_load_dwordx4 a[148:151], v16, s[8:11], s22 offen offset:1024
    s_add_u32 s22, s29, s64
    buffer_load_dwordx4 a[152:155], v16, s[8:11], s22 offen offset:0
    buffer_load_dwordx4 a[156:159], v16, s[8:11], s22 offen offset:1024
    s_add_u32 s22, s26, s65
    buffer_load_dwordx4 a[160:163], v16, s[8:11], s22 offen offset:0
    buffer_load_dwordx4 a[164:167], v16, s[8:11], s22 offen offset:1024
    s_add_u32 s22, s27, s65
    buffer_load_dwordx4 v[176:179], v16, s[8:11], s22 offen offset:0
    buffer_load_dwordx4 v[180:183], v16, s[8:11], s22 offen offset:1024
    s_add_u32 s22, s28, s65
    buffer_load_dwordx4 v[184:187], v16, s[8:11], s22 offen offset:0
    buffer_load_dwordx4 v[188:191], v16, s[8:11], s22 offen offset:1024
    s_add_u32 s22, s29, s65
    buffer_load_dwordx4 v[192:195], v16, s[8:11], s22 offen offset:0
    buffer_load_dwordx4 v[196:199], v16, s[8:11], s22 offen offset:1024
    s_add_u32 s22, s26, s66
    buffer_load_dwordx4 v[224:227], v16, s[8:11], s22 offen offset:0
    buffer_load_dwordx4 v[228:231], v16, s[8:11], s22 offen offset:1024
    s_add_u32 s22, s27, s66
    buffer_load_dwordx4 v[232:235], v16, s[8:11], s22 offen offset:0
    buffer_load_dwordx4 v[236:239], v16, s[8:11], s22 offen offset:1024
    s_add_u32 s22, s28, s66
    buffer_load_dwordx4 v[240:243], v16, s[8:11], s22 offen offset:0
    buffer_load_dwordx4 v[244:247], v16, s[8:11], s22 offen offset:1024
    s_add_u32 s22, s29, s66
    buffer_load_dwordx4 v[248:251], v16, s[8:11], s22 offen offset:0
    buffer_load_dwordx4 v[252:255], v16, s[8:11], s22 offen offset:1024
    s_waitcnt vmcnt(12)
    s_load_dword s72, s[56:57], 0x0 glc
    s_load_dword s73, s[56:57], 0x80 glc
    s_load_dword s74, s[56:57], 0x100 glc
    s_load_dword s75, s[56:57], 0x180 glc
    s_mov_b32 s58, s22
    s_waitcnt lgkmcnt(0)
    s_min_u32 s72, s72, s73
    s_min_u32 s74, s74, s75
    s_min_u32 s59, s72, s74
    s_cmp_lt_u32 s59, 7
    s_cbranch_scc1 la0_B_noearly
    s_add_u32 s22, s44, 0
    s_add_u32 m0, s34, 0
    s_nop 0
    buffer_load_dwordx4 v8, s[8:11], s22 offen offset:0 sc1 lds
    s_add_u32 m0, s34, 1024
    s_nop 0
    buffer_load_dwordx4 v8, s[8:11], s22 offen offset:1024 sc1 lds
    s_add_u32 s22, s44, 28672
    s_add_u32 m0, s34, 1024
    s_nop 0
    buffer_load_dwordx4 v8, s[8:11], s22 offen offset:0 sc1 lds
    s_add_u32 m0, s34, 2048
    s_nop 0
    buffer_load_dwordx4 v8, s[8:11], s22 offen offset:1024 sc1 lds
    s_add_u32 s22, s44, 57344
    s_add_u32 m0, s34, 4096
    s_nop 0
    buffer_load_dwordx4 v8, s[8:11], s22 offen offset:0 sc1 lds
    s_add_u32 m0, s34, 5120
    s_nop 0
    buffer_load_dwordx4 v8, s[8:11], s22 offen offset:1024 sc1 lds
    s_add_u32 s22, s44, 86016
    s_add_u32 m0, s34, 5120
    s_nop 0
    buffer_load_dwordx4 v8, s[8:11], s22 offen offset:0 sc1 lds
    s_add_u32 m0, s34, 6144
    s_nop 0
    buffer_load_dwordx4 v8, s[8:11], s22 offen offset:1024 sc1 lds
la0_B_noearly:
    s_mov_b32 s22, s58
    s_cmp_lg_u32 s89, 0
    s_cbranch_scc1 la0_B_pre
    s_add_u32 s22, s24, s60
    buffer_load_dwordx4 a[168:171], v16, s[8:11], s22 offen offset:0
    buffer_load_dwordx4 a[172:175], v16, s[8:11], s22 offen offset:1024
    s_add_u32 s22, s25, s60
    buffer_load_dwordx4 a[224:227], v16, s[8:11], s22 offen offset:0
    buffer_load_dwordx4 a[228:231], v16, s[8:11], s22 offen offset:1024
    s_add_u32 s22, s24, s61
    buffer_load_dwordx4 a[176:179], v16, s[8:11], s22 offen offset:0
    buffer_load_dwordx4 a[180:183], v16, s[8:11], s22 offen offset:1024
    s_add_u32 s22, s25, s61
    buffer_load_dwordx4 a[232:235], v16, s[8:11], s22 offen offset:0
    buffer_load_dwordx4 a[236:239], v16, s[8:11], s22 offen offset:1024
    s_add_u32 s22, s24, s62
    buffer_load_dwordx4 a[184:187], v16, s[8:11], s22 offen offset:0
    buffer_load_dwordx4 a[188:191], v16, s[8:11], s22 offen offset:1024
    s_add_u32 s22, s25, s62
    buffer_load_dwordx4 a[240:243], v16, s[8:11], s22 offen offset:0
    buffer_load_dwordx4 a[244:247], v16, s[8:11], s22 offen offset:1024
    s_add_u32 s22, s24, s63
    buffer_load_dwordx4 a[192:195], v16, s[8:11], s22 offen offset:0
    buffer_load_dwordx4 a[196:199], v16, s[8:11], s22 offen offset:1024
    s_add_u32 s22, s25, s63
    buffer_load_dwordx4 a[248:251], v16, s[8:11], s22 offen offset:0
    buffer_load_dwordx4 a[252:255], v16, s[8:11], s22 offen offset:1024
    s_add_u32 s22, s24, s64
    buffer_load_dwordx4 a[200:203], v16, s[8:11], s22 offen offset:0
    buffer_load_dwordx4 a[204:207], v16, s[8:11], s22 offen offset:1024
    s_add_u32 s22, s25, s64
    buffer_load_dwordx4 v[200:203], v16, s[8:11], s22 offen offset:0
    buffer_load_dwordx4 v[204:207], v16, s[8:11], s22 offen offset:1024
    s_add_u32 s22, s24, s65
    buffer_load_dwordx4 a[208:211], v16, s[8:11], s22 offen offset:0
    buffer_load_dwordx4 a[212:215], v16, s[8:11], s22 offen offset:1024
    s_add_u32 s22, s25, s65
    buffer_load_dwordx4 v[208:211], v16, s[8:11], s22 offen offset:0
    buffer_load_dwordx4 v[212:215], v16, s[8:11], s22 offen offset:1024
    s_add_u32 s22, s24, s66
    buffer_load_dwordx4 a[216:219], v16, s[8:11], s22 offen offset:0
    buffer_load_dwordx4 a[220:223], v16, s[8:11], s22 offen offset:1024
    s_add_u32 s22, s25, s66
    buffer_load_dwordx4 v[216:219], v16, s[8:11], s22 offen offset:0
    buffer_load_dwordx4 v[220:223], v16, s[8:11], s22 offen offset:1024
la0_B_pre:
    s_lshr_b32 s78, s62, 1
    s_add_u32 s78, s78, 0x1d000
    s_lshr_b32 s79, s63, 1
    s_add_u32 s79, s79, 0x1d000
    s_lshr_b32 s80, s64, 1
    s_add_u32 s80, s80, 0x1d000
    s_lshr_b32 s81, s65, 1
    s_add_u32 s81, s81, 0x1d000
    s_lshr_b32 s82, s66, 1
    s_add_u32 s82, s82, 0x1d000
    s_lshl_b32 s22, s3, 11
    v_bfe_u32 v6, v1, 5, 1
    v_lshlrev_b32 v6, 9, v6
    v_bfe_u32 v2, v1, 2, 2
    v_lshlrev_b32 v2, 7, v2
    v_add_u32 v6, v6, v2
    v_bfe_u32 v2, v1, 0, 1
    v_lshlrev_b32 v2, 6, v2
    v_add_u32 v6, v6, v2
    v_bfe_u32 v2, v1, 1, 1
    v_lshlrev_b32 v2, 5, v2
    v_add_u32 v6, v6, v2
    v_bfe_u32 v2, v1, 4, 1
    v_lshlrev_b32 v2, 4, v2
    v_add_u32 v6, v6, v2
    v_add_u32 v6, s22, v6
    s_lshl_b32 s22, s3, 9
    v_bfe_u32 v7, v1, 2, 2
    v_lshlrev_b32 v7, 7, v7
    v_bfe_u32 v2, v1, 0, 1
    v_lshlrev_b32 v2, 6, v2
    v_add_u32 v7, v7, v2
    v_bfe_u32 v2, v1, 4, 1
    v_lshlrev_b32 v2, 5, v2
    v_add_u32 v7, v7, v2
    v_bfe_u32 v2, v1, 1, 1
    v_lshlrev_b32 v2, 4, v2
    v_add_u32 v7, v7, v2
    v_add_u32 v7, 0x2000, v7
    v_add_u32 v7, s22, v7
    v_cmp_le_u32 vcc, 32, v1
    v_mov_b32 v3, 0x40000000
    s_nop 0
    v_cndmask_b32 v7, v7, v3, vcc
    v_lshlrev_b32 v8, 4, v1
    v_add_u32 v14, s33, v8
    s_lshl_b32 s22, s3, 10
    v_bfe_u32 v9, v1, 4, 2
    v_lshlrev_b32 v9, 8, v9
    v_bfe_u32 v2, v1, 0, 4
    v_lshlrev_b32 v2, 2, v2
    v_add_u32 v9, v9, v2
    v_add_u32 v9, 0x1c000, v9
    v_add_u32 v9, s22, v9
    s_lshl_b32 s22, s3, 9
    v_bfe_u32 v10, v1, 4, 2
    v_lshlrev_b32 v10, 7, v10
    v_bfe_u32 v2, v1, 0, 4
    v_lshlrev_b32 v2, 3, v2
    v_add_u32 v10, v10, v2
    v_add_u32 v10, 0x1c000, v10
    v_add_u32 v10, s22, v10
    s_lshl_b32 s22, s3, 9
    v_bfe_u32 v13, v1, 0, 2
    v_lshlrev_b32 v13, 7, v13
    v_add_u32 v13, s22, v13
    v_mov_b32 v108, 0
    v_mov_b32 v109, 0
    v_mov_b32 v110, 0
    v_mov_b32 v111, 0
    v_mov_b32 v112, 0
    v_mov_b32 v113, 0
    v_mov_b32 v114, 0
    v_mov_b32 v115, 0
    v_mov_b32 v116, 0
    v_mov_b32 v117, 0
    v_mov_b32 v118, 0
    v_mov_b32 v119, 0
    v_mov_b32 v120, 0
    v_mov_b32 v121, 0
    v_mov_b32 v122, 0
    v_mov_b32 v123, 0
    s_lshl_b32 s22, s3, 11
    v_add_u32 v5, s22, v5
    s_cmp_eq_u32 s3, 3
    s_movk_i32 s35, 1024
    s_cselect_b32 s35, -6144, s35
    s_lshl_b32 s36, s3, 11
    s_add_u32 s36, s36, 0x1d000
    v_add_u32 v2, s36, v8
    s_lshl_b32 s34, s3, 13
    s_add_u32 s34, s34, 0x1f000
    v_add_u32 v3, s34, v8
    s_mov_b32 s40, 0
    s_mov_b32 s43, 0x4208000
    s_add_u32 s43, s43, s84
    s_add_u32 s49, s41, s35
    s_lshl_b32 s22, s20, 1
    s_mul_i32 s45, s3, 28
    s_add_u32 s45, s45, s22
    s_lshl_b32 s45, s45, 10
    s_add_u32 s45, s45, 0x37e4000
    s_add_u32 s45, s45, s84
    s_mov_b32 s46, 0x4212000
    s_add_u32 s46, s46, s84
    s_mov_b32 s47, 0x428e000
    s_add_u32 s47, s47, s84
    s_lshl_b32 s48, s20, 7
    s_add_u32 s48, s48, 0x4289000
    s_add_u32 s48, s48, s84
    s_cmp_lt_u32 s59, 7
    s_cselect_b32 s76, 0, 62
    s_add_u32 s47, s47, 2048
    s_add_u32 s44, s44, 458752
    s_mov_b32 s16, s8
    s_mov_b32 s17, s9
    s_mov_b32 s18, s10
    s_mov_b32 s19, s11
    s_mov_b32 s52, s8
    s_mov_b32 s53, s9
    s_mov_b32 s54, 0
    s_mov_b32 s55, s11
    s_mov_b32 s22, 0x1180800
    s_mov_b32 s91, 0
    v_mov_b32 v46, 0
ts_6:
    buffer_load_dword v44, v46, s[8:11], s22 offen sc1
    s_waitcnt vmcnt(0)
    v_readfirstlane_b32 s88, v44
    s_nop 0
    s_cmp_lg_u32 s88, 0
    s_cbranch_scc1 ts_6_ok
    s_sleep 8
    s_add_u32 s91, s91, 1
    s_cmp_lt_u32 s91, 100
    s_cbranch_scc1 ts_6
    v_mov_b32 v44, 2
    v_mov_b32 v45, 0
    s_mov_b64 exec, 1
    buffer_atomic_cmpswap v[44:45], v46, s[8:11], s22 offen
    s_mov_b64 exec, -1
    s_waitcnt vmcnt(0)
    s_mov_b32 s91, 0
    s_branch ts_6
ts_6_ok:
    s_cmp_eq_u32 s88, 2
    s_cselect_b32 s29, 0, 2
    .p2align 6
la0_B_loop:
    v_mov_b32 v46, 0
    v_mov_b32 v47, 0
    v_mov_b32 v48, 0
    v_mov_b32 v49, 0
    v_mov_b32 v50, 0
    v_mov_b32 v51, 0
    v_mov_b32 v52, 0
    v_mov_b32 v53, 0
    v_mov_b32 v54, 0
    v_mov_b32 v55, 0
    v_mov_b32 v56, 0
    v_mov_b32 v57, 0
    v_mov_b32 v58, 0
    v_mov_b32 v59, 0
    v_mov_b32 v60, 0
    v_mov_b32 v61, 0
    v_mov_b32 v62, 0
    v_mov_b32 v63, 0
    v_mov_b32 v64, 0
    v_mov_b32 v65, 0
    v_mov_b32 v66, 0
    v_mov_b32 v67, 0
    v_mov_b32 v68, 0
    v_mov_b32 v69, 0
    v_mov_b32 v70, 0
    v_mov_b32 v71, 0
    v_mov_b32 v72, 0
    v_mov_b32 v73, 0
    v_mov_b32 v74, 0
    v_mov_b32 v75, 0
    ds_read_b128 v[76:79], v3 offset:0
    ds_read_b128 v[80:83], v3 offset:1024
    ds_read_b128 v[84:87], v3 offset:2048
    ds_read_b128 v[88:91], v3 offset:3072
    ds_read_b128 v[92:95], v3 offset:4096
    ds_read_b128 v[96:99], v3 offset:5120
    ds_read_b128 v[100:103], v3 offset:6144
    ds_read_b128 v[104:107], v3 offset:7168
    ds_read_b128 v[124:127], v14 offset:0
    ds_read_b128 v[128:131], v14 offset:1024
    ds_read_b128 v[132:135], v14 offset:14336
    ds_read_b128 v[136:139], v14 offset:15360
    s_and_b32 s22, s40, 3
    s_cmp_lg_u32 s22, 3
    s_cbranch_scc1 la0_B_yok2
    s_cmp_ge_u32 s40, 62
    s_cbranch_scc1 la0_B_yok2
    v_cmp_gt_u32 vcc, 7, v0
    s_cbranch_vccz la0_B_yok1
    s_mov_b32 s91, 0
la0_B_yf1:
    buffer_load_dword v0, v13, s[8:11], s47 offen sc1
    s_waitcnt vmcnt(0)
    v_cmp_gt_u32 vcc, 7, v0
    s_cbranch_vccz la0_B_yok1
    s_sleep 4
    s_add_u32 s91, s91, 1
    s_cmp_lt_u32 s91, s90
    s_cbranch_scc1 la0_B_yf1
    s_mov_b32 s90, 0
    s_branch la0_B_yok1
la0_B_yok1:
    s_add_u32 s47, s47, 2048
la0_B_yok2:
    s_cmp_lt_u32 s40, s76
    s_cselect_b32 s18, s10, 0
    v_mov_b32 v44, 0
    v_mov_b32 v45, 0
    s_waitcnt vmcnt(0)
    v_add_u32 v24, s78, v8
    v_add_u32 v28, s79, v8
    v_add_u32 v32, s80, v8
    v_add_u32 v36, s81, v8
    v_add_u32 v40, s82, v8
    s_mov_b32 s91, 0
la0_B_poll:
    buffer_load_dwordx4 v[156:159], v5, s[8:11], s41 offen sc1
    buffer_load_dwordx4 v[160:163], v5, s[8:11], s49 offen sc1
    buffer_load_dword v0, v13, s[8:11], s47 offen sc1
    s_waitcnt vmcnt(2)
    ds_write_b128 v2, v[156:159]
    s_waitcnt vmcnt(1)
    ds_write_b128 v2, v[160:163] offset:1024
    v_max3_u32 v168, v156, v157, v158
    v_max3_u32 v168, v168, v159, v160
    v_max3_u32 v168, v168, v161, v162
    v_max_u32 v168, v168, v163
    s_waitcnt vmcnt(0)
    v_cmp_eq_u32 vcc, -1, v168
    s_cbranch_vccz la0_B_go
    s_add_u32 s91, s91, 1
    s_cmp_lt_u32 s91, s90
    s_cbranch_scc1 la0_B_poll
    s_mov_b32 s90, 0
    s_branch la0_B_go
la0_B_go:
    v_smfmac_f32_16x16x64_bf16 v[44:47], v[156:159], a[168:175], v4
    s_add_u32 s22, s44, 0
    s_add_u32 m0, s34, 0
    s_nop 0
    buffer_load_dwordx4 v8, s[16:19], s22 offen offset:0 sc1 lds
    ds_read_b128 v[140:143], v14 offset:2048
    v_smfmac_f32_16x16x64_bf16 v[48:51], v[156:159], a[224:231], v4
    s_add_u32 m0, s34, 1024
    s_nop 0
    buffer_load_dwordx4 v8, s[16:19], s22 offen offset:1024 sc1 lds
    ds_read_b128 v[144:147], v14 offset:3072
    v_smfmac_f32_16x16x64_bf16 v[52:55], v[156:159], a[0:7], v4
    s_add_u32 s22, s44, 28672
    s_add_u32 m0, s34, 1024
    s_nop 0
    buffer_load_dwordx4 v8, s[16:19], s22 offen offset:0 sc1 lds
    ds_read_b128 v[148:151], v14 offset:16384
    v_smfmac_f32_16x16x64_bf16 v[56:59], v[156:159], a[8:15], v4
    s_waitcnt lgkmcnt(0)
    s_barrier
    s_add_u32 m0, s34, 2048
    s_nop 0
    buffer_load_dwordx4 v8, s[16:19], s22 offen offset:1024 sc1 lds
    ds_read_b128 v[152:155], v14 offset:17408
    v_smfmac_f32_16x16x64_bf16 v[60:63], v[156:159], a[16:23], v4
    s_add_u32 s22, s44, 57344
    s_add_u32 m0, s34, 4096
    s_nop 0
    buffer_load_dwordx4 v8, s[16:19], s22 offen offset:0 sc1 lds
    ds_read_b128 v[24:27], v24
    v_smfmac_f32_16x16x64_bf16 v[64:67], v[156:159], a[24:31], v4
    s_add_u32 m0, s34, 5120
    s_nop 0
    buffer_load_dwordx4 v8, s[16:19], s22 offen offset:1024 sc1 lds
    ds_read_b128 v[28:31], v28
    v_smfmac_f32_16x16x64_bf16 v[68:71], v[156:159], v[124:131], v4
    s_add_u32 s22, s44, 86016
    s_add_u32 m0, s34, 5120
    s_nop 0
    buffer_load_dwordx4 v8, s[16:19], s22 offen offset:0 sc1 lds
    ds_read_b128 v[32:35], v32
    v_smfmac_f32_16x16x64_bf16 v[72:75], v[156:159], v[132:139], v4
    s_add_u32 m0, s34, 6144
    s_nop 0
    buffer_load_dwordx4 v8, s[16:19], s22 offen offset:1024 sc1 lds
    ds_read_b128 v[36:39], v36
    v_smfmac_f32_16x16x64_bf16 v[44:47], v[160:163], a[176:183], v4
    buffer_store_dwordx4 v[108:111], v8, s[52:55], s45 offen offset:0 sc1
    ds_read_b128 v[40:43], v40
    v_smfmac_f32_16x16x64_bf16 v[48:51], v[160:163], a[232:239], v4
    buffer_store_dwordx4 v[116:119], v8, s[52:55], s45 offen offset:1024 sc1
    ds_read_b128 v[124:127], v14 offset:4096
    v_smfmac_f32_16x16x64_bf16 v[52:55], v[160:163], a[32:39], v4
    ds_read_b128 v[128:131], v14 offset:5120
    v_smfmac_f32_16x16x64_bf16 v[56:59], v[160:163], a[40:47], v4
    ds_read_b128 v[132:135], v14 offset:18432
    v_smfmac_f32_16x16x64_bf16 v[60:63], v[160:163], a[48:55], v4
    ds_read_b128 v[136:139], v14 offset:19456
    v_smfmac_f32_16x16x64_bf16 v[64:67], v[160:163], a[56:63], v4
    s_waitcnt lgkmcnt(9)
    v_smfmac_f32_16x16x64_bf16 v[68:71], v[160:163], v[140:147], v4
    v_smfmac_f32_16x16x64_bf16 v[72:75], v[160:163], v[148:155], v4
    s_waitcnt lgkmcnt(8)
    v_smfmac_f32_16x16x64_bf16 v[44:47], v[24:27], a[184:191], v4
    ds_read_b128 v[140:143], v14 offset:6144
    v_smfmac_f32_16x16x64_bf16 v[48:51], v[24:27], a[240:247], v4
    ds_read_b128 v[144:147], v14 offset:7168
    v_smfmac_f32_16x16x64_bf16 v[52:55], v[24:27], a[64:71], v4
    ds_read_b128 v[148:151], v14 offset:20480
    v_smfmac_f32_16x16x64_bf16 v[56:59], v[24:27], a[72:79], v4
    ds_read_b128 v[152:155], v14 offset:21504
    v_smfmac_f32_16x16x64_bf16 v[60:63], v[24:27], a[80:87], v4
    v_smfmac_f32_16x16x64_bf16 v[64:67], v[24:27], a[88:95], v4
    s_waitcnt lgkmcnt(4)
    v_smfmac_f32_16x16x64_bf16 v[68:71], v[24:27], v[124:131], v4
    v_smfmac_f32_16x16x64_bf16 v[72:75], v[24:27], v[132:139], v4
    s_waitcnt lgkmcnt(11)
    v_smfmac_f32_16x16x64_bf16 v[44:47], v[28:31], a[192:199], v4
    ds_read_b128 v[124:127], v14 offset:8192
    v_smfmac_f32_16x16x64_bf16 v[48:51], v[28:31], a[248:255], v4
    ds_read_b128 v[128:131], v14 offset:9216
    v_smfmac_f32_16x16x64_bf16 v[52:55], v[28:31], a[96:103], v4
    ds_read_b128 v[132:135], v14 offset:22528
    v_smfmac_f32_16x16x64_bf16 v[56:59], v[28:31], a[104:111], v4
    ds_read_b128 v[136:139], v14 offset:23552
    v_smfmac_f32_16x16x64_bf16 v[60:63], v[28:31], a[112:119], v4
    v_smfmac_f32_16x16x64_bf16 v[64:67], v[28:31], a[120:127], v4
    s_waitcnt lgkmcnt(4)
    v_smfmac_f32_16x16x64_bf16 v[68:71], v[28:31], v[140:147], v4
    v_smfmac_f32_16x16x64_bf16 v[72:75], v[28:31], v[148:155], v4
    s_waitcnt lgkmcnt(14)
    v_smfmac_f32_16x16x64_bf16 v[44:47], v[32:35], a[200:207], v4
    ds_read_b128 v[140:143], v14 offset:10240
    v_smfmac_f32_16x16x64_bf16 v[48:51], v[32:35], v[200:207], v4
    ds_read_b128 v[144:147], v14 offset:11264
    v_smfmac_f32_16x16x64_bf16 v[52:55], v[32:35], a[128:135], v4
    ds_read_b128 v[148:151], v14 offset:24576
    v_smfmac_f32_16x16x64_bf16 v[56:59], v[32:35], a[136:143], v4
    ds_read_b128 v[152:155], v14 offset:25600
    v_smfmac_f32_16x16x64_bf16 v[60:63], v[32:35], a[144:151], v4
    ds_read_b128 v[16:19], v14 offset:12288
    v_smfmac_f32_16x16x64_bf16 v[64:67], v[32:35], a[152:159], v4
    ds_read_b128 v[20:23], v14 offset:13312
    s_waitcnt lgkmcnt(6)
    v_smfmac_f32_16x16x64_bf16 v[68:71], v[32:35], v[124:131], v4
    ds_read_b128 v[156:159], v14 offset:26624
    v_smfmac_f32_16x16x64_bf16 v[72:75], v[32:35], v[132:139], v4
    ds_read_b128 v[160:163], v14 offset:27648
    s_waitcnt lgkmcnt(15)
    v_smfmac_f32_16x16x64_bf16 v[44:47], v[36:39], a[208:215], v4
    s_waitcnt lgkmcnt(15)
    v_smfmac_f32_16x16x64_bf16 v[44:47], v[40:43], a[216:223], v4
    v_smfmac_f32_16x16x64_bf16 v[48:51], v[36:39], v[208:215], v4
    v_smfmac_f32_16x16x64_bf16 v[48:51], v[40:43], v[216:223], v4
    v_smfmac_f32_16x16x64_bf16 v[52:55], v[36:39], a[160:167], v4
    v_add_f32 v44, v44, v46
    v_add_f32 v45, v45, v47
    v_smfmac_f32_16x16x64_bf16 v[52:55], v[40:43], v[224:231], v4
    v_cvt_pk_bf16_f32 v108, v44, v45
    v_smfmac_f32_16x16x64_bf16 v[56:59], v[36:39], v[176:183], v4
    v_add_f32 v48, v48, v50
    v_add_f32 v49, v49, v51
    v_smfmac_f32_16x16x64_bf16 v[56:59], v[40:43], v[232:239], v4
    v_cvt_pk_bf16_f32 v116, v48, v49
    v_smfmac_f32_16x16x64_bf16 v[60:63], v[36:39], v[184:191], v4
    v_add_f32 v52, v52, v54
    v_add_f32 v53, v53, v55
    v_smfmac_f32_16x16x64_bf16 v[60:63], v[40:43], v[240:247], v4
    v_cvt_pk_bf16_f32 v109, v52, v53
    v_smfmac_f32_16x16x64_bf16 v[64:67], v[36:39], v[192:199], v4
    v_add_f32 v56, v56, v58
    v_add_f32 v57, v57, v59
    v_smfmac_f32_16x16x64_bf16 v[64:67], v[40:43], v[248:255], v4
    v_cvt_pk_bf16_f32 v117, v56, v57
    s_waitcnt lgkmcnt(4)
    v_smfmac_f32_16x16x64_bf16 v[68:71], v[36:39], v[140:147], v4
    v_add_f32 v60, v60, v62
    v_add_f32 v61, v61, v63
    s_waitcnt lgkmcnt(0)
    v_smfmac_f32_16x16x64_bf16 v[68:71], v[40:43], v[16:23], v4
    v_cvt_pk_bf16_f32 v110, v60, v61
    v_smfmac_f32_16x16x64_bf16 v[72:75], v[36:39], v[148:155], v4
    v_add_f32 v64, v64, v66
    v_add_f32 v65, v65, v67
    v_smfmac_f32_16x16x64_bf16 v[72:75], v[40:43], v[156:163], v4
    v_cvt_pk_bf16_f32 v118, v64, v65
    s_add_u32 s45, s45, 114688
    s_add_u32 s46, s46, 7168
    s_add_u32 s44, s44, 458752
    s_cmp_ge_u32 s40, 62
    s_cselect_b32 s54, s10, 0
    v_mov_b32 v168, 0
    v_mov_b32 v169, 0
    v_mov_b32 v170, 0
    v_mov_b32 v171, 0
    v_mov_b32 v172, 0
    v_mov_b32 v173, 0
    v_mov_b32 v174, 0
    v_mov_b32 v175, 0
    v_add_f32 v68, v68, v70
    v_add_f32 v69, v69, v71
    v_cvt_pk_bf16_f32 v111, v68, v69
    v_add_f32 v72, v72, v74
    v_add_f32 v73, v73, v75
    v_cvt_pk_bf16_f32 v119, v72, v73
    s_cmp_eq_u32 s76, 0
    s_cbranch_scc1 la0_B_y0
la0_B_hop:
    s_cmp_eq_u32 s40, 63
    s_cbranch_scc1 la0_B_last
    s_add_u32 s22, s40, 1
    s_and_b32 s22, s22, 3
    s_mul_i32 s41, s22, 7168
    s_add_u32 s41, s41, 0x4200000
    s_add_u32 s41, s41, s84
    s_add_u32 s49, s41, s35
    s_xor_b32 s22, s22, 2
    s_mul_i32 s42, s22, 7168
    s_add_u32 s42, s42, 0x4200000
    s_add_u32 s42, s42, s84
    v_mov_b32 v45, -1
    s_mov_b32 s91, 0
    s_waitcnt vmcnt(0)
    buffer_load_dwordx4 v[16:19], v6, s[8:11], s43 offen sc1
    buffer_load_dwordx4 v[20:23], v6, s[8:11], s43 offen offset:1024 sc1
    buffer_load_dwordx4 v[24:27], v7, s[8:11], s43 offen sc1
    s_sleep 2
    s_nop 12
    .p2align 6
la0_B_pollP:
    buffer_load_dwordx4 v[156:159], v6, s[8:11], s43 offen sc1
    buffer_load_dwordx4 v[160:163], v6, s[8:11], s43 offen offset:1024 sc1
    buffer_load_dwordx4 v[164:167], v7, s[8:11], s43 offen sc1
    s_waitcnt vmcnt(5)
    v_smfmac_f32_16x16x64_bf16 v[168:171], v[16:19], v[76:83], v4
    v_smfmac_f32_16x16x64_bf16 v[172:175], v[16:19], v[84:91], v4
    v_max3_u32 v44, v16, v17, v18
    s_waitcnt vmcnt(4)
    v_smfmac_f32_16x16x64_bf16 v[168:171], v[20:23], v[92:99], v4
    v_smfmac_f32_16x16x64_bf16 v[172:175], v[20:23], v[100:107], v4
    v_max3_u32 v44, v44, v19, v20
    v_max3_u32 v44, v44, v21, v22
    s_waitcnt vmcnt(3)
    v_smfmac_f32_16x16x64_bf16 v[168:171], v[24:27], v[108:115], v4
    v_smfmac_f32_16x16x64_bf16 v[172:175], v[24:27], v[116:123], v4
    v_max3_u32 v44, v44, v23, v24
    v_max3_u32 v44, v44, v25, v26
    v_max_u32 v44, v44, v27
    v_cmp_eq_u32 vcc, -1, v44
    s_cbranch_vccnz la0_B_try1
la0_B_red:
    v_pk_add_f32 v[168:169], v[168:169], v[170:171]
    ds_write_b32 v9, v168 offset:0
    ds_write_b32 v9, v169 offset:128
    v_pk_add_f32 v[172:173], v[172:173], v[174:175]
    ds_write_b32 v9, v172 offset:64
    ds_write_b32 v9, v173 offset:192
    s_cmp_ge_u32 s3, s29
    s_waitcnt lgkmcnt(0)
    s_barrier
    s_cbranch_scc1 la0_B_other
    ds_read_b64 v[48:49], v10 offset:0
    ds_read_b64 v[50:51], v10 offset:1024
    ds_read_b64 v[52:53], v10 offset:2048
    ds_read_b64 v[54:55], v10 offset:3072
    s_waitcnt lgkmcnt(2)
    v_pk_add_f32 v[48:49], v[48:49], v[50:51]
    s_waitcnt lgkmcnt(0)
    v_pk_add_f32 v[52:53], v[52:53], v[54:55]
    v_pk_add_f32 v[48:49], v[48:49], v[52:53]
    v_cvt_pk_bf16_f32 v15, v48, v49
    buffer_store_dword v15, v11, s[8:11], s41 offen
    buffer_store_dword v45, v11, s[8:11], s42 offen
    buffer_store_dword v15, v12, s[8:11], s46 offen
la0_B_next:
    s_add_u32 s40, s40, 1
    s_and_b32 s22, s40, 3
    s_mul_i32 s43, s22, 10240
    s_add_u32 s43, s43, 0x4208000
    s_add_u32 s43, s43, s84
    s_branch la0_B_loop
    .p2align 6
la0_B_try1:
    buffer_load_dwordx4 v[16:19], v6, s[8:11], s43 offen sc1
    buffer_load_dwordx4 v[20:23], v6, s[8:11], s43 offen offset:1024 sc1
    buffer_load_dwordx4 v[24:27], v7, s[8:11], s43 offen sc1
    v_mov_b32 v168, 0
    v_mov_b32 v169, 0
    v_mov_b32 v170, 0
    v_mov_b32 v171, 0
    v_mov_b32 v172, 0
    v_mov_b32 v173, 0
    v_mov_b32 v174, 0
    v_mov_b32 v175, 0
    s_waitcnt vmcnt(5)
    v_smfmac_f32_16x16x64_bf16 v[168:171], v[156:159], v[76:83], v4
    v_smfmac_f32_16x16x64_bf16 v[172:175], v[156:159], v[84:91], v4
    v_max3_u32 v44, v156, v157, v158
    s_waitcnt vmcnt(4)
    v_smfmac_f32_16x16x64_bf16 v[168:171], v[160:163], v[92:99], v4
    v_smfmac_f32_16x16x64_bf16 v[172:175], v[160:163], v[100:107], v4
    v_max3_u32 v44, v44, v159, v160
    v_max3_u32 v44, v44, v161, v162
    s_waitcnt vmcnt(3)
    v_smfmac_f32_16x16x64_bf16 v[168:171], v[164:167], v[108:115], v4
    v_smfmac_f32_16x16x64_bf16 v[172:175], v[164:167], v[116:123], v4
    v_max3_u32 v44, v44, v163, v164
    v_max3_u32 v44, v44, v165, v166
    v_max_u32 v44, v44, v167
    v_cmp_eq_u32 vcc, -1, v44
    s_cbranch_vccnz la0_B_againP
    v_pk_add_f32 v[168:169], v[168:169], v[170:171]
    ds_write_b32 v9, v168 offset:0
    ds_write_b32 v9, v169 offset:128
    v_pk_add_f32 v[172:173], v[172:173], v[174:175]
    ds_write_b32 v9, v172 offset:64
    ds_write_b32 v9, v173 offset:192
    s_cmp_ge_u32 s3, s29
    s_waitcnt lgkmcnt(0)
    s_barrier
    s_cbranch_scc1 la0_B_other
    ds_read_b64 v[48:49], v10 offset:0
    ds_read_b64 v[50:51], v10 offset:1024
    ds_read_b64 v[52:53], v10 offset:2048
    ds_read_b64 v[54:55], v10 offset:3072
    s_waitcnt lgkmcnt(2)
    v_pk_add_f32 v[48:49], v[48:49], v[50:51]
    s_waitcnt lgkmcnt(0)
    v_pk_add_f32 v[52:53], v[52:53], v[54:55]
    v_pk_add_f32 v[48:49], v[48:49], v[52:53]
    v_cvt_pk_bf16_f32 v15, v48, v49
    buffer_store_dword v15, v11, s[8:11], s41 offen
    buffer_store_dword v45, v11, s[8:11], s42 offen
    buffer_store_dword v15, v12, s[8:11], s46 offen
    s_branch la0_B_next
la0_B_y0:
    s_sub_u32 s47, s47, 2048
    s_mov_b32 s91, 0
la0_B_yf0:
    buffer_load_dword v0, v13, s[8:11], s47 offen sc1
    s_waitcnt vmcnt(0)
    v_cmp_gt_u32 vcc, 7, v0
    s_cbranch_vccz la0_B_yok0
    s_sleep 4
    s_add_u32 s91, s91, 1
    s_cmp_lt_u32 s91, s90
    s_cbranch_scc1 la0_B_yf0
    s_mov_b32 s90, 0
    s_branch la0_B_yok0
la0_B_yok0:
    s_add_u32 s47, s47, 2048
    s_sub_u32 s44, s44, 917504
    s_add_u32 s22, s44, 0
    s_add_u32 m0, s34, 0
    s_nop 0
    buffer_load_dwordx4 v8, s[8:11], s22 offen offset:0 sc1 lds
    s_add_u32 m0, s34, 1024
    s_nop 0
    buffer_load_dwordx4 v8, s[8:11], s22 offen offset:1024 sc1 lds
    s_add_u32 s22, s44, 28672
    s_add_u32 m0, s34, 1024
    s_nop 0
    buffer_load_dwordx4 v8, s[8:11], s22 offen offset:0 sc1 lds
    s_add_u32 m0, s34, 2048
    s_nop 0
    buffer_load_dwordx4 v8, s[8:11], s22 offen offset:1024 sc1 lds
    s_add_u32 s22, s44, 57344
    s_add_u32 m0, s34, 4096
    s_nop 0
    buffer_load_dwordx4 v8, s[8:11], s22 offen offset:0 sc1 lds
    s_add_u32 m0, s34, 5120
    s_nop 0
    buffer_load_dwordx4 v8, s[8:11], s22 offen offset:1024 sc1 lds
    s_add_u32 s22, s44, 86016
    s_add_u32 m0, s34, 5120
    s_nop 0
    buffer_load_dwordx4 v8, s[8:11], s22 offen offset:0 sc1 lds
    s_add_u32 m0, s34, 6144
    s_nop 0
    buffer_load_dwordx4 v8, s[8:11], s22 offen offset:1024 sc1 lds
    s_add_u32 s44, s44, 458752
    s_waitcnt vmcnt(0)
    ds_read_b128 v[76:79], v3 offset:0
    ds_read_b128 v[80:83], v3 offset:1024
    ds_read_b128 v[84:87], v3 offset:2048
    ds_read_b128 v[88:91], v3 offset:3072
    ds_read_b128 v[92:95], v3 offset:4096
    ds_read_b128 v[96:99], v3 offset:5120
    ds_read_b128 v[100:103], v3 offset:6144
    ds_read_b128 v[104:107], v3 offset:7168
    s_waitcnt lgkmcnt(0)
    s_add_u32 s22, s44, 0
    s_add_u32 m0, s34, 0
    s_nop 0
    buffer_load_dwordx4 v8, s[8:11], s22 offen offset:0 sc1 lds
    s_add_u32 m0, s34, 1024
    s_nop 0
    buffer_load_dwordx4 v8, s[8:11], s22 offen offset:1024 sc1 lds
    s_add_u32 s22, s44, 28672
    s_add_u32 m0, s34, 1024
    s_nop 0
    buffer_load_dwordx4 v8, s[8:11], s22 offen offset:0 sc1 lds
    s_add_u32 m0, s34, 2048
    s_nop 0
    buffer_load_dwordx4 v8, s[8:11], s22 offen offset:1024 sc1 lds
    s_add_u32 s22, s44, 57344
    s_add_u32 m0, s34, 4096
    s_nop 0
    buffer_load_dwordx4 v8, s[8:11], s22 offen offset:0 sc1 lds
    s_add_u32 m0, s34, 5120
    s_nop 0
    buffer_load_dwordx4 v8, s[8:11], s22 offen offset:1024 sc1 lds
    s_add_u32 s22, s44, 86016
    s_add_u32 m0, s34, 5120
    s_nop 0
    buffer_load_dwordx4 v8, s[8:11], s22 offen offset:0 sc1 lds
    s_add_u32 m0, s34, 6144
    s_nop 0
    buffer_load_dwordx4 v8, s[8:11], s22 offen offset:1024 sc1 lds
    s_add_u32 s44, s44, 458752
    s_mov_b32 s76, 62
    s_branch la0_B_hop
la0_B_other:
    s_cmp_ge_u32 s3, 2
    s_cbranch_scc1 la0_B_next
    ds_read_b64 v[48:49], v10 offset:0
    ds_read_b64 v[50:51], v10 offset:1024
    ds_read_b64 v[52:53], v10 offset:2048
    ds_read_b64 v[54:55], v10 offset:3072
    s_waitcnt lgkmcnt(2)
    v_pk_add_f32 v[48:49], v[48:49], v[50:51]
    s_waitcnt lgkmcnt(0)
    v_pk_add_f32 v[52:53], v[52:53], v[54:55]
    v_pk_add_f32 v[48:49], v[48:49], v[52:53]
    v_cvt_pk_bf16_f32 v15, v48, v49
    buffer_store_dword v15, v11, s[8:11], s41 offen sc1
    buffer_store_dword v45, v11, s[8:11], s42 offen sc1
    buffer_store_dword v15, v12, s[8:11], s46 offen sc1
    s_branch la0_B_next
la0_B_againP:
    v_mov_b32 v168, 0
    v_mov_b32 v169, 0
    v_mov_b32 v170, 0
    v_mov_b32 v171, 0
    v_mov_b32 v172, 0
    v_mov_b32 v173, 0
    v_mov_b32 v174, 0
    v_mov_b32 v175, 0
    s_add_u32 s91, s91, 1
    s_cmp_lt_u32 s91, s90
    s_cbranch_scc1 la0_B_pollP
    s_mov_b32 s90, 0
    s_branch la0_B_red
la0_B_last:
    buffer_store_dwordx4 v[108:111], v8, s[8:11], s45 offen offset:0 sc1
    buffer_store_dwordx4 v[116:119], v8, s[8:11], s45 offen offset:1024 sc1
    s_waitcnt vmcnt(0)
    s_barrier
    s_cmp_lg_u32 s3, 2
    s_cbranch_scc1 la0_job
    v_mov_b32 v156, 1
    v_mov_b32 v157, 0
    s_mov_b64 exec, 1
    buffer_store_dword v156, v157, s[8:11], s48 offen sc1
    buffer_store_dword v156, v157, s[8:11], s48 offen offset:2048 sc1
    s_branch la0_job
la0_pref:
    s_sub_u32 s22, s20, 30
    s_lshl_b32 s22, s22, 2
    s_add_u32 s22, s22, s3
    s_cmp_lg_u32 s22, 0
    s_cbranch_scc1 la0_pref_y0
    v_lshlrev_b32 v4, 4, v1
    v_mov_b32 v5, 0
    v_mov_b32 v6, 1
    v_mov_b32 v7, 0
    s_mov_b32 s22, 0x1180800
    s_mov_b64 exec, 1
    buffer_atomic_cmpswap v[6:7], v5, s[8:11], s22 offen
    s_mov_b64 exec, -1
    s_mov_b32 s40, 0
    s_mov_b32 s41, 0x4212000
    s_add_u32 s41, s41, s84
    s_mov_b32 s42, 0x3f00000
    s_add_u32 s42, s42, s84
    s_mov_b32 s43, 0x4287000
    s_add_u32 s43, s43, s84
la0_fw_loop:
    s_mov_b32 s91, 0
    s_add_u32 s44, s41, 4096
    s_add_u32 s45, s42, 4096
la0_fw_poll:
    buffer_load_dwordx4 v[8:11], v4, s[8:11], s41 offen offset:0 sc1
    buffer_load_dwordx4 v[12:15], v4, s[8:11], s41 offen offset:1024 sc1
    buffer_load_dwordx4 v[16:19], v4, s[8:11], s41 offen offset:2048 sc1
    buffer_load_dwordx4 v[20:23], v4, s[8:11], s41 offen offset:3072 sc1
    buffer_load_dwordx4 v[24:27], v4, s[8:11], s44 offen offset:0 sc1
    buffer_load_dwordx4 v[28:31], v4, s[8:11], s44 offen offset:1024 sc1
    buffer_load_dwordx4 v[32:35], v4, s[8:11], s44 offen offset:2048 sc1
    s_waitcnt vmcnt(6)
    v_max3_u32 v7, v8, v9, v10
    v_max_u32 v7, v7, v11
    s_waitcnt vmcnt(5)
    v_max3_u32 v7, v7, v12, v13
    v_max3_u32 v7, v7, v14, v15
    s_waitcnt vmcnt(4)
    v_max3_u32 v7, v7, v16, v17
    v_max3_u32 v7, v7, v18, v19
    s_waitcnt vmcnt(3)
    v_max3_u32 v7, v7, v20, v21
    v_max3_u32 v7, v7, v22, v23
    s_waitcnt vmcnt(2)
    v_max3_u32 v7, v7, v24, v25
    v_max3_u32 v7, v7, v26, v27
    s_waitcnt vmcnt(1)
    v_max3_u32 v7, v7, v28, v29
    v_max3_u32 v7, v7, v30, v31
    s_waitcnt vmcnt(0)
    v_max3_u32 v7, v7, v32, v33
    v_max3_u32 v7, v7, v34, v35
    v_cmp_eq_u32 vcc, -1, v7
    s_cbranch_vccz la0_fw_ok
    s_sleep 2
    s_add_u32 s91, s91, 1
    s_cmp_lt_u32 s91, s90
    s_cbranch_scc1 la0_fw_poll
    s_mov_b32 s90, 0
    s_branch la0_fw_ok
la0_fw_ok:
    buffer_store_dwordx4 v[8:11], v4, s[8:11], s42 offen offset:0 sc1
    buffer_store_dwordx4 v[12:15], v4, s[8:11], s42 offen offset:1024 sc1
    buffer_store_dwordx4 v[16:19], v4, s[8:11], s42 offen offset:2048 sc1
    buffer_store_dwordx4 v[20:23], v4, s[8:11], s42 offen offset:3072 sc1
    buffer_store_dwordx4 v[24:27], v4, s[8:11], s45 offen offset:0 sc1
    buffer_store_dwordx4 v[28:31], v4, s[8:11], s45 offen offset:1024 sc1
    buffer_store_dwordx4 v[32:35], v4, s[8:11], s45 offen offset:2048 sc1
    s_waitcnt vmcnt(0)
    s_mov_b64 exec, 1
    buffer_store_dword v6, v5, s[8:11], s43 offen sc1
    s_mov_b64 exec, -1
    s_add_u32 s40, s40, 1
    s_add_u32 s41, s41, 7168
    s_add_u32 s42, s42, 7168
    s_add_u32 s43, s43, 128
    s_cmp_lt_u32 s40, 64
    s_cbranch_scc1 la0_fw_loop
    s_branch la0_job
la0_pref_y0:
    s_cmp_lg_u32 s22, 1
    s_cbranch_scc1 la0_job
    v_lshlrev_b32 v4, 7, v1
    v_mov_b32 v5, 0
    s_mov_b32 s40, 0
    s_mov_b32 s44, 0x1a00000
    s_add_u32 s44, s44, s84
    s_mov_b32 s41, 0x4286e80
    s_add_u32 s41, s41, s84
la0_xp_loop:
    s_cmp_lt_u32 s40, 3
    s_cbranch_scc1 la0_xp_ok
    s_mov_b32 s91, 0
la0_xp_poll:
    buffer_load_dword v6, v5, s[8:11], s41 offen sc1
    s_waitcnt vmcnt(0)
    v_cmp_eq_u32 vcc, 0, v6
    s_cbranch_vccz la0_xp_ok
    s_sleep 2
    s_add_u32 s91, s91, 1
    s_cmp_lt_u32 s91, s90
    s_cbranch_scc1 la0_xp_poll
    s_mov_b32 s90, 0
    s_branch la0_xp_ok
la0_xp_ok:
    s_lshr_b32 s22, s40, 2
    s_lshl_b32 s22, s22, 11
    s_add_u32 s22, s22, 0x428e000
    s_add_u32 s22, s22, s84
    s_mov_b32 s91, 0
la0_xp_y:
    buffer_load_dword v6, v5, s[8:11], s22 offen sc1
    s_waitcnt vmcnt(0)
    v_cmp_eq_u32 vcc, 0, v6
    s_cbranch_vccz la0_xp_yok
    s_sleep 2
    s_add_u32 s91, s91, 1
    s_cmp_lt_u32 s91, s90
    s_cbranch_scc1 la0_xp_y
    s_mov_b32 s90, 0
    s_branch la0_xp_yok
la0_xp_yok:
    buffer_load_dword v8, v4, s[8:11], s44 offen sc1
    s_add_u32 s44, s44, 8192
    buffer_load_dword v9, v4, s[8:11], s44 offen sc1
    s_add_u32 s44, s44, 8192
    buffer_load_dword v10, v4, s[8:11], s44 offen sc1
    s_add_u32 s44, s44, 8192
    s_mov_b32 exec_hi, 0
    buffer_load_dword v11, v4, s[8:11], s44 offen sc1
    s_add_u32 s44, s44, 4096
    s_mov_b32 exec_hi, -1
    s_add_u32 s40, s40, 1
    s_add_u32 s41, s41, 128
    s_cmp_lt_u32 s40, 63
    s_cbranch_scc1 la0_xp_loop
    s_branch la0_job
la0_worker:
    s_cmp_eq_u32 s89, 0
    s_cbranch_scc1 la0_W_fast
    s_mov_b32 s36, 0
la0_O_pull:
    s_cmp_lg_u32 s3, 0
    s_cbranch_scc1 la0_oq_w
    s_mov_b32 s22, 0x4282080
    s_add_u32 s22, s22, s84
    v_mov_b32 v2, 1
    v_mov_b32 v3, 0
    s_mov_b64 exec, 1
    buffer_atomic_add v2, v3, s[8:11], s22 offen sc0
    v_mov_b32 v3, 0x27ff4
    s_waitcnt vmcnt(0)
    ds_write_b32 v3, v2
    s_mov_b64 exec, -1
    s_waitcnt lgkmcnt(0)
la0_oq_w:
    s_barrier
    v_mov_b32 v3, 0x27ff4
    ds_read_b32 v2, v3
    s_waitcnt lgkmcnt(0)
    v_readfirstlane_b32 s35, v2
    s_barrier
    s_cmp_lt_u32 s35, 128
    s_cbranch_scc1 la0_O_job
    s_cmp_lg_u32 s36, 0
    s_cbranch_scc1 la0_W_idx
la0_W_fast:
    v_lshlrev_b32 v7, 4, v1
    s_cmp_lg_u32 s3, 0
    s_cbranch_scc1 la0_fq_w
    s_mov_b32 s22, 0x4282100
    s_add_u32 s22, s22, s84
    v_mov_b32 v2, 1
    v_mov_b32 v3, 0
    s_mov_b64 exec, 1
    buffer_atomic_add v2, v3, s[8:11], s22 offen sc0
    v_mov_b32 v3, 0x27ff4
    s_waitcnt vmcnt(0)
    ds_write_b32 v3, v2
    s_mov_b64 exec, -1
    s_waitcnt lgkmcnt(0)
la0_fq_w:
    s_barrier
    v_mov_b32 v3, 0x27ff4
    ds_read_b32 v2, v3
    s_waitcnt lgkmcnt(0)
    v_readfirstlane_b32 s34, v2
    s_barrier
    s_lshl_b32 s22, 224, s89
    s_cmp_ge_u32 s34, s22
    s_cbranch_scc1 la0_W_first
    s_mul_i32 s33, s34, 586
    s_lshr_b32 s33, s33, 16
    s_mul_i32 s22, s33, 112
    s_sub_u32 s34, s34, s22
    s_mul_i32 s31, s34, 9363
    s_lshr_b32 s31, s31, 16
    s_mul_i32 s22, s31, 7
    s_sub_u32 s34, s34, s22
    s_lshl_b32 s34, s34, 2
    s_add_u32 s34, s34, s3
    s_mul_i32 s23, s31, 28
    s_add_u32 s23, s23, s34
    s_mul_i32 s23, s23, 14336
    s_add_u32 s23, s23, 0x0
    buffer_load_dwordx4 a[200:203], v7, s[8:11], s23 offen offset:0
    buffer_load_dwordx4 a[204:207], v7, s[8:11], s23 offen offset:1024
    buffer_load_dwordx4 a[208:211], v7, s[8:11], s23 offen offset:2048
    buffer_load_dwordx4 a[212:215], v7, s[8:11], s23 offen offset:3072
    s_add_u32 s23, s23, 4096
    buffer_load_dwordx4 a[216:219], v7, s[8:11], s23 offen offset:0
    buffer_load_dwordx4 a[220:223], v7, s[8:11], s23 offen offset:1024
    buffer_load_dwordx4 a[224:227], v7, s[8:11], s23 offen offset:2048
    buffer_load_dwordx4 a[228:231], v7, s[8:11], s23 offen offset:3072
    s_add_u32 s23, s23, 4096
    buffer_load_dwordx4 a[232:235], v7, s[8:11], s23 offen offset:0
    buffer_load_dwordx4 a[236:239], v7, s[8:11], s23 offen offset:1024
    buffer_load_dwordx4 a[240:243], v7, s[8:11], s23 offen offset:2048
    buffer_load_dwordx4 a[244:247], v7, s[8:11], s23 offen offset:3072
    s_add_u32 s23, s23, 4096
    buffer_load_dwordx4 a[248:251], v7, s[8:11], s23 offen offset:0
    buffer_load_dwordx4 a[252:255], v7, s[8:11], s23 offen offset:1024
    s_cmp_eq_u32 s89, 0
    s_cbranch_scc1 wt_7_ok
    s_mov_b32 s91, 0
    v_mbcnt_lo_u32_b32 v2, -1, 0
    v_mbcnt_hi_u32_b32 v2, -1, v2
    v_and_b32 v2, 7, v2
    v_lshlrev_b32 v2, 7, v2
    s_lshl_b32 s22, s33, 10
    s_add_u32 s22, s22, 0x428a000
    s_add_u32 s22, s22, s84
wt_7:
    buffer_load_dword v3, v2, s[8:11], s22 offen sc1
    s_waitcnt vmcnt(0)
    v_cmp_eq_u32 vcc, 0, v3
    s_cbranch_vccz wt_7_ok
    s_sleep 2
    s_add_u32 s91, s91, 1
    s_cmp_lt_u32 s91, s90
    s_cbranch_scc1 wt_7
    s_mov_b32 s90, 0
    s_branch wt_7_ok
wt_7_ok:
    s_lshl_b32 s22, s33, 2
    s_add_u32 s22, s22, s3
    s_mul_i32 s22, s22, 28672
    s_add_u32 s22, s22, 0x1800000
    s_add_u32 s22, s22, s84
    s_mul_i32 s23, s3, 28672
    s_add_u32 m0, s23, 0
    s_nop 0
    buffer_load_dwordx4 v7, s[8:11], s22 offen offset:0 sc1 lds
    buffer_load_dwordx4 v7, s[8:11], s22 offen offset:1024 sc1 lds
    buffer_load_dwordx4 v7, s[8:11], s22 offen offset:2048 sc1 lds
    buffer_load_dwordx4 v7, s[8:11], s22 offen offset:3072 sc1 lds
    s_add_u32 s22, s22, 4096
    s_add_u32 m0, s23, 4096
    s_nop 0
    buffer_load_dwordx4 v7, s[8:11], s22 offen offset:0 sc1 lds
    buffer_load_dwordx4 v7, s[8:11], s22 offen offset:1024 sc1 lds
    buffer_load_dwordx4 v7, s[8:11], s22 offen offset:2048 sc1 lds
    buffer_load_dwordx4 v7, s[8:11], s22 offen offset:3072 sc1 lds
    s_add_u32 s22, s22, 4096
    s_add_u32 m0, s23, 8192
    s_nop 0
    buffer_load_dwordx4 v7, s[8:11], s22 offen offset:0 sc1 lds
    buffer_load_dwordx4 v7, s[8:11], s22 offen offset:1024 sc1 lds
    buffer_load_dwordx4 v7, s[8:11], s22 offen offset:2048 sc1 lds
    buffer_load_dwordx4 v7, s[8:11], s22 offen offset:3072 sc1 lds
    s_add_u32 s22, s22, 4096
    s_add_u32 m0, s23, 12288
    s_nop 0
    buffer_load_dwordx4 v7, s[8:11], s22 offen offset:0 sc1 lds
    buffer_load_dwordx4 v7, s[8:11], s22 offen offset:1024 sc1 lds
    buffer_load_dwordx4 v7, s[8:11], s22 offen offset:2048 sc1 lds
    buffer_load_dwordx4 v7, s[8:11], s22 offen offset:3072 sc1 lds
    s_add_u32 s22, s22, 4096
    s_add_u32 m0, s23, 16384
    s_nop 0
    buffer_load_dwordx4 v7, s[8:11], s22 offen offset:0 sc1 lds
    buffer_load_dwordx4 v7, s[8:11], s22 offen offset:1024 sc1 lds
    buffer_load_dwordx4 v7, s[8:11], s22 offen offset:2048 sc1 lds
    buffer_load_dwordx4 v7, s[8:11], s22 offen offset:3072 sc1 lds
    s_add_u32 s22, s22, 4096
    s_add_u32 m0, s23, 20480
    s_nop 0
    buffer_load_dwordx4 v7, s[8:11], s22 offen offset:0 sc1 lds
    buffer_load_dwordx4 v7, s[8:11], s22 offen offset:1024 sc1 lds
    buffer_load_dwordx4 v7, s[8:11], s22 offen offset:2048 sc1 lds
    buffer_load_dwordx4 v7, s[8:11], s22 offen offset:3072 sc1 lds
    s_add_u32 s22, s22, 4096
    s_add_u32 m0, s23, 24576
    s_nop 0
    buffer_load_dwordx4 v7, s[8:11], s22 offen offset:0 sc1 lds
    buffer_load_dwordx4 v7, s[8:11], s22 offen offset:1024 sc1 lds
    buffer_load_dwordx4 v7, s[8:11], s22 offen offset:2048 sc1 lds
    buffer_load_dwordx4 v7, s[8:11], s22 offen offset:3072 sc1 lds
    s_add_u32 s22, s22, 4096
    v_add_u32 v9, 57344, v7
    s_waitcnt vmcnt(0)
    s_barrier
    ds_read_b128 v[128:131], v7 offset:0
    ds_read_b128 v[132:135], v7 offset:14336
    ds_read_b128 v[136:139], v7 offset:28672
    ds_read_b128 v[140:143], v7 offset:43008
    ds_read_b128 v[144:147], v9 offset:0
    ds_read_b128 v[148:151], v9 offset:14336
    ds_read_b128 v[152:155], v9 offset:28672
    ds_read_b128 v[156:159], v9 offset:43008
    s_waitcnt lgkmcnt(7)
    v_mfma_f32_16x16x32_bf16 v[32:35], v[128:131], a[200:203], 0
    ds_read_b128 v[160:163], v7 offset:1024
    s_waitcnt lgkmcnt(7)
    v_mfma_f32_16x16x32_bf16 v[36:39], v[132:135], a[200:203], 0
    ds_read_b128 v[164:167], v7 offset:15360
    s_waitcnt lgkmcnt(7)
    v_mfma_f32_16x16x32_bf16 v[40:43], v[136:139], a[200:203], 0
    ds_read_b128 v[168:171], v7 offset:29696
    s_waitcnt lgkmcnt(7)
    v_mfma_f32_16x16x32_bf16 v[44:47], v[140:143], a[200:203], 0
    ds_read_b128 v[172:175], v7 offset:44032
    s_waitcnt lgkmcnt(7)
    v_mfma_f32_16x16x32_bf16 v[48:51], v[144:147], a[200:203], 0
    ds_read_b128 v[176:179], v9 offset:1024
    s_waitcnt lgkmcnt(7)
    v_mfma_f32_16x16x32_bf16 v[52:55], v[148:151], a[200:203], 0
    ds_read_b128 v[180:183], v9 offset:15360
    s_waitcnt lgkmcnt(7)
    v_mfma_f32_16x16x32_bf16 v[56:59], v[152:155], a[200:203], 0
    ds_read_b128 v[184:187], v9 offset:29696
    s_waitcnt lgkmcnt(7)
    v_mfma_f32_16x16x32_bf16 v[60:63], v[156:159], a[200:203], 0
    ds_read_b128 v[188:191], v9 offset:44032
    s_waitcnt lgkmcnt(7)
    v_mfma_f32_16x16x32_bf16 v[32:35], v[160:163], a[204:207], v[32:35]
    ds_read_b128 v[128:131], v7 offset:2048
    s_waitcnt lgkmcnt(7)
    v_mfma_f32_16x16x32_bf16 v[36:39], v[164:167], a[204:207], v[36:39]
    ds_read_b128 v[132:135], v7 offset:16384
    s_waitcnt lgkmcnt(7)
    v_mfma_f32_16x16x32_bf16 v[40:43], v[168:171], a[204:207], v[40:43]
    ds_read_b128 v[136:139], v7 offset:30720
    s_waitcnt lgkmcnt(7)
    v_mfma_f32_16x16x32_bf16 v[44:47], v[172:175], a[204:207], v[44:47]
    ds_read_b128 v[140:143], v7 offset:45056
    s_waitcnt lgkmcnt(7)
    v_mfma_f32_16x16x32_bf16 v[48:51], v[176:179], a[204:207], v[48:51]
    ds_read_b128 v[144:147], v9 offset:2048
    s_waitcnt lgkmcnt(7)
    v_mfma_f32_16x16x32_bf16 v[52:55], v[180:183], a[204:207], v[52:55]
    ds_read_b128 v[148:151], v9 offset:16384
    s_waitcnt lgkmcnt(7)
    v_mfma_f32_16x16x32_bf16 v[56:59], v[184:187], a[204:207], v[56:59]
    ds_read_b128 v[152:155], v9 offset:30720
    s_waitcnt lgkmcnt(7)
    v_mfma_f32_16x16x32_bf16 v[60:63], v[188:191], a[204:207], v[60:63]
    ds_read_b128 v[156:159], v9 offset:45056
    s_waitcnt lgkmcnt(7)
    v_mfma_f32_16x16x32_bf16 v[32:35], v[128:131], a[208:211], v[32:35]
    ds_read_b128 v[160:163], v7 offset:3072
    s_waitcnt lgkmcnt(7)
    v_mfma_f32_16x16x32_bf16 v[36:39], v[132:135], a[208:211], v[36:39]
    ds_read_b128 v[164:167], v7 offset:17408
    s_waitcnt lgkmcnt(7)
    v_mfma_f32_16x16x32_bf16 v[40:43], v[136:139], a[208:211], v[40:43]
    ds_read_b128 v[168:171], v7 offset:31744
    s_waitcnt lgkmcnt(7)
    v_mfma_f32_16x16x32_bf16 v[44:47], v[140:143], a[208:211], v[44:47]
    ds_read_b128 v[172:175], v7 offset:46080
    s_waitcnt lgkmcnt(7)
    v_mfma_f32_16x16x32_bf16 v[48:51], v[144:147], a[208:211], v[48:51]
    ds_read_b128 v[176:179], v9 offset:3072
    s_waitcnt lgkmcnt(7)
    v_mfma_f32_16x16x32_bf16 v[52:55], v[148:151], a[208:211], v[52:55]
    ds_read_b128 v[180:183], v9 offset:17408
    s_waitcnt lgkmcnt(7)
    v_mfma_f32_16x16x32_bf16 v[56:59], v[152:155], a[208:211], v[56:59]
    ds_read_b128 v[184:187], v9 offset:31744
    s_waitcnt lgkmcnt(7)
    v_mfma_f32_16x16x32_bf16 v[60:63], v[156:159], a[208:211], v[60:63]
    ds_read_b128 v[188:191], v9 offset:46080
    s_waitcnt lgkmcnt(7)
    v_mfma_f32_16x16x32_bf16 v[32:35], v[160:163], a[212:215], v[32:35]
    ds_read_b128 v[128:131], v7 offset:4096
    s_waitcnt lgkmcnt(7)
    v_mfma_f32_16x16x32_bf16 v[36:39], v[164:167], a[212:215], v[36:39]
    ds_read_b128 v[132:135], v7 offset:18432
    s_waitcnt lgkmcnt(7)
    v_mfma_f32_16x16x32_bf16 v[40:43], v[168:171], a[212:215], v[40:43]
    ds_read_b128 v[136:139], v7 offset:32768
    s_waitcnt lgkmcnt(7)
    v_mfma_f32_16x16x32_bf16 v[44:47], v[172:175], a[212:215], v[44:47]
    ds_read_b128 v[140:143], v7 offset:47104
    s_waitcnt lgkmcnt(7)
    v_mfma_f32_16x16x32_bf16 v[48:51], v[176:179], a[212:215], v[48:51]
    ds_read_b128 v[144:147], v9 offset:4096
    s_waitcnt lgkmcnt(7)
    v_mfma_f32_16x16x32_bf16 v[52:55], v[180:183], a[212:215], v[52:55]
    ds_read_b128 v[148:151], v9 offset:18432
    s_waitcnt lgkmcnt(7)
    v_mfma_f32_16x16x32_bf16 v[56:59], v[184:187], a[212:215], v[56:59]
    ds_read_b128 v[152:155], v9 offset:32768
    s_waitcnt lgkmcnt(7)
    v_mfma_f32_16x16x32_bf16 v[60:63], v[188:191], a[212:215], v[60:63]
    ds_read_b128 v[156:159], v9 offset:47104
    s_waitcnt lgkmcnt(7)
    v_mfma_f32_16x16x32_bf16 v[32:35], v[128:131], a[216:219], v[32:35]
    ds_read_b128 v[160:163], v7 offset:5120
    s_waitcnt lgkmcnt(7)
    v_mfma_f32_16x16x32_bf16 v[36:39], v[132:135], a[216:219], v[36:39]
    ds_read_b128 v[164:167], v7 offset:19456
    s_waitcnt lgkmcnt(7)
    v_mfma_f32_16x16x32_bf16 v[40:43], v[136:139], a[216:219], v[40:43]
    ds_read_b128 v[168:171], v7 offset:33792
    s_waitcnt lgkmcnt(7)
    v_mfma_f32_16x16x32_bf16 v[44:47], v[140:143], a[216:219], v[44:47]
    ds_read_b128 v[172:175], v7 offset:48128
    s_waitcnt lgkmcnt(7)
    v_mfma_f32_16x16x32_bf16 v[48:51], v[144:147], a[216:219], v[48:51]
    ds_read_b128 v[176:179], v9 offset:5120
    s_waitcnt lgkmcnt(7)
    v_mfma_f32_16x16x32_bf16 v[52:55], v[148:151], a[216:219], v[52:55]
    ds_read_b128 v[180:183], v9 offset:19456
    s_waitcnt lgkmcnt(7)
    v_mfma_f32_16x16x32_bf16 v[56:59], v[152:155], a[216:219], v[56:59]
    ds_read_b128 v[184:187], v9 offset:33792
    s_waitcnt lgkmcnt(7)
    v_mfma_f32_16x16x32_bf16 v[60:63], v[156:159], a[216:219], v[60:63]
    ds_read_b128 v[188:191], v9 offset:48128
    s_waitcnt lgkmcnt(7)
    v_mfma_f32_16x16x32_bf16 v[32:35], v[160:163], a[220:223], v[32:35]
    ds_read_b128 v[128:131], v7 offset:6144
    s_waitcnt lgkmcnt(7)
    v_mfma_f32_16x16x32_bf16 v[36:39], v[164:167], a[220:223], v[36:39]
    ds_read_b128 v[132:135], v7 offset:20480
    s_waitcnt lgkmcnt(7)
    v_mfma_f32_16x16x32_bf16 v[40:43], v[168:171], a[220:223], v[40:43]
    ds_read_b128 v[136:139], v7 offset:34816
    s_waitcnt lgkmcnt(7)
    v_mfma_f32_16x16x32_bf16 v[44:47], v[172:175], a[220:223], v[44:47]
    ds_read_b128 v[140:143], v7 offset:49152
    s_waitcnt lgkmcnt(7)
    v_mfma_f32_16x16x32_bf16 v[48:51], v[176:179], a[220:223], v[48:51]
    ds_read_b128 v[144:147], v9 offset:6144
    s_waitcnt lgkmcnt(7)
    v_mfma_f32_16x16x32_bf16 v[52:55], v[180:183], a[220:223], v[52:55]
    ds_read_b128 v[148:151], v9 offset:20480
    s_waitcnt lgkmcnt(7)
    v_mfma_f32_16x16x32_bf16 v[56:59], v[184:187], a[220:223], v[56:59]
    ds_read_b128 v[152:155], v9 offset:34816
    s_waitcnt lgkmcnt(7)
    v_mfma_f32_16x16x32_bf16 v[60:63], v[188:191], a[220:223], v[60:63]
    ds_read_b128 v[156:159], v9 offset:49152
    s_waitcnt lgkmcnt(7)
    v_mfma_f32_16x16x32_bf16 v[32:35], v[128:131], a[224:227], v[32:35]
    ds_read_b128 v[160:163], v7 offset:7168
    s_waitcnt lgkmcnt(7)
    v_mfma_f32_16x16x32_bf16 v[36:39], v[132:135], a[224:227], v[36:39]
    ds_read_b128 v[164:167], v7 offset:21504
    s_waitcnt lgkmcnt(7)
    v_mfma_f32_16x16x32_bf16 v[40:43], v[136:139], a[224:227], v[40:43]
    ds_read_b128 v[168:171], v7 offset:35840
    s_waitcnt lgkmcnt(7)
    v_mfma_f32_16x16x32_bf16 v[44:47], v[140:143], a[224:227], v[44:47]
    ds_read_b128 v[172:175], v7 offset:50176
    s_waitcnt lgkmcnt(7)
    v_mfma_f32_16x16x32_bf16 v[48:51], v[144:147], a[224:227], v[48:51]
    ds_read_b128 v[176:179], v9 offset:7168
    s_waitcnt lgkmcnt(7)
    v_mfma_f32_16x16x32_bf16 v[52:55], v[148:151], a[224:227], v[52:55]
    ds_read_b128 v[180:183], v9 offset:21504
    s_waitcnt lgkmcnt(7)
    v_mfma_f32_16x16x32_bf16 v[56:59], v[152:155], a[224:227], v[56:59]
    ds_read_b128 v[184:187], v9 offset:35840
    s_waitcnt lgkmcnt(7)
    v_mfma_f32_16x16x32_bf16 v[60:63], v[156:159], a[224:227], v[60:63]
    ds_read_b128 v[188:191], v9 offset:50176
    s_waitcnt lgkmcnt(7)
    v_mfma_f32_16x16x32_bf16 v[32:35], v[160:163], a[228:231], v[32:35]
    ds_read_b128 v[128:131], v7 offset:8192
    s_waitcnt lgkmcnt(7)
    v_mfma_f32_16x16x32_bf16 v[36:39], v[164:167], a[228:231], v[36:39]
    ds_read_b128 v[132:135], v7 offset:22528
    s_waitcnt lgkmcnt(7)
    v_mfma_f32_16x16x32_bf16 v[40:43], v[168:171], a[228:231], v[40:43]
    ds_read_b128 v[136:139], v7 offset:36864
    s_waitcnt lgkmcnt(7)
    v_mfma_f32_16x16x32_bf16 v[44:47], v[172:175], a[228:231], v[44:47]
    ds_read_b128 v[140:143], v7 offset:51200
    s_waitcnt lgkmcnt(7)
    v_mfma_f32_16x16x32_bf16 v[48:51], v[176:179], a[228:231], v[48:51]
    ds_read_b128 v[144:147], v9 offset:8192
    s_waitcnt lgkmcnt(7)
    v_mfma_f32_16x16x32_bf16 v[52:55], v[180:183], a[228:231], v[52:55]
    ds_read_b128 v[148:151], v9 offset:22528
    s_waitcnt lgkmcnt(7)
    v_mfma_f32_16x16x32_bf16 v[56:59], v[184:187], a[228:231], v[56:59]
    ds_read_b128 v[152:155], v9 offset:36864
    s_waitcnt lgkmcnt(7)
    v_mfma_f32_16x16x32_bf16 v[60:63], v[188:191], a[228:231], v[60:63]
    ds_read_b128 v[156:159], v9 offset:51200
    s_waitcnt lgkmcnt(7)
    v_mfma_f32_16x16x32_bf16 v[32:35], v[128:131], a[232:235], v[32:35]
    ds_read_b128 v[160:163], v7 offset:9216
    s_waitcnt lgkmcnt(7)
    v_mfma_f32_16x16x32_bf16 v[36:39], v[132:135], a[232:235], v[36:39]
    ds_read_b128 v[164:167], v7 offset:23552
    s_waitcnt lgkmcnt(7)
    v_mfma_f32_16x16x32_bf16 v[40:43], v[136:139], a[232:235], v[40:43]
    ds_read_b128 v[168:171], v7 offset:37888
    s_waitcnt lgkmcnt(7)
    v_mfma_f32_16x16x32_bf16 v[44:47], v[140:143], a[232:235], v[44:47]
    ds_read_b128 v[172:175], v7 offset:52224
    s_waitcnt lgkmcnt(7)
    v_mfma_f32_16x16x32_bf16 v[48:51], v[144:147], a[232:235], v[48:51]
    ds_read_b128 v[176:179], v9 offset:9216
    s_waitcnt lgkmcnt(7)
    v_mfma_f32_16x16x32_bf16 v[52:55], v[148:151], a[232:235], v[52:55]
    ds_read_b128 v[180:183], v9 offset:23552
    s_waitcnt lgkmcnt(7)
    v_mfma_f32_16x16x32_bf16 v[56:59], v[152:155], a[232:235], v[56:59]
    ds_read_b128 v[184:187], v9 offset:37888
    s_waitcnt lgkmcnt(7)
    v_mfma_f32_16x16x32_bf16 v[60:63], v[156:159], a[232:235], v[60:63]
    ds_read_b128 v[188:191], v9 offset:52224
    s_waitcnt lgkmcnt(7)
    v_mfma_f32_16x16x32_bf16 v[32:35], v[160:163], a[236:239], v[32:35]
    ds_read_b128 v[128:131], v7 offset:10240
    s_waitcnt lgkmcnt(7)
    v_mfma_f32_16x16x32_bf16 v[36:39], v[164:167], a[236:239], v[36:39]
    ds_read_b128 v[132:135], v7 offset:24576
    s_waitcnt lgkmcnt(7)
    v_mfma_f32_16x16x32_bf16 v[40:43], v[168:171], a[236:239], v[40:43]
    ds_read_b128 v[136:139], v7 offset:38912
    s_waitcnt lgkmcnt(7)
    v_mfma_f32_16x16x32_bf16 v[44:47], v[172:175], a[236:239], v[44:47]
    ds_read_b128 v[140:143], v7 offset:53248
    s_waitcnt lgkmcnt(7)
    v_mfma_f32_16x16x32_bf16 v[48:51], v[176:179], a[236:239], v[48:51]
    ds_read_b128 v[144:147], v9 offset:10240
    s_waitcnt lgkmcnt(7)
    v_mfma_f32_16x16x32_bf16 v[52:55], v[180:183], a[236:239], v[52:55]
    ds_read_b128 v[148:151], v9 offset:24576
    s_waitcnt lgkmcnt(7)
    v_mfma_f32_16x16x32_bf16 v[56:59], v[184:187], a[236:239], v[56:59]
    ds_read_b128 v[152:155], v9 offset:38912
    s_waitcnt lgkmcnt(7)
    v_mfma_f32_16x16x32_bf16 v[60:63], v[188:191], a[236:239], v[60:63]
    ds_read_b128 v[156:159], v9 offset:53248
    s_waitcnt lgkmcnt(7)
    v_mfma_f32_16x16x32_bf16 v[32:35], v[128:131], a[240:243], v[32:35]
    ds_read_b128 v[160:163], v7 offset:11264
    s_waitcnt lgkmcnt(7)
    v_mfma_f32_16x16x32_bf16 v[36:39], v[132:135], a[240:243], v[36:39]
    ds_read_b128 v[164:167], v7 offset:25600
    s_waitcnt lgkmcnt(7)
    v_mfma_f32_16x16x32_bf16 v[40:43], v[136:139], a[240:243], v[40:43]
    ds_read_b128 v[168:171], v7 offset:39936
    s_waitcnt lgkmcnt(7)
    v_mfma_f32_16x16x32_bf16 v[44:47], v[140:143], a[240:243], v[44:47]
    ds_read_b128 v[172:175], v7 offset:54272
    s_waitcnt lgkmcnt(7)
    v_mfma_f32_16x16x32_bf16 v[48:51], v[144:147], a[240:243], v[48:51]
    ds_read_b128 v[176:179], v9 offset:11264
    s_waitcnt lgkmcnt(7)
    v_mfma_f32_16x16x32_bf16 v[52:55], v[148:151], a[240:243], v[52:55]
    ds_read_b128 v[180:183], v9 offset:25600
    s_waitcnt lgkmcnt(7)
    v_mfma_f32_16x16x32_bf16 v[56:59], v[152:155], a[240:243], v[56:59]
    ds_read_b128 v[184:187], v9 offset:39936
    s_waitcnt lgkmcnt(7)
    v_mfma_f32_16x16x32_bf16 v[60:63], v[156:159], a[240:243], v[60:63]
    ds_read_b128 v[188:191], v9 offset:54272
    s_waitcnt lgkmcnt(7)
    v_mfma_f32_16x16x32_bf16 v[32:35], v[160:163], a[244:247], v[32:35]
    ds_read_b128 v[128:131], v7 offset:12288
    s_waitcnt lgkmcnt(7)
    v_mfma_f32_16x16x32_bf16 v[36:39], v[164:167], a[244:247], v[36:39]
    ds_read_b128 v[132:135], v7 offset:26624
    s_waitcnt lgkmcnt(7)
    v_mfma_f32_16x16x32_bf16 v[40:43], v[168:171], a[244:247], v[40:43]
    ds_read_b128 v[136:139], v7 offset:40960
    s_waitcnt lgkmcnt(7)
    v_mfma_f32_16x16x32_bf16 v[44:47], v[172:175], a[244:247], v[44:47]
    ds_read_b128 v[140:143], v7 offset:55296
    s_waitcnt lgkmcnt(7)
    v_mfma_f32_16x16x32_bf16 v[48:51], v[176:179], a[244:247], v[48:51]
    ds_read_b128 v[144:147], v9 offset:12288
    s_waitcnt lgkmcnt(7)
    v_mfma_f32_16x16x32_bf16 v[52:55], v[180:183], a[244:247], v[52:55]
    ds_read_b128 v[148:151], v9 offset:26624
    s_waitcnt lgkmcnt(7)
    v_mfma_f32_16x16x32_bf16 v[56:59], v[184:187], a[244:247], v[56:59]
    ds_read_b128 v[152:155], v9 offset:40960
    s_waitcnt lgkmcnt(7)
    v_mfma_f32_16x16x32_bf16 v[60:63], v[188:191], a[244:247], v[60:63]
    ds_read_b128 v[156:159], v9 offset:55296
    s_waitcnt lgkmcnt(7)
    v_mfma_f32_16x16x32_bf16 v[32:35], v[128:131], a[248:251], v[32:35]
    ds_read_b128 v[160:163], v7 offset:13312
    s_waitcnt lgkmcnt(7)
    v_mfma_f32_16x16x32_bf16 v[36:39], v[132:135], a[248:251], v[36:39]
    ds_read_b128 v[164:167], v7 offset:27648
    s_waitcnt lgkmcnt(7)
    v_mfma_f32_16x16x32_bf16 v[40:43], v[136:139], a[248:251], v[40:43]
    ds_read_b128 v[168:171], v7 offset:41984
    s_waitcnt lgkmcnt(7)
    v_mfma_f32_16x16x32_bf16 v[44:47], v[140:143], a[248:251], v[44:47]
    ds_read_b128 v[172:175], v7 offset:56320
    s_waitcnt lgkmcnt(7)
    v_mfma_f32_16x16x32_bf16 v[48:51], v[144:147], a[248:251], v[48:51]
    ds_read_b128 v[176:179], v9 offset:13312
    s_waitcnt lgkmcnt(7)
    v_mfma_f32_16x16x32_bf16 v[52:55], v[148:151], a[248:251], v[52:55]
    ds_read_b128 v[180:183], v9 offset:27648
    s_waitcnt lgkmcnt(7)
    v_mfma_f32_16x16x32_bf16 v[56:59], v[152:155], a[248:251], v[56:59]
    ds_read_b128 v[184:187], v9 offset:41984
    s_waitcnt lgkmcnt(7)
    v_mfma_f32_16x16x32_bf16 v[60:63], v[156:159], a[248:251], v[60:63]
    ds_read_b128 v[188:191], v9 offset:56320
    s_waitcnt lgkmcnt(7)
    v_mfma_f32_16x16x32_bf16 v[32:35], v[160:163], a[252:255], v[32:35]
    s_waitcnt lgkmcnt(6)
    v_mfma_f32_16x16x32_bf16 v[36:39], v[164:167], a[252:255], v[36:39]
    s_waitcnt lgkmcnt(5)
    v_mfma_f32_16x16x32_bf16 v[40:43], v[168:171], a[252:255], v[40:43]
    s_waitcnt lgkmcnt(4)
    v_mfma_f32_16x16x32_bf16 v[44:47], v[172:175], a[252:255], v[44:47]
    s_waitcnt lgkmcnt(3)
    v_mfma_f32_16x16x32_bf16 v[48:51], v[176:179], a[252:255], v[48:51]
    s_waitcnt lgkmcnt(2)
    v_mfma_f32_16x16x32_bf16 v[52:55], v[180:183], a[252:255], v[52:55]
    s_waitcnt lgkmcnt(1)
    v_mfma_f32_16x16x32_bf16 v[56:59], v[184:187], a[252:255], v[56:59]
    s_waitcnt lgkmcnt(0)
    v_mfma_f32_16x16x32_bf16 v[60:63], v[188:191], a[252:255], v[60:63]
    s_lshl_b32 s22, s33, 6
    s_add_u32 s22, s22, s31
    s_mul_i32 s22, s22, 28
    s_add_u32 s22, s22, s34
    s_lshl_b32 s22, s22, 10
    s_add_u32 s22, s22, 0x1c00000
    s_add_u32 s22, s22, s84
    v_cvt_pk_bf16_f32 v12, v32, v33
    v_cvt_pk_bf16_f32 v13, v36, v37
    v_cvt_pk_bf16_f32 v14, v34, v35
    v_cvt_pk_bf16_f32 v15, v38, v39
    buffer_store_dwordx4 v[12:15], v7, s[8:11], s22 offen sc1
    s_add_u32 s22, s22, 458752
    v_cvt_pk_bf16_f32 v16, v40, v41
    v_cvt_pk_bf16_f32 v17, v44, v45
    v_cvt_pk_bf16_f32 v18, v42, v43
    v_cvt_pk_bf16_f32 v19, v46, v47
    buffer_store_dwordx4 v[16:19], v7, s[8:11], s22 offen sc1
    s_add_u32 s22, s22, 458752
    v_cvt_pk_bf16_f32 v20, v48, v49
    v_cvt_pk_bf16_f32 v21, v52, v53
    v_cvt_pk_bf16_f32 v22, v50, v51
    v_cvt_pk_bf16_f32 v23, v54, v55
    buffer_store_dwordx4 v[20:23], v7, s[8:11], s22 offen sc1
    s_add_u32 s22, s22, 458752
    v_cvt_pk_bf16_f32 v24, v56, v57
    v_cvt_pk_bf16_f32 v25, v60, v61
    v_cvt_pk_bf16_f32 v26, v58, v59
    v_cvt_pk_bf16_f32 v27, v62, v63
    buffer_store_dwordx4 v[24:27], v7, s[8:11], s22 offen sc1
    s_add_u32 s22, s22, 458752
    s_waitcnt vmcnt(0)
    s_barrier
    s_cmp_lg_u32 s3, 0
    s_cbranch_scc1 la0_W_fast
    s_lshl_b32 s22, s33, 4
    s_add_u32 s22, s22, s31
    s_lshl_b32 s22, s22, 7
    s_add_u32 s22, s22, 0x428e000
    s_add_u32 s22, s22, s84
    v_mov_b32 v2, 1
    v_mov_b32 v3, 0
    s_mov_b64 exec, 1
    buffer_atomic_add v2, v3, s[8:11], s22 offen
    s_mov_b64 exec, -1
    s_branch la0_W_fast
la0_W_first:
    s_cmp_lt_i32 s83, 0
    s_cbranch_scc1 la0_oaddf
    s_lshl_b32 s22, s3, 2
    s_cmp_eq_u32 s3, 3
    s_cselect_b32 s22, 11, s22
    s_lshl_b32 s22, s22, 7
    v_bfe_u32 v12, v1, 0, 4
    v_mul_u32_u24 v12, 0x700, v12
    v_bfe_u32 v2, v1, 4, 2
    v_lshlrev_b32 v2, 5, v2
    v_add_u32 v12, v12, v2
    v_add_u32 v12, s22, v12
    ds_write_b128 v12, a[160:163] offset:0
    ds_write_b128 v12, a[164:167] offset:16
    ds_write_b128 v12, a[168:171] offset:128
    ds_write_b128 v12, a[172:175] offset:144
    ds_write_b128 v12, a[176:179] offset:256
    ds_write_b128 v12, a[180:183] offset:272
    s_cmp_ge_u32 s3, 2
    s_cbranch_scc1 la0_oaddf_w
    ds_write_b128 v12, a[184:187] offset:384
    ds_write_b128 v12, a[188:191] offset:400
la0_oaddf_w:
    s_mul_i32 s23, s3, 7168
    v_lshlrev_b32 v13, 2, v1
    v_add_u32 v12, s23, v13
    s_mul_i32 s22, s83, 28672
    s_add_u32 s22, s22, s23
    s_add_u32 s22, s22, 0xe00000
    s_add_u32 s23, s22, 4096
    s_waitcnt lgkmcnt(0)
    s_barrier
    ds_read_b32 v32, v12 offset:0
    ds_read_b32 v33, v12 offset:256
    ds_read_b32 v34, v12 offset:512
    ds_read_b32 v35, v12 offset:768
    ds_read_b32 v36, v12 offset:1024
    ds_read_b32 v37, v12 offset:1280
    ds_read_b32 v38, v12 offset:1536
    ds_read_b32 v39, v12 offset:1792
    ds_read_b32 v40, v12 offset:2048
    ds_read_b32 v41, v12 offset:2304
    ds_read_b32 v42, v12 offset:2560
    ds_read_b32 v43, v12 offset:2816
    ds_read_b32 v44, v12 offset:3072
    ds_read_b32 v45, v12 offset:3328
    s_waitcnt lgkmcnt(13)
    buffer_atomic_add_f32 v32, v13, s[8:11], s22 offen offset:0
    s_waitcnt lgkmcnt(12)
    buffer_atomic_add_f32 v33, v13, s[8:11], s22 offen offset:256
    s_waitcnt lgkmcnt(11)
    buffer_atomic_add_f32 v34, v13, s[8:11], s22 offen offset:512
    s_waitcnt lgkmcnt(10)
    buffer_atomic_add_f32 v35, v13, s[8:11], s22 offen offset:768
    s_waitcnt lgkmcnt(9)
    buffer_atomic_add_f32 v36, v13, s[8:11], s22 offen offset:1024
    s_waitcnt lgkmcnt(8)
    buffer_atomic_add_f32 v37, v13, s[8:11], s22 offen offset:1280
    s_waitcnt lgkmcnt(7)
    buffer_atomic_add_f32 v38, v13, s[8:11], s22 offen offset:1536
    s_waitcnt lgkmcnt(6)
    buffer_atomic_add_f32 v39, v13, s[8:11], s22 offen offset:1792
    s_waitcnt lgkmcnt(5)
    buffer_atomic_add_f32 v40, v13, s[8:11], s22 offen offset:2048
    s_waitcnt lgkmcnt(4)
    buffer_atomic_add_f32 v41, v13, s[8:11], s22 offen offset:2304
    s_waitcnt lgkmcnt(3)
    buffer_atomic_add_f32 v42, v13, s[8:11], s22 offen offset:2560
    s_waitcnt lgkmcnt(2)
    buffer_atomic_add_f32 v43, v13, s[8:11], s22 offen offset:2816
    s_waitcnt lgkmcnt(1)
    buffer_atomic_add_f32 v44, v13, s[8:11], s22 offen offset:3072
    s_waitcnt lgkmcnt(0)
    buffer_atomic_add_f32 v45, v13, s[8:11], s22 offen offset:3328
    ds_read_b32 v46, v12 offset:3584
    ds_read_b32 v47, v12 offset:3840
    ds_read_b32 v48, v12 offset:4096
    ds_read_b32 v49, v12 offset:4352
    ds_read_b32 v50, v12 offset:4608
    ds_read_b32 v51, v12 offset:4864
    ds_read_b32 v52, v12 offset:5120
    ds_read_b32 v53, v12 offset:5376
    ds_read_b32 v54, v12 offset:5632
    ds_read_b32 v55, v12 offset:5888
    ds_read_b32 v56, v12 offset:6144
    ds_read_b32 v57, v12 offset:6400
    ds_read_b32 v58, v12 offset:6656
    ds_read_b32 v59, v12 offset:6912
    s_waitcnt lgkmcnt(13)
    buffer_atomic_add_f32 v46, v13, s[8:11], s22 offen offset:3584
    s_waitcnt lgkmcnt(12)
    buffer_atomic_add_f32 v47, v13, s[8:11], s22 offen offset:3840
    s_waitcnt lgkmcnt(11)
    buffer_atomic_add_f32 v48, v13, s[8:11], s23 offen offset:0
    s_waitcnt lgkmcnt(10)
    buffer_atomic_add_f32 v49, v13, s[8:11], s23 offen offset:256
    s_waitcnt lgkmcnt(9)
    buffer_atomic_add_f32 v50, v13, s[8:11], s23 offen offset:512
    s_waitcnt lgkmcnt(8)
    buffer_atomic_add_f32 v51, v13, s[8:11], s23 offen offset:768
    s_waitcnt lgkmcnt(7)
    buffer_atomic_add_f32 v52, v13, s[8:11], s23 offen offset:1024
    s_waitcnt lgkmcnt(6)
    buffer_atomic_add_f32 v53, v13, s[8:11], s23 offen offset:1280
    s_waitcnt lgkmcnt(5)
    buffer_atomic_add_f32 v54, v13, s[8:11], s23 offen offset:1536
    s_waitcnt lgkmcnt(4)
    buffer_atomic_add_f32 v55, v13, s[8:11], s23 offen offset:1792
    s_waitcnt lgkmcnt(3)
    buffer_atomic_add_f32 v56, v13, s[8:11], s23 offen offset:2048
    s_waitcnt lgkmcnt(2)
    buffer_atomic_add_f32 v57, v13, s[8:11], s23 offen offset:2304
    s_waitcnt lgkmcnt(1)
    buffer_atomic_add_f32 v58, v13, s[8:11], s23 offen offset:2560
    s_waitcnt lgkmcnt(0)
    buffer_atomic_add_f32 v59, v13, s[8:11], s23 offen offset:2816
    s_waitcnt vmcnt(0)
    s_barrier
    s_cmp_lg_u32 s3, 0
    s_cbranch_scc1 la0_oaddf_c
    s_lshr_b32 s22, s83, 1
    s_lshl_b32 s22, s22, 7
    s_add_u32 s22, s22, 0x4298000
    s_add_u32 s22, s22, s84
    v_mov_b32 v2, 1
    v_mov_b32 v3, 0
    s_mov_b64 exec, 1
    buffer_atomic_add v2, v3, s[8:11], s22 offen
    s_mov_b64 exec, -1
la0_oaddf_c:
    s_mov_b32 s83, -1
la0_oaddf:
    s_mov_b32 s36, 1
    s_cmp_lg_u32 s89, 0
    s_cbranch_scc1 la0_O_pull
la0_W_idx:
    s_sub_u32 s22, s21, 1
    s_and_b32 s22, s22, 7
    s_lshl_b32 s22, s22, 5
    s_add_u32 s22, s22, s20
    s_cmp_ge_u32 s20, 32
    s_cbranch_scc1 la0_W_scan
    s_cmp_ge_u32 s22, 224
    s_cbranch_scc1 la0_W_scan
    s_mul_i32 s31, s22, 4682
    s_lshr_b32 s31, s31, 16
    s_mul_i32 s23, s31, 14
    s_sub_u32 s30, s22, s23
    s_mov_b32 s32, -1
la0_W_item:
    v_lshlrev_b32 v7, 4, v1
    s_sub_u32 s22, s30, 14
    s_lshl_b32 s22, s22, 2
    s_add_u32 s22, s22, s32
    s_add_u32 s22, s22, 14
    s_cmp_lt_i32 s32, 0
    s_cselect_b32 s22, s30, s22
    s_lshl_b32 s22, s22, 4
    s_add_u32 s22, s22, s31
    s_lshl_b32 s22, s22, 5
    s_add_u32 s85, s22, 0x4283000
    s_add_u32 s85, s85, s84
    s_cmp_lg_u32 s3, 0
    s_cbranch_scc1 la0_W_noclaim
    v_mov_b32 v11, 1
    v_mov_b32 v3, 0
    s_mov_b64 exec, 1
    buffer_atomic_add v11, v3, s[8:11], s85 offen sc0
    s_mov_b64 exec, -1
la0_W_noclaim:
    s_mul_i32 s22, s31, 28
    s_mul_i32 s23, s3, 7
    s_add_u32 s23, s23, s22
    s_mul_i32 s23, s23, 14336
    s_add_u32 s23, s23, 0x0
    s_add_u32 s50, s23, 0
    s_add_u32 s51, s23, 14336
    s_add_u32 s52, s23, 28672
    s_add_u32 s53, s23, 43008
    s_add_u32 s54, s23, 57344
    s_add_u32 s55, s23, 71680
    s_add_u32 s56, s23, 86016
    s_lshr_b32 s24, s3, 1
    s_and_b32 s25, s3, 1
    s_mul_i32 s23, s24, 14
    s_add_u32 s23, s23, s22
    s_lshl_b32 s26, s25, 3
    s_add_u32 s26, s26, s23
    s_mul_i32 s26, s26, 14336
    s_add_u32 s26, s26, 0x620000
    s_add_u32 s60, s26, 0
    s_add_u32 s61, s26, 14336
    s_add_u32 s62, s26, 28672
    s_add_u32 s63, s26, 43008
    s_add_u32 s64, s26, 57344
    s_add_u32 s65, s26, 71680
    s_add_u32 s26, s23, s25
    s_add_u32 s26, s26, 6
    s_mul_i32 s26, s26, 14336
    s_add_u32 s66, s26, 0x620000
    s_cmp_eq_u32 s89, 0
    s_cbranch_scc1 wt_8_ok
    s_mov_b32 s91, 0
    v_mbcnt_lo_u32_b32 v2, -1, 0
    v_mbcnt_hi_u32_b32 v2, -1, v2
    v_and_b32 v2, 7, v2
    v_lshlrev_b32 v2, 7, v2
    s_lshl_b32 s22, s30, 10
    s_add_u32 s22, s22, 0x428a000
    s_add_u32 s22, s22, s84
wt_8:
    buffer_load_dword v3, v2, s[8:11], s22 offen sc1
    s_waitcnt vmcnt(0)
    v_cmp_eq_u32 vcc, 0, v3
    s_cbranch_vccz wt_8_ok
    s_sleep 2
    s_add_u32 s91, s91, 1
    s_cmp_lt_u32 s91, s90
    s_cbranch_scc1 wt_8
    s_mov_b32 s90, 0
    s_branch wt_8_ok
wt_8_ok:
    s_lshl_b32 s22, s30, 2
    s_add_u32 s22, s22, s3
    s_mul_i32 s22, s22, 28672
    s_add_u32 s22, s22, 0x1800000
    s_add_u32 s22, s22, s84
    s_mul_i32 s23, s3, 28672
    s_add_u32 m0, s23, 0
    s_nop 0
    buffer_load_dwordx4 v7, s[8:11], s22 offen offset:0 sc1 lds
    buffer_load_dwordx4 v7, s[8:11], s22 offen offset:1024 sc1 lds
    buffer_load_dwordx4 v7, s[8:11], s22 offen offset:2048 sc1 lds
    buffer_load_dwordx4 v7, s[8:11], s22 offen offset:3072 sc1 lds
    s_add_u32 s22, s22, 4096
    s_add_u32 m0, s23, 4096
    s_nop 0
    buffer_load_dwordx4 v7, s[8:11], s22 offen offset:0 sc1 lds
    buffer_load_dwordx4 v7, s[8:11], s22 offen offset:1024 sc1 lds
    buffer_load_dwordx4 v7, s[8:11], s22 offen offset:2048 sc1 lds
    buffer_load_dwordx4 v7, s[8:11], s22 offen offset:3072 sc1 lds
    s_add_u32 s22, s22, 4096
    s_add_u32 m0, s23, 8192
    s_nop 0
    buffer_load_dwordx4 v7, s[8:11], s22 offen offset:0 sc1 lds
    buffer_load_dwordx4 v7, s[8:11], s22 offen offset:1024 sc1 lds
    buffer_load_dwordx4 v7, s[8:11], s22 offen offset:2048 sc1 lds
    buffer_load_dwordx4 v7, s[8:11], s22 offen offset:3072 sc1 lds
    s_add_u32 s22, s22, 4096
    s_add_u32 m0, s23, 12288
    s_nop 0
    buffer_load_dwordx4 v7, s[8:11], s22 offen offset:0 sc1 lds
    buffer_load_dwordx4 v7, s[8:11], s22 offen offset:1024 sc1 lds
    buffer_load_dwordx4 v7, s[8:11], s22 offen offset:2048 sc1 lds
    buffer_load_dwordx4 v7, s[8:11], s22 offen offset:3072 sc1 lds
    s_add_u32 s22, s22, 4096
    s_add_u32 m0, s23, 16384
    s_nop 0
    buffer_load_dwordx4 v7, s[8:11], s22 offen offset:0 sc1 lds
    buffer_load_dwordx4 v7, s[8:11], s22 offen offset:1024 sc1 lds
    buffer_load_dwordx4 v7, s[8:11], s22 offen offset:2048 sc1 lds
    buffer_load_dwordx4 v7, s[8:11], s22 offen offset:3072 sc1 lds
    s_add_u32 s22, s22, 4096
    s_add_u32 m0, s23, 20480
    s_nop 0
    buffer_load_dwordx4 v7, s[8:11], s22 offen offset:0 sc1 lds
    buffer_load_dwordx4 v7, s[8:11], s22 offen offset:1024 sc1 lds
    buffer_load_dwordx4 v7, s[8:11], s22 offen offset:2048 sc1 lds
    buffer_load_dwordx4 v7, s[8:11], s22 offen offset:3072 sc1 lds
    s_add_u32 s22, s22, 4096
    s_add_u32 m0, s23, 24576
    s_nop 0
    buffer_load_dwordx4 v7, s[8:11], s22 offen offset:0 sc1 lds
    buffer_load_dwordx4 v7, s[8:11], s22 offen offset:1024 sc1 lds
    buffer_load_dwordx4 v7, s[8:11], s22 offen offset:2048 sc1 lds
    buffer_load_dwordx4 v7, s[8:11], s22 offen offset:3072 sc1 lds
    s_add_u32 s22, s22, 4096
    buffer_load_dwordx4 a[176:179], v7, s[8:11], s50 offen offset:0
    buffer_load_dwordx4 a[180:183], v7, s[8:11], s51 offen offset:0
    buffer_load_dwordx4 a[184:187], v7, s[8:11], s52 offen offset:0
    buffer_load_dwordx4 a[188:191], v7, s[8:11], s53 offen offset:0
    buffer_load_dwordx4 a[192:195], v7, s[8:11], s54 offen offset:0
    buffer_load_dwordx4 a[196:199], v7, s[8:11], s55 offen offset:0
    buffer_load_dwordx4 a[200:203], v7, s[8:11], s56 offen offset:0
    buffer_load_dwordx4 a[204:207], v7, s[8:11], s50 offen offset:1024
    buffer_load_dwordx4 a[208:211], v7, s[8:11], s51 offen offset:1024
    buffer_load_dwordx4 a[212:215], v7, s[8:11], s52 offen offset:1024
    buffer_load_dwordx4 a[216:219], v7, s[8:11], s53 offen offset:1024
    buffer_load_dwordx4 a[220:223], v7, s[8:11], s54 offen offset:1024
    buffer_load_dwordx4 a[224:227], v7, s[8:11], s55 offen offset:1024
    buffer_load_dwordx4 a[228:231], v7, s[8:11], s56 offen offset:1024
    s_waitcnt vmcnt(0)
    s_cmp_lg_u32 s3, 0
    s_cbranch_scc1 la0_W_noclaim2
    v_mov_b32 v3, 0x27ff0
    s_mov_b64 exec, 1
    ds_write_b32 v3, v11
    s_mov_b64 exec, -1
    s_waitcnt lgkmcnt(0)
la0_W_noclaim2:
    s_barrier
    v_mov_b32 v3, 0x27ff0
    ds_read_b32 v2, v3
    s_waitcnt lgkmcnt(0)
    v_readfirstlane_b32 s22, v2
    s_nop 0
    s_cmp_lg_u32 s22, 0
    s_cbranch_scc1 la0_W_scan
    v_mov_b32 v8, v7
    v_add_u32 v9, 57344, v7
    ds_read_b128 a[112:115], v8 offset:0
    ds_read_b128 a[116:119], v8 offset:14336
    ds_read_b128 a[120:123], v8 offset:28672
    ds_read_b128 a[124:127], v8 offset:43008
    ds_read_b128 a[128:131], v9 offset:0
    ds_read_b128 a[132:135], v9 offset:14336
    ds_read_b128 a[136:139], v9 offset:28672
    ds_read_b128 a[140:143], v9 offset:43008
    s_mov_b32 s70, s50
    s_mov_b32 s71, s51
    s_mov_b32 s72, s52
    s_mov_b32 s73, s53
    s_mov_b32 s74, s54
    s_mov_b32 s75, s55
    s_mov_b32 s76, s56
    v_mov_b32 v10, v7
    s_waitcnt lgkmcnt(0)
    s_waitcnt vmcnt(13)
    v_mfma_f32_16x16x32_bf16 v[32:35], a[112:115], a[176:179], 0
    v_mfma_f32_16x16x32_bf16 v[36:39], a[116:119], a[176:179], 0
    ds_read_b128 a[144:147], v8 offset:1024
    v_mfma_f32_16x16x32_bf16 v[40:43], a[120:123], a[176:179], 0
    v_mfma_f32_16x16x32_bf16 v[44:47], a[124:127], a[176:179], 0
    v_mfma_f32_16x16x32_bf16 v[48:51], a[128:131], a[176:179], 0
    v_mfma_f32_16x16x32_bf16 v[52:55], a[132:135], a[176:179], 0
    v_mfma_f32_16x16x32_bf16 v[56:59], a[136:139], a[176:179], 0
    v_mfma_f32_16x16x32_bf16 v[60:63], a[140:143], a[176:179], 0
    buffer_load_dwordx4 a[176:179], v10, s[8:11], s70 offen offset:2048
    s_waitcnt vmcnt(13)
    v_mfma_f32_16x16x32_bf16 v[64:67], a[112:115], a[180:183], 0
    v_mfma_f32_16x16x32_bf16 v[68:71], a[116:119], a[180:183], 0
    ds_read_b128 a[148:151], v8 offset:15360
    v_mfma_f32_16x16x32_bf16 v[72:75], a[120:123], a[180:183], 0
    v_mfma_f32_16x16x32_bf16 v[76:79], a[124:127], a[180:183], 0
    v_mfma_f32_16x16x32_bf16 v[80:83], a[128:131], a[180:183], 0
    v_mfma_f32_16x16x32_bf16 v[84:87], a[132:135], a[180:183], 0
    v_mfma_f32_16x16x32_bf16 v[88:91], a[136:139], a[180:183], 0
    v_mfma_f32_16x16x32_bf16 v[92:95], a[140:143], a[180:183], 0
    buffer_load_dwordx4 a[180:183], v10, s[8:11], s71 offen offset:2048
    s_waitcnt vmcnt(13)
    v_mfma_f32_16x16x32_bf16 v[96:99], a[112:115], a[184:187], 0
    v_mfma_f32_16x16x32_bf16 v[100:103], a[116:119], a[184:187], 0
    ds_read_b128 a[152:155], v8 offset:29696
    v_mfma_f32_16x16x32_bf16 v[104:107], a[120:123], a[184:187], 0
    v_mfma_f32_16x16x32_bf16 v[108:111], a[124:127], a[184:187], 0
    v_mfma_f32_16x16x32_bf16 v[112:115], a[128:131], a[184:187], 0
    v_mfma_f32_16x16x32_bf16 v[116:119], a[132:135], a[184:187], 0
    v_mfma_f32_16x16x32_bf16 v[120:123], a[136:139], a[184:187], 0
    v_mfma_f32_16x16x32_bf16 v[124:127], a[140:143], a[184:187], 0
    buffer_load_dwordx4 a[184:187], v10, s[8:11], s72 offen offset:2048
    s_waitcnt vmcnt(13)
    v_mfma_f32_16x16x32_bf16 v[128:131], a[112:115], a[188:191], 0
    v_mfma_f32_16x16x32_bf16 v[132:135], a[116:119], a[188:191], 0
    ds_read_b128 a[156:159], v8 offset:44032
    v_mfma_f32_16x16x32_bf16 v[136:139], a[120:123], a[188:191], 0
    v_mfma_f32_16x16x32_bf16 v[140:143], a[124:127], a[188:191], 0
    v_mfma_f32_16x16x32_bf16 v[144:147], a[128:131], a[188:191], 0
    v_mfma_f32_16x16x32_bf16 v[148:151], a[132:135], a[188:191], 0
    v_mfma_f32_16x16x32_bf16 v[152:155], a[136:139], a[188:191], 0
    v_mfma_f32_16x16x32_bf16 v[156:159], a[140:143], a[188:191], 0
    buffer_load_dwordx4 a[188:191], v10, s[8:11], s73 offen offset:2048
    s_waitcnt vmcnt(13)
    v_mfma_f32_16x16x32_bf16 v[160:163], a[112:115], a[192:195], 0
    v_mfma_f32_16x16x32_bf16 v[164:167], a[116:119], a[192:195], 0
    ds_read_b128 a[160:163], v9 offset:1024
    v_mfma_f32_16x16x32_bf16 v[168:171], a[120:123], a[192:195], 0
    v_mfma_f32_16x16x32_bf16 v[172:175], a[124:127], a[192:195], 0
    v_mfma_f32_16x16x32_bf16 v[176:179], a[128:131], a[192:195], 0
    v_mfma_f32_16x16x32_bf16 v[180:183], a[132:135], a[192:195], 0
    v_mfma_f32_16x16x32_bf16 v[184:187], a[136:139], a[192:195], 0
    v_mfma_f32_16x16x32_bf16 v[188:191], a[140:143], a[192:195], 0
    buffer_load_dwordx4 a[192:195], v10, s[8:11], s74 offen offset:2048
    s_waitcnt vmcnt(13)
    v_mfma_f32_16x16x32_bf16 v[192:195], a[112:115], a[196:199], 0
    v_mfma_f32_16x16x32_bf16 v[196:199], a[116:119], a[196:199], 0
    ds_read_b128 a[164:167], v9 offset:15360
    v_mfma_f32_16x16x32_bf16 v[200:203], a[120:123], a[196:199], 0
    v_mfma_f32_16x16x32_bf16 v[204:207], a[124:127], a[196:199], 0
    v_mfma_f32_16x16x32_bf16 v[208:211], a[128:131], a[196:199], 0
    v_mfma_f32_16x16x32_bf16 v[212:215], a[132:135], a[196:199], 0
    v_mfma_f32_16x16x32_bf16 v[216:219], a[136:139], a[196:199], 0
    v_mfma_f32_16x16x32_bf16 v[220:223], a[140:143], a[196:199], 0
    buffer_load_dwordx4 a[196:199], v10, s[8:11], s75 offen offset:2048
    s_waitcnt vmcnt(13)
    v_mfma_f32_16x16x32_bf16 v[224:227], a[112:115], a[200:203], 0
    v_mfma_f32_16x16x32_bf16 v[228:231], a[116:119], a[200:203], 0
    ds_read_b128 a[168:171], v9 offset:29696
    v_mfma_f32_16x16x32_bf16 v[232:235], a[120:123], a[200:203], 0
    v_mfma_f32_16x16x32_bf16 v[236:239], a[124:127], a[200:203], 0
    ds_read_b128 a[172:175], v9 offset:44032
    v_mfma_f32_16x16x32_bf16 v[240:243], a[128:131], a[200:203], 0
    v_mfma_f32_16x16x32_bf16 v[244:247], a[132:135], a[200:203], 0
    v_mfma_f32_16x16x32_bf16 v[248:251], a[136:139], a[200:203], 0
    v_mfma_f32_16x16x32_bf16 v[252:255], a[140:143], a[200:203], 0
    buffer_load_dwordx4 a[200:203], v10, s[8:11], s76 offen offset:2048
    s_waitcnt lgkmcnt(0)
    s_waitcnt vmcnt(13)
    v_mfma_f32_16x16x32_bf16 v[32:35], a[144:147], a[204:207], v[32:35]
    v_mfma_f32_16x16x32_bf16 v[36:39], a[148:151], a[204:207], v[36:39]
    ds_read_b128 a[112:115], v8 offset:2048
    v_mfma_f32_16x16x32_bf16 v[40:43], a[152:155], a[204:207], v[40:43]
    v_mfma_f32_16x16x32_bf16 v[44:47], a[156:159], a[204:207], v[44:47]
    v_mfma_f32_16x16x32_bf16 v[48:51], a[160:163], a[204:207], v[48:51]
    v_mfma_f32_16x16x32_bf16 v[52:55], a[164:167], a[204:207], v[52:55]
    v_mfma_f32_16x16x32_bf16 v[56:59], a[168:171], a[204:207], v[56:59]
    v_mfma_f32_16x16x32_bf16 v[60:63], a[172:175], a[204:207], v[60:63]
    buffer_load_dwordx4 a[204:207], v10, s[8:11], s70 offen offset:3072
    s_waitcnt vmcnt(13)
    v_mfma_f32_16x16x32_bf16 v[64:67], a[144:147], a[208:211], v[64:67]
    v_mfma_f32_16x16x32_bf16 v[68:71], a[148:151], a[208:211], v[68:71]
    ds_read_b128 a[116:119], v8 offset:16384
    v_mfma_f32_16x16x32_bf16 v[72:75], a[152:155], a[208:211], v[72:75]
    v_mfma_f32_16x16x32_bf16 v[76:79], a[156:159], a[208:211], v[76:79]
    v_mfma_f32_16x16x32_bf16 v[80:83], a[160:163], a[208:211], v[80:83]
    v_mfma_f32_16x16x32_bf16 v[84:87], a[164:167], a[208:211], v[84:87]
    v_mfma_f32_16x16x32_bf16 v[88:91], a[168:171], a[208:211], v[88:91]
    v_mfma_f32_16x16x32_bf16 v[92:95], a[172:175], a[208:211], v[92:95]
    buffer_load_dwordx4 a[208:211], v10, s[8:11], s71 offen offset:3072
    s_waitcnt vmcnt(13)
    v_mfma_f32_16x16x32_bf16 v[96:99], a[144:147], a[212:215], v[96:99]
    v_mfma_f32_16x16x32_bf16 v[100:103], a[148:151], a[212:215], v[100:103]
    ds_read_b128 a[120:123], v8 offset:30720
    v_mfma_f32_16x16x32_bf16 v[104:107], a[152:155], a[212:215], v[104:107]
    v_mfma_f32_16x16x32_bf16 v[108:111], a[156:159], a[212:215], v[108:111]
    v_mfma_f32_16x16x32_bf16 v[112:115], a[160:163], a[212:215], v[112:115]
    v_mfma_f32_16x16x32_bf16 v[116:119], a[164:167], a[212:215], v[116:119]
    v_mfma_f32_16x16x32_bf16 v[120:123], a[168:171], a[212:215], v[120:123]
    v_mfma_f32_16x16x32_bf16 v[124:127], a[172:175], a[212:215], v[124:127]
    buffer_load_dwordx4 a[212:215], v10, s[8:11], s72 offen offset:3072
    s_waitcnt vmcnt(13)
    v_mfma_f32_16x16x32_bf16 v[128:131], a[144:147], a[216:219], v[128:131]
    v_mfma_f32_16x16x32_bf16 v[132:135], a[148:151], a[216:219], v[132:135]
    ds_read_b128 a[124:127], v8 offset:45056
    v_mfma_f32_16x16x32_bf16 v[136:139], a[152:155], a[216:219], v[136:139]
    v_mfma_f32_16x16x32_bf16 v[140:143], a[156:159], a[216:219], v[140:143]
    v_mfma_f32_16x16x32_bf16 v[144:147], a[160:163], a[216:219], v[144:147]
    v_mfma_f32_16x16x32_bf16 v[148:151], a[164:167], a[216:219], v[148:151]
    v_mfma_f32_16x16x32_bf16 v[152:155], a[168:171], a[216:219], v[152:155]
    v_mfma_f32_16x16x32_bf16 v[156:159], a[172:175], a[216:219], v[156:159]
    buffer_load_dwordx4 a[216:219], v10, s[8:11], s73 offen offset:3072
    s_waitcnt vmcnt(13)
    v_mfma_f32_16x16x32_bf16 v[160:163], a[144:147], a[220:223], v[160:163]
    v_mfma_f32_16x16x32_bf16 v[164:167], a[148:151], a[220:223], v[164:167]
    ds_read_b128 a[128:131], v9 offset:2048
    v_mfma_f32_16x16x32_bf16 v[168:171], a[152:155], a[220:223], v[168:171]
    v_mfma_f32_16x16x32_bf16 v[172:175], a[156:159], a[220:223], v[172:175]
    v_mfma_f32_16x16x32_bf16 v[176:179], a[160:163], a[220:223], v[176:179]
    v_mfma_f32_16x16x32_bf16 v[180:183], a[164:167], a[220:223], v[180:183]
    v_mfma_f32_16x16x32_bf16 v[184:187], a[168:171], a[220:223], v[184:187]
    v_mfma_f32_16x16x32_bf16 v[188:191], a[172:175], a[220:223], v[188:191]
    buffer_load_dwordx4 a[220:223], v10, s[8:11], s74 offen offset:3072
    s_waitcnt vmcnt(13)
    v_mfma_f32_16x16x32_bf16 v[192:195], a[144:147], a[224:227], v[192:195]
    v_mfma_f32_16x16x32_bf16 v[196:199], a[148:151], a[224:227], v[196:199]
    ds_read_b128 a[132:135], v9 offset:16384
    v_mfma_f32_16x16x32_bf16 v[200:203], a[152:155], a[224:227], v[200:203]
    v_mfma_f32_16x16x32_bf16 v[204:207], a[156:159], a[224:227], v[204:207]
    v_mfma_f32_16x16x32_bf16 v[208:211], a[160:163], a[224:227], v[208:211]
    v_mfma_f32_16x16x32_bf16 v[212:215], a[164:167], a[224:227], v[212:215]
    v_mfma_f32_16x16x32_bf16 v[216:219], a[168:171], a[224:227], v[216:219]
    v_mfma_f32_16x16x32_bf16 v[220:223], a[172:175], a[224:227], v[220:223]
    buffer_load_dwordx4 a[224:227], v10, s[8:11], s75 offen offset:3072
    s_waitcnt vmcnt(13)
    v_mfma_f32_16x16x32_bf16 v[224:227], a[144:147], a[228:231], v[224:227]
    v_mfma_f32_16x16x32_bf16 v[228:231], a[148:151], a[228:231], v[228:231]
    ds_read_b128 a[136:139], v9 offset:30720
    v_mfma_f32_16x16x32_bf16 v[232:235], a[152:155], a[228:231], v[232:235]
    v_mfma_f32_16x16x32_bf16 v[236:239], a[156:159], a[228:231], v[236:239]
    ds_read_b128 a[140:143], v9 offset:45056
    v_mfma_f32_16x16x32_bf16 v[240:243], a[160:163], a[228:231], v[240:243]
    v_mfma_f32_16x16x32_bf16 v[244:247], a[164:167], a[228:231], v[244:247]
    v_mfma_f32_16x16x32_bf16 v[248:251], a[168:171], a[228:231], v[248:251]
    v_mfma_f32_16x16x32_bf16 v[252:255], a[172:175], a[228:231], v[252:255]
    buffer_load_dwordx4 a[228:231], v10, s[8:11], s76 offen offset:3072
    s_waitcnt lgkmcnt(0)
    v_add_u32 v10, 2048, v10
    v_add_u32 v8, 2048, v8
    v_add_u32 v9, 2048, v9
    s_mov_b32 s40, 1
la0_W_gY:
    s_cmp_lg_u32 s40, 6
    s_cbranch_scc1 la0_W_gY_n
    s_sub_u32 s70, s60, 2048
    s_sub_u32 s71, s61, 2048
    s_sub_u32 s72, s62, 2048
    s_sub_u32 s73, s63, 2048
    s_sub_u32 s74, s64, 2048
    s_sub_u32 s75, s65, 2048
    s_sub_u32 s76, s66, 2048
    v_mov_b32 v10, v7
la0_W_gY_n:
    s_waitcnt vmcnt(13)
    v_mfma_f32_16x16x32_bf16 v[32:35], a[112:115], a[176:179], v[32:35]
    v_mfma_f32_16x16x32_bf16 v[36:39], a[116:119], a[176:179], v[36:39]
    ds_read_b128 a[144:147], v8 offset:1024
    v_mfma_f32_16x16x32_bf16 v[40:43], a[120:123], a[176:179], v[40:43]
    v_mfma_f32_16x16x32_bf16 v[44:47], a[124:127], a[176:179], v[44:47]
    v_mfma_f32_16x16x32_bf16 v[48:51], a[128:131], a[176:179], v[48:51]
    v_mfma_f32_16x16x32_bf16 v[52:55], a[132:135], a[176:179], v[52:55]
    v_mfma_f32_16x16x32_bf16 v[56:59], a[136:139], a[176:179], v[56:59]
    v_mfma_f32_16x16x32_bf16 v[60:63], a[140:143], a[176:179], v[60:63]
    buffer_load_dwordx4 a[176:179], v10, s[8:11], s70 offen offset:2048
    s_waitcnt vmcnt(13)
    v_mfma_f32_16x16x32_bf16 v[64:67], a[112:115], a[180:183], v[64:67]
    v_mfma_f32_16x16x32_bf16 v[68:71], a[116:119], a[180:183], v[68:71]
    ds_read_b128 a[148:151], v8 offset:15360
    v_mfma_f32_16x16x32_bf16 v[72:75], a[120:123], a[180:183], v[72:75]
    v_mfma_f32_16x16x32_bf16 v[76:79], a[124:127], a[180:183], v[76:79]
    v_mfma_f32_16x16x32_bf16 v[80:83], a[128:131], a[180:183], v[80:83]
    v_mfma_f32_16x16x32_bf16 v[84:87], a[132:135], a[180:183], v[84:87]
    v_mfma_f32_16x16x32_bf16 v[88:91], a[136:139], a[180:183], v[88:91]
    v_mfma_f32_16x16x32_bf16 v[92:95], a[140:143], a[180:183], v[92:95]
    buffer_load_dwordx4 a[180:183], v10, s[8:11], s71 offen offset:2048
    s_waitcnt vmcnt(13)
    v_mfma_f32_16x16x32_bf16 v[96:99], a[112:115], a[184:187], v[96:99]
    v_mfma_f32_16x16x32_bf16 v[100:103], a[116:119], a[184:187], v[100:103]
    ds_read_b128 a[152:155], v8 offset:29696
    v_mfma_f32_16x16x32_bf16 v[104:107], a[120:123], a[184:187], v[104:107]
    v_mfma_f32_16x16x32_bf16 v[108:111], a[124:127], a[184:187], v[108:111]
    v_mfma_f32_16x16x32_bf16 v[112:115], a[128:131], a[184:187], v[112:115]
    v_mfma_f32_16x16x32_bf16 v[116:119], a[132:135], a[184:187], v[116:119]
    v_mfma_f32_16x16x32_bf16 v[120:123], a[136:139], a[184:187], v[120:123]
    v_mfma_f32_16x16x32_bf16 v[124:127], a[140:143], a[184:187], v[124:127]
    buffer_load_dwordx4 a[184:187], v10, s[8:11], s72 offen offset:2048
    s_waitcnt vmcnt(13)
    v_mfma_f32_16x16x32_bf16 v[128:131], a[112:115], a[188:191], v[128:131]
    v_mfma_f32_16x16x32_bf16 v[132:135], a[116:119], a[188:191], v[132:135]
    ds_read_b128 a[156:159], v8 offset:44032
    v_mfma_f32_16x16x32_bf16 v[136:139], a[120:123], a[188:191], v[136:139]
    v_mfma_f32_16x16x32_bf16 v[140:143], a[124:127], a[188:191], v[140:143]
    v_mfma_f32_16x16x32_bf16 v[144:147], a[128:131], a[188:191], v[144:147]
    v_mfma_f32_16x16x32_bf16 v[148:151], a[132:135], a[188:191], v[148:151]
    v_mfma_f32_16x16x32_bf16 v[152:155], a[136:139], a[188:191], v[152:155]
    v_mfma_f32_16x16x32_bf16 v[156:159], a[140:143], a[188:191], v[156:159]
    buffer_load_dwordx4 a[188:191], v10, s[8:11], s73 offen offset:2048
    s_waitcnt vmcnt(13)
    v_mfma_f32_16x16x32_bf16 v[160:163], a[112:115], a[192:195], v[160:163]
    v_mfma_f32_16x16x32_bf16 v[164:167], a[116:119], a[192:195], v[164:167]
    ds_read_b128 a[160:163], v9 offset:1024
    v_mfma_f32_16x16x32_bf16 v[168:171], a[120:123], a[192:195], v[168:171]
    v_mfma_f32_16x16x32_bf16 v[172:175], a[124:127], a[192:195], v[172:175]
    v_mfma_f32_16x16x32_bf16 v[176:179], a[128:131], a[192:195], v[176:179]
    v_mfma_f32_16x16x32_bf16 v[180:183], a[132:135], a[192:195], v[180:183]
    v_mfma_f32_16x16x32_bf16 v[184:187], a[136:139], a[192:195], v[184:187]
    v_mfma_f32_16x16x32_bf16 v[188:191], a[140:143], a[192:195], v[188:191]
    buffer_load_dwordx4 a[192:195], v10, s[8:11], s74 offen offset:2048
    s_waitcnt vmcnt(13)
    v_mfma_f32_16x16x32_bf16 v[192:195], a[112:115], a[196:199], v[192:195]
    v_mfma_f32_16x16x32_bf16 v[196:199], a[116:119], a[196:199], v[196:199]
    ds_read_b128 a[164:167], v9 offset:15360
    v_mfma_f32_16x16x32_bf16 v[200:203], a[120:123], a[196:199], v[200:203]
    v_mfma_f32_16x16x32_bf16 v[204:207], a[124:127], a[196:199], v[204:207]
    v_mfma_f32_16x16x32_bf16 v[208:211], a[128:131], a[196:199], v[208:211]
    v_mfma_f32_16x16x32_bf16 v[212:215], a[132:135], a[196:199], v[212:215]
    v_mfma_f32_16x16x32_bf16 v[216:219], a[136:139], a[196:199], v[216:219]
    v_mfma_f32_16x16x32_bf16 v[220:223], a[140:143], a[196:199], v[220:223]
    buffer_load_dwordx4 a[196:199], v10, s[8:11], s75 offen offset:2048
    s_waitcnt vmcnt(13)
    v_mfma_f32_16x16x32_bf16 v[224:227], a[112:115], a[200:203], v[224:227]
    v_mfma_f32_16x16x32_bf16 v[228:231], a[116:119], a[200:203], v[228:231]
    ds_read_b128 a[168:171], v9 offset:29696
    v_mfma_f32_16x16x32_bf16 v[232:235], a[120:123], a[200:203], v[232:235]
    v_mfma_f32_16x16x32_bf16 v[236:239], a[124:127], a[200:203], v[236:239]
    ds_read_b128 a[172:175], v9 offset:44032
    v_mfma_f32_16x16x32_bf16 v[240:243], a[128:131], a[200:203], v[240:243]
    v_mfma_f32_16x16x32_bf16 v[244:247], a[132:135], a[200:203], v[244:247]
    v_mfma_f32_16x16x32_bf16 v[248:251], a[136:139], a[200:203], v[248:251]
    v_mfma_f32_16x16x32_bf16 v[252:255], a[140:143], a[200:203], v[252:255]
    buffer_load_dwordx4 a[200:203], v10, s[8:11], s76 offen offset:2048
    s_waitcnt lgkmcnt(0)
    s_waitcnt vmcnt(13)
    v_mfma_f32_16x16x32_bf16 v[32:35], a[144:147], a[204:207], v[32:35]
    v_mfma_f32_16x16x32_bf16 v[36:39], a[148:151], a[204:207], v[36:39]
    ds_read_b128 a[112:115], v8 offset:2048
    v_mfma_f32_16x16x32_bf16 v[40:43], a[152:155], a[204:207], v[40:43]
    v_mfma_f32_16x16x32_bf16 v[44:47], a[156:159], a[204:207], v[44:47]
    v_mfma_f32_16x16x32_bf16 v[48:51], a[160:163], a[204:207], v[48:51]
    v_mfma_f32_16x16x32_bf16 v[52:55], a[164:167], a[204:207], v[52:55]
    v_mfma_f32_16x16x32_bf16 v[56:59], a[168:171], a[204:207], v[56:59]
    v_mfma_f32_16x16x32_bf16 v[60:63], a[172:175], a[204:207], v[60:63]
    buffer_load_dwordx4 a[204:207], v10, s[8:11], s70 offen offset:3072
    s_waitcnt vmcnt(13)
    v_mfma_f32_16x16x32_bf16 v[64:67], a[144:147], a[208:211], v[64:67]
    v_mfma_f32_16x16x32_bf16 v[68:71], a[148:151], a[208:211], v[68:71]
    ds_read_b128 a[116:119], v8 offset:16384
    v_mfma_f32_16x16x32_bf16 v[72:75], a[152:155], a[208:211], v[72:75]
    v_mfma_f32_16x16x32_bf16 v[76:79], a[156:159], a[208:211], v[76:79]
    v_mfma_f32_16x16x32_bf16 v[80:83], a[160:163], a[208:211], v[80:83]
    v_mfma_f32_16x16x32_bf16 v[84:87], a[164:167], a[208:211], v[84:87]
    v_mfma_f32_16x16x32_bf16 v[88:91], a[168:171], a[208:211], v[88:91]
    v_mfma_f32_16x16x32_bf16 v[92:95], a[172:175], a[208:211], v[92:95]
    buffer_load_dwordx4 a[208:211], v10, s[8:11], s71 offen offset:3072
    s_waitcnt vmcnt(13)
    v_mfma_f32_16x16x32_bf16 v[96:99], a[144:147], a[212:215], v[96:99]
    v_mfma_f32_16x16x32_bf16 v[100:103], a[148:151], a[212:215], v[100:103]
    ds_read_b128 a[120:123], v8 offset:30720
    v_mfma_f32_16x16x32_bf16 v[104:107], a[152:155], a[212:215], v[104:107]
    v_mfma_f32_16x16x32_bf16 v[108:111], a[156:159], a[212:215], v[108:111]
    v_mfma_f32_16x16x32_bf16 v[112:115], a[160:163], a[212:215], v[112:115]
    v_mfma_f32_16x16x32_bf16 v[116:119], a[164:167], a[212:215], v[116:119]
    v_mfma_f32_16x16x32_bf16 v[120:123], a[168:171], a[212:215], v[120:123]
    v_mfma_f32_16x16x32_bf16 v[124:127], a[172:175], a[212:215], v[124:127]
    buffer_load_dwordx4 a[212:215], v10, s[8:11], s72 offen offset:3072
    s_waitcnt vmcnt(13)
    v_mfma_f32_16x16x32_bf16 v[128:131], a[144:147], a[216:219], v[128:131]
    v_mfma_f32_16x16x32_bf16 v[132:135], a[148:151], a[216:219], v[132:135]
    ds_read_b128 a[124:127], v8 offset:45056
    v_mfma_f32_16x16x32_bf16 v[136:139], a[152:155], a[216:219], v[136:139]
    v_mfma_f32_16x16x32_bf16 v[140:143], a[156:159], a[216:219], v[140:143]
    v_mfma_f32_16x16x32_bf16 v[144:147], a[160:163], a[216:219], v[144:147]
    v_mfma_f32_16x16x32_bf16 v[148:151], a[164:167], a[216:219], v[148:151]
    v_mfma_f32_16x16x32_bf16 v[152:155], a[168:171], a[216:219], v[152:155]
    v_mfma_f32_16x16x32_bf16 v[156:159], a[172:175], a[216:219], v[156:159]
    buffer_load_dwordx4 a[216:219], v10, s[8:11], s73 offen offset:3072
    s_waitcnt vmcnt(13)
    v_mfma_f32_16x16x32_bf16 v[160:163], a[144:147], a[220:223], v[160:163]
    v_mfma_f32_16x16x32_bf16 v[164:167], a[148:151], a[220:223], v[164:167]
    ds_read_b128 a[128:131], v9 offset:2048
    v_mfma_f32_16x16x32_bf16 v[168:171], a[152:155], a[220:223], v[168:171]
    v_mfma_f32_16x16x32_bf16 v[172:175], a[156:159], a[220:223], v[172:175]
    v_mfma_f32_16x16x32_bf16 v[176:179], a[160:163], a[220:223], v[176:179]
    v_mfma_f32_16x16x32_bf16 v[180:183], a[164:167], a[220:223], v[180:183]
    v_mfma_f32_16x16x32_bf16 v[184:187], a[168:171], a[220:223], v[184:187]
    v_mfma_f32_16x16x32_bf16 v[188:191], a[172:175], a[220:223], v[188:191]
    buffer_load_dwordx4 a[220:223], v10, s[8:11], s74 offen offset:3072
    s_waitcnt vmcnt(13)
    v_mfma_f32_16x16x32_bf16 v[192:195], a[144:147], a[224:227], v[192:195]
    v_mfma_f32_16x16x32_bf16 v[196:199], a[148:151], a[224:227], v[196:199]
    ds_read_b128 a[132:135], v9 offset:16384
    v_mfma_f32_16x16x32_bf16 v[200:203], a[152:155], a[224:227], v[200:203]
    v_mfma_f32_16x16x32_bf16 v[204:207], a[156:159], a[224:227], v[204:207]
    v_mfma_f32_16x16x32_bf16 v[208:211], a[160:163], a[224:227], v[208:211]
    v_mfma_f32_16x16x32_bf16 v[212:215], a[164:167], a[224:227], v[212:215]
    v_mfma_f32_16x16x32_bf16 v[216:219], a[168:171], a[224:227], v[216:219]
    v_mfma_f32_16x16x32_bf16 v[220:223], a[172:175], a[224:227], v[220:223]
    buffer_load_dwordx4 a[224:227], v10, s[8:11], s75 offen offset:3072
    s_waitcnt vmcnt(13)
    v_mfma_f32_16x16x32_bf16 v[224:227], a[144:147], a[228:231], v[224:227]
    v_mfma_f32_16x16x32_bf16 v[228:231], a[148:151], a[228:231], v[228:231]
    ds_read_b128 a[136:139], v9 offset:30720
    v_mfma_f32_16x16x32_bf16 v[232:235], a[152:155], a[228:231], v[232:235]
    v_mfma_f32_16x16x32_bf16 v[236:239], a[156:159], a[228:231], v[236:239]
    ds_read_b128 a[140:143], v9 offset:45056
    v_mfma_f32_16x16x32_bf16 v[240:243], a[160:163], a[228:231], v[240:243]
    v_mfma_f32_16x16x32_bf16 v[244:247], a[164:167], a[228:231], v[244:247]
    v_mfma_f32_16x16x32_bf16 v[248:251], a[168:171], a[228:231], v[248:251]
    v_mfma_f32_16x16x32_bf16 v[252:255], a[172:175], a[228:231], v[252:255]
    buffer_load_dwordx4 a[228:231], v10, s[8:11], s76 offen offset:3072
    s_waitcnt lgkmcnt(0)
    v_add_u32 v10, 2048, v10
    v_add_u32 v8, 2048, v8
    v_add_u32 v9, 2048, v9
    s_add_u32 s40, s40, 1
    s_cmp_lt_u32 s40, 7
    s_cbranch_scc1 la0_W_gY
    s_mov_b32 s16, s8
    s_mov_b32 s17, s9
    s_mov_b32 s19, s11
    s_cmp_le_i32 s32, 0
    s_cselect_b32 s18, s10, 0
    s_lshl_b32 s22, s30, 6
    s_add_u32 s22, s22, s31
    s_mul_i32 s22, s22, 28
    s_mul_i32 s23, s3, 7
    s_add_u32 s22, s22, s23
    s_lshl_b32 s22, s22, 10
    s_add_u32 s22, s22, 0x1c00000
    s_add_u32 s22, s22, s84
    v_cvt_pk_bf16_f32 v12, v32, v33
    v_cvt_pk_bf16_f32 v13, v36, v37
    v_cvt_pk_bf16_f32 v14, v34, v35
    v_cvt_pk_bf16_f32 v15, v38, v39
    buffer_store_dwordx4 v[12:15], v7, s[16:19], s22 offen offset:0 sc1
    v_accvgpr_write_b32 a0, v12
    v_accvgpr_write_b32 a1, v13
    v_accvgpr_write_b32 a2, v14
    v_accvgpr_write_b32 a3, v15
    v_cvt_pk_bf16_f32 v16, v64, v65
    v_cvt_pk_bf16_f32 v17, v68, v69
    v_cvt_pk_bf16_f32 v18, v66, v67
    v_cvt_pk_bf16_f32 v19, v70, v71
    buffer_store_dwordx4 v[16:19], v7, s[16:19], s22 offen offset:1024 sc1
    v_accvgpr_write_b32 a4, v16
    v_accvgpr_write_b32 a5, v17
    v_accvgpr_write_b32 a6, v18
    v_accvgpr_write_b32 a7, v19
    v_cvt_pk_bf16_f32 v20, v96, v97
    v_cvt_pk_bf16_f32 v21, v100, v101
    v_cvt_pk_bf16_f32 v22, v98, v99
    v_cvt_pk_bf16_f32 v23, v102, v103
    buffer_store_dwordx4 v[20:23], v7, s[16:19], s22 offen offset:2048 sc1
    v_accvgpr_write_b32 a8, v20
    v_accvgpr_write_b32 a9, v21
    v_accvgpr_write_b32 a10, v22
    v_accvgpr_write_b32 a11, v23
    v_cvt_pk_bf16_f32 v24, v128, v129
    v_cvt_pk_bf16_f32 v25, v132, v133
    v_cvt_pk_bf16_f32 v26, v130, v131
    v_cvt_pk_bf16_f32 v27, v134, v135
    buffer_store_dwordx4 v[24:27], v7, s[16:19], s22 offen offset:3072 sc1
    v_accvgpr_write_b32 a12, v24
    v_accvgpr_write_b32 a13, v25
    v_accvgpr_write_b32 a14, v26
    v_accvgpr_write_b32 a15, v27
    v_cvt_pk_bf16_f32 v28, v160, v161
    v_cvt_pk_bf16_f32 v29, v164, v165
    v_cvt_pk_bf16_f32 v30, v162, v163
    v_cvt_pk_bf16_f32 v31, v166, v167
    s_add_u32 s23, s22, 4096
    buffer_store_dwordx4 v[28:31], v7, s[16:19], s23 offen offset:0 sc1
    v_accvgpr_write_b32 a16, v28
    v_accvgpr_write_b32 a17, v29
    v_accvgpr_write_b32 a18, v30
    v_accvgpr_write_b32 a19, v31
    v_cvt_pk_bf16_f32 v12, v192, v193
    v_cvt_pk_bf16_f32 v13, v196, v197
    v_cvt_pk_bf16_f32 v14, v194, v195
    v_cvt_pk_bf16_f32 v15, v198, v199
    buffer_store_dwordx4 v[12:15], v7, s[16:19], s23 offen offset:1024 sc1
    v_accvgpr_write_b32 a20, v12
    v_accvgpr_write_b32 a21, v13
    v_accvgpr_write_b32 a22, v14
    v_accvgpr_write_b32 a23, v15
    v_cvt_pk_bf16_f32 v16, v224, v225
    v_cvt_pk_bf16_f32 v17, v228, v229
    v_cvt_pk_bf16_f32 v18, v226, v227
    v_cvt_pk_bf16_f32 v19, v230, v231
    buffer_store_dwordx4 v[16:19], v7, s[16:19], s23 offen offset:2048 sc1
    v_accvgpr_write_b32 a24, v16
    v_accvgpr_write_b32 a25, v17
    v_accvgpr_write_b32 a26, v18
    v_accvgpr_write_b32 a27, v19
    s_add_u32 s22, s22, 458752
    v_cvt_pk_bf16_f32 v20, v40, v41
    v_cvt_pk_bf16_f32 v21, v44, v45
    v_cvt_pk_bf16_f32 v22, v42, v43
    v_cvt_pk_bf16_f32 v23, v46, v47
    buffer_store_dwordx4 v[20:23], v7, s[16:19], s22 offen offset:0 sc1
    v_accvgpr_write_b32 a28, v20
    v_accvgpr_write_b32 a29, v21
    v_accvgpr_write_b32 a30, v22
    v_accvgpr_write_b32 a31, v23
    v_cvt_pk_bf16_f32 v24, v72, v73
    v_cvt_pk_bf16_f32 v25, v76, v77
    v_cvt_pk_bf16_f32 v26, v74, v75
    v_cvt_pk_bf16_f32 v27, v78, v79
    buffer_store_dwordx4 v[24:27], v7, s[16:19], s22 offen offset:1024 sc1
    v_accvgpr_write_b32 a32, v24
    v_accvgpr_write_b32 a33, v25
    v_accvgpr_write_b32 a34, v26
    v_accvgpr_write_b32 a35, v27
    v_cvt_pk_bf16_f32 v28, v104, v105
    v_cvt_pk_bf16_f32 v29, v108, v109
    v_cvt_pk_bf16_f32 v30, v106, v107
    v_cvt_pk_bf16_f32 v31, v110, v111
    buffer_store_dwordx4 v[28:31], v7, s[16:19], s22 offen offset:2048 sc1
    v_accvgpr_write_b32 a36, v28
    v_accvgpr_write_b32 a37, v29
    v_accvgpr_write_b32 a38, v30
    v_accvgpr_write_b32 a39, v31
    v_cvt_pk_bf16_f32 v12, v136, v137
    v_cvt_pk_bf16_f32 v13, v140, v141
    v_cvt_pk_bf16_f32 v14, v138, v139
    v_cvt_pk_bf16_f32 v15, v142, v143
    buffer_store_dwordx4 v[12:15], v7, s[16:19], s22 offen offset:3072 sc1
    v_accvgpr_write_b32 a40, v12
    v_accvgpr_write_b32 a41, v13
    v_accvgpr_write_b32 a42, v14
    v_accvgpr_write_b32 a43, v15
    v_cvt_pk_bf16_f32 v16, v168, v169
    v_cvt_pk_bf16_f32 v17, v172, v173
    v_cvt_pk_bf16_f32 v18, v170, v171
    v_cvt_pk_bf16_f32 v19, v174, v175
    s_add_u32 s23, s22, 4096
    buffer_store_dwordx4 v[16:19], v7, s[16:19], s23 offen offset:0 sc1
    v_accvgpr_write_b32 a44, v16
    v_accvgpr_write_b32 a45, v17
    v_accvgpr_write_b32 a46, v18
    v_accvgpr_write_b32 a47, v19
    v_cvt_pk_bf16_f32 v20, v200, v201
    v_cvt_pk_bf16_f32 v21, v204, v205
    v_cvt_pk_bf16_f32 v22, v202, v203
    v_cvt_pk_bf16_f32 v23, v206, v207
    buffer_store_dwordx4 v[20:23], v7, s[16:19], s23 offen offset:1024 sc1
    v_accvgpr_write_b32 a48, v20
    v_accvgpr_write_b32 a49, v21
    v_accvgpr_write_b32 a50, v22
    v_accvgpr_write_b32 a51, v23
    v_cvt_pk_bf16_f32 v24, v232, v233
    v_cvt_pk_bf16_f32 v25, v236, v237
    v_cvt_pk_bf16_f32 v26, v234, v235
    v_cvt_pk_bf16_f32 v27, v238, v239
    buffer_store_dwordx4 v[24:27], v7, s[16:19], s23 offen offset:2048 sc1
    v_accvgpr_write_b32 a52, v24
    v_accvgpr_write_b32 a53, v25
    v_accvgpr_write_b32 a54, v26
    v_accvgpr_write_b32 a55, v27
    s_add_u32 s22, s22, 458752
    v_cvt_pk_bf16_f32 v28, v48, v49
    v_cvt_pk_bf16_f32 v29, v52, v53
    v_cvt_pk_bf16_f32 v30, v50, v51
    v_cvt_pk_bf16_f32 v31, v54, v55
    buffer_store_dwordx4 v[28:31], v7, s[16:19], s22 offen offset:0 sc1
    v_accvgpr_write_b32 a56, v28
    v_accvgpr_write_b32 a57, v29
    v_accvgpr_write_b32 a58, v30
    v_accvgpr_write_b32 a59, v31
    v_cvt_pk_bf16_f32 v12, v80, v81
    v_cvt_pk_bf16_f32 v13, v84, v85
    v_cvt_pk_bf16_f32 v14, v82, v83
    v_cvt_pk_bf16_f32 v15, v86, v87
    buffer_store_dwordx4 v[12:15], v7, s[16:19], s22 offen offset:1024 sc1
    v_accvgpr_write_b32 a60, v12
    v_accvgpr_write_b32 a61, v13
    v_accvgpr_write_b32 a62, v14
    v_accvgpr_write_b32 a63, v15
    v_cvt_pk_bf16_f32 v16, v112, v113
    v_cvt_pk_bf16_f32 v17, v116, v117
    v_cvt_pk_bf16_f32 v18, v114, v115
    v_cvt_pk_bf16_f32 v19, v118, v119
    buffer_store_dwordx4 v[16:19], v7, s[16:19], s22 offen offset:2048 sc1
    v_accvgpr_write_b32 a64, v16
    v_accvgpr_write_b32 a65, v17
    v_accvgpr_write_b32 a66, v18
    v_accvgpr_write_b32 a67, v19
    v_cvt_pk_bf16_f32 v20, v144, v145
    v_cvt_pk_bf16_f32 v21, v148, v149
    v_cvt_pk_bf16_f32 v22, v146, v147
    v_cvt_pk_bf16_f32 v23, v150, v151
    buffer_store_dwordx4 v[20:23], v7, s[16:19], s22 offen offset:3072 sc1
    v_accvgpr_write_b32 a68, v20
    v_accvgpr_write_b32 a69, v21
    v_accvgpr_write_b32 a70, v22
    v_accvgpr_write_b32 a71, v23
    v_cvt_pk_bf16_f32 v24, v176, v177
    v_cvt_pk_bf16_f32 v25, v180, v181
    v_cvt_pk_bf16_f32 v26, v178, v179
    v_cvt_pk_bf16_f32 v27, v182, v183
    s_add_u32 s23, s22, 4096
    buffer_store_dwordx4 v[24:27], v7, s[16:19], s23 offen offset:0 sc1
    v_accvgpr_write_b32 a72, v24
    v_accvgpr_write_b32 a73, v25
    v_accvgpr_write_b32 a74, v26
    v_accvgpr_write_b32 a75, v27
    v_cvt_pk_bf16_f32 v28, v208, v209
    v_cvt_pk_bf16_f32 v29, v212, v213
    v_cvt_pk_bf16_f32 v30, v210, v211
    v_cvt_pk_bf16_f32 v31, v214, v215
    buffer_store_dwordx4 v[28:31], v7, s[16:19], s23 offen offset:1024 sc1
    v_accvgpr_write_b32 a76, v28
    v_accvgpr_write_b32 a77, v29
    v_accvgpr_write_b32 a78, v30
    v_accvgpr_write_b32 a79, v31
    v_cvt_pk_bf16_f32 v12, v240, v241
    v_cvt_pk_bf16_f32 v13, v244, v245
    v_cvt_pk_bf16_f32 v14, v242, v243
    v_cvt_pk_bf16_f32 v15, v246, v247
    buffer_store_dwordx4 v[12:15], v7, s[16:19], s23 offen offset:2048 sc1
    v_accvgpr_write_b32 a80, v12
    v_accvgpr_write_b32 a81, v13
    v_accvgpr_write_b32 a82, v14
    v_accvgpr_write_b32 a83, v15
    s_add_u32 s22, s22, 458752
    v_cvt_pk_bf16_f32 v16, v56, v57
    v_cvt_pk_bf16_f32 v17, v60, v61
    v_cvt_pk_bf16_f32 v18, v58, v59
    v_cvt_pk_bf16_f32 v19, v62, v63
    buffer_store_dwordx4 v[16:19], v7, s[16:19], s22 offen offset:0 sc1
    v_accvgpr_write_b32 a84, v16
    v_accvgpr_write_b32 a85, v17
    v_accvgpr_write_b32 a86, v18
    v_accvgpr_write_b32 a87, v19
    v_cvt_pk_bf16_f32 v20, v88, v89
    v_cvt_pk_bf16_f32 v21, v92, v93
    v_cvt_pk_bf16_f32 v22, v90, v91
    v_cvt_pk_bf16_f32 v23, v94, v95
    buffer_store_dwordx4 v[20:23], v7, s[16:19], s22 offen offset:1024 sc1
    v_accvgpr_write_b32 a88, v20
    v_accvgpr_write_b32 a89, v21
    v_accvgpr_write_b32 a90, v22
    v_accvgpr_write_b32 a91, v23
    v_cvt_pk_bf16_f32 v24, v120, v121
    v_cvt_pk_bf16_f32 v25, v124, v125
    v_cvt_pk_bf16_f32 v26, v122, v123
    v_cvt_pk_bf16_f32 v27, v126, v127
    buffer_store_dwordx4 v[24:27], v7, s[16:19], s22 offen offset:2048 sc1
    v_accvgpr_write_b32 a92, v24
    v_accvgpr_write_b32 a93, v25
    v_accvgpr_write_b32 a94, v26
    v_accvgpr_write_b32 a95, v27
    v_cvt_pk_bf16_f32 v28, v152, v153
    v_cvt_pk_bf16_f32 v29, v156, v157
    v_cvt_pk_bf16_f32 v30, v154, v155
    v_cvt_pk_bf16_f32 v31, v158, v159
    buffer_store_dwordx4 v[28:31], v7, s[16:19], s22 offen offset:3072 sc1
    v_accvgpr_write_b32 a96, v28
    v_accvgpr_write_b32 a97, v29
    v_accvgpr_write_b32 a98, v30
    v_accvgpr_write_b32 a99, v31
    v_cvt_pk_bf16_f32 v12, v184, v185
    v_cvt_pk_bf16_f32 v13, v188, v189
    v_cvt_pk_bf16_f32 v14, v186, v187
    v_cvt_pk_bf16_f32 v15, v190, v191
    s_add_u32 s23, s22, 4096
    buffer_store_dwordx4 v[12:15], v7, s[16:19], s23 offen offset:0 sc1
    v_accvgpr_write_b32 a100, v12
    v_accvgpr_write_b32 a101, v13
    v_accvgpr_write_b32 a102, v14
    v_accvgpr_write_b32 a103, v15
    v_cvt_pk_bf16_f32 v16, v216, v217
    v_cvt_pk_bf16_f32 v17, v220, v221
    v_cvt_pk_bf16_f32 v18, v218, v219
    v_cvt_pk_bf16_f32 v19, v222, v223
    buffer_store_dwordx4 v[16:19], v7, s[16:19], s23 offen offset:1024 sc1
    v_accvgpr_write_b32 a104, v16
    v_accvgpr_write_b32 a105, v17
    v_accvgpr_write_b32 a106, v18
    v_accvgpr_write_b32 a107, v19
    v_cvt_pk_bf16_f32 v20, v248, v249
    v_cvt_pk_bf16_f32 v21, v252, v253
    v_cvt_pk_bf16_f32 v22, v250, v251
    v_cvt_pk_bf16_f32 v23, v254, v255
    buffer_store_dwordx4 v[20:23], v7, s[16:19], s23 offen offset:2048 sc1
    v_accvgpr_write_b32 a108, v20
    v_accvgpr_write_b32 a109, v21
    v_accvgpr_write_b32 a110, v22
    v_accvgpr_write_b32 a111, v23
    s_add_u32 s22, s22, 458752
    v_mov_b32 v8, v7
    v_add_u32 v9, 57344, v7
    ds_read_b128 a[112:115], v8 offset:0
    ds_read_b128 a[116:119], v8 offset:14336
    ds_read_b128 a[120:123], v8 offset:28672
    ds_read_b128 a[124:127], v8 offset:43008
    ds_read_b128 a[128:131], v9 offset:0
    ds_read_b128 a[132:135], v9 offset:14336
    ds_read_b128 a[136:139], v9 offset:28672
    ds_read_b128 a[140:143], v9 offset:43008
    s_mov_b32 s70, s60
    s_mov_b32 s71, s61
    s_mov_b32 s72, s62
    s_mov_b32 s73, s63
    s_mov_b32 s74, s64
    s_mov_b32 s75, s65
    s_mov_b32 s76, s66
    v_mov_b32 v10, v7
    s_waitcnt lgkmcnt(0)
    s_waitcnt vmcnt(41)
    v_mfma_f32_16x16x32_bf16 v[32:35], a[176:179], a[112:115], 0
    v_mfma_f32_16x16x32_bf16 v[36:39], a[176:179], a[116:119], 0
    ds_read_b128 a[144:147], v8 offset:1024
    v_mfma_f32_16x16x32_bf16 v[40:43], a[176:179], a[120:123], 0
    v_mfma_f32_16x16x32_bf16 v[44:47], a[176:179], a[124:127], 0
    v_mfma_f32_16x16x32_bf16 v[48:51], a[176:179], a[128:131], 0
    v_mfma_f32_16x16x32_bf16 v[52:55], a[176:179], a[132:135], 0
    v_mfma_f32_16x16x32_bf16 v[56:59], a[176:179], a[136:139], 0
    v_mfma_f32_16x16x32_bf16 v[60:63], a[176:179], a[140:143], 0
    buffer_load_dwordx4 a[176:179], v10, s[8:11], s70 offen offset:2048
    s_waitcnt vmcnt(41)
    v_mfma_f32_16x16x32_bf16 v[64:67], a[180:183], a[112:115], 0
    v_mfma_f32_16x16x32_bf16 v[68:71], a[180:183], a[116:119], 0
    ds_read_b128 a[148:151], v8 offset:15360
    v_mfma_f32_16x16x32_bf16 v[72:75], a[180:183], a[120:123], 0
    v_mfma_f32_16x16x32_bf16 v[76:79], a[180:183], a[124:127], 0
    v_mfma_f32_16x16x32_bf16 v[80:83], a[180:183], a[128:131], 0
    v_mfma_f32_16x16x32_bf16 v[84:87], a[180:183], a[132:135], 0
    v_mfma_f32_16x16x32_bf16 v[88:91], a[180:183], a[136:139], 0
    v_mfma_f32_16x16x32_bf16 v[92:95], a[180:183], a[140:143], 0
    buffer_load_dwordx4 a[180:183], v10, s[8:11], s71 offen offset:2048
    s_waitcnt vmcnt(41)
    v_mfma_f32_16x16x32_bf16 v[96:99], a[184:187], a[112:115], 0
    v_mfma_f32_16x16x32_bf16 v[100:103], a[184:187], a[116:119], 0
    ds_read_b128 a[152:155], v8 offset:29696
    v_mfma_f32_16x16x32_bf16 v[104:107], a[184:187], a[120:123], 0
    v_mfma_f32_16x16x32_bf16 v[108:111], a[184:187], a[124:127], 0
    v_mfma_f32_16x16x32_bf16 v[112:115], a[184:187], a[128:131], 0
    v_mfma_f32_16x16x32_bf16 v[116:119], a[184:187], a[132:135], 0
    v_mfma_f32_16x16x32_bf16 v[120:123], a[184:187], a[136:139], 0
    v_mfma_f32_16x16x32_bf16 v[124:127], a[184:187], a[140:143], 0
    buffer_load_dwordx4 a[184:187], v10, s[8:11], s72 offen offset:2048
    s_waitcnt vmcnt(41)
    v_mfma_f32_16x16x32_bf16 v[128:131], a[188:191], a[112:115], 0
    v_mfma_f32_16x16x32_bf16 v[132:135], a[188:191], a[116:119], 0
    ds_read_b128 a[156:159], v8 offset:44032
    v_mfma_f32_16x16x32_bf16 v[136:139], a[188:191], a[120:123], 0
    v_mfma_f32_16x16x32_bf16 v[140:143], a[188:191], a[124:127], 0
    v_mfma_f32_16x16x32_bf16 v[144:147], a[188:191], a[128:131], 0
    v_mfma_f32_16x16x32_bf16 v[148:151], a[188:191], a[132:135], 0
    v_mfma_f32_16x16x32_bf16 v[152:155], a[188:191], a[136:139], 0
    v_mfma_f32_16x16x32_bf16 v[156:159], a[188:191], a[140:143], 0
    buffer_load_dwordx4 a[188:191], v10, s[8:11], s73 offen offset:2048
    s_waitcnt vmcnt(41)
    v_mfma_f32_16x16x32_bf16 v[160:163], a[192:195], a[112:115], 0
    v_mfma_f32_16x16x32_bf16 v[164:167], a[192:195], a[116:119], 0
    ds_read_b128 a[160:163], v9 offset:1024
    v_mfma_f32_16x16x32_bf16 v[168:171], a[192:195], a[120:123], 0
    v_mfma_f32_16x16x32_bf16 v[172:175], a[192:195], a[124:127], 0
    v_mfma_f32_16x16x32_bf16 v[176:179], a[192:195], a[128:131], 0
    v_mfma_f32_16x16x32_bf16 v[180:183], a[192:195], a[132:135], 0
    v_mfma_f32_16x16x32_bf16 v[184:187], a[192:195], a[136:139], 0
    v_mfma_f32_16x16x32_bf16 v[188:191], a[192:195], a[140:143], 0
    buffer_load_dwordx4 a[192:195], v10, s[8:11], s74 offen offset:2048
    s_waitcnt vmcnt(41)
    v_mfma_f32_16x16x32_bf16 v[192:195], a[196:199], a[112:115], 0
    v_mfma_f32_16x16x32_bf16 v[196:199], a[196:199], a[116:119], 0
    ds_read_b128 a[164:167], v9 offset:15360
    v_mfma_f32_16x16x32_bf16 v[200:203], a[196:199], a[120:123], 0
    v_mfma_f32_16x16x32_bf16 v[204:207], a[196:199], a[124:127], 0
    v_mfma_f32_16x16x32_bf16 v[208:211], a[196:199], a[128:131], 0
    v_mfma_f32_16x16x32_bf16 v[212:215], a[196:199], a[132:135], 0
    v_mfma_f32_16x16x32_bf16 v[216:219], a[196:199], a[136:139], 0
    v_mfma_f32_16x16x32_bf16 v[220:223], a[196:199], a[140:143], 0
    buffer_load_dwordx4 a[196:199], v10, s[8:11], s75 offen offset:2048
    s_waitcnt vmcnt(41)
    v_mfma_f32_16x16x32_bf16 v[224:227], a[200:203], a[112:115], 0
    v_mfma_f32_16x16x32_bf16 v[228:231], a[200:203], a[116:119], 0
    ds_read_b128 a[168:171], v9 offset:29696
    v_mfma_f32_16x16x32_bf16 v[232:235], a[200:203], a[120:123], 0
    v_mfma_f32_16x16x32_bf16 v[236:239], a[200:203], a[124:127], 0
    ds_read_b128 a[172:175], v9 offset:44032
    v_mfma_f32_16x16x32_bf16 v[240:243], a[200:203], a[128:131], 0
    v_mfma_f32_16x16x32_bf16 v[244:247], a[200:203], a[132:135], 0
    v_mfma_f32_16x16x32_bf16 v[248:251], a[200:203], a[136:139], 0
    v_mfma_f32_16x16x32_bf16 v[252:255], a[200:203], a[140:143], 0
    buffer_load_dwordx4 a[200:203], v10, s[8:11], s76 offen offset:2048
    s_waitcnt lgkmcnt(0)
    s_waitcnt vmcnt(41)
    v_mfma_f32_16x16x32_bf16 v[32:35], a[204:207], a[144:147], v[32:35]
    v_mfma_f32_16x16x32_bf16 v[36:39], a[204:207], a[148:151], v[36:39]
    ds_read_b128 a[112:115], v8 offset:2048
    v_mfma_f32_16x16x32_bf16 v[40:43], a[204:207], a[152:155], v[40:43]
    v_mfma_f32_16x16x32_bf16 v[44:47], a[204:207], a[156:159], v[44:47]
    v_mfma_f32_16x16x32_bf16 v[48:51], a[204:207], a[160:163], v[48:51]
    v_mfma_f32_16x16x32_bf16 v[52:55], a[204:207], a[164:167], v[52:55]
    v_mfma_f32_16x16x32_bf16 v[56:59], a[204:207], a[168:171], v[56:59]
    v_mfma_f32_16x16x32_bf16 v[60:63], a[204:207], a[172:175], v[60:63]
    buffer_load_dwordx4 a[204:207], v10, s[8:11], s70 offen offset:3072
    s_waitcnt vmcnt(41)
    v_mfma_f32_16x16x32_bf16 v[64:67], a[208:211], a[144:147], v[64:67]
    v_mfma_f32_16x16x32_bf16 v[68:71], a[208:211], a[148:151], v[68:71]
    ds_read_b128 a[116:119], v8 offset:16384
    v_mfma_f32_16x16x32_bf16 v[72:75], a[208:211], a[152:155], v[72:75]
    v_mfma_f32_16x16x32_bf16 v[76:79], a[208:211], a[156:159], v[76:79]
    v_mfma_f32_16x16x32_bf16 v[80:83], a[208:211], a[160:163], v[80:83]
    v_mfma_f32_16x16x32_bf16 v[84:87], a[208:211], a[164:167], v[84:87]
    v_mfma_f32_16x16x32_bf16 v[88:91], a[208:211], a[168:171], v[88:91]
    v_mfma_f32_16x16x32_bf16 v[92:95], a[208:211], a[172:175], v[92:95]
    buffer_load_dwordx4 a[208:211], v10, s[8:11], s71 offen offset:3072
    s_waitcnt vmcnt(41)
    v_mfma_f32_16x16x32_bf16 v[96:99], a[212:215], a[144:147], v[96:99]
    v_mfma_f32_16x16x32_bf16 v[100:103], a[212:215], a[148:151], v[100:103]
    ds_read_b128 a[120:123], v8 offset:30720
    v_mfma_f32_16x16x32_bf16 v[104:107], a[212:215], a[152:155], v[104:107]
    v_mfma_f32_16x16x32_bf16 v[108:111], a[212:215], a[156:159], v[108:111]
    v_mfma_f32_16x16x32_bf16 v[112:115], a[212:215], a[160:163], v[112:115]
    v_mfma_f32_16x16x32_bf16 v[116:119], a[212:215], a[164:167], v[116:119]
    v_mfma_f32_16x16x32_bf16 v[120:123], a[212:215], a[168:171], v[120:123]
    v_mfma_f32_16x16x32_bf16 v[124:127], a[212:215], a[172:175], v[124:127]
    buffer_load_dwordx4 a[212:215], v10, s[8:11], s72 offen offset:3072
    s_waitcnt vmcnt(41)
    v_mfma_f32_16x16x32_bf16 v[128:131], a[216:219], a[144:147], v[128:131]
    v_mfma_f32_16x16x32_bf16 v[132:135], a[216:219], a[148:151], v[132:135]
    ds_read_b128 a[124:127], v8 offset:45056
    v_mfma_f32_16x16x32_bf16 v[136:139], a[216:219], a[152:155], v[136:139]
    v_mfma_f32_16x16x32_bf16 v[140:143], a[216:219], a[156:159], v[140:143]
    v_mfma_f32_16x16x32_bf16 v[144:147], a[216:219], a[160:163], v[144:147]
    v_mfma_f32_16x16x32_bf16 v[148:151], a[216:219], a[164:167], v[148:151]
    v_mfma_f32_16x16x32_bf16 v[152:155], a[216:219], a[168:171], v[152:155]
    v_mfma_f32_16x16x32_bf16 v[156:159], a[216:219], a[172:175], v[156:159]
    buffer_load_dwordx4 a[216:219], v10, s[8:11], s73 offen offset:3072
    s_waitcnt vmcnt(41)
    v_mfma_f32_16x16x32_bf16 v[160:163], a[220:223], a[144:147], v[160:163]
    v_mfma_f32_16x16x32_bf16 v[164:167], a[220:223], a[148:151], v[164:167]
    ds_read_b128 a[128:131], v9 offset:2048
    v_mfma_f32_16x16x32_bf16 v[168:171], a[220:223], a[152:155], v[168:171]
    v_mfma_f32_16x16x32_bf16 v[172:175], a[220:223], a[156:159], v[172:175]
    v_mfma_f32_16x16x32_bf16 v[176:179], a[220:223], a[160:163], v[176:179]
    v_mfma_f32_16x16x32_bf16 v[180:183], a[220:223], a[164:167], v[180:183]
    v_mfma_f32_16x16x32_bf16 v[184:187], a[220:223], a[168:171], v[184:187]
    v_mfma_f32_16x16x32_bf16 v[188:191], a[220:223], a[172:175], v[188:191]
    buffer_load_dwordx4 a[220:223], v10, s[8:11], s74 offen offset:3072
    s_waitcnt vmcnt(41)
    v_mfma_f32_16x16x32_bf16 v[192:195], a[224:227], a[144:147], v[192:195]
    v_mfma_f32_16x16x32_bf16 v[196:199], a[224:227], a[148:151], v[196:199]
    ds_read_b128 a[132:135], v9 offset:16384
    v_mfma_f32_16x16x32_bf16 v[200:203], a[224:227], a[152:155], v[200:203]
    v_mfma_f32_16x16x32_bf16 v[204:207], a[224:227], a[156:159], v[204:207]
    v_mfma_f32_16x16x32_bf16 v[208:211], a[224:227], a[160:163], v[208:211]
    v_mfma_f32_16x16x32_bf16 v[212:215], a[224:227], a[164:167], v[212:215]
    v_mfma_f32_16x16x32_bf16 v[216:219], a[224:227], a[168:171], v[216:219]
    v_mfma_f32_16x16x32_bf16 v[220:223], a[224:227], a[172:175], v[220:223]
    buffer_load_dwordx4 a[224:227], v10, s[8:11], s75 offen offset:3072
    s_waitcnt vmcnt(41)
    v_mfma_f32_16x16x32_bf16 v[224:227], a[228:231], a[144:147], v[224:227]
    v_mfma_f32_16x16x32_bf16 v[228:231], a[228:231], a[148:151], v[228:231]
    ds_read_b128 a[136:139], v9 offset:30720
    v_mfma_f32_16x16x32_bf16 v[232:235], a[228:231], a[152:155], v[232:235]
    v_mfma_f32_16x16x32_bf16 v[236:239], a[228:231], a[156:159], v[236:239]
    ds_read_b128 a[140:143], v9 offset:45056
    v_mfma_f32_16x16x32_bf16 v[240:243], a[228:231], a[160:163], v[240:243]
    v_mfma_f32_16x16x32_bf16 v[244:247], a[228:231], a[164:167], v[244:247]
    v_mfma_f32_16x16x32_bf16 v[248:251], a[228:231], a[168:171], v[248:251]
    v_mfma_f32_16x16x32_bf16 v[252:255], a[228:231], a[172:175], v[252:255]
    buffer_load_dwordx4 a[228:231], v10, s[8:11], s76 offen offset:3072
    s_waitcnt lgkmcnt(0)
    v_add_u32 v10, 2048, v10
    v_add_u32 v8, 2048, v8
    v_add_u32 v9, 2048, v9
    s_waitcnt vmcnt(14)
    s_barrier
    s_cmp_lg_u32 s3, 0
    s_cbranch_scc1 la0_W_nof
    s_lshl_b32 s22, s30, 4
    s_add_u32 s22, s22, s31
    s_lshl_b32 s22, s22, 7
    s_add_u32 s22, s22, 0x428e000
    s_add_u32 s22, s22, s84
    v_mov_b32 v2, 7
    v_mov_b32 v3, 0
    s_mov_b64 exec, 1
    buffer_atomic_add v2, v3, s[16:19], s22 offen
    s_mov_b64 exec, -1
la0_W_nof:
    s_mov_b32 s40, 1
la0_W_gT:
    s_waitcnt vmcnt(13)
    v_mfma_f32_16x16x32_bf16 v[32:35], a[176:179], a[112:115], v[32:35]
    v_mfma_f32_16x16x32_bf16 v[36:39], a[176:179], a[116:119], v[36:39]
    ds_read_b128 a[144:147], v8 offset:1024
    v_mfma_f32_16x16x32_bf16 v[40:43], a[176:179], a[120:123], v[40:43]
    v_mfma_f32_16x16x32_bf16 v[44:47], a[176:179], a[124:127], v[44:47]
    v_mfma_f32_16x16x32_bf16 v[48:51], a[176:179], a[128:131], v[48:51]
    v_mfma_f32_16x16x32_bf16 v[52:55], a[176:179], a[132:135], v[52:55]
    v_mfma_f32_16x16x32_bf16 v[56:59], a[176:179], a[136:139], v[56:59]
    v_mfma_f32_16x16x32_bf16 v[60:63], a[176:179], a[140:143], v[60:63]
    buffer_load_dwordx4 a[176:179], v10, s[8:11], s70 offen offset:2048
    s_waitcnt vmcnt(13)
    v_mfma_f32_16x16x32_bf16 v[64:67], a[180:183], a[112:115], v[64:67]
    v_mfma_f32_16x16x32_bf16 v[68:71], a[180:183], a[116:119], v[68:71]
    ds_read_b128 a[148:151], v8 offset:15360
    v_mfma_f32_16x16x32_bf16 v[72:75], a[180:183], a[120:123], v[72:75]
    v_mfma_f32_16x16x32_bf16 v[76:79], a[180:183], a[124:127], v[76:79]
    v_mfma_f32_16x16x32_bf16 v[80:83], a[180:183], a[128:131], v[80:83]
    v_mfma_f32_16x16x32_bf16 v[84:87], a[180:183], a[132:135], v[84:87]
    v_mfma_f32_16x16x32_bf16 v[88:91], a[180:183], a[136:139], v[88:91]
    v_mfma_f32_16x16x32_bf16 v[92:95], a[180:183], a[140:143], v[92:95]
    buffer_load_dwordx4 a[180:183], v10, s[8:11], s71 offen offset:2048
    s_waitcnt vmcnt(13)
    v_mfma_f32_16x16x32_bf16 v[96:99], a[184:187], a[112:115], v[96:99]
    v_mfma_f32_16x16x32_bf16 v[100:103], a[184:187], a[116:119], v[100:103]
    ds_read_b128 a[152:155], v8 offset:29696
    v_mfma_f32_16x16x32_bf16 v[104:107], a[184:187], a[120:123], v[104:107]
    v_mfma_f32_16x16x32_bf16 v[108:111], a[184:187], a[124:127], v[108:111]
    v_mfma_f32_16x16x32_bf16 v[112:115], a[184:187], a[128:131], v[112:115]
    v_mfma_f32_16x16x32_bf16 v[116:119], a[184:187], a[132:135], v[116:119]
    v_mfma_f32_16x16x32_bf16 v[120:123], a[184:187], a[136:139], v[120:123]
    v_mfma_f32_16x16x32_bf16 v[124:127], a[184:187], a[140:143], v[124:127]
    buffer_load_dwordx4 a[184:187], v10, s[8:11], s72 offen offset:2048
    s_waitcnt vmcnt(13)
    v_mfma_f32_16x16x32_bf16 v[128:131], a[188:191], a[112:115], v[128:131]
    v_mfma_f32_16x16x32_bf16 v[132:135], a[188:191], a[116:119], v[132:135]
    ds_read_b128 a[156:159], v8 offset:44032
    v_mfma_f32_16x16x32_bf16 v[136:139], a[188:191], a[120:123], v[136:139]
    v_mfma_f32_16x16x32_bf16 v[140:143], a[188:191], a[124:127], v[140:143]
    v_mfma_f32_16x16x32_bf16 v[144:147], a[188:191], a[128:131], v[144:147]
    v_mfma_f32_16x16x32_bf16 v[148:151], a[188:191], a[132:135], v[148:151]
    v_mfma_f32_16x16x32_bf16 v[152:155], a[188:191], a[136:139], v[152:155]
    v_mfma_f32_16x16x32_bf16 v[156:159], a[188:191], a[140:143], v[156:159]
    buffer_load_dwordx4 a[188:191], v10, s[8:11], s73 offen offset:2048
    s_waitcnt vmcnt(13)
    v_mfma_f32_16x16x32_bf16 v[160:163], a[192:195], a[112:115], v[160:163]
    v_mfma_f32_16x16x32_bf16 v[164:167], a[192:195], a[116:119], v[164:167]
    ds_read_b128 a[160:163], v9 offset:1024
    v_mfma_f32_16x16x32_bf16 v[168:171], a[192:195], a[120:123], v[168:171]
    v_mfma_f32_16x16x32_bf16 v[172:175], a[192:195], a[124:127], v[172:175]
    v_mfma_f32_16x16x32_bf16 v[176:179], a[192:195], a[128:131], v[176:179]
    v_mfma_f32_16x16x32_bf16 v[180:183], a[192:195], a[132:135], v[180:183]
    v_mfma_f32_16x16x32_bf16 v[184:187], a[192:195], a[136:139], v[184:187]
    v_mfma_f32_16x16x32_bf16 v[188:191], a[192:195], a[140:143], v[188:191]
    buffer_load_dwordx4 a[192:195], v10, s[8:11], s74 offen offset:2048
    s_waitcnt vmcnt(13)
    v_mfma_f32_16x16x32_bf16 v[192:195], a[196:199], a[112:115], v[192:195]
    v_mfma_f32_16x16x32_bf16 v[196:199], a[196:199], a[116:119], v[196:199]
    ds_read_b128 a[164:167], v9 offset:15360
    v_mfma_f32_16x16x32_bf16 v[200:203], a[196:199], a[120:123], v[200:203]
    v_mfma_f32_16x16x32_bf16 v[204:207], a[196:199], a[124:127], v[204:207]
    v_mfma_f32_16x16x32_bf16 v[208:211], a[196:199], a[128:131], v[208:211]
    v_mfma_f32_16x16x32_bf16 v[212:215], a[196:199], a[132:135], v[212:215]
    v_mfma_f32_16x16x32_bf16 v[216:219], a[196:199], a[136:139], v[216:219]
    v_mfma_f32_16x16x32_bf16 v[220:223], a[196:199], a[140:143], v[220:223]
    buffer_load_dwordx4 a[196:199], v10, s[8:11], s75 offen offset:2048
    s_waitcnt vmcnt(13)
    v_mfma_f32_16x16x32_bf16 v[224:227], a[200:203], a[112:115], v[224:227]
    v_mfma_f32_16x16x32_bf16 v[228:231], a[200:203], a[116:119], v[228:231]
    ds_read_b128 a[168:171], v9 offset:29696
    v_mfma_f32_16x16x32_bf16 v[232:235], a[200:203], a[120:123], v[232:235]
    v_mfma_f32_16x16x32_bf16 v[236:239], a[200:203], a[124:127], v[236:239]
    ds_read_b128 a[172:175], v9 offset:44032
    v_mfma_f32_16x16x32_bf16 v[240:243], a[200:203], a[128:131], v[240:243]
    v_mfma_f32_16x16x32_bf16 v[244:247], a[200:203], a[132:135], v[244:247]
    v_mfma_f32_16x16x32_bf16 v[248:251], a[200:203], a[136:139], v[248:251]
    v_mfma_f32_16x16x32_bf16 v[252:255], a[200:203], a[140:143], v[252:255]
    buffer_load_dwordx4 a[200:203], v10, s[8:11], s76 offen offset:2048
    s_waitcnt lgkmcnt(0)
    s_waitcnt vmcnt(13)
    v_mfma_f32_16x16x32_bf16 v[32:35], a[204:207], a[144:147], v[32:35]
    v_mfma_f32_16x16x32_bf16 v[36:39], a[204:207], a[148:151], v[36:39]
    ds_read_b128 a[112:115], v8 offset:2048
    v_mfma_f32_16x16x32_bf16 v[40:43], a[204:207], a[152:155], v[40:43]
    v_mfma_f32_16x16x32_bf16 v[44:47], a[204:207], a[156:159], v[44:47]
    v_mfma_f32_16x16x32_bf16 v[48:51], a[204:207], a[160:163], v[48:51]
    v_mfma_f32_16x16x32_bf16 v[52:55], a[204:207], a[164:167], v[52:55]
    v_mfma_f32_16x16x32_bf16 v[56:59], a[204:207], a[168:171], v[56:59]
    v_mfma_f32_16x16x32_bf16 v[60:63], a[204:207], a[172:175], v[60:63]
    buffer_load_dwordx4 a[204:207], v10, s[8:11], s70 offen offset:3072
    s_waitcnt vmcnt(13)
    v_mfma_f32_16x16x32_bf16 v[64:67], a[208:211], a[144:147], v[64:67]
    v_mfma_f32_16x16x32_bf16 v[68:71], a[208:211], a[148:151], v[68:71]
    ds_read_b128 a[116:119], v8 offset:16384
    v_mfma_f32_16x16x32_bf16 v[72:75], a[208:211], a[152:155], v[72:75]
    v_mfma_f32_16x16x32_bf16 v[76:79], a[208:211], a[156:159], v[76:79]
    v_mfma_f32_16x16x32_bf16 v[80:83], a[208:211], a[160:163], v[80:83]
    v_mfma_f32_16x16x32_bf16 v[84:87], a[208:211], a[164:167], v[84:87]
    v_mfma_f32_16x16x32_bf16 v[88:91], a[208:211], a[168:171], v[88:91]
    v_mfma_f32_16x16x32_bf16 v[92:95], a[208:211], a[172:175], v[92:95]
    buffer_load_dwordx4 a[208:211], v10, s[8:11], s71 offen offset:3072
    s_waitcnt vmcnt(13)
    v_mfma_f32_16x16x32_bf16 v[96:99], a[212:215], a[144:147], v[96:99]
    v_mfma_f32_16x16x32_bf16 v[100:103], a[212:215], a[148:151], v[100:103]
    ds_read_b128 a[120:123], v8 offset:30720
    v_mfma_f32_16x16x32_bf16 v[104:107], a[212:215], a[152:155], v[104:107]
    v_mfma_f32_16x16x32_bf16 v[108:111], a[212:215], a[156:159], v[108:111]
    v_mfma_f32_16x16x32_bf16 v[112:115], a[212:215], a[160:163], v[112:115]
    v_mfma_f32_16x16x32_bf16 v[116:119], a[212:215], a[164:167], v[116:119]
    v_mfma_f32_16x16x32_bf16 v[120:123], a[212:215], a[168:171], v[120:123]
    v_mfma_f32_16x16x32_bf16 v[124:127], a[212:215], a[172:175], v[124:127]
    buffer_load_dwordx4 a[212:215], v10, s[8:11], s72 offen offset:3072
    s_waitcnt vmcnt(13)
    v_mfma_f32_16x16x32_bf16 v[128:131], a[216:219], a[144:147], v[128:131]
    v_mfma_f32_16x16x32_bf16 v[132:135], a[216:219], a[148:151], v[132:135]
    ds_read_b128 a[124:127], v8 offset:45056
    v_mfma_f32_16x16x32_bf16 v[136:139], a[216:219], a[152:155], v[136:139]
    v_mfma_f32_16x16x32_bf16 v[140:143], a[216:219], a[156:159], v[140:143]
    v_mfma_f32_16x16x32_bf16 v[144:147], a[216:219], a[160:163], v[144:147]
    v_mfma_f32_16x16x32_bf16 v[148:151], a[216:219], a[164:167], v[148:151]
    v_mfma_f32_16x16x32_bf16 v[152:155], a[216:219], a[168:171], v[152:155]
    v_mfma_f32_16x16x32_bf16 v[156:159], a[216:219], a[172:175], v[156:159]
    buffer_load_dwordx4 a[216:219], v10, s[8:11], s73 offen offset:3072
    s_waitcnt vmcnt(13)
    v_mfma_f32_16x16x32_bf16 v[160:163], a[220:223], a[144:147], v[160:163]
    v_mfma_f32_16x16x32_bf16 v[164:167], a[220:223], a[148:151], v[164:167]
    ds_read_b128 a[128:131], v9 offset:2048
    v_mfma_f32_16x16x32_bf16 v[168:171], a[220:223], a[152:155], v[168:171]
    v_mfma_f32_16x16x32_bf16 v[172:175], a[220:223], a[156:159], v[172:175]
    v_mfma_f32_16x16x32_bf16 v[176:179], a[220:223], a[160:163], v[176:179]
    v_mfma_f32_16x16x32_bf16 v[180:183], a[220:223], a[164:167], v[180:183]
    v_mfma_f32_16x16x32_bf16 v[184:187], a[220:223], a[168:171], v[184:187]
    v_mfma_f32_16x16x32_bf16 v[188:191], a[220:223], a[172:175], v[188:191]
    buffer_load_dwordx4 a[220:223], v10, s[8:11], s74 offen offset:3072
    s_waitcnt vmcnt(13)
    v_mfma_f32_16x16x32_bf16 v[192:195], a[224:227], a[144:147], v[192:195]
    v_mfma_f32_16x16x32_bf16 v[196:199], a[224:227], a[148:151], v[196:199]
    ds_read_b128 a[132:135], v9 offset:16384
    v_mfma_f32_16x16x32_bf16 v[200:203], a[224:227], a[152:155], v[200:203]
    v_mfma_f32_16x16x32_bf16 v[204:207], a[224:227], a[156:159], v[204:207]
    v_mfma_f32_16x16x32_bf16 v[208:211], a[224:227], a[160:163], v[208:211]
    v_mfma_f32_16x16x32_bf16 v[212:215], a[224:227], a[164:167], v[212:215]
    v_mfma_f32_16x16x32_bf16 v[216:219], a[224:227], a[168:171], v[216:219]
    v_mfma_f32_16x16x32_bf16 v[220:223], a[224:227], a[172:175], v[220:223]
    buffer_load_dwordx4 a[224:227], v10, s[8:11], s75 offen offset:3072
    s_waitcnt vmcnt(13)
    v_mfma_f32_16x16x32_bf16 v[224:227], a[228:231], a[144:147], v[224:227]
    v_mfma_f32_16x16x32_bf16 v[228:231], a[228:231], a[148:151], v[228:231]
    ds_read_b128 a[136:139], v9 offset:30720
    v_mfma_f32_16x16x32_bf16 v[232:235], a[228:231], a[152:155], v[232:235]
    v_mfma_f32_16x16x32_bf16 v[236:239], a[228:231], a[156:159], v[236:239]
    ds_read_b128 a[140:143], v9 offset:45056
    v_mfma_f32_16x16x32_bf16 v[240:243], a[228:231], a[160:163], v[240:243]
    v_mfma_f32_16x16x32_bf16 v[244:247], a[228:231], a[164:167], v[244:247]
    v_mfma_f32_16x16x32_bf16 v[248:251], a[228:231], a[168:171], v[248:251]
    v_mfma_f32_16x16x32_bf16 v[252:255], a[228:231], a[172:175], v[252:255]
    buffer_load_dwordx4 a[228:231], v10, s[8:11], s76 offen offset:3072
    s_waitcnt lgkmcnt(0)
    v_add_u32 v10, 2048, v10
    v_add_u32 v8, 2048, v8
    v_add_u32 v9, 2048, v9
    s_add_u32 s40, s40, 1
    s_cmp_lt_u32 s40, 7
    s_cbranch_scc1 la0_W_gT
    s_waitcnt vmcnt(0)
    s_cmp_eq_u32 s25, 0
    s_cselect_b64 s[28:29], -1, 0
    v_cvt_pk_bf16_f32 v32, v32, v64
    v_accvgpr_write_b32 a112, v32
    v_cvt_pk_bf16_f32 v33, v33, v65
    v_accvgpr_write_b32 a113, v33
    v_cvt_pk_bf16_f32 v34, v34, v66
    v_accvgpr_write_b32 a114, v34
    v_cvt_pk_bf16_f32 v35, v35, v67
    v_accvgpr_write_b32 a115, v35
    v_cvt_pk_bf16_f32 v96, v96, v128
    v_accvgpr_write_b32 a116, v96
    v_cvt_pk_bf16_f32 v97, v97, v129
    v_accvgpr_write_b32 a117, v97
    v_cvt_pk_bf16_f32 v98, v98, v130
    v_accvgpr_write_b32 a118, v98
    v_cvt_pk_bf16_f32 v99, v99, v131
    v_accvgpr_write_b32 a119, v99
    v_cvt_pk_bf16_f32 v160, v160, v192
    v_accvgpr_write_b32 a120, v160
    v_cvt_pk_bf16_f32 v161, v161, v193
    v_accvgpr_write_b32 a121, v161
    v_cvt_pk_bf16_f32 v162, v162, v194
    v_accvgpr_write_b32 a122, v162
    v_cvt_pk_bf16_f32 v163, v163, v195
    v_accvgpr_write_b32 a123, v163
    v_cndmask_b32 v2, v224, 0, s[28:29]
    v_cndmask_b32 v224, 0, v224, s[28:29]
    v_cvt_pk_bf16_f32 v224, v224, v2
    v_accvgpr_write_b32 a124, v224
    v_cndmask_b32 v2, v225, 0, s[28:29]
    v_cndmask_b32 v225, 0, v225, s[28:29]
    v_cvt_pk_bf16_f32 v225, v225, v2
    v_accvgpr_write_b32 a125, v225
    v_cndmask_b32 v2, v226, 0, s[28:29]
    v_cndmask_b32 v226, 0, v226, s[28:29]
    v_cvt_pk_bf16_f32 v226, v226, v2
    v_accvgpr_write_b32 a126, v226
    v_cndmask_b32 v2, v227, 0, s[28:29]
    v_cndmask_b32 v227, 0, v227, s[28:29]
    v_cvt_pk_bf16_f32 v227, v227, v2
    v_accvgpr_write_b32 a127, v227
    v_cvt_pk_bf16_f32 v36, v36, v68
    v_accvgpr_write_b32 a128, v36
    v_cvt_pk_bf16_f32 v37, v37, v69
    v_accvgpr_write_b32 a129, v37
    v_cvt_pk_bf16_f32 v38, v38, v70
    v_accvgpr_write_b32 a130, v38
    v_cvt_pk_bf16_f32 v39, v39, v71
    v_accvgpr_write_b32 a131, v39
    v_cvt_pk_bf16_f32 v100, v100, v132
    v_accvgpr_write_b32 a132, v100
    v_cvt_pk_bf16_f32 v101, v101, v133
    v_accvgpr_write_b32 a133, v101
    v_cvt_pk_bf16_f32 v102, v102, v134
    v_accvgpr_write_b32 a134, v102
    v_cvt_pk_bf16_f32 v103, v103, v135
    v_accvgpr_write_b32 a135, v103
    v_cvt_pk_bf16_f32 v164, v164, v196
    v_accvgpr_write_b32 a136, v164
    v_cvt_pk_bf16_f32 v165, v165, v197
    v_accvgpr_write_b32 a137, v165
    v_cvt_pk_bf16_f32 v166, v166, v198
    v_accvgpr_write_b32 a138, v166
    v_cvt_pk_bf16_f32 v167, v167, v199
    v_accvgpr_write_b32 a139, v167
    v_cndmask_b32 v2, v228, 0, s[28:29]
    v_cndmask_b32 v228, 0, v228, s[28:29]
    v_cvt_pk_bf16_f32 v228, v228, v2
    v_accvgpr_write_b32 a140, v228
    v_cndmask_b32 v2, v229, 0, s[28:29]
    v_cndmask_b32 v229, 0, v229, s[28:29]
    v_cvt_pk_bf16_f32 v229, v229, v2
    v_accvgpr_write_b32 a141, v229
    v_cndmask_b32 v2, v230, 0, s[28:29]
    v_cndmask_b32 v230, 0, v230, s[28:29]
    v_cvt_pk_bf16_f32 v230, v230, v2
    v_accvgpr_write_b32 a142, v230
    v_cndmask_b32 v2, v231, 0, s[28:29]
    v_cndmask_b32 v231, 0, v231, s[28:29]
    v_cvt_pk_bf16_f32 v231, v231, v2
    v_accvgpr_write_b32 a143, v231
    v_cvt_pk_bf16_f32 v40, v40, v72
    v_accvgpr_write_b32 a144, v40
    v_cvt_pk_bf16_f32 v41, v41, v73
    v_accvgpr_write_b32 a145, v41
    v_cvt_pk_bf16_f32 v42, v42, v74
    v_accvgpr_write_b32 a146, v42
    v_cvt_pk_bf16_f32 v43, v43, v75
    v_accvgpr_write_b32 a147, v43
    v_cvt_pk_bf16_f32 v104, v104, v136
    v_accvgpr_write_b32 a148, v104
    v_cvt_pk_bf16_f32 v105, v105, v137
    v_accvgpr_write_b32 a149, v105
    v_cvt_pk_bf16_f32 v106, v106, v138
    v_accvgpr_write_b32 a150, v106
    v_cvt_pk_bf16_f32 v107, v107, v139
    v_accvgpr_write_b32 a151, v107
    v_cvt_pk_bf16_f32 v168, v168, v200
    v_accvgpr_write_b32 a152, v168
    v_cvt_pk_bf16_f32 v169, v169, v201
    v_accvgpr_write_b32 a153, v169
    v_cvt_pk_bf16_f32 v170, v170, v202
    v_accvgpr_write_b32 a154, v170
    v_cvt_pk_bf16_f32 v171, v171, v203
    v_accvgpr_write_b32 a155, v171
    v_cndmask_b32 v2, v232, 0, s[28:29]
    v_cndmask_b32 v232, 0, v232, s[28:29]
    v_cvt_pk_bf16_f32 v232, v232, v2
    v_accvgpr_write_b32 a156, v232
    v_cndmask_b32 v2, v233, 0, s[28:29]
    v_cndmask_b32 v233, 0, v233, s[28:29]
    v_cvt_pk_bf16_f32 v233, v233, v2
    v_accvgpr_write_b32 a157, v233
    v_cndmask_b32 v2, v234, 0, s[28:29]
    v_cndmask_b32 v234, 0, v234, s[28:29]
    v_cvt_pk_bf16_f32 v234, v234, v2
    v_accvgpr_write_b32 a158, v234
    v_cndmask_b32 v2, v235, 0, s[28:29]
    v_cndmask_b32 v235, 0, v235, s[28:29]
    v_cvt_pk_bf16_f32 v235, v235, v2
    v_accvgpr_write_b32 a159, v235
    v_cvt_pk_bf16_f32 v44, v44, v76
    v_accvgpr_write_b32 a160, v44
    v_cvt_pk_bf16_f32 v45, v45, v77
    v_accvgpr_write_b32 a161, v45
    v_cvt_pk_bf16_f32 v46, v46, v78
    v_accvgpr_write_b32 a162, v46
    v_cvt_pk_bf16_f32 v47, v47, v79
    v_accvgpr_write_b32 a163, v47
    v_cvt_pk_bf16_f32 v108, v108, v140
    v_accvgpr_write_b32 a164, v108
    v_cvt_pk_bf16_f32 v109, v109, v141
    v_accvgpr_write_b32 a165, v109
    v_cvt_pk_bf16_f32 v110, v110, v142
    v_accvgpr_write_b32 a166, v110
    v_cvt_pk_bf16_f32 v111, v111, v143
    v_accvgpr_write_b32 a167, v111
    v_cvt_pk_bf16_f32 v172, v172, v204
    v_accvgpr_write_b32 a168, v172
    v_cvt_pk_bf16_f32 v173, v173, v205
    v_accvgpr_write_b32 a169, v173
    v_cvt_pk_bf16_f32 v174, v174, v206
    v_accvgpr_write_b32 a170, v174
    v_cvt_pk_bf16_f32 v175, v175, v207
    v_accvgpr_write_b32 a171, v175
    v_cndmask_b32 v2, v236, 0, s[28:29]
    v_cndmask_b32 v236, 0, v236, s[28:29]
    v_cvt_pk_bf16_f32 v236, v236, v2
    v_accvgpr_write_b32 a172, v236
    v_cndmask_b32 v2, v237, 0, s[28:29]
    v_cndmask_b32 v237, 0, v237, s[28:29]
    v_cvt_pk_bf16_f32 v237, v237, v2
    v_accvgpr_write_b32 a173, v237
    v_cndmask_b32 v2, v238, 0, s[28:29]
    v_cndmask_b32 v238, 0, v238, s[28:29]
    v_cvt_pk_bf16_f32 v238, v238, v2
    v_accvgpr_write_b32 a174, v238
    v_cndmask_b32 v2, v239, 0, s[28:29]
    v_cndmask_b32 v239, 0, v239, s[28:29]
    v_cvt_pk_bf16_f32 v239, v239, v2
    v_accvgpr_write_b32 a175, v239
    v_cvt_pk_bf16_f32 v48, v48, v80
    v_accvgpr_write_b32 a176, v48
    v_cvt_pk_bf16_f32 v49, v49, v81
    v_accvgpr_write_b32 a177, v49
    v_cvt_pk_bf16_f32 v50, v50, v82
    v_accvgpr_write_b32 a178, v50
    v_cvt_pk_bf16_f32 v51, v51, v83
    v_accvgpr_write_b32 a179, v51
    v_cvt_pk_bf16_f32 v112, v112, v144
    v_accvgpr_write_b32 a180, v112
    v_cvt_pk_bf16_f32 v113, v113, v145
    v_accvgpr_write_b32 a181, v113
    v_cvt_pk_bf16_f32 v114, v114, v146
    v_accvgpr_write_b32 a182, v114
    v_cvt_pk_bf16_f32 v115, v115, v147
    v_accvgpr_write_b32 a183, v115
    v_cvt_pk_bf16_f32 v176, v176, v208
    v_accvgpr_write_b32 a184, v176
    v_cvt_pk_bf16_f32 v177, v177, v209
    v_accvgpr_write_b32 a185, v177
    v_cvt_pk_bf16_f32 v178, v178, v210
    v_accvgpr_write_b32 a186, v178
    v_cvt_pk_bf16_f32 v179, v179, v211
    v_accvgpr_write_b32 a187, v179
    v_cndmask_b32 v2, v240, 0, s[28:29]
    v_cndmask_b32 v240, 0, v240, s[28:29]
    v_cvt_pk_bf16_f32 v240, v240, v2
    v_accvgpr_write_b32 a188, v240
    v_cndmask_b32 v2, v241, 0, s[28:29]
    v_cndmask_b32 v241, 0, v241, s[28:29]
    v_cvt_pk_bf16_f32 v241, v241, v2
    v_accvgpr_write_b32 a189, v241
    v_cndmask_b32 v2, v242, 0, s[28:29]
    v_cndmask_b32 v242, 0, v242, s[28:29]
    v_cvt_pk_bf16_f32 v242, v242, v2
    v_accvgpr_write_b32 a190, v242
    v_cndmask_b32 v2, v243, 0, s[28:29]
    v_cndmask_b32 v243, 0, v243, s[28:29]
    v_cvt_pk_bf16_f32 v243, v243, v2
    v_accvgpr_write_b32 a191, v243
    v_cvt_pk_bf16_f32 v52, v52, v84
    v_accvgpr_write_b32 a192, v52
    v_cvt_pk_bf16_f32 v53, v53, v85
    v_accvgpr_write_b32 a193, v53
    v_cvt_pk_bf16_f32 v54, v54, v86
    v_accvgpr_write_b32 a194, v54
    v_cvt_pk_bf16_f32 v55, v55, v87
    v_accvgpr_write_b32 a195, v55
    v_cvt_pk_bf16_f32 v116, v116, v148
    v_accvgpr_write_b32 a196, v116
    v_cvt_pk_bf16_f32 v117, v117, v149
    v_accvgpr_write_b32 a197, v117
    v_cvt_pk_bf16_f32 v118, v118, v150
    v_accvgpr_write_b32 a198, v118
    v_cvt_pk_bf16_f32 v119, v119, v151
    v_accvgpr_write_b32 a199, v119
    v_cvt_pk_bf16_f32 v180, v180, v212
    v_accvgpr_write_b32 a200, v180
    v_cvt_pk_bf16_f32 v181, v181, v213
    v_accvgpr_write_b32 a201, v181
    v_cvt_pk_bf16_f32 v182, v182, v214
    v_accvgpr_write_b32 a202, v182
    v_cvt_pk_bf16_f32 v183, v183, v215
    v_accvgpr_write_b32 a203, v183
    v_cndmask_b32 v2, v244, 0, s[28:29]
    v_cndmask_b32 v244, 0, v244, s[28:29]
    v_cvt_pk_bf16_f32 v244, v244, v2
    v_accvgpr_write_b32 a204, v244
    v_cndmask_b32 v2, v245, 0, s[28:29]
    v_cndmask_b32 v245, 0, v245, s[28:29]
    v_cvt_pk_bf16_f32 v245, v245, v2
    v_accvgpr_write_b32 a205, v245
    v_cndmask_b32 v2, v246, 0, s[28:29]
    v_cndmask_b32 v246, 0, v246, s[28:29]
    v_cvt_pk_bf16_f32 v246, v246, v2
    v_accvgpr_write_b32 a206, v246
    v_cndmask_b32 v2, v247, 0, s[28:29]
    v_cndmask_b32 v247, 0, v247, s[28:29]
    v_cvt_pk_bf16_f32 v247, v247, v2
    v_accvgpr_write_b32 a207, v247
    v_cvt_pk_bf16_f32 v56, v56, v88
    v_accvgpr_write_b32 a208, v56
    v_cvt_pk_bf16_f32 v57, v57, v89
    v_accvgpr_write_b32 a209, v57
    v_cvt_pk_bf16_f32 v58, v58, v90
    v_accvgpr_write_b32 a210, v58
    v_cvt_pk_bf16_f32 v59, v59, v91
    v_accvgpr_write_b32 a211, v59
    v_cvt_pk_bf16_f32 v120, v120, v152
    v_accvgpr_write_b32 a212, v120
    v_cvt_pk_bf16_f32 v121, v121, v153
    v_accvgpr_write_b32 a213, v121
    v_cvt_pk_bf16_f32 v122, v122, v154
    v_accvgpr_write_b32 a214, v122
    v_cvt_pk_bf16_f32 v123, v123, v155
    v_accvgpr_write_b32 a215, v123
    v_cvt_pk_bf16_f32 v184, v184, v216
    v_accvgpr_write_b32 a216, v184
    v_cvt_pk_bf16_f32 v185, v185, v217
    v_accvgpr_write_b32 a217, v185
    v_cvt_pk_bf16_f32 v186, v186, v218
    v_accvgpr_write_b32 a218, v186
    v_cvt_pk_bf16_f32 v187, v187, v219
    v_accvgpr_write_b32 a219, v187
    v_cndmask_b32 v2, v248, 0, s[28:29]
    v_cndmask_b32 v248, 0, v248, s[28:29]
    v_cvt_pk_bf16_f32 v248, v248, v2
    v_accvgpr_write_b32 a220, v248
    v_cndmask_b32 v2, v249, 0, s[28:29]
    v_cndmask_b32 v249, 0, v249, s[28:29]
    v_cvt_pk_bf16_f32 v249, v249, v2
    v_accvgpr_write_b32 a221, v249
    v_cndmask_b32 v2, v250, 0, s[28:29]
    v_cndmask_b32 v250, 0, v250, s[28:29]
    v_cvt_pk_bf16_f32 v250, v250, v2
    v_accvgpr_write_b32 a222, v250
    v_cndmask_b32 v2, v251, 0, s[28:29]
    v_cndmask_b32 v251, 0, v251, s[28:29]
    v_cvt_pk_bf16_f32 v251, v251, v2
    v_accvgpr_write_b32 a223, v251
    v_cvt_pk_bf16_f32 v60, v60, v92
    v_accvgpr_write_b32 a224, v60
    v_cvt_pk_bf16_f32 v61, v61, v93
    v_accvgpr_write_b32 a225, v61
    v_cvt_pk_bf16_f32 v62, v62, v94
    v_accvgpr_write_b32 a226, v62
    v_cvt_pk_bf16_f32 v63, v63, v95
    v_accvgpr_write_b32 a227, v63
    v_cvt_pk_bf16_f32 v124, v124, v156
    v_accvgpr_write_b32 a228, v124
    v_cvt_pk_bf16_f32 v125, v125, v157
    v_accvgpr_write_b32 a229, v125
    v_cvt_pk_bf16_f32 v126, v126, v158
    v_accvgpr_write_b32 a230, v126
    v_cvt_pk_bf16_f32 v127, v127, v159
    v_accvgpr_write_b32 a231, v127
    v_cvt_pk_bf16_f32 v188, v188, v220
    v_accvgpr_write_b32 a232, v188
    v_cvt_pk_bf16_f32 v189, v189, v221
    v_accvgpr_write_b32 a233, v189
    v_cvt_pk_bf16_f32 v190, v190, v222
    v_accvgpr_write_b32 a234, v190
    v_cvt_pk_bf16_f32 v191, v191, v223
    v_accvgpr_write_b32 a235, v191
    v_cndmask_b32 v2, v252, 0, s[28:29]
    v_cndmask_b32 v252, 0, v252, s[28:29]
    v_cvt_pk_bf16_f32 v252, v252, v2
    v_accvgpr_write_b32 a236, v252
    v_cndmask_b32 v2, v253, 0, s[28:29]
    v_cndmask_b32 v253, 0, v253, s[28:29]
    v_cvt_pk_bf16_f32 v253, v253, v2
    v_accvgpr_write_b32 a237, v253
    v_cndmask_b32 v2, v254, 0, s[28:29]
    v_cndmask_b32 v254, 0, v254, s[28:29]
    v_cvt_pk_bf16_f32 v254, v254, v2
    v_accvgpr_write_b32 a238, v254
    v_cndmask_b32 v2, v255, 0, s[28:29]
    v_cndmask_b32 v255, 0, v255, s[28:29]
    v_cvt_pk_bf16_f32 v255, v255, v2
    v_accvgpr_write_b32 a239, v255
    s_mul_i32 s22, s24, 7
    s_lshl_b32 s23, s25, 2
    s_add_u32 s23, s23, s22
    s_lshl_b32 s23, s23, 10
    s_add_u32 s22, s22, 3
    s_lshl_b32 s22, s22, 10
    v_add_u32 v12, s23, v7
    v_add_u32 v13, 57344, v12
    v_add_u32 v14, s22, v7
    v_add_u32 v15, 57344, v14
    s_lshr_b32 s67, s23, 4
    s_lshr_b32 s68, s22, 4
    ds_read_b128 v[96:99], v12 offset:0
    ds_read_b128 v[100:103], v12 offset:1024
    ds_read_b128 v[104:107], v12 offset:2048
    ds_read_b128 v[108:111], v14 offset:0
    ds_read_b128 v[112:115], v12 offset:14336
    ds_read_b128 v[116:119], v12 offset:15360
    ds_read_b128 v[120:123], v12 offset:16384
    ds_read_b128 v[124:127], v14 offset:14336
    ds_read_b128 v[128:131], v12 offset:28672
    ds_read_b128 v[132:135], v12 offset:29696
    ds_read_b128 v[136:139], v12 offset:30720
    ds_read_b128 v[140:143], v14 offset:28672
    ds_read_b128 v[144:147], v12 offset:43008
    ds_read_b128 v[148:151], v12 offset:44032
    ds_read_b128 v[152:155], v12 offset:45056
    ds_read_b128 v[156:159], v14 offset:43008
    s_waitcnt lgkmcnt(8)
    v_mfma_f32_16x16x32_bf16 v[32:35], v[96:99], a[112:115], 0
    v_mfma_f32_16x16x32_bf16 v[36:39], v[96:99], a[128:131], 0
    v_mfma_f32_16x16x32_bf16 v[40:43], v[112:115], a[128:131], 0
    v_mfma_f32_16x16x32_bf16 v[32:35], v[100:103], a[116:119], v[32:35]
    v_mfma_f32_16x16x32_bf16 v[36:39], v[100:103], a[132:135], v[36:39]
    v_mfma_f32_16x16x32_bf16 v[40:43], v[116:119], a[132:135], v[40:43]
    v_mfma_f32_16x16x32_bf16 v[32:35], v[104:107], a[120:123], v[32:35]
    v_mfma_f32_16x16x32_bf16 v[36:39], v[104:107], a[136:139], v[36:39]
    v_mfma_f32_16x16x32_bf16 v[40:43], v[120:123], a[136:139], v[40:43]
    v_mfma_f32_16x16x32_bf16 v[32:35], v[108:111], a[124:127], v[32:35]
    v_mfma_f32_16x16x32_bf16 v[36:39], v[108:111], a[140:143], v[36:39]
    v_mfma_f32_16x16x32_bf16 v[40:43], v[124:127], a[140:143], v[40:43]
    ds_read_b128 v[160:163], v13 offset:0
    ds_read_b128 v[164:167], v13 offset:1024
    ds_read_b128 v[168:171], v13 offset:2048
    ds_read_b128 v[172:175], v15 offset:0
    ds_read_b128 v[176:179], v13 offset:14336
    ds_read_b128 v[180:183], v13 offset:15360
    ds_read_b128 v[184:187], v13 offset:16384
    ds_read_b128 v[188:191], v15 offset:14336
    s_waitcnt lgkmcnt(8)
    v_mfma_f32_16x16x32_bf16 v[44:47], v[128:131], a[144:147], 0
    v_mfma_f32_16x16x32_bf16 v[48:51], v[128:131], a[160:163], 0
    v_mfma_f32_16x16x32_bf16 v[52:55], v[144:147], a[160:163], 0
    v_mfma_f32_16x16x32_bf16 v[44:47], v[132:135], a[148:151], v[44:47]
    v_mfma_f32_16x16x32_bf16 v[48:51], v[132:135], a[164:167], v[48:51]
    v_mfma_f32_16x16x32_bf16 v[52:55], v[148:151], a[164:167], v[52:55]
    v_mfma_f32_16x16x32_bf16 v[44:47], v[136:139], a[152:155], v[44:47]
    v_mfma_f32_16x16x32_bf16 v[48:51], v[136:139], a[168:171], v[48:51]
    v_mfma_f32_16x16x32_bf16 v[52:55], v[152:155], a[168:171], v[52:55]
    v_mfma_f32_16x16x32_bf16 v[44:47], v[140:143], a[156:159], v[44:47]
    v_mfma_f32_16x16x32_bf16 v[48:51], v[140:143], a[172:175], v[48:51]
    v_mfma_f32_16x16x32_bf16 v[52:55], v[156:159], a[172:175], v[52:55]
    ds_read_b128 v[192:195], v13 offset:28672
    ds_read_b128 v[196:199], v13 offset:29696
    ds_read_b128 v[200:203], v13 offset:30720
    ds_read_b128 v[204:207], v15 offset:28672
    ds_read_b128 v[208:211], v13 offset:43008
    ds_read_b128 v[212:215], v13 offset:44032
    ds_read_b128 v[216:219], v13 offset:45056
    ds_read_b128 v[220:223], v15 offset:43008
    s_waitcnt lgkmcnt(8)
    v_mfma_f32_16x16x32_bf16 v[56:59], v[160:163], a[176:179], 0
    v_mfma_f32_16x16x32_bf16 v[60:63], v[160:163], a[192:195], 0
    v_mfma_f32_16x16x32_bf16 v[64:67], v[176:179], a[192:195], 0
    v_mfma_f32_16x16x32_bf16 v[56:59], v[164:167], a[180:183], v[56:59]
    v_mfma_f32_16x16x32_bf16 v[60:63], v[164:167], a[196:199], v[60:63]
    v_mfma_f32_16x16x32_bf16 v[64:67], v[180:183], a[196:199], v[64:67]
    v_mfma_f32_16x16x32_bf16 v[56:59], v[168:171], a[184:187], v[56:59]
    v_mfma_f32_16x16x32_bf16 v[60:63], v[168:171], a[200:203], v[60:63]
    v_mfma_f32_16x16x32_bf16 v[64:67], v[184:187], a[200:203], v[64:67]
    v_mfma_f32_16x16x32_bf16 v[56:59], v[172:175], a[188:191], v[56:59]
    v_mfma_f32_16x16x32_bf16 v[60:63], v[172:175], a[204:207], v[60:63]
    v_mfma_f32_16x16x32_bf16 v[64:67], v[188:191], a[204:207], v[64:67]
    s_waitcnt lgkmcnt(0)
    v_mfma_f32_16x16x32_bf16 v[68:71], v[192:195], a[208:211], 0
    v_mfma_f32_16x16x32_bf16 v[72:75], v[192:195], a[224:227], 0
    v_mfma_f32_16x16x32_bf16 v[76:79], v[208:211], a[224:227], 0
    v_mfma_f32_16x16x32_bf16 v[68:71], v[196:199], a[212:215], v[68:71]
    v_mfma_f32_16x16x32_bf16 v[72:75], v[196:199], a[228:231], v[72:75]
    v_mfma_f32_16x16x32_bf16 v[76:79], v[212:215], a[228:231], v[76:79]
    v_mfma_f32_16x16x32_bf16 v[68:71], v[200:203], a[216:219], v[68:71]
    v_mfma_f32_16x16x32_bf16 v[72:75], v[200:203], a[232:235], v[72:75]
    v_mfma_f32_16x16x32_bf16 v[76:79], v[216:219], a[232:235], v[76:79]
    v_mfma_f32_16x16x32_bf16 v[68:71], v[204:207], a[220:223], v[68:71]
    v_mfma_f32_16x16x32_bf16 v[72:75], v[204:207], a[236:239], v[72:75]
    v_mfma_f32_16x16x32_bf16 v[76:79], v[220:223], a[236:239], v[76:79]
    s_barrier
    s_mul_i32 s22, s3, 12288
    v_add_u32 v12, s22, v7
    ds_write_b128 v12, v[32:35] offset:0
    ds_write_b128 v12, v[36:39] offset:1024
    ds_write_b128 v12, v[40:43] offset:2048
    ds_write_b128 v12, v[44:47] offset:3072
    ds_write_b128 v12, v[48:51] offset:4096
    ds_write_b128 v12, v[52:55] offset:5120
    ds_write_b128 v12, v[56:59] offset:6144
    ds_write_b128 v12, v[60:63] offset:7168
    ds_write_b128 v12, v[64:67] offset:8192
    ds_write_b128 v12, v[68:71] offset:9216
    ds_write_b128 v12, v[72:75] offset:10240
    ds_write_b128 v12, v[76:79] offset:11264
    s_waitcnt lgkmcnt(0)
    s_barrier
    ds_read_b128 v[96:99], v7 offset:0
    ds_read_b128 v[100:103], v7 offset:12288
    ds_read_b128 v[104:107], v7 offset:24576
    ds_read_b128 v[108:111], v7 offset:36864
    ds_read_b128 v[112:115], v7 offset:1024
    ds_read_b128 v[116:119], v7 offset:13312
    ds_read_b128 v[120:123], v7 offset:25600
    ds_read_b128 v[124:127], v7 offset:37888
    ds_read_b128 v[128:131], v7 offset:2048
    ds_read_b128 v[132:135], v7 offset:14336
    ds_read_b128 v[136:139], v7 offset:26624
    ds_read_b128 v[140:143], v7 offset:38912
    s_waitcnt lgkmcnt(8)
    v_pk_add_f32 v[96:97], v[96:97], v[100:101]
    v_pk_add_f32 v[104:105], v[104:105], v[108:109]
    v_pk_add_f32 v[32:33], v[96:97], v[104:105]
    v_pk_add_f32 v[98:99], v[98:99], v[102:103]
    v_pk_add_f32 v[106:107], v[106:107], v[110:111]
    v_pk_add_f32 v[34:35], v[98:99], v[106:107]
    s_waitcnt lgkmcnt(4)
    v_pk_add_f32 v[112:113], v[112:113], v[116:117]
    v_pk_add_f32 v[120:121], v[120:121], v[124:125]
    v_pk_add_f32 v[36:37], v[112:113], v[120:121]
    v_pk_add_f32 v[114:115], v[114:115], v[118:119]
    v_pk_add_f32 v[122:123], v[122:123], v[126:127]
    v_pk_add_f32 v[38:39], v[114:115], v[122:123]
    s_waitcnt lgkmcnt(0)
    v_pk_add_f32 v[128:129], v[128:129], v[132:133]
    v_pk_add_f32 v[136:137], v[136:137], v[140:141]
    v_pk_add_f32 v[40:41], v[128:129], v[136:137]
    v_pk_add_f32 v[130:131], v[130:131], v[134:135]
    v_pk_add_f32 v[138:139], v[138:139], v[142:143]
    v_pk_add_f32 v[42:43], v[130:131], v[138:139]
    ds_read_b128 v[96:99], v7 offset:3072
    ds_read_b128 v[100:103], v7 offset:15360
    ds_read_b128 v[104:107], v7 offset:27648
    ds_read_b128 v[108:111], v7 offset:39936
    ds_read_b128 v[112:115], v7 offset:4096
    ds_read_b128 v[116:119], v7 offset:16384
    ds_read_b128 v[120:123], v7 offset:28672
    ds_read_b128 v[124:127], v7 offset:40960
    ds_read_b128 v[128:131], v7 offset:5120
    ds_read_b128 v[132:135], v7 offset:17408
    ds_read_b128 v[136:139], v7 offset:29696
    ds_read_b128 v[140:143], v7 offset:41984
    s_waitcnt lgkmcnt(8)
    v_pk_add_f32 v[96:97], v[96:97], v[100:101]
    v_pk_add_f32 v[104:105], v[104:105], v[108:109]
    v_pk_add_f32 v[44:45], v[96:97], v[104:105]
    v_pk_add_f32 v[98:99], v[98:99], v[102:103]
    v_pk_add_f32 v[106:107], v[106:107], v[110:111]
    v_pk_add_f32 v[46:47], v[98:99], v[106:107]
    s_waitcnt lgkmcnt(4)
    v_pk_add_f32 v[112:113], v[112:113], v[116:117]
    v_pk_add_f32 v[120:121], v[120:121], v[124:125]
    v_pk_add_f32 v[48:49], v[112:113], v[120:121]
    v_pk_add_f32 v[114:115], v[114:115], v[118:119]
    v_pk_add_f32 v[122:123], v[122:123], v[126:127]
    v_pk_add_f32 v[50:51], v[114:115], v[122:123]
    s_waitcnt lgkmcnt(0)
    v_pk_add_f32 v[128:129], v[128:129], v[132:133]
    v_pk_add_f32 v[136:137], v[136:137], v[140:141]
    v_pk_add_f32 v[52:53], v[128:129], v[136:137]
    v_pk_add_f32 v[130:131], v[130:131], v[134:135]
    v_pk_add_f32 v[138:139], v[138:139], v[142:143]
    v_pk_add_f32 v[54:55], v[130:131], v[138:139]
    ds_read_b128 v[96:99], v7 offset:6144
    ds_read_b128 v[100:103], v7 offset:18432
    ds_read_b128 v[104:107], v7 offset:30720
    ds_read_b128 v[108:111], v7 offset:43008
    ds_read_b128 v[112:115], v7 offset:7168
    ds_read_b128 v[116:119], v7 offset:19456
    ds_read_b128 v[120:123], v7 offset:31744
    ds_read_b128 v[124:127], v7 offset:44032
    ds_read_b128 v[128:131], v7 offset:8192
    ds_read_b128 v[132:135], v7 offset:20480
    ds_read_b128 v[136:139], v7 offset:32768
    ds_read_b128 v[140:143], v7 offset:45056
    s_waitcnt lgkmcnt(8)
    v_pk_add_f32 v[96:97], v[96:97], v[100:101]
    v_pk_add_f32 v[104:105], v[104:105], v[108:109]
    v_pk_add_f32 v[56:57], v[96:97], v[104:105]
    v_pk_add_f32 v[98:99], v[98:99], v[102:103]
    v_pk_add_f32 v[106:107], v[106:107], v[110:111]
    v_pk_add_f32 v[58:59], v[98:99], v[106:107]
    s_waitcnt lgkmcnt(4)
    v_pk_add_f32 v[112:113], v[112:113], v[116:117]
    v_pk_add_f32 v[120:121], v[120:121], v[124:125]
    v_pk_add_f32 v[60:61], v[112:113], v[120:121]
    v_pk_add_f32 v[114:115], v[114:115], v[118:119]
    v_pk_add_f32 v[122:123], v[122:123], v[126:127]
    v_pk_add_f32 v[62:63], v[114:115], v[122:123]
    s_waitcnt lgkmcnt(0)
    v_pk_add_f32 v[128:129], v[128:129], v[132:133]
    v_pk_add_f32 v[136:137], v[136:137], v[140:141]
    v_pk_add_f32 v[64:65], v[128:129], v[136:137]
    v_pk_add_f32 v[130:131], v[130:131], v[134:135]
    v_pk_add_f32 v[138:139], v[138:139], v[142:143]
    v_pk_add_f32 v[66:67], v[130:131], v[138:139]
    ds_read_b128 v[96:99], v7 offset:9216
    ds_read_b128 v[100:103], v7 offset:21504
    ds_read_b128 v[104:107], v7 offset:33792
    ds_read_b128 v[108:111], v7 offset:46080
    ds_read_b128 v[112:115], v7 offset:10240
    ds_read_b128 v[116:119], v7 offset:22528
    ds_read_b128 v[120:123], v7 offset:34816
    ds_read_b128 v[124:127], v7 offset:47104
    ds_read_b128 v[128:131], v7 offset:11264
    ds_read_b128 v[132:135], v7 offset:23552
    ds_read_b128 v[136:139], v7 offset:35840
    ds_read_b128 v[140:143], v7 offset:48128
    s_waitcnt lgkmcnt(8)
    v_pk_add_f32 v[96:97], v[96:97], v[100:101]
    v_pk_add_f32 v[104:105], v[104:105], v[108:109]
    v_pk_add_f32 v[68:69], v[96:97], v[104:105]
    v_pk_add_f32 v[98:99], v[98:99], v[102:103]
    v_pk_add_f32 v[106:107], v[106:107], v[110:111]
    v_pk_add_f32 v[70:71], v[98:99], v[106:107]
    s_waitcnt lgkmcnt(4)
    v_pk_add_f32 v[112:113], v[112:113], v[116:117]
    v_pk_add_f32 v[120:121], v[120:121], v[124:125]
    v_pk_add_f32 v[72:73], v[112:113], v[120:121]
    v_pk_add_f32 v[114:115], v[114:115], v[118:119]
    v_pk_add_f32 v[122:123], v[122:123], v[126:127]
    v_pk_add_f32 v[74:75], v[114:115], v[122:123]
    s_waitcnt lgkmcnt(0)
    v_pk_add_f32 v[128:129], v[128:129], v[132:133]
    v_pk_add_f32 v[136:137], v[136:137], v[140:141]
    v_pk_add_f32 v[76:77], v[128:129], v[136:137]
    v_pk_add_f32 v[130:131], v[130:131], v[134:135]
    v_pk_add_f32 v[138:139], v[138:139], v[142:143]
    v_pk_add_f32 v[78:79], v[130:131], v[138:139]
    v_bfe_u32 v2, v1, 4, 2
    v_lshlrev_b32 v2, 2, v2
    v_and_b32 v3, 15, v1
    v_sub_u32 v3, v3, v2
    v_mov_b32 v2, 0xf149f2ca
    v_cmp_le_i32 vcc, 0, v3
    s_nop 1
    v_cndmask_b32 v32, v2, v32, vcc
    v_cndmask_b32 v40, v2, v40, vcc
    v_cndmask_b32 v44, v2, v44, vcc
    v_cndmask_b32 v52, v2, v52, vcc
    v_cndmask_b32 v56, v2, v56, vcc
    v_cndmask_b32 v64, v2, v64, vcc
    v_cndmask_b32 v68, v2, v68, vcc
    v_cndmask_b32 v76, v2, v76, vcc
    v_cmp_le_i32 vcc, 1, v3
    s_nop 1
    v_cndmask_b32 v33, v2, v33, vcc
    v_cndmask_b32 v41, v2, v41, vcc
    v_cndmask_b32 v45, v2, v45, vcc
    v_cndmask_b32 v53, v2, v53, vcc
    v_cndmask_b32 v57, v2, v57, vcc
    v_cndmask_b32 v65, v2, v65, vcc
    v_cndmask_b32 v69, v2, v69, vcc
    v_cndmask_b32 v77, v2, v77, vcc
    v_cmp_le_i32 vcc, 2, v3
    s_nop 1
    v_cndmask_b32 v34, v2, v34, vcc
    v_cndmask_b32 v42, v2, v42, vcc
    v_cndmask_b32 v46, v2, v46, vcc
    v_cndmask_b32 v54, v2, v54, vcc
    v_cndmask_b32 v58, v2, v58, vcc
    v_cndmask_b32 v66, v2, v66, vcc
    v_cndmask_b32 v70, v2, v70, vcc
    v_cndmask_b32 v78, v2, v78, vcc
    v_cmp_le_i32 vcc, 3, v3
    s_nop 1
    v_cndmask_b32 v35, v2, v35, vcc
    v_cndmask_b32 v43, v2, v43, vcc
    v_cndmask_b32 v47, v2, v47, vcc
    v_cndmask_b32 v55, v2, v55, vcc
    v_cndmask_b32 v59, v2, v59, vcc
    v_cndmask_b32 v67, v2, v67, vcc
    v_cndmask_b32 v71, v2, v71, vcc
    v_cndmask_b32 v79, v2, v79, vcc
    v_bfe_u32 v12, v1, 2, 2
    v_mul_u32_u24 v12, 0x700, v12
    v_bfe_u32 v2, v1, 0, 1
    v_mul_u32_u24 v2, 0x380, v2
    v_add_u32 v12, v12, v2
    v_bfe_u32 v2, v1, 4, 2
    v_lshlrev_b32 v2, 4, v2
    v_add_u32 v12, v12, v2
    v_bfe_u32 v2, v1, 1, 1
    v_cmp_eq_u32 vcc, 1, v2
    v_mov_b32 v3, 0x40000000
    s_nop 0
    v_cndmask_b32 v12, v12, v3, vcc
    v_add_u32 v13, s68, v12
    v_add_u32 v12, s67, v12
    s_and_b32 s22, s31, 3
    s_lshl_b32 s22, s22, 2
    v_add_u32 v14, s22, v7
    v_min_u32 v15, 13, v1
    v_lshlrev_b32 v15, 7, v15
    s_mul_i32 s22, s3, 448
    v_bfe_u32 v16, v1, 4, 2
    v_mul_u32_u24 v16, 0x1c00, v16
    v_bfe_u32 v2, v1, 0, 4
    v_lshlrev_b32 v2, 2, v2
    v_add_u32 v16, v16, v2
    v_add_u32 v16, s22, v16
    s_lshl_b32 s22, s3, 10
    v_add_u32 v17, s22, v7
    s_mov_b32 s41, 0x4289000
    s_add_u32 s41, s41, s84
    s_mul_i32 s42, s30, 28672
    s_add_u32 s42, s42, 0x3f00000
    s_add_u32 s42, s42, s84
    s_lshl_b32 s43, s30, 4
    s_lshr_b32 s22, s31, 2
    s_add_u32 s43, s43, s22
    s_mul_i32 s43, s43, 28
    s_mul_i32 s22, s3, 7
    s_add_u32 s43, s43, s22
    s_lshl_b32 s43, s43, 10
    s_add_u32 s43, s43, 0x3800000
    s_add_u32 s43, s43, s84
    s_mul_i32 s44, s30, 229376
    s_add_u32 s44, s44, 0xe00000
    s_lshl_b32 s45, s30, 9
    s_add_u32 s45, s45, 0x4287000
    s_add_u32 s45, s45, s84
    s_cmp_eq_u32 s30, 13
    s_cselect_b32 s37, 3, 15
    s_lshl_b32 s34, 1, s32
    s_cmp_lt_i32 s32, 0
    s_cselect_b32 s37, s37, s34
    s_cmp_eq_u32 s32, 12
    s_cselect_b32 s37, 12, s37
    s_cmp_eq_u32 s30, 15
    s_cselect_b32 s33, s32, 0
    s_cmp_ge_u32 s33, 2
    s_cselect_b32 s33, 1, 0
    s_cbranch_scc1 la0_W_seg
la0_W_half:
    s_flbit_i32_b32 s34, s37
    s_sub_u32 s34, 31, s34
    s_lshl_b32 s34, s34, 7
    s_add_u32 s34, s34, s45
    buffer_load_dwordx4 v[80:83], v7, s[8:11], s50 offen offset:0
    buffer_load_dwordx4 v[84:87], v7, s[8:11], s51 offen offset:0
    buffer_load_dwordx4 v[88:91], v7, s[8:11], s52 offen offset:0
    buffer_load_dwordx4 v[92:95], v7, s[8:11], s53 offen offset:0
    buffer_load_dwordx4 v[96:99], v7, s[8:11], s54 offen offset:0
    buffer_load_dwordx4 v[100:103], v7, s[8:11], s55 offen offset:0
    buffer_load_dwordx4 v[104:107], v7, s[8:11], s56 offen offset:0
    buffer_load_dwordx4 v[108:111], v7, s[8:11], s50 offen offset:1024
    buffer_load_dwordx4 v[112:115], v7, s[8:11], s51 offen offset:1024
    buffer_load_dwordx4 v[116:119], v7, s[8:11], s52 offen offset:1024
    buffer_load_dwordx4 v[120:123], v7, s[8:11], s53 offen offset:1024
    buffer_load_dwordx4 v[124:127], v7, s[8:11], s54 offen offset:1024
    buffer_load_dwordx4 v[128:131], v7, s[8:11], s55 offen offset:1024
    buffer_load_dwordx4 v[132:135], v7, s[8:11], s56 offen offset:1024
    s_mov_b32 s91, 0
    s_mov_b32 s35, 0x1180800
la0_W_pm:
    s_cmp_lg_u32 s3, 0
    s_cbranch_scc1 la0_W_pm_w
    v_mov_b32 v19, 0
    buffer_load_dword v2, v19, s[8:11], s34 offen sc1
    buffer_load_dword v3, v19, s[8:11], s35 offen sc1
    v_mov_b32 v19, 0x27ff0
    s_waitcnt vmcnt(0)
    ds_write_b64 v19, v[2:3]
    s_waitcnt lgkmcnt(0)
la0_W_pm_w:
    s_barrier
    v_mov_b32 v19, 0x27ff0
    ds_read_b64 v[2:3], v19
    s_waitcnt lgkmcnt(0)
    v_readfirstlane_b32 s22, v2
    v_readfirstlane_b32 s23, v3
    s_barrier
    s_cmp_lg_u32 s22, 0
    s_cbranch_scc1 la0_W_pm_ok
    s_cmp_eq_u32 s23, 1
    s_cbranch_scc1 la0_W_pm_s
    s_cmp_lg_u32 s87, 0
    s_cbranch_scc1 la0_W_pm_s
    s_cmp_eq_u32 s23, 2
    s_cbranch_scc1 la0_W_join
    s_cmp_eq_u32 s91, 200
    s_cbranch_scc1 la0_W_decide
la0_W_pm_s:
    s_sleep 6
    s_add_u32 s91, s91, 1
    s_cmp_lt_u32 s91, s90
    s_cbranch_scc1 la0_W_pm
    s_mov_b32 s90, 0
    s_branch la0_W_pm_ok
la0_W_decide:
    s_add_u32 s91, s91, 1
    s_cmp_lg_u32 s3, 0
    s_cbranch_scc1 la0_W_pm
    v_mov_b32 v2, 2
    v_mov_b32 v3, 0
    v_mov_b32 v19, 0
    s_mov_b64 exec, 1
    buffer_atomic_cmpswap v[2:3], v19, s[8:11], s35 offen
    s_mov_b64 exec, -1
    s_waitcnt vmcnt(0)
    s_branch la0_W_pm
la0_W_join:
    s_mov_b32 s87, 1
    s_cmp_lg_u32 s3, 0
    s_cbranch_scc1 la0_W_join_w
    s_mov_b32 s22, 0x1180000
    v_mov_b32 v2, 1
    v_mov_b32 v19, 0
    s_mov_b64 exec, 1
    buffer_atomic_add v2, v19, s[8:11], s22 offen sc0
    v_mov_b32 v3, 0x27ff0
    s_waitcnt vmcnt(0)
    ds_write_b32 v3, v2
    s_mov_b64 exec, -1
    s_waitcnt lgkmcnt(0)
la0_W_join_w:
    s_barrier
    v_mov_b32 v3, 0x27ff0
    ds_read_b32 v2, v3
    s_waitcnt lgkmcnt(0)
    v_readfirstlane_b32 s20, v2
    s_waitcnt vmcnt(0)
    s_barrier
    s_cmp_gt_u32 s20, 30
    s_cbranch_scc1 la0_W_pm
    v_mov_b32 v2, 0
    v_mov_b32 v3, 0
    s_mov_b64 exec, 1
    buffer_store_dword v2, v3, s[8:11], s85 offen sc1
    s_mov_b64 exec, -1
    s_waitcnt vmcnt(0)
    s_branch la0_role
la0_W_pm_ok:
    s_waitcnt vmcnt(0)
    v_bfe_u32 v18, v1, 1, 1
    v_mul_u32_u24 v18, 0x1c00, v18
    v_bfe_u32 v2, v1, 2, 2
    v_mul_u32_u24 v2, 0x700, v2
    v_add_u32 v18, v18, v2
    v_bfe_u32 v2, v1, 0, 1
    v_mul_u32_u24 v2, 0x380, v2
    v_add_u32 v18, v18, v2
    v_bfe_u32 v2, v1, 4, 2
    v_lshlrev_b32 v2, 4, v2
    v_add_u32 v18, v18, v2
    s_lshr_b32 s22, s3, 1
    s_mul_i32 s22, s22, 14336
    s_mul_i32 s23, s25, 448
    s_add_u32 s22, s22, s23
    s_add_u32 s22, s22, s42
    s_mul_i32 s23, s3, 7168
    s_add_u32 s23, s23, 0x10000
    s_add_u32 m0, s23, 0
    s_nop 0
    buffer_load_dwordx4 v18, s[8:11], s22 offen offset:0 sc1 lds
    s_add_u32 m0, s23, 960
    s_nop 0
    buffer_load_dwordx4 v18, s[8:11], s22 offen offset:64 sc1 lds
    s_add_u32 m0, s23, 1920
    s_nop 0
    buffer_load_dwordx4 v18, s[8:11], s22 offen offset:128 sc1 lds
    s_add_u32 m0, s23, 2880
    s_nop 0
    buffer_load_dwordx4 v18, s[8:11], s22 offen offset:192 sc1 lds
    s_add_u32 m0, s23, 3840
    s_nop 0
    buffer_load_dwordx4 v18, s[8:11], s22 offen offset:256 sc1 lds
    s_add_u32 m0, s23, 4800
    s_nop 0
    buffer_load_dwordx4 v18, s[8:11], s22 offen offset:320 sc1 lds
    s_add_u32 m0, s23, 5760
    s_nop 0
    buffer_load_dwordx4 v18, s[8:11], s22 offen offset:384 sc1 lds
    v_add_u32 v18, 0x10000, v7
    s_waitcnt vmcnt(0)
    s_barrier
    v_mov_b32 v10, v7
    ds_read_b128 v[244:247], v18 offset:0
    ds_read_b128 v[248:251], v18 offset:14336
    ds_read_b128 v[20:23], v18 offset:1024
    ds_read_b128 v[24:27], v18 offset:15360
    s_waitcnt lgkmcnt(2)
    v_mfma_f32_16x16x32_bf16 v[160:163], v[244:247], v[80:83], 0
    v_mfma_f32_16x16x32_bf16 v[188:191], v[248:251], v[80:83], 0
    buffer_load_dwordx4 v[80:83], v10, s[8:11], s50 offen offset:2048
    v_mfma_f32_16x16x32_bf16 v[164:167], v[244:247], v[84:87], 0
    v_mfma_f32_16x16x32_bf16 v[192:195], v[248:251], v[84:87], 0
    buffer_load_dwordx4 v[84:87], v10, s[8:11], s51 offen offset:2048
    v_mfma_f32_16x16x32_bf16 v[168:171], v[244:247], v[88:91], 0
    v_mfma_f32_16x16x32_bf16 v[196:199], v[248:251], v[88:91], 0
    buffer_load_dwordx4 v[88:91], v10, s[8:11], s52 offen offset:2048
    v_mfma_f32_16x16x32_bf16 v[172:175], v[244:247], v[92:95], 0
    v_mfma_f32_16x16x32_bf16 v[200:203], v[248:251], v[92:95], 0
    buffer_load_dwordx4 v[92:95], v10, s[8:11], s53 offen offset:2048
    v_mfma_f32_16x16x32_bf16 v[176:179], v[244:247], v[96:99], 0
    v_mfma_f32_16x16x32_bf16 v[204:207], v[248:251], v[96:99], 0
    buffer_load_dwordx4 v[96:99], v10, s[8:11], s54 offen offset:2048
    v_mfma_f32_16x16x32_bf16 v[180:183], v[244:247], v[100:103], 0
    v_mfma_f32_16x16x32_bf16 v[208:211], v[248:251], v[100:103], 0
    buffer_load_dwordx4 v[100:103], v10, s[8:11], s55 offen offset:2048
    v_mfma_f32_16x16x32_bf16 v[184:187], v[244:247], v[104:107], 0
    v_mfma_f32_16x16x32_bf16 v[212:215], v[248:251], v[104:107], 0
    buffer_load_dwordx4 v[104:107], v10, s[8:11], s56 offen offset:2048
    ds_read_b128 v[244:247], v18 offset:2048
    ds_read_b128 v[248:251], v18 offset:16384
    s_waitcnt lgkmcnt(2)
    v_mfma_f32_16x16x32_bf16 v[160:163], v[20:23], v[108:111], v[160:163]
    v_mfma_f32_16x16x32_bf16 v[188:191], v[24:27], v[108:111], v[188:191]
    buffer_load_dwordx4 v[108:111], v10, s[8:11], s50 offen offset:3072
    v_mfma_f32_16x16x32_bf16 v[164:167], v[20:23], v[112:115], v[164:167]
    v_mfma_f32_16x16x32_bf16 v[192:195], v[24:27], v[112:115], v[192:195]
    buffer_load_dwordx4 v[112:115], v10, s[8:11], s51 offen offset:3072
    v_mfma_f32_16x16x32_bf16 v[168:171], v[20:23], v[116:119], v[168:171]
    v_mfma_f32_16x16x32_bf16 v[196:199], v[24:27], v[116:119], v[196:199]
    buffer_load_dwordx4 v[116:119], v10, s[8:11], s52 offen offset:3072
    v_mfma_f32_16x16x32_bf16 v[172:175], v[20:23], v[120:123], v[172:175]
    v_mfma_f32_16x16x32_bf16 v[200:203], v[24:27], v[120:123], v[200:203]
    buffer_load_dwordx4 v[120:123], v10, s[8:11], s53 offen offset:3072
    v_mfma_f32_16x16x32_bf16 v[176:179], v[20:23], v[124:127], v[176:179]
    v_mfma_f32_16x16x32_bf16 v[204:207], v[24:27], v[124:127], v[204:207]
    buffer_load_dwordx4 v[124:127], v10, s[8:11], s54 offen offset:3072
    v_mfma_f32_16x16x32_bf16 v[180:183], v[20:23], v[128:131], v[180:183]
    v_mfma_f32_16x16x32_bf16 v[208:211], v[24:27], v[128:131], v[208:211]
    buffer_load_dwordx4 v[128:131], v10, s[8:11], s55 offen offset:3072
    v_mfma_f32_16x16x32_bf16 v[184:187], v[20:23], v[132:135], v[184:187]
    v_mfma_f32_16x16x32_bf16 v[212:215], v[24:27], v[132:135], v[212:215]
    buffer_load_dwordx4 v[132:135], v10, s[8:11], s56 offen offset:3072
    v_add_u32 v10, 4096, v10
    ds_read_b128 v[20:23], v18 offset:3072
    ds_read_b128 v[24:27], v18 offset:17408
    s_waitcnt lgkmcnt(2)
    s_waitcnt vmcnt(13)
    v_mfma_f32_16x16x32_bf16 v[160:163], v[244:247], v[80:83], v[160:163]
    v_mfma_f32_16x16x32_bf16 v[188:191], v[248:251], v[80:83], v[188:191]
    buffer_load_dwordx4 v[80:83], v10, s[8:11], s50 offen offset:0
    s_waitcnt vmcnt(13)
    v_mfma_f32_16x16x32_bf16 v[164:167], v[244:247], v[84:87], v[164:167]
    v_mfma_f32_16x16x32_bf16 v[192:195], v[248:251], v[84:87], v[192:195]
    buffer_load_dwordx4 v[84:87], v10, s[8:11], s51 offen offset:0
    s_waitcnt vmcnt(13)
    v_mfma_f32_16x16x32_bf16 v[168:171], v[244:247], v[88:91], v[168:171]
    v_mfma_f32_16x16x32_bf16 v[196:199], v[248:251], v[88:91], v[196:199]
    buffer_load_dwordx4 v[88:91], v10, s[8:11], s52 offen offset:0
    s_waitcnt vmcnt(13)
    v_mfma_f32_16x16x32_bf16 v[172:175], v[244:247], v[92:95], v[172:175]
    v_mfma_f32_16x16x32_bf16 v[200:203], v[248:251], v[92:95], v[200:203]
    buffer_load_dwordx4 v[92:95], v10, s[8:11], s53 offen offset:0
    s_waitcnt vmcnt(13)
    v_mfma_f32_16x16x32_bf16 v[176:179], v[244:247], v[96:99], v[176:179]
    v_mfma_f32_16x16x32_bf16 v[204:207], v[248:251], v[96:99], v[204:207]
    buffer_load_dwordx4 v[96:99], v10, s[8:11], s54 offen offset:0
    s_waitcnt vmcnt(13)
    v_mfma_f32_16x16x32_bf16 v[180:183], v[244:247], v[100:103], v[180:183]
    v_mfma_f32_16x16x32_bf16 v[208:211], v[248:251], v[100:103], v[208:211]
    buffer_load_dwordx4 v[100:103], v10, s[8:11], s55 offen offset:0
    s_waitcnt vmcnt(13)
    v_mfma_f32_16x16x32_bf16 v[184:187], v[244:247], v[104:107], v[184:187]
    v_mfma_f32_16x16x32_bf16 v[212:215], v[248:251], v[104:107], v[212:215]
    buffer_load_dwordx4 v[104:107], v10, s[8:11], s56 offen offset:0
    ds_read_b128 v[244:247], v18 offset:4096
    ds_read_b128 v[248:251], v18 offset:18432
    s_waitcnt lgkmcnt(2)
    s_waitcnt vmcnt(13)
    v_mfma_f32_16x16x32_bf16 v[160:163], v[20:23], v[108:111], v[160:163]
    v_mfma_f32_16x16x32_bf16 v[188:191], v[24:27], v[108:111], v[188:191]
    buffer_load_dwordx4 v[108:111], v10, s[8:11], s50 offen offset:1024
    s_waitcnt vmcnt(13)
    v_mfma_f32_16x16x32_bf16 v[164:167], v[20:23], v[112:115], v[164:167]
    v_mfma_f32_16x16x32_bf16 v[192:195], v[24:27], v[112:115], v[192:195]
    buffer_load_dwordx4 v[112:115], v10, s[8:11], s51 offen offset:1024
    s_waitcnt vmcnt(13)
    v_mfma_f32_16x16x32_bf16 v[168:171], v[20:23], v[116:119], v[168:171]
    v_mfma_f32_16x16x32_bf16 v[196:199], v[24:27], v[116:119], v[196:199]
    buffer_load_dwordx4 v[116:119], v10, s[8:11], s52 offen offset:1024
    s_waitcnt vmcnt(13)
    v_mfma_f32_16x16x32_bf16 v[172:175], v[20:23], v[120:123], v[172:175]
    v_mfma_f32_16x16x32_bf16 v[200:203], v[24:27], v[120:123], v[200:203]
    buffer_load_dwordx4 v[120:123], v10, s[8:11], s53 offen offset:1024
    s_waitcnt vmcnt(13)
    v_mfma_f32_16x16x32_bf16 v[176:179], v[20:23], v[124:127], v[176:179]
    v_mfma_f32_16x16x32_bf16 v[204:207], v[24:27], v[124:127], v[204:207]
    buffer_load_dwordx4 v[124:127], v10, s[8:11], s54 offen offset:1024
    s_waitcnt vmcnt(13)
    v_mfma_f32_16x16x32_bf16 v[180:183], v[20:23], v[128:131], v[180:183]
    v_mfma_f32_16x16x32_bf16 v[208:211], v[24:27], v[128:131], v[208:211]
    buffer_load_dwordx4 v[128:131], v10, s[8:11], s55 offen offset:1024
    s_waitcnt vmcnt(13)
    v_mfma_f32_16x16x32_bf16 v[184:187], v[20:23], v[132:135], v[184:187]
    v_mfma_f32_16x16x32_bf16 v[212:215], v[24:27], v[132:135], v[212:215]
    buffer_load_dwordx4 v[132:135], v10, s[8:11], s56 offen offset:1024
    ds_read_b128 v[20:23], v18 offset:5120
    ds_read_b128 v[24:27], v18 offset:19456
    s_waitcnt lgkmcnt(2)
    s_waitcnt vmcnt(13)
    v_mfma_f32_16x16x32_bf16 v[160:163], v[244:247], v[80:83], v[160:163]
    v_mfma_f32_16x16x32_bf16 v[188:191], v[248:251], v[80:83], v[188:191]
    buffer_load_dwordx4 v[80:83], v10, s[8:11], s50 offen offset:2048
    s_waitcnt vmcnt(13)
    v_mfma_f32_16x16x32_bf16 v[164:167], v[244:247], v[84:87], v[164:167]
    v_mfma_f32_16x16x32_bf16 v[192:195], v[248:251], v[84:87], v[192:195]
    buffer_load_dwordx4 v[84:87], v10, s[8:11], s51 offen offset:2048
    s_waitcnt vmcnt(13)
    v_mfma_f32_16x16x32_bf16 v[168:171], v[244:247], v[88:91], v[168:171]
    v_mfma_f32_16x16x32_bf16 v[196:199], v[248:251], v[88:91], v[196:199]
    buffer_load_dwordx4 v[88:91], v10, s[8:11], s52 offen offset:2048
    s_waitcnt vmcnt(13)
    v_mfma_f32_16x16x32_bf16 v[172:175], v[244:247], v[92:95], v[172:175]
    v_mfma_f32_16x16x32_bf16 v[200:203], v[248:251], v[92:95], v[200:203]
    buffer_load_dwordx4 v[92:95], v10, s[8:11], s53 offen offset:2048
    s_waitcnt vmcnt(13)
    v_mfma_f32_16x16x32_bf16 v[176:179], v[244:247], v[96:99], v[176:179]
    v_mfma_f32_16x16x32_bf16 v[204:207], v[248:251], v[96:99], v[204:207]
    buffer_load_dwordx4 v[96:99], v10, s[8:11], s54 offen offset:2048
    s_waitcnt vmcnt(13)
    v_mfma_f32_16x16x32_bf16 v[180:183], v[244:247], v[100:103], v[180:183]
    v_mfma_f32_16x16x32_bf16 v[208:211], v[248:251], v[100:103], v[208:211]
    buffer_load_dwordx4 v[100:103], v10, s[8:11], s55 offen offset:2048
    s_waitcnt vmcnt(13)
    v_mfma_f32_16x16x32_bf16 v[184:187], v[244:247], v[104:107], v[184:187]
    v_mfma_f32_16x16x32_bf16 v[212:215], v[248:251], v[104:107], v[212:215]
    buffer_load_dwordx4 v[104:107], v10, s[8:11], s56 offen offset:2048
    ds_read_b128 v[244:247], v18 offset:6144
    ds_read_b128 v[248:251], v18 offset:20480
    s_waitcnt lgkmcnt(2)
    s_waitcnt vmcnt(13)
    v_mfma_f32_16x16x32_bf16 v[160:163], v[20:23], v[108:111], v[160:163]
    v_mfma_f32_16x16x32_bf16 v[188:191], v[24:27], v[108:111], v[188:191]
    buffer_load_dwordx4 v[108:111], v10, s[8:11], s50 offen offset:3072
    s_waitcnt vmcnt(13)
    v_mfma_f32_16x16x32_bf16 v[164:167], v[20:23], v[112:115], v[164:167]
    v_mfma_f32_16x16x32_bf16 v[192:195], v[24:27], v[112:115], v[192:195]
    buffer_load_dwordx4 v[112:115], v10, s[8:11], s51 offen offset:3072
    s_waitcnt vmcnt(13)
    v_mfma_f32_16x16x32_bf16 v[168:171], v[20:23], v[116:119], v[168:171]
    v_mfma_f32_16x16x32_bf16 v[196:199], v[24:27], v[116:119], v[196:199]
    buffer_load_dwordx4 v[116:119], v10, s[8:11], s52 offen offset:3072
    s_waitcnt vmcnt(13)
    v_mfma_f32_16x16x32_bf16 v[172:175], v[20:23], v[120:123], v[172:175]
    v_mfma_f32_16x16x32_bf16 v[200:203], v[24:27], v[120:123], v[200:203]
    buffer_load_dwordx4 v[120:123], v10, s[8:11], s53 offen offset:3072
    s_waitcnt vmcnt(13)
    v_mfma_f32_16x16x32_bf16 v[176:179], v[20:23], v[124:127], v[176:179]
    v_mfma_f32_16x16x32_bf16 v[204:207], v[24:27], v[124:127], v[204:207]
    buffer_load_dwordx4 v[124:127], v10, s[8:11], s54 offen offset:3072
    s_waitcnt vmcnt(13)
    v_mfma_f32_16x16x32_bf16 v[180:183], v[20:23], v[128:131], v[180:183]
    v_mfma_f32_16x16x32_bf16 v[208:211], v[24:27], v[128:131], v[208:211]
    buffer_load_dwordx4 v[128:131], v10, s[8:11], s55 offen offset:3072
    s_waitcnt vmcnt(13)
    v_mfma_f32_16x16x32_bf16 v[184:187], v[20:23], v[132:135], v[184:187]
    v_mfma_f32_16x16x32_bf16 v[212:215], v[24:27], v[132:135], v[212:215]
    buffer_load_dwordx4 v[132:135], v10, s[8:11], s56 offen offset:3072
    v_add_u32 v10, 4096, v10
    ds_read_b128 v[20:23], v18 offset:7168
    ds_read_b128 v[24:27], v18 offset:21504
    s_waitcnt lgkmcnt(2)
    s_waitcnt vmcnt(13)
    v_mfma_f32_16x16x32_bf16 v[160:163], v[244:247], v[80:83], v[160:163]
    v_mfma_f32_16x16x32_bf16 v[188:191], v[248:251], v[80:83], v[188:191]
    buffer_load_dwordx4 v[80:83], v10, s[8:11], s50 offen offset:0
    s_waitcnt vmcnt(13)
    v_mfma_f32_16x16x32_bf16 v[164:167], v[244:247], v[84:87], v[164:167]
    v_mfma_f32_16x16x32_bf16 v[192:195], v[248:251], v[84:87], v[192:195]
    buffer_load_dwordx4 v[84:87], v10, s[8:11], s51 offen offset:0
    s_waitcnt vmcnt(13)
    v_mfma_f32_16x16x32_bf16 v[168:171], v[244:247], v[88:91], v[168:171]
    v_mfma_f32_16x16x32_bf16 v[196:199], v[248:251], v[88:91], v[196:199]
    buffer_load_dwordx4 v[88:91], v10, s[8:11], s52 offen offset:0
    s_waitcnt vmcnt(13)
    v_mfma_f32_16x16x32_bf16 v[172:175], v[244:247], v[92:95], v[172:175]
    v_mfma_f32_16x16x32_bf16 v[200:203], v[248:251], v[92:95], v[200:203]
    buffer_load_dwordx4 v[92:95], v10, s[8:11], s53 offen offset:0
    s_waitcnt vmcnt(13)
    v_mfma_f32_16x16x32_bf16 v[176:179], v[244:247], v[96:99], v[176:179]
    v_mfma_f32_16x16x32_bf16 v[204:207], v[248:251], v[96:99], v[204:207]
    buffer_load_dwordx4 v[96:99], v10, s[8:11], s54 offen offset:0
    s_waitcnt vmcnt(13)
    v_mfma_f32_16x16x32_bf16 v[180:183], v[244:247], v[100:103], v[180:183]
    v_mfma_f32_16x16x32_bf16 v[208:211], v[248:251], v[100:103], v[208:211]
    buffer_load_dwordx4 v[100:103], v10, s[8:11], s55 offen offset:0
    s_waitcnt vmcnt(13)
    v_mfma_f32_16x16x32_bf16 v[184:187], v[244:247], v[104:107], v[184:187]
    v_mfma_f32_16x16x32_bf16 v[212:215], v[248:251], v[104:107], v[212:215]
    buffer_load_dwordx4 v[104:107], v10, s[8:11], s56 offen offset:0
    ds_read_b128 v[244:247], v18 offset:8192
    ds_read_b128 v[248:251], v18 offset:22528
    s_waitcnt lgkmcnt(2)
    s_waitcnt vmcnt(13)
    v_mfma_f32_16x16x32_bf16 v[160:163], v[20:23], v[108:111], v[160:163]
    v_mfma_f32_16x16x32_bf16 v[188:191], v[24:27], v[108:111], v[188:191]
    buffer_load_dwordx4 v[108:111], v10, s[8:11], s50 offen offset:1024
    s_waitcnt vmcnt(13)
    v_mfma_f32_16x16x32_bf16 v[164:167], v[20:23], v[112:115], v[164:167]
    v_mfma_f32_16x16x32_bf16 v[192:195], v[24:27], v[112:115], v[192:195]
    buffer_load_dwordx4 v[112:115], v10, s[8:11], s51 offen offset:1024
    s_waitcnt vmcnt(13)
    v_mfma_f32_16x16x32_bf16 v[168:171], v[20:23], v[116:119], v[168:171]
    v_mfma_f32_16x16x32_bf16 v[196:199], v[24:27], v[116:119], v[196:199]
    buffer_load_dwordx4 v[116:119], v10, s[8:11], s52 offen offset:1024
    s_waitcnt vmcnt(13)
    v_mfma_f32_16x16x32_bf16 v[172:175], v[20:23], v[120:123], v[172:175]
    v_mfma_f32_16x16x32_bf16 v[200:203], v[24:27], v[120:123], v[200:203]
    buffer_load_dwordx4 v[120:123], v10, s[8:11], s53 offen offset:1024
    s_waitcnt vmcnt(13)
    v_mfma_f32_16x16x32_bf16 v[176:179], v[20:23], v[124:127], v[176:179]
    v_mfma_f32_16x16x32_bf16 v[204:207], v[24:27], v[124:127], v[204:207]
    buffer_load_dwordx4 v[124:127], v10, s[8:11], s54 offen offset:1024
    s_waitcnt vmcnt(13)
    v_mfma_f32_16x16x32_bf16 v[180:183], v[20:23], v[128:131], v[180:183]
    v_mfma_f32_16x16x32_bf16 v[208:211], v[24:27], v[128:131], v[208:211]
    buffer_load_dwordx4 v[128:131], v10, s[8:11], s55 offen offset:1024
    s_waitcnt vmcnt(13)
    v_mfma_f32_16x16x32_bf16 v[184:187], v[20:23], v[132:135], v[184:187]
    v_mfma_f32_16x16x32_bf16 v[212:215], v[24:27], v[132:135], v[212:215]
    buffer_load_dwordx4 v[132:135], v10, s[8:11], s56 offen offset:1024
    ds_read_b128 v[20:23], v18 offset:9216
    ds_read_b128 v[24:27], v18 offset:23552
    s_waitcnt lgkmcnt(2)
    s_waitcnt vmcnt(13)
    v_mfma_f32_16x16x32_bf16 v[160:163], v[244:247], v[80:83], v[160:163]
    v_mfma_f32_16x16x32_bf16 v[188:191], v[248:251], v[80:83], v[188:191]
    buffer_load_dwordx4 v[80:83], v10, s[8:11], s50 offen offset:2048
    s_waitcnt vmcnt(13)
    v_mfma_f32_16x16x32_bf16 v[164:167], v[244:247], v[84:87], v[164:167]
    v_mfma_f32_16x16x32_bf16 v[192:195], v[248:251], v[84:87], v[192:195]
    buffer_load_dwordx4 v[84:87], v10, s[8:11], s51 offen offset:2048
    s_waitcnt vmcnt(13)
    v_mfma_f32_16x16x32_bf16 v[168:171], v[244:247], v[88:91], v[168:171]
    v_mfma_f32_16x16x32_bf16 v[196:199], v[248:251], v[88:91], v[196:199]
    buffer_load_dwordx4 v[88:91], v10, s[8:11], s52 offen offset:2048
    s_waitcnt vmcnt(13)
    v_mfma_f32_16x16x32_bf16 v[172:175], v[244:247], v[92:95], v[172:175]
    v_mfma_f32_16x16x32_bf16 v[200:203], v[248:251], v[92:95], v[200:203]
    buffer_load_dwordx4 v[92:95], v10, s[8:11], s53 offen offset:2048
    s_waitcnt vmcnt(13)
    v_mfma_f32_16x16x32_bf16 v[176:179], v[244:247], v[96:99], v[176:179]
    v_mfma_f32_16x16x32_bf16 v[204:207], v[248:251], v[96:99], v[204:207]
    buffer_load_dwordx4 v[96:99], v10, s[8:11], s54 offen offset:2048
    s_waitcnt vmcnt(13)
    v_mfma_f32_16x16x32_bf16 v[180:183], v[244:247], v[100:103], v[180:183]
    v_mfma_f32_16x16x32_bf16 v[208:211], v[248:251], v[100:103], v[208:211]
    buffer_load_dwordx4 v[100:103], v10, s[8:11], s55 offen offset:2048
    s_waitcnt vmcnt(13)
    v_mfma_f32_16x16x32_bf16 v[184:187], v[244:247], v[104:107], v[184:187]
    v_mfma_f32_16x16x32_bf16 v[212:215], v[248:251], v[104:107], v[212:215]
    buffer_load_dwordx4 v[104:107], v10, s[8:11], s56 offen offset:2048
    ds_read_b128 v[244:247], v18 offset:10240
    ds_read_b128 v[248:251], v18 offset:24576
    s_waitcnt lgkmcnt(2)
    s_waitcnt vmcnt(13)
    v_mfma_f32_16x16x32_bf16 v[160:163], v[20:23], v[108:111], v[160:163]
    v_mfma_f32_16x16x32_bf16 v[188:191], v[24:27], v[108:111], v[188:191]
    buffer_load_dwordx4 v[108:111], v10, s[8:11], s50 offen offset:3072
    s_waitcnt vmcnt(13)
    v_mfma_f32_16x16x32_bf16 v[164:167], v[20:23], v[112:115], v[164:167]
    v_mfma_f32_16x16x32_bf16 v[192:195], v[24:27], v[112:115], v[192:195]
    buffer_load_dwordx4 v[112:115], v10, s[8:11], s51 offen offset:3072
    s_waitcnt vmcnt(13)
    v_mfma_f32_16x16x32_bf16 v[168:171], v[20:23], v[116:119], v[168:171]
    v_mfma_f32_16x16x32_bf16 v[196:199], v[24:27], v[116:119], v[196:199]
    buffer_load_dwordx4 v[116:119], v10, s[8:11], s52 offen offset:3072
    s_waitcnt vmcnt(13)
    v_mfma_f32_16x16x32_bf16 v[172:175], v[20:23], v[120:123], v[172:175]
    v_mfma_f32_16x16x32_bf16 v[200:203], v[24:27], v[120:123], v[200:203]
    buffer_load_dwordx4 v[120:123], v10, s[8:11], s53 offen offset:3072
    s_waitcnt vmcnt(13)
    v_mfma_f32_16x16x32_bf16 v[176:179], v[20:23], v[124:127], v[176:179]
    v_mfma_f32_16x16x32_bf16 v[204:207], v[24:27], v[124:127], v[204:207]
    buffer_load_dwordx4 v[124:127], v10, s[8:11], s54 offen offset:3072
    s_waitcnt vmcnt(13)
    v_mfma_f32_16x16x32_bf16 v[180:183], v[20:23], v[128:131], v[180:183]
    v_mfma_f32_16x16x32_bf16 v[208:211], v[24:27], v[128:131], v[208:211]
    buffer_load_dwordx4 v[128:131], v10, s[8:11], s55 offen offset:3072
    s_waitcnt vmcnt(13)
    v_mfma_f32_16x16x32_bf16 v[184:187], v[20:23], v[132:135], v[184:187]
    v_mfma_f32_16x16x32_bf16 v[212:215], v[24:27], v[132:135], v[212:215]
    buffer_load_dwordx4 v[132:135], v10, s[8:11], s56 offen offset:3072
    v_add_u32 v10, 4096, v10
    ds_read_b128 v[20:23], v18 offset:11264
    ds_read_b128 v[24:27], v18 offset:25600
    s_waitcnt lgkmcnt(2)
    s_waitcnt vmcnt(13)
    v_mfma_f32_16x16x32_bf16 v[160:163], v[244:247], v[80:83], v[160:163]
    v_mfma_f32_16x16x32_bf16 v[188:191], v[248:251], v[80:83], v[188:191]
    buffer_load_dwordx4 v[80:83], v10, s[8:11], s50 offen offset:0
    s_waitcnt vmcnt(13)
    v_mfma_f32_16x16x32_bf16 v[164:167], v[244:247], v[84:87], v[164:167]
    v_mfma_f32_16x16x32_bf16 v[192:195], v[248:251], v[84:87], v[192:195]
    buffer_load_dwordx4 v[84:87], v10, s[8:11], s51 offen offset:0
    s_waitcnt vmcnt(13)
    v_mfma_f32_16x16x32_bf16 v[168:171], v[244:247], v[88:91], v[168:171]
    v_mfma_f32_16x16x32_bf16 v[196:199], v[248:251], v[88:91], v[196:199]
    buffer_load_dwordx4 v[88:91], v10, s[8:11], s52 offen offset:0
    s_waitcnt vmcnt(13)
    v_mfma_f32_16x16x32_bf16 v[172:175], v[244:247], v[92:95], v[172:175]
    v_mfma_f32_16x16x32_bf16 v[200:203], v[248:251], v[92:95], v[200:203]
    buffer_load_dwordx4 v[92:95], v10, s[8:11], s53 offen offset:0
    s_waitcnt vmcnt(13)
    v_mfma_f32_16x16x32_bf16 v[176:179], v[244:247], v[96:99], v[176:179]
    v_mfma_f32_16x16x32_bf16 v[204:207], v[248:251], v[96:99], v[204:207]
    buffer_load_dwordx4 v[96:99], v10, s[8:11], s54 offen offset:0
    s_waitcnt vmcnt(13)
    v_mfma_f32_16x16x32_bf16 v[180:183], v[244:247], v[100:103], v[180:183]
    v_mfma_f32_16x16x32_bf16 v[208:211], v[248:251], v[100:103], v[208:211]
    buffer_load_dwordx4 v[100:103], v10, s[8:11], s55 offen offset:0
    s_waitcnt vmcnt(13)
    v_mfma_f32_16x16x32_bf16 v[184:187], v[244:247], v[104:107], v[184:187]
    v_mfma_f32_16x16x32_bf16 v[212:215], v[248:251], v[104:107], v[212:215]
    buffer_load_dwordx4 v[104:107], v10, s[8:11], s56 offen offset:0
    ds_read_b128 v[244:247], v18 offset:12288
    ds_read_b128 v[248:251], v18 offset:26624
    s_waitcnt lgkmcnt(2)
    s_waitcnt vmcnt(13)
    v_mfma_f32_16x16x32_bf16 v[160:163], v[20:23], v[108:111], v[160:163]
    v_mfma_f32_16x16x32_bf16 v[188:191], v[24:27], v[108:111], v[188:191]
    buffer_load_dwordx4 v[108:111], v10, s[8:11], s50 offen offset:1024
    s_waitcnt vmcnt(13)
    v_mfma_f32_16x16x32_bf16 v[164:167], v[20:23], v[112:115], v[164:167]
    v_mfma_f32_16x16x32_bf16 v[192:195], v[24:27], v[112:115], v[192:195]
    buffer_load_dwordx4 v[112:115], v10, s[8:11], s51 offen offset:1024
    s_waitcnt vmcnt(13)
    v_mfma_f32_16x16x32_bf16 v[168:171], v[20:23], v[116:119], v[168:171]
    v_mfma_f32_16x16x32_bf16 v[196:199], v[24:27], v[116:119], v[196:199]
    buffer_load_dwordx4 v[116:119], v10, s[8:11], s52 offen offset:1024
    s_waitcnt vmcnt(13)
    v_mfma_f32_16x16x32_bf16 v[172:175], v[20:23], v[120:123], v[172:175]
    v_mfma_f32_16x16x32_bf16 v[200:203], v[24:27], v[120:123], v[200:203]
    buffer_load_dwordx4 v[120:123], v10, s[8:11], s53 offen offset:1024
    s_waitcnt vmcnt(13)
    v_mfma_f32_16x16x32_bf16 v[176:179], v[20:23], v[124:127], v[176:179]
    v_mfma_f32_16x16x32_bf16 v[204:207], v[24:27], v[124:127], v[204:207]
    buffer_load_dwordx4 v[124:127], v10, s[8:11], s54 offen offset:1024
    s_waitcnt vmcnt(13)
    v_mfma_f32_16x16x32_bf16 v[180:183], v[20:23], v[128:131], v[180:183]
    v_mfma_f32_16x16x32_bf16 v[208:211], v[24:27], v[128:131], v[208:211]
    buffer_load_dwordx4 v[128:131], v10, s[8:11], s55 offen offset:1024
    s_waitcnt vmcnt(13)
    v_mfma_f32_16x16x32_bf16 v[184:187], v[20:23], v[132:135], v[184:187]
    v_mfma_f32_16x16x32_bf16 v[212:215], v[24:27], v[132:135], v[212:215]
    buffer_load_dwordx4 v[132:135], v10, s[8:11], s56 offen offset:1024
    ds_read_b128 v[20:23], v18 offset:13312
    ds_read_b128 v[24:27], v18 offset:27648
    s_waitcnt lgkmcnt(2)
    s_waitcnt vmcnt(13)
    v_mfma_f32_16x16x32_bf16 v[160:163], v[244:247], v[80:83], v[160:163]
    v_mfma_f32_16x16x32_bf16 v[188:191], v[248:251], v[80:83], v[188:191]
    s_waitcnt vmcnt(12)
    v_mfma_f32_16x16x32_bf16 v[164:167], v[244:247], v[84:87], v[164:167]
    v_mfma_f32_16x16x32_bf16 v[192:195], v[248:251], v[84:87], v[192:195]
    s_waitcnt vmcnt(11)
    v_mfma_f32_16x16x32_bf16 v[168:171], v[244:247], v[88:91], v[168:171]
    v_mfma_f32_16x16x32_bf16 v[196:199], v[248:251], v[88:91], v[196:199]
    s_waitcnt vmcnt(10)
    v_mfma_f32_16x16x32_bf16 v[172:175], v[244:247], v[92:95], v[172:175]
    v_mfma_f32_16x16x32_bf16 v[200:203], v[248:251], v[92:95], v[200:203]
    s_waitcnt vmcnt(9)
    v_mfma_f32_16x16x32_bf16 v[176:179], v[244:247], v[96:99], v[176:179]
    v_mfma_f32_16x16x32_bf16 v[204:207], v[248:251], v[96:99], v[204:207]
    s_waitcnt vmcnt(8)
    v_mfma_f32_16x16x32_bf16 v[180:183], v[244:247], v[100:103], v[180:183]
    v_mfma_f32_16x16x32_bf16 v[208:211], v[248:251], v[100:103], v[208:211]
    s_waitcnt vmcnt(7)
    v_mfma_f32_16x16x32_bf16 v[184:187], v[244:247], v[104:107], v[184:187]
    v_mfma_f32_16x16x32_bf16 v[212:215], v[248:251], v[104:107], v[212:215]
    s_waitcnt lgkmcnt(0)
    s_waitcnt vmcnt(6)
    v_mfma_f32_16x16x32_bf16 v[160:163], v[20:23], v[108:111], v[160:163]
    v_mfma_f32_16x16x32_bf16 v[188:191], v[24:27], v[108:111], v[188:191]
    s_waitcnt vmcnt(5)
    v_mfma_f32_16x16x32_bf16 v[164:167], v[20:23], v[112:115], v[164:167]
    v_mfma_f32_16x16x32_bf16 v[192:195], v[24:27], v[112:115], v[192:195]
    s_waitcnt vmcnt(4)
    v_mfma_f32_16x16x32_bf16 v[168:171], v[20:23], v[116:119], v[168:171]
    v_mfma_f32_16x16x32_bf16 v[196:199], v[24:27], v[116:119], v[196:199]
    s_waitcnt vmcnt(3)
    v_mfma_f32_16x16x32_bf16 v[172:175], v[20:23], v[120:123], v[172:175]
    v_mfma_f32_16x16x32_bf16 v[200:203], v[24:27], v[120:123], v[200:203]
    s_waitcnt vmcnt(2)
    v_mfma_f32_16x16x32_bf16 v[176:179], v[20:23], v[124:127], v[176:179]
    v_mfma_f32_16x16x32_bf16 v[204:207], v[24:27], v[124:127], v[204:207]
    s_waitcnt vmcnt(1)
    v_mfma_f32_16x16x32_bf16 v[180:183], v[20:23], v[128:131], v[180:183]
    v_mfma_f32_16x16x32_bf16 v[208:211], v[24:27], v[128:131], v[208:211]
    s_waitcnt vmcnt(0)
    v_mfma_f32_16x16x32_bf16 v[184:187], v[20:23], v[132:135], v[184:187]
    v_mfma_f32_16x16x32_bf16 v[212:215], v[24:27], v[132:135], v[212:215]
    v_add_u32 v10, 4096, v10
    v_cvt_pk_bf16_f32 v216, v160, v161
    v_cvt_pk_bf16_f32 v223, v162, v163
    v_cvt_pk_bf16_f32 v217, v164, v165
    v_cvt_pk_bf16_f32 v224, v166, v167
    v_cvt_pk_bf16_f32 v218, v168, v169
    v_cvt_pk_bf16_f32 v225, v170, v171
    v_cvt_pk_bf16_f32 v219, v172, v173
    v_cvt_pk_bf16_f32 v226, v174, v175
    v_cvt_pk_bf16_f32 v220, v176, v177
    v_cvt_pk_bf16_f32 v227, v178, v179
    v_cvt_pk_bf16_f32 v221, v180, v181
    v_cvt_pk_bf16_f32 v228, v182, v183
    v_cvt_pk_bf16_f32 v222, v184, v185
    v_cvt_pk_bf16_f32 v229, v186, v187
    v_cvt_pk_bf16_f32 v230, v188, v189
    v_cvt_pk_bf16_f32 v237, v190, v191
    v_cvt_pk_bf16_f32 v231, v192, v193
    v_cvt_pk_bf16_f32 v238, v194, v195
    v_cvt_pk_bf16_f32 v232, v196, v197
    v_cvt_pk_bf16_f32 v239, v198, v199
    v_cvt_pk_bf16_f32 v233, v200, v201
    v_cvt_pk_bf16_f32 v240, v202, v203
    v_cvt_pk_bf16_f32 v234, v204, v205
    v_cvt_pk_bf16_f32 v241, v206, v207
    v_cvt_pk_bf16_f32 v235, v208, v209
    v_cvt_pk_bf16_f32 v242, v210, v211
    v_cvt_pk_bf16_f32 v236, v212, v213
    v_cvt_pk_bf16_f32 v243, v214, v215
la0_W_seg:
    v_mov_b32 v96, 0
    v_mov_b32 v97, 0
    v_mov_b32 v98, 0
    v_mov_b32 v99, 0
    v_mov_b32 v100, 0
    v_mov_b32 v101, 0
    v_mov_b32 v102, 0
    v_mov_b32 v103, 0
    v_mov_b32 v104, 0
    v_mov_b32 v105, 0
    v_mov_b32 v106, 0
    v_mov_b32 v107, 0
    v_mov_b32 v108, 0
    v_mov_b32 v109, 0
    v_mov_b32 v110, 0
    v_mov_b32 v111, 0
    v_mov_b32 v112, 0
    v_mov_b32 v113, 0
    v_mov_b32 v114, 0
    v_mov_b32 v115, 0
    v_mov_b32 v116, 0
    v_mov_b32 v117, 0
    v_mov_b32 v118, 0
    v_mov_b32 v119, 0
    v_mov_b32 v120, 0
    v_mov_b32 v121, 0
    v_mov_b32 v122, 0
    v_mov_b32 v123, 0
    v_mov_b32 v140, 0
    v_mov_b32 v141, 0
    v_mov_b32 v142, 0
    v_mov_b32 v143, 0
    v_mov_b32 v144, 0
    v_mov_b32 v145, 0
    v_mov_b32 v146, 0
    v_mov_b32 v147, 0
    s_bitcmp0_b32 s37, 0
    s_cbranch_scc1 la0_W_p0_skip
    v_mov_b32 v96, v216
    v_mov_b32 v100, v217
    v_mov_b32 v104, v218
    v_mov_b32 v108, v219
    v_mov_b32 v112, v220
    v_mov_b32 v116, v221
    v_mov_b32 v120, v222
la0_W_p0_go:
    buffer_load_dwordx4 v[80:83], v12, s[8:11], s42 offen offset:0 sc1
    buffer_load_dwordx4 v[84:87], v12, s[8:11], s42 offen offset:64 sc1
    buffer_load_dwordx4 v[88:91], v12, s[8:11], s42 offen offset:128 sc1
    buffer_load_dwordx4 v[92:95], v13, s[8:11], s42 offen sc1
    s_waitcnt vmcnt(3)
    v_mfma_f32_16x16x32_bf16 v[124:127], v[80:83], a[112:115], 0
    v_mfma_f32_16x16x32_bf16 v[128:131], v[80:83], a[128:131], 0
    s_waitcnt vmcnt(2)
    v_mfma_f32_16x16x32_bf16 v[124:127], v[84:87], a[116:119], v[124:127]
    v_mfma_f32_16x16x32_bf16 v[128:131], v[84:87], a[132:135], v[128:131]
    s_waitcnt vmcnt(1)
    v_mfma_f32_16x16x32_bf16 v[124:127], v[88:91], a[120:123], v[124:127]
    v_mfma_f32_16x16x32_bf16 v[128:131], v[88:91], a[136:139], v[128:131]
    s_waitcnt vmcnt(0)
    v_mfma_f32_16x16x32_bf16 v[124:127], v[92:95], a[124:127], v[124:127]
    v_mfma_f32_16x16x32_bf16 v[128:131], v[92:95], a[140:143], v[128:131]
    s_nop 7
    v_mov_b32 v126, v128
    v_mov_b32 v127, v129
    ds_write_b128 v17, v[124:127] offset:49152
    s_waitcnt lgkmcnt(0)
    s_barrier
    ds_read_b128 v[160:163], v7 offset:49152
    ds_read_b128 v[164:167], v7 offset:50176
    ds_read_b128 v[168:171], v7 offset:51200
    ds_read_b128 v[172:175], v7 offset:52224
    s_waitcnt lgkmcnt(0)
    v_pk_add_f32 v[160:161], v[160:161], v[164:165]
    v_pk_add_f32 v[168:169], v[168:169], v[172:173]
    v_pk_add_f32 v[124:125], v[160:161], v[168:169]
    v_pk_add_f32 v[162:163], v[162:163], v[166:167]
    v_pk_add_f32 v[170:171], v[170:171], v[174:175]
    v_pk_add_f32 v[126:127], v[162:163], v[170:171]
    v_max_f32 v148, v124, v125
    v_max3_f32 v148, v148, v32, v33
    v_max3_f32 v148, v148, v34, v35
    v_mov_b32 v149, v148
    s_nop 1
    v_permlane16_swap_b32 v148, v149
    v_max_f32 v148, v148, v149
    v_mov_b32 v149, v148
    s_nop 1
    v_permlane32_swap_b32 v148, v149
    v_max_f32 v148, v148, v149
    v_sub_f32 v124, v124, v148
    v_sub_f32 v125, v125, v148
    v_sub_f32 v32, v32, v148
    v_sub_f32 v33, v33, v148
    v_sub_f32 v34, v34, v148
    v_sub_f32 v35, v35, v148
    v_exp_f32 v124, v124
    v_exp_f32 v125, v125
    v_exp_f32 v32, v32
    v_exp_f32 v33, v33
    v_exp_f32 v34, v34
    v_exp_f32 v35, v35
    v_add_f32 v148, v124, v125
    v_add_f32 v148, v148, v32
    v_add_f32 v148, v148, v33
    v_add_f32 v148, v148, v34
    v_add_f32 v148, v148, v35
    v_mov_b32 v149, v148
    s_nop 1
    v_permlane16_swap_b32 v148, v149
    v_add_f32 v148, v148, v149
    v_mov_b32 v149, v148
    s_nop 1
    v_permlane32_swap_b32 v148, v149
    v_add_f32 v148, v148, v149
    v_rcp_f32 v148, v148
    s_nop 0
    v_mul_f32 v124, v124, v148
    v_mul_f32 v125, v125, v148
    v_mul_f32 v32, v32, v148
    v_mul_f32 v33, v33, v148
    v_mul_f32 v34, v34, v148
    v_mul_f32 v35, v35, v148
    v_cvt_pk_bf16_f32 v140, v124, v125
    v_cvt_pk_bf16_f32 v132, v32, v33
    v_cvt_pk_bf16_f32 v134, v34, v35
    v_mov_b32 v133, 0
    v_mov_b32 v135, 0
    v_max_f32 v150, v126, v127
    v_max3_f32 v150, v150, v36, v37
    v_max3_f32 v150, v150, v38, v39
    v_max3_f32 v150, v150, v40, v41
    v_max3_f32 v150, v150, v42, v43
    v_mov_b32 v151, v150
    s_nop 1
    v_permlane16_swap_b32 v150, v151
    v_max_f32 v150, v150, v151
    v_mov_b32 v151, v150
    s_nop 1
    v_permlane32_swap_b32 v150, v151
    v_max_f32 v150, v150, v151
    v_sub_f32 v126, v126, v150
    v_sub_f32 v127, v127, v150
    v_sub_f32 v36, v36, v150
    v_sub_f32 v37, v37, v150
    v_sub_f32 v38, v38, v150
    v_sub_f32 v39, v39, v150
    v_sub_f32 v40, v40, v150
    v_sub_f32 v41, v41, v150
    v_sub_f32 v42, v42, v150
    v_sub_f32 v43, v43, v150
    v_exp_f32 v126, v126
    v_exp_f32 v127, v127
    v_exp_f32 v36, v36
    v_exp_f32 v37, v37
    v_exp_f32 v38, v38
    v_exp_f32 v39, v39
    v_exp_f32 v40, v40
    v_exp_f32 v41, v41
    v_exp_f32 v42, v42
    v_exp_f32 v43, v43
    v_add_f32 v150, v126, v127
    v_add_f32 v150, v150, v36
    v_add_f32 v150, v150, v37
    v_add_f32 v150, v150, v38
    v_add_f32 v150, v150, v39
    v_add_f32 v150, v150, v40
    v_add_f32 v150, v150, v41
    v_add_f32 v150, v150, v42
    v_add_f32 v150, v150, v43
    v_mov_b32 v151, v150
    s_nop 1
    v_permlane16_swap_b32 v150, v151
    v_add_f32 v150, v150, v151
    v_mov_b32 v151, v150
    s_nop 1
    v_permlane32_swap_b32 v150, v151
    v_add_f32 v150, v150, v151
    v_rcp_f32 v150, v150
    s_nop 0
    v_mul_f32 v126, v126, v150
    v_mul_f32 v127, v127, v150
    v_mul_f32 v36, v36, v150
    v_mul_f32 v37, v37, v150
    v_mul_f32 v38, v38, v150
    v_mul_f32 v39, v39, v150
    v_mul_f32 v40, v40, v150
    v_mul_f32 v41, v41, v150
    v_mul_f32 v42, v42, v150
    v_mul_f32 v43, v43, v150
    v_cvt_pk_bf16_f32 v144, v126, v127
    v_cvt_pk_bf16_f32 v136, v36, v37
    v_cvt_pk_bf16_f32 v138, v38, v39
    v_cvt_pk_bf16_f32 v137, v40, v41
    v_cvt_pk_bf16_f32 v139, v42, v43
    v_mfma_f32_16x16x32_bf16 v[160:163], v[132:135], a[0:3], 0
    v_mfma_f32_16x16x32_bf16 v[164:167], v[132:135], a[4:7], 0
    v_mfma_f32_16x16x32_bf16 v[168:171], v[132:135], a[8:11], 0
    v_mfma_f32_16x16x32_bf16 v[172:175], v[132:135], a[12:15], 0
    v_mfma_f32_16x16x32_bf16 v[176:179], v[132:135], a[16:19], 0
    v_mfma_f32_16x16x32_bf16 v[180:183], v[132:135], a[20:23], 0
    v_mfma_f32_16x16x32_bf16 v[184:187], v[132:135], a[24:27], 0
    v_mfma_f32_16x16x32_bf16 v[188:191], v[136:139], a[0:3], 0
    v_mfma_f32_16x16x32_bf16 v[192:195], v[136:139], a[4:7], 0
    v_mfma_f32_16x16x32_bf16 v[196:199], v[136:139], a[8:11], 0
    v_mfma_f32_16x16x32_bf16 v[200:203], v[136:139], a[12:15], 0
    v_mfma_f32_16x16x32_bf16 v[204:207], v[136:139], a[16:19], 0
    v_mfma_f32_16x16x32_bf16 v[208:211], v[136:139], a[20:23], 0
    v_mfma_f32_16x16x32_bf16 v[212:215], v[136:139], a[24:27], 0
    v_mfma_f32_16x16x32_bf16 v[160:163], v[140:143], v[96:99], v[160:163]
    v_mfma_f32_16x16x32_bf16 v[164:167], v[140:143], v[100:103], v[164:167]
    v_mfma_f32_16x16x32_bf16 v[168:171], v[140:143], v[104:107], v[168:171]
    v_mfma_f32_16x16x32_bf16 v[172:175], v[140:143], v[108:111], v[172:175]
    v_mfma_f32_16x16x32_bf16 v[176:179], v[140:143], v[112:115], v[176:179]
    v_mfma_f32_16x16x32_bf16 v[180:183], v[140:143], v[116:119], v[180:183]
    v_mfma_f32_16x16x32_bf16 v[184:187], v[140:143], v[120:123], v[184:187]
    v_mfma_f32_16x16x32_bf16 v[188:191], v[144:147], v[96:99], v[188:191]
    v_mfma_f32_16x16x32_bf16 v[192:195], v[144:147], v[100:103], v[192:195]
    v_mfma_f32_16x16x32_bf16 v[196:199], v[144:147], v[104:107], v[196:199]
    v_mfma_f32_16x16x32_bf16 v[200:203], v[144:147], v[108:111], v[200:203]
    v_mfma_f32_16x16x32_bf16 v[204:207], v[144:147], v[112:115], v[204:207]
    v_mfma_f32_16x16x32_bf16 v[208:211], v[144:147], v[116:119], v[208:211]
    v_mfma_f32_16x16x32_bf16 v[212:215], v[144:147], v[120:123], v[212:215]
    s_add_u32 s22, s44, 0
    buffer_atomic_add_f32 v160, v16, s[8:11], s22 offen offset:0
    buffer_atomic_add_f32 v164, v16, s[8:11], s22 offen offset:64
    buffer_atomic_add_f32 v168, v16, s[8:11], s22 offen offset:128
    buffer_atomic_add_f32 v172, v16, s[8:11], s22 offen offset:192
    buffer_atomic_add_f32 v176, v16, s[8:11], s22 offen offset:256
    buffer_atomic_add_f32 v180, v16, s[8:11], s22 offen offset:320
    buffer_atomic_add_f32 v184, v16, s[8:11], s22 offen offset:384
    s_add_u32 s22, s44, 1792
    buffer_atomic_add_f32 v161, v16, s[8:11], s22 offen offset:0
    buffer_atomic_add_f32 v165, v16, s[8:11], s22 offen offset:64
    buffer_atomic_add_f32 v169, v16, s[8:11], s22 offen offset:128
    buffer_atomic_add_f32 v173, v16, s[8:11], s22 offen offset:192
    buffer_atomic_add_f32 v177, v16, s[8:11], s22 offen offset:256
    buffer_atomic_add_f32 v181, v16, s[8:11], s22 offen offset:320
    buffer_atomic_add_f32 v185, v16, s[8:11], s22 offen offset:384
    s_add_u32 s22, s44, 3584
    buffer_atomic_add_f32 v162, v16, s[8:11], s22 offen offset:0
    buffer_atomic_add_f32 v166, v16, s[8:11], s22 offen offset:64
    buffer_atomic_add_f32 v170, v16, s[8:11], s22 offen offset:128
    buffer_atomic_add_f32 v174, v16, s[8:11], s22 offen offset:192
    buffer_atomic_add_f32 v178, v16, s[8:11], s22 offen offset:256
    buffer_atomic_add_f32 v182, v16, s[8:11], s22 offen offset:320
    buffer_atomic_add_f32 v186, v16, s[8:11], s22 offen offset:384
    s_add_u32 s22, s44, 5376
    buffer_atomic_add_f32 v163, v16, s[8:11], s22 offen offset:0
    buffer_atomic_add_f32 v167, v16, s[8:11], s22 offen offset:64
    buffer_atomic_add_f32 v171, v16, s[8:11], s22 offen offset:128
    buffer_atomic_add_f32 v175, v16, s[8:11], s22 offen offset:192
    buffer_atomic_add_f32 v179, v16, s[8:11], s22 offen offset:256
    buffer_atomic_add_f32 v183, v16, s[8:11], s22 offen offset:320
    buffer_atomic_add_f32 v187, v16, s[8:11], s22 offen offset:384
    s_add_u32 s22, s44, 28672
    buffer_atomic_add_f32 v188, v16, s[8:11], s22 offen offset:0
    buffer_atomic_add_f32 v192, v16, s[8:11], s22 offen offset:64
    buffer_atomic_add_f32 v196, v16, s[8:11], s22 offen offset:128
    buffer_atomic_add_f32 v200, v16, s[8:11], s22 offen offset:192
    buffer_atomic_add_f32 v204, v16, s[8:11], s22 offen offset:256
    buffer_atomic_add_f32 v208, v16, s[8:11], s22 offen offset:320
    buffer_atomic_add_f32 v212, v16, s[8:11], s22 offen offset:384
    s_add_u32 s22, s44, 30464
    buffer_atomic_add_f32 v189, v16, s[8:11], s22 offen offset:0
    buffer_atomic_add_f32 v193, v16, s[8:11], s22 offen offset:64
    buffer_atomic_add_f32 v197, v16, s[8:11], s22 offen offset:128
    buffer_atomic_add_f32 v201, v16, s[8:11], s22 offen offset:192
    buffer_atomic_add_f32 v205, v16, s[8:11], s22 offen offset:256
    buffer_atomic_add_f32 v209, v16, s[8:11], s22 offen offset:320
    buffer_atomic_add_f32 v213, v16, s[8:11], s22 offen offset:384
    s_add_u32 s22, s44, 32256
    buffer_atomic_add_f32 v190, v16, s[8:11], s22 offen offset:0
    buffer_atomic_add_f32 v194, v16, s[8:11], s22 offen offset:64
    buffer_atomic_add_f32 v198, v16, s[8:11], s22 offen offset:128
    buffer_atomic_add_f32 v202, v16, s[8:11], s22 offen offset:192
    buffer_atomic_add_f32 v206, v16, s[8:11], s22 offen offset:256
    buffer_atomic_add_f32 v210, v16, s[8:11], s22 offen offset:320
    buffer_atomic_add_f32 v214, v16, s[8:11], s22 offen offset:384
    s_add_u32 s22, s44, 34048
    buffer_atomic_add_f32 v191, v16, s[8:11], s22 offen offset:0
    buffer_atomic_add_f32 v195, v16, s[8:11], s22 offen offset:64
    buffer_atomic_add_f32 v199, v16, s[8:11], s22 offen offset:128
    buffer_atomic_add_f32 v203, v16, s[8:11], s22 offen offset:192
    buffer_atomic_add_f32 v207, v16, s[8:11], s22 offen offset:256
    buffer_atomic_add_f32 v211, v16, s[8:11], s22 offen offset:320
    buffer_atomic_add_f32 v215, v16, s[8:11], s22 offen offset:384
la0_W_p0_skip:
    s_add_u32 s42, s42, 7168
    s_add_u32 s43, s43, 114688
    s_add_u32 s44, s44, 57344
    s_bitcmp0_b32 s37, 1
    s_cbranch_scc1 la0_W_p1_skip
    v_mov_b32 v96, v223
    v_mov_b32 v100, v224
    v_mov_b32 v104, v225
    v_mov_b32 v108, v226
    v_mov_b32 v112, v227
    v_mov_b32 v116, v228
    v_mov_b32 v120, v229
la0_W_p1_go:
    s_waitcnt vmcnt(50)
    buffer_load_dwordx4 v[80:83], v12, s[8:11], s42 offen offset:0 sc1
    buffer_load_dwordx4 v[84:87], v12, s[8:11], s42 offen offset:64 sc1
    buffer_load_dwordx4 v[88:91], v12, s[8:11], s42 offen offset:128 sc1
    buffer_load_dwordx4 v[92:95], v13, s[8:11], s42 offen sc1
    s_waitcnt vmcnt(3)
    v_mfma_f32_16x16x32_bf16 v[124:127], v[80:83], a[144:147], 0
    v_mfma_f32_16x16x32_bf16 v[128:131], v[80:83], a[160:163], 0
    s_waitcnt vmcnt(2)
    v_mfma_f32_16x16x32_bf16 v[124:127], v[84:87], a[148:151], v[124:127]
    v_mfma_f32_16x16x32_bf16 v[128:131], v[84:87], a[164:167], v[128:131]
    s_waitcnt vmcnt(1)
    v_mfma_f32_16x16x32_bf16 v[124:127], v[88:91], a[152:155], v[124:127]
    v_mfma_f32_16x16x32_bf16 v[128:131], v[88:91], a[168:171], v[128:131]
    s_waitcnt vmcnt(0)
    v_mfma_f32_16x16x32_bf16 v[124:127], v[92:95], a[156:159], v[124:127]
    v_mfma_f32_16x16x32_bf16 v[128:131], v[92:95], a[172:175], v[128:131]
    s_nop 7
    v_mov_b32 v126, v128
    v_mov_b32 v127, v129
    ds_write_b128 v17, v[124:127] offset:53248
    s_waitcnt lgkmcnt(0)
    s_barrier
    ds_read_b128 v[160:163], v7 offset:53248
    ds_read_b128 v[164:167], v7 offset:54272
    ds_read_b128 v[168:171], v7 offset:55296
    ds_read_b128 v[172:175], v7 offset:56320
    s_waitcnt lgkmcnt(0)
    v_pk_add_f32 v[160:161], v[160:161], v[164:165]
    v_pk_add_f32 v[168:169], v[168:169], v[172:173]
    v_pk_add_f32 v[124:125], v[160:161], v[168:169]
    v_pk_add_f32 v[162:163], v[162:163], v[166:167]
    v_pk_add_f32 v[170:171], v[170:171], v[174:175]
    v_pk_add_f32 v[126:127], v[162:163], v[170:171]
    v_max_f32 v148, v124, v125
    v_max3_f32 v148, v148, v44, v45
    v_max3_f32 v148, v148, v46, v47
    v_mov_b32 v149, v148
    s_nop 1
    v_permlane16_swap_b32 v148, v149
    v_max_f32 v148, v148, v149
    v_mov_b32 v149, v148
    s_nop 1
    v_permlane32_swap_b32 v148, v149
    v_max_f32 v148, v148, v149
    v_sub_f32 v124, v124, v148
    v_sub_f32 v125, v125, v148
    v_sub_f32 v44, v44, v148
    v_sub_f32 v45, v45, v148
    v_sub_f32 v46, v46, v148
    v_sub_f32 v47, v47, v148
    v_exp_f32 v124, v124
    v_exp_f32 v125, v125
    v_exp_f32 v44, v44
    v_exp_f32 v45, v45
    v_exp_f32 v46, v46
    v_exp_f32 v47, v47
    v_add_f32 v148, v124, v125
    v_add_f32 v148, v148, v44
    v_add_f32 v148, v148, v45
    v_add_f32 v148, v148, v46
    v_add_f32 v148, v148, v47
    v_mov_b32 v149, v148
    s_nop 1
    v_permlane16_swap_b32 v148, v149
    v_add_f32 v148, v148, v149
    v_mov_b32 v149, v148
    s_nop 1
    v_permlane32_swap_b32 v148, v149
    v_add_f32 v148, v148, v149
    v_rcp_f32 v148, v148
    s_nop 0
    v_mul_f32 v124, v124, v148
    v_mul_f32 v125, v125, v148
    v_mul_f32 v44, v44, v148
    v_mul_f32 v45, v45, v148
    v_mul_f32 v46, v46, v148
    v_mul_f32 v47, v47, v148
    v_cvt_pk_bf16_f32 v140, v124, v125
    v_cvt_pk_bf16_f32 v132, v44, v45
    v_cvt_pk_bf16_f32 v134, v46, v47
    v_mov_b32 v133, 0
    v_mov_b32 v135, 0
    v_max_f32 v150, v126, v127
    v_max3_f32 v150, v150, v48, v49
    v_max3_f32 v150, v150, v50, v51
    v_max3_f32 v150, v150, v52, v53
    v_max3_f32 v150, v150, v54, v55
    v_mov_b32 v151, v150
    s_nop 1
    v_permlane16_swap_b32 v150, v151
    v_max_f32 v150, v150, v151
    v_mov_b32 v151, v150
    s_nop 1
    v_permlane32_swap_b32 v150, v151
    v_max_f32 v150, v150, v151
    v_sub_f32 v126, v126, v150
    v_sub_f32 v127, v127, v150
    v_sub_f32 v48, v48, v150
    v_sub_f32 v49, v49, v150
    v_sub_f32 v50, v50, v150
    v_sub_f32 v51, v51, v150
    v_sub_f32 v52, v52, v150
    v_sub_f32 v53, v53, v150
    v_sub_f32 v54, v54, v150
    v_sub_f32 v55, v55, v150
    v_exp_f32 v126, v126
    v_exp_f32 v127, v127
    v_exp_f32 v48, v48
    v_exp_f32 v49, v49
    v_exp_f32 v50, v50
    v_exp_f32 v51, v51
    v_exp_f32 v52, v52
    v_exp_f32 v53, v53
    v_exp_f32 v54, v54
    v_exp_f32 v55, v55
    v_add_f32 v150, v126, v127
    v_add_f32 v150, v150, v48
    v_add_f32 v150, v150, v49
    v_add_f32 v150, v150, v50
    v_add_f32 v150, v150, v51
    v_add_f32 v150, v150, v52
    v_add_f32 v150, v150, v53
    v_add_f32 v150, v150, v54
    v_add_f32 v150, v150, v55
    v_mov_b32 v151, v150
    s_nop 1
    v_permlane16_swap_b32 v150, v151
    v_add_f32 v150, v150, v151
    v_mov_b32 v151, v150
    s_nop 1
    v_permlane32_swap_b32 v150, v151
    v_add_f32 v150, v150, v151
    v_rcp_f32 v150, v150
    s_nop 0
    v_mul_f32 v126, v126, v150
    v_mul_f32 v127, v127, v150
    v_mul_f32 v48, v48, v150
    v_mul_f32 v49, v49, v150
    v_mul_f32 v50, v50, v150
    v_mul_f32 v51, v51, v150
    v_mul_f32 v52, v52, v150
    v_mul_f32 v53, v53, v150
    v_mul_f32 v54, v54, v150
    v_mul_f32 v55, v55, v150
    v_cvt_pk_bf16_f32 v144, v126, v127
    v_cvt_pk_bf16_f32 v136, v48, v49
    v_cvt_pk_bf16_f32 v138, v50, v51
    v_cvt_pk_bf16_f32 v137, v52, v53
    v_cvt_pk_bf16_f32 v139, v54, v55
    v_mfma_f32_16x16x32_bf16 v[160:163], v[132:135], a[28:31], 0
    v_mfma_f32_16x16x32_bf16 v[164:167], v[132:135], a[32:35], 0
    v_mfma_f32_16x16x32_bf16 v[168:171], v[132:135], a[36:39], 0
    v_mfma_f32_16x16x32_bf16 v[172:175], v[132:135], a[40:43], 0
    v_mfma_f32_16x16x32_bf16 v[176:179], v[132:135], a[44:47], 0
    v_mfma_f32_16x16x32_bf16 v[180:183], v[132:135], a[48:51], 0
    v_mfma_f32_16x16x32_bf16 v[184:187], v[132:135], a[52:55], 0
    v_mfma_f32_16x16x32_bf16 v[188:191], v[136:139], a[28:31], 0
    v_mfma_f32_16x16x32_bf16 v[192:195], v[136:139], a[32:35], 0
    v_mfma_f32_16x16x32_bf16 v[196:199], v[136:139], a[36:39], 0
    v_mfma_f32_16x16x32_bf16 v[200:203], v[136:139], a[40:43], 0
    v_mfma_f32_16x16x32_bf16 v[204:207], v[136:139], a[44:47], 0
    v_mfma_f32_16x16x32_bf16 v[208:211], v[136:139], a[48:51], 0
    v_mfma_f32_16x16x32_bf16 v[212:215], v[136:139], a[52:55], 0
    v_mfma_f32_16x16x32_bf16 v[160:163], v[140:143], v[96:99], v[160:163]
    v_mfma_f32_16x16x32_bf16 v[164:167], v[140:143], v[100:103], v[164:167]
    v_mfma_f32_16x16x32_bf16 v[168:171], v[140:143], v[104:107], v[168:171]
    v_mfma_f32_16x16x32_bf16 v[172:175], v[140:143], v[108:111], v[172:175]
    v_mfma_f32_16x16x32_bf16 v[176:179], v[140:143], v[112:115], v[176:179]
    v_mfma_f32_16x16x32_bf16 v[180:183], v[140:143], v[116:119], v[180:183]
    v_mfma_f32_16x16x32_bf16 v[184:187], v[140:143], v[120:123], v[184:187]
    v_mfma_f32_16x16x32_bf16 v[188:191], v[144:147], v[96:99], v[188:191]
    v_mfma_f32_16x16x32_bf16 v[192:195], v[144:147], v[100:103], v[192:195]
    v_mfma_f32_16x16x32_bf16 v[196:199], v[144:147], v[104:107], v[196:199]
    v_mfma_f32_16x16x32_bf16 v[200:203], v[144:147], v[108:111], v[200:203]
    v_mfma_f32_16x16x32_bf16 v[204:207], v[144:147], v[112:115], v[204:207]
    v_mfma_f32_16x16x32_bf16 v[208:211], v[144:147], v[116:119], v[208:211]
    v_mfma_f32_16x16x32_bf16 v[212:215], v[144:147], v[120:123], v[212:215]
    s_add_u32 s22, s44, 0
    buffer_atomic_add_f32 v160, v16, s[8:11], s22 offen offset:0
    buffer_atomic_add_f32 v164, v16, s[8:11], s22 offen offset:64
    buffer_atomic_add_f32 v168, v16, s[8:11], s22 offen offset:128
    buffer_atomic_add_f32 v172, v16, s[8:11], s22 offen offset:192
    buffer_atomic_add_f32 v176, v16, s[8:11], s22 offen offset:256
    buffer_atomic_add_f32 v180, v16, s[8:11], s22 offen offset:320
    buffer_atomic_add_f32 v184, v16, s[8:11], s22 offen offset:384
    s_add_u32 s22, s44, 1792
    buffer_atomic_add_f32 v161, v16, s[8:11], s22 offen offset:0
    buffer_atomic_add_f32 v165, v16, s[8:11], s22 offen offset:64
    buffer_atomic_add_f32 v169, v16, s[8:11], s22 offen offset:128
    buffer_atomic_add_f32 v173, v16, s[8:11], s22 offen offset:192
    buffer_atomic_add_f32 v177, v16, s[8:11], s22 offen offset:256
    buffer_atomic_add_f32 v181, v16, s[8:11], s22 offen offset:320
    buffer_atomic_add_f32 v185, v16, s[8:11], s22 offen offset:384
    s_add_u32 s22, s44, 3584
    buffer_atomic_add_f32 v162, v16, s[8:11], s22 offen offset:0
    buffer_atomic_add_f32 v166, v16, s[8:11], s22 offen offset:64
    buffer_atomic_add_f32 v170, v16, s[8:11], s22 offen offset:128
    buffer_atomic_add_f32 v174, v16, s[8:11], s22 offen offset:192
    buffer_atomic_add_f32 v178, v16, s[8:11], s22 offen offset:256
    buffer_atomic_add_f32 v182, v16, s[8:11], s22 offen offset:320
    buffer_atomic_add_f32 v186, v16, s[8:11], s22 offen offset:384
    s_add_u32 s22, s44, 5376
    buffer_atomic_add_f32 v163, v16, s[8:11], s22 offen offset:0
    buffer_atomic_add_f32 v167, v16, s[8:11], s22 offen offset:64
    buffer_atomic_add_f32 v171, v16, s[8:11], s22 offen offset:128
    buffer_atomic_add_f32 v175, v16, s[8:11], s22 offen offset:192
    buffer_atomic_add_f32 v179, v16, s[8:11], s22 offen offset:256
    buffer_atomic_add_f32 v183, v16, s[8:11], s22 offen offset:320
    buffer_atomic_add_f32 v187, v16, s[8:11], s22 offen offset:384
    s_add_u32 s22, s44, 28672
    buffer_atomic_add_f32 v188, v16, s[8:11], s22 offen offset:0
    buffer_atomic_add_f32 v192, v16, s[8:11], s22 offen offset:64
    buffer_atomic_add_f32 v196, v16, s[8:11], s22 offen offset:128
    buffer_atomic_add_f32 v200, v16, s[8:11], s22 offen offset:192
    buffer_atomic_add_f32 v204, v16, s[8:11], s22 offen offset:256
    buffer_atomic_add_f32 v208, v16, s[8:11], s22 offen offset:320
    buffer_atomic_add_f32 v212, v16, s[8:11], s22 offen offset:384
    s_add_u32 s22, s44, 30464
    buffer_atomic_add_f32 v189, v16, s[8:11], s22 offen offset:0
    buffer_atomic_add_f32 v193, v16, s[8:11], s22 offen offset:64
    buffer_atomic_add_f32 v197, v16, s[8:11], s22 offen offset:128
    buffer_atomic_add_f32 v201, v16, s[8:11], s22 offen offset:192
    buffer_atomic_add_f32 v205, v16, s[8:11], s22 offen offset:256
    buffer_atomic_add_f32 v209, v16, s[8:11], s22 offen offset:320
    buffer_atomic_add_f32 v213, v16, s[8:11], s22 offen offset:384
    s_add_u32 s22, s44, 32256
    buffer_atomic_add_f32 v190, v16, s[8:11], s22 offen offset:0
    buffer_atomic_add_f32 v194, v16, s[8:11], s22 offen offset:64
    buffer_atomic_add_f32 v198, v16, s[8:11], s22 offen offset:128
    buffer_atomic_add_f32 v202, v16, s[8:11], s22 offen offset:192
    buffer_atomic_add_f32 v206, v16, s[8:11], s22 offen offset:256
    buffer_atomic_add_f32 v210, v16, s[8:11], s22 offen offset:320
    buffer_atomic_add_f32 v214, v16, s[8:11], s22 offen offset:384
    s_add_u32 s22, s44, 34048
    buffer_atomic_add_f32 v191, v16, s[8:11], s22 offen offset:0
    buffer_atomic_add_f32 v195, v16, s[8:11], s22 offen offset:64
    buffer_atomic_add_f32 v199, v16, s[8:11], s22 offen offset:128
    buffer_atomic_add_f32 v203, v16, s[8:11], s22 offen offset:192
    buffer_atomic_add_f32 v207, v16, s[8:11], s22 offen offset:256
    buffer_atomic_add_f32 v211, v16, s[8:11], s22 offen offset:320
    buffer_atomic_add_f32 v215, v16, s[8:11], s22 offen offset:384
la0_W_p1_skip:
    s_add_u32 s42, s42, 7168
    s_add_u32 s43, s43, 114688
    s_add_u32 s44, s44, 57344
    s_bitcmp0_b32 s37, 2
    s_cbranch_scc1 la0_W_p2_skip
    v_mov_b32 v96, v230
    v_mov_b32 v100, v231
    v_mov_b32 v104, v232
    v_mov_b32 v108, v233
    v_mov_b32 v112, v234
    v_mov_b32 v116, v235
    v_mov_b32 v120, v236
    s_cmp_eq_u32 s33, 0
    s_cbranch_scc1 la0_W_p2_go
    s_mov_b32 s91, 0
    v_mov_b32 v2, 0
la0_W_p2:
    buffer_load_dword v3, v2, s[8:11], s45 offen offset:256 sc1
    s_waitcnt vmcnt(0)
    v_cmp_eq_u32 vcc, 0, v3
    s_cbranch_vccz la0_W_p2_go
    s_sleep 2
    s_add_u32 s91, s91, 1
    s_cmp_lt_u32 s91, s90
    s_cbranch_scc1 la0_W_p2
    s_mov_b32 s90, 0
    s_branch la0_W_p2_go
la0_W_p2_go:
    s_waitcnt vmcnt(50)
    buffer_load_dwordx4 v[80:83], v12, s[8:11], s42 offen offset:0 sc1
    buffer_load_dwordx4 v[84:87], v12, s[8:11], s42 offen offset:64 sc1
    buffer_load_dwordx4 v[88:91], v12, s[8:11], s42 offen offset:128 sc1
    buffer_load_dwordx4 v[92:95], v13, s[8:11], s42 offen sc1
    s_waitcnt vmcnt(3)
    v_mfma_f32_16x16x32_bf16 v[124:127], v[80:83], a[176:179], 0
    v_mfma_f32_16x16x32_bf16 v[128:131], v[80:83], a[192:195], 0
    s_waitcnt vmcnt(2)
    v_mfma_f32_16x16x32_bf16 v[124:127], v[84:87], a[180:183], v[124:127]
    v_mfma_f32_16x16x32_bf16 v[128:131], v[84:87], a[196:199], v[128:131]
    s_waitcnt vmcnt(1)
    v_mfma_f32_16x16x32_bf16 v[124:127], v[88:91], a[184:187], v[124:127]
    v_mfma_f32_16x16x32_bf16 v[128:131], v[88:91], a[200:203], v[128:131]
    s_waitcnt vmcnt(0)
    v_mfma_f32_16x16x32_bf16 v[124:127], v[92:95], a[188:191], v[124:127]
    v_mfma_f32_16x16x32_bf16 v[128:131], v[92:95], a[204:207], v[128:131]
    s_nop 7
    v_mov_b32 v126, v128
    v_mov_b32 v127, v129
    ds_write_b128 v17, v[124:127] offset:49152
    s_waitcnt lgkmcnt(0)
    s_barrier
    ds_read_b128 v[160:163], v7 offset:49152
    ds_read_b128 v[164:167], v7 offset:50176
    ds_read_b128 v[168:171], v7 offset:51200
    ds_read_b128 v[172:175], v7 offset:52224
    s_waitcnt lgkmcnt(0)
    v_pk_add_f32 v[160:161], v[160:161], v[164:165]
    v_pk_add_f32 v[168:169], v[168:169], v[172:173]
    v_pk_add_f32 v[124:125], v[160:161], v[168:169]
    v_pk_add_f32 v[162:163], v[162:163], v[166:167]
    v_pk_add_f32 v[170:171], v[170:171], v[174:175]
    v_pk_add_f32 v[126:127], v[162:163], v[170:171]
    v_max_f32 v148, v124, v125
    v_max3_f32 v148, v148, v56, v57
    v_max3_f32 v148, v148, v58, v59
    v_mov_b32 v149, v148
    s_nop 1
    v_permlane16_swap_b32 v148, v149
    v_max_f32 v148, v148, v149
    v_mov_b32 v149, v148
    s_nop 1
    v_permlane32_swap_b32 v148, v149
    v_max_f32 v148, v148, v149
    v_sub_f32 v124, v124, v148
    v_sub_f32 v125, v125, v148
    v_sub_f32 v56, v56, v148
    v_sub_f32 v57, v57, v148
    v_sub_f32 v58, v58, v148
    v_sub_f32 v59, v59, v148
    v_exp_f32 v124, v124
    v_exp_f32 v125, v125
    v_exp_f32 v56, v56
    v_exp_f32 v57, v57
    v_exp_f32 v58, v58
    v_exp_f32 v59, v59
    v_add_f32 v148, v124, v125
    v_add_f32 v148, v148, v56
    v_add_f32 v148, v148, v57
    v_add_f32 v148, v148, v58
    v_add_f32 v148, v148, v59
    v_mov_b32 v149, v148
    s_nop 1
    v_permlane16_swap_b32 v148, v149
    v_add_f32 v148, v148, v149
    v_mov_b32 v149, v148
    s_nop 1
    v_permlane32_swap_b32 v148, v149
    v_add_f32 v148, v148, v149
    v_rcp_f32 v148, v148
    s_nop 0
    v_mul_f32 v124, v124, v148
    v_mul_f32 v125, v125, v148
    v_mul_f32 v56, v56, v148
    v_mul_f32 v57, v57, v148
    v_mul_f32 v58, v58, v148
    v_mul_f32 v59, v59, v148
    v_cvt_pk_bf16_f32 v140, v124, v125
    v_cvt_pk_bf16_f32 v132, v56, v57
    v_cvt_pk_bf16_f32 v134, v58, v59
    v_mov_b32 v133, 0
    v_mov_b32 v135, 0
    v_max_f32 v150, v126, v127
    v_max3_f32 v150, v150, v60, v61
    v_max3_f32 v150, v150, v62, v63
    v_max3_f32 v150, v150, v64, v65
    v_max3_f32 v150, v150, v66, v67
    v_mov_b32 v151, v150
    s_nop 1
    v_permlane16_swap_b32 v150, v151
    v_max_f32 v150, v150, v151
    v_mov_b32 v151, v150
    s_nop 1
    v_permlane32_swap_b32 v150, v151
    v_max_f32 v150, v150, v151
    v_sub_f32 v126, v126, v150
    v_sub_f32 v127, v127, v150
    v_sub_f32 v60, v60, v150
    v_sub_f32 v61, v61, v150
    v_sub_f32 v62, v62, v150
    v_sub_f32 v63, v63, v150
    v_sub_f32 v64, v64, v150
    v_sub_f32 v65, v65, v150
    v_sub_f32 v66, v66, v150
    v_sub_f32 v67, v67, v150
    v_exp_f32 v126, v126
    v_exp_f32 v127, v127
    v_exp_f32 v60, v60
    v_exp_f32 v61, v61
    v_exp_f32 v62, v62
    v_exp_f32 v63, v63
    v_exp_f32 v64, v64
    v_exp_f32 v65, v65
    v_exp_f32 v66, v66
    v_exp_f32 v67, v67
    v_add_f32 v150, v126, v127
    v_add_f32 v150, v150, v60
    v_add_f32 v150, v150, v61
    v_add_f32 v150, v150, v62
    v_add_f32 v150, v150, v63
    v_add_f32 v150, v150, v64
    v_add_f32 v150, v150, v65
    v_add_f32 v150, v150, v66
    v_add_f32 v150, v150, v67
    v_mov_b32 v151, v150
    s_nop 1
    v_permlane16_swap_b32 v150, v151
    v_add_f32 v150, v150, v151
    v_mov_b32 v151, v150
    s_nop 1
    v_permlane32_swap_b32 v150, v151
    v_add_f32 v150, v150, v151
    v_rcp_f32 v150, v150
    s_nop 0
    v_mul_f32 v126, v126, v150
    v_mul_f32 v127, v127, v150
    v_mul_f32 v60, v60, v150
    v_mul_f32 v61, v61, v150
    v_mul_f32 v62, v62, v150
    v_mul_f32 v63, v63, v150
    v_mul_f32 v64, v64, v150
    v_mul_f32 v65, v65, v150
    v_mul_f32 v66, v66, v150
    v_mul_f32 v67, v67, v150
    v_cvt_pk_bf16_f32 v144, v126, v127
    v_cvt_pk_bf16_f32 v136, v60, v61
    v_cvt_pk_bf16_f32 v138, v62, v63
    v_cvt_pk_bf16_f32 v137, v64, v65
    v_cvt_pk_bf16_f32 v139, v66, v67
    v_mfma_f32_16x16x32_bf16 v[160:163], v[132:135], a[56:59], 0
    v_mfma_f32_16x16x32_bf16 v[164:167], v[132:135], a[60:63], 0
    v_mfma_f32_16x16x32_bf16 v[168:171], v[132:135], a[64:67], 0
    v_mfma_f32_16x16x32_bf16 v[172:175], v[132:135], a[68:71], 0
    v_mfma_f32_16x16x32_bf16 v[176:179], v[132:135], a[72:75], 0
    v_mfma_f32_16x16x32_bf16 v[180:183], v[132:135], a[76:79], 0
    v_mfma_f32_16x16x32_bf16 v[184:187], v[132:135], a[80:83], 0
    v_mfma_f32_16x16x32_bf16 v[188:191], v[136:139], a[56:59], 0
    v_mfma_f32_16x16x32_bf16 v[192:195], v[136:139], a[60:63], 0
    v_mfma_f32_16x16x32_bf16 v[196:199], v[136:139], a[64:67], 0
    v_mfma_f32_16x16x32_bf16 v[200:203], v[136:139], a[68:71], 0
    v_mfma_f32_16x16x32_bf16 v[204:207], v[136:139], a[72:75], 0
    v_mfma_f32_16x16x32_bf16 v[208:211], v[136:139], a[76:79], 0
    v_mfma_f32_16x16x32_bf16 v[212:215], v[136:139], a[80:83], 0
    s_cmp_eq_u32 s33, 0
    s_cbranch_scc1 la0_W_p2_wok
    s_mov_b32 s91, 0
la0_W_p2_w:
    buffer_load_dword v3, v15, s[8:11], s41 offen offset:0 sc1
    s_waitcnt vmcnt(0)
    v_cmp_eq_u32 vcc, 0, v3
    s_cbranch_vccz la0_W_p2_wl
    s_sleep 1
    s_add_u32 s91, s91, 1
    s_cmp_lt_u32 s91, s90
    s_cbranch_scc1 la0_W_p2_w
    s_mov_b32 s90, 0
    s_branch la0_W_p2_wl
la0_W_p2_wl:
    s_add_u32 s22, s43, 4096
    buffer_load_dword v96, v14, s[8:11], s43 offen offset:0 sc1
    buffer_load_dword v100, v14, s[8:11], s43 offen offset:1024 sc1
    buffer_load_dword v104, v14, s[8:11], s43 offen offset:2048 sc1
    buffer_load_dword v108, v14, s[8:11], s43 offen offset:3072 sc1
    buffer_load_dword v112, v14, s[8:11], s22 offen offset:0 sc1
    buffer_load_dword v116, v14, s[8:11], s22 offen offset:1024 sc1
    buffer_load_dword v120, v14, s[8:11], s22 offen offset:2048 sc1
    s_waitcnt vmcnt(0)
la0_W_p2_wok:
    v_mfma_f32_16x16x32_bf16 v[160:163], v[140:143], v[96:99], v[160:163]
    v_mfma_f32_16x16x32_bf16 v[164:167], v[140:143], v[100:103], v[164:167]
    v_mfma_f32_16x16x32_bf16 v[168:171], v[140:143], v[104:107], v[168:171]
    v_mfma_f32_16x16x32_bf16 v[172:175], v[140:143], v[108:111], v[172:175]
    v_mfma_f32_16x16x32_bf16 v[176:179], v[140:143], v[112:115], v[176:179]
    v_mfma_f32_16x16x32_bf16 v[180:183], v[140:143], v[116:119], v[180:183]
    v_mfma_f32_16x16x32_bf16 v[184:187], v[140:143], v[120:123], v[184:187]
    v_mfma_f32_16x16x32_bf16 v[188:191], v[144:147], v[96:99], v[188:191]
    v_mfma_f32_16x16x32_bf16 v[192:195], v[144:147], v[100:103], v[192:195]
    v_mfma_f32_16x16x32_bf16 v[196:199], v[144:147], v[104:107], v[196:199]
    v_mfma_f32_16x16x32_bf16 v[200:203], v[144:147], v[108:111], v[200:203]
    v_mfma_f32_16x16x32_bf16 v[204:207], v[144:147], v[112:115], v[204:207]
    v_mfma_f32_16x16x32_bf16 v[208:211], v[144:147], v[116:119], v[208:211]
    v_mfma_f32_16x16x32_bf16 v[212:215], v[144:147], v[120:123], v[212:215]
    s_add_u32 s22, s44, 0
    buffer_atomic_add_f32 v160, v16, s[8:11], s22 offen offset:0
    buffer_atomic_add_f32 v164, v16, s[8:11], s22 offen offset:64
    buffer_atomic_add_f32 v168, v16, s[8:11], s22 offen offset:128
    buffer_atomic_add_f32 v172, v16, s[8:11], s22 offen offset:192
    buffer_atomic_add_f32 v176, v16, s[8:11], s22 offen offset:256
    buffer_atomic_add_f32 v180, v16, s[8:11], s22 offen offset:320
    buffer_atomic_add_f32 v184, v16, s[8:11], s22 offen offset:384
    s_add_u32 s22, s44, 1792
    buffer_atomic_add_f32 v161, v16, s[8:11], s22 offen offset:0
    buffer_atomic_add_f32 v165, v16, s[8:11], s22 offen offset:64
    buffer_atomic_add_f32 v169, v16, s[8:11], s22 offen offset:128
    buffer_atomic_add_f32 v173, v16, s[8:11], s22 offen offset:192
    buffer_atomic_add_f32 v177, v16, s[8:11], s22 offen offset:256
    buffer_atomic_add_f32 v181, v16, s[8:11], s22 offen offset:320
    buffer_atomic_add_f32 v185, v16, s[8:11], s22 offen offset:384
    s_add_u32 s22, s44, 3584
    buffer_atomic_add_f32 v162, v16, s[8:11], s22 offen offset:0
    buffer_atomic_add_f32 v166, v16, s[8:11], s22 offen offset:64
    buffer_atomic_add_f32 v170, v16, s[8:11], s22 offen offset:128
    buffer_atomic_add_f32 v174, v16, s[8:11], s22 offen offset:192
    buffer_atomic_add_f32 v178, v16, s[8:11], s22 offen offset:256
    buffer_atomic_add_f32 v182, v16, s[8:11], s22 offen offset:320
    buffer_atomic_add_f32 v186, v16, s[8:11], s22 offen offset:384
    s_add_u32 s22, s44, 5376
    buffer_atomic_add_f32 v163, v16, s[8:11], s22 offen offset:0
    buffer_atomic_add_f32 v167, v16, s[8:11], s22 offen offset:64
    buffer_atomic_add_f32 v171, v16, s[8:11], s22 offen offset:128
    buffer_atomic_add_f32 v175, v16, s[8:11], s22 offen offset:192
    buffer_atomic_add_f32 v179, v16, s[8:11], s22 offen offset:256
    buffer_atomic_add_f32 v183, v16, s[8:11], s22 offen offset:320
    buffer_atomic_add_f32 v187, v16, s[8:11], s22 offen offset:384
    s_add_u32 s22, s44, 28672
    buffer_atomic_add_f32 v188, v16, s[8:11], s22 offen offset:0
    buffer_atomic_add_f32 v192, v16, s[8:11], s22 offen offset:64
    buffer_atomic_add_f32 v196, v16, s[8:11], s22 offen offset:128
    buffer_atomic_add_f32 v200, v16, s[8:11], s22 offen offset:192
    buffer_atomic_add_f32 v204, v16, s[8:11], s22 offen offset:256
    buffer_atomic_add_f32 v208, v16, s[8:11], s22 offen offset:320
    buffer_atomic_add_f32 v212, v16, s[8:11], s22 offen offset:384
    s_add_u32 s22, s44, 30464
    buffer_atomic_add_f32 v189, v16, s[8:11], s22 offen offset:0
    buffer_atomic_add_f32 v193, v16, s[8:11], s22 offen offset:64
    buffer_atomic_add_f32 v197, v16, s[8:11], s22 offen offset:128
    buffer_atomic_add_f32 v201, v16, s[8:11], s22 offen offset:192
    buffer_atomic_add_f32 v205, v16, s[8:11], s22 offen offset:256
    buffer_atomic_add_f32 v209, v16, s[8:11], s22 offen offset:320
    buffer_atomic_add_f32 v213, v16, s[8:11], s22 offen offset:384
    s_add_u32 s22, s44, 32256
    buffer_atomic_add_f32 v190, v16, s[8:11], s22 offen offset:0
    buffer_atomic_add_f32 v194, v16, s[8:11], s22 offen offset:64
    buffer_atomic_add_f32 v198, v16, s[8:11], s22 offen offset:128
    buffer_atomic_add_f32 v202, v16, s[8:11], s22 offen offset:192
    buffer_atomic_add_f32 v206, v16, s[8:11], s22 offen offset:256
    buffer_atomic_add_f32 v210, v16, s[8:11], s22 offen offset:320
    buffer_atomic_add_f32 v214, v16, s[8:11], s22 offen offset:384
    s_add_u32 s22, s44, 34048
    buffer_atomic_add_f32 v191, v16, s[8:11], s22 offen offset:0
    buffer_atomic_add_f32 v195, v16, s[8:11], s22 offen offset:64
    buffer_atomic_add_f32 v199, v16, s[8:11], s22 offen offset:128
    buffer_atomic_add_f32 v203, v16, s[8:11], s22 offen offset:192
    buffer_atomic_add_f32 v207, v16, s[8:11], s22 offen offset:256
    buffer_atomic_add_f32 v211, v16, s[8:11], s22 offen offset:320
    buffer_atomic_add_f32 v215, v16, s[8:11], s22 offen offset:384
la0_W_p2_skip:
    s_add_u32 s42, s42, 7168
    s_add_u32 s43, s43, 114688
    s_add_u32 s44, s44, 57344
    s_bitcmp0_b32 s37, 3
    s_cbranch_scc1 la0_W_p3_skip
    v_mov_b32 v96, v237
    v_mov_b32 v100, v238
    v_mov_b32 v104, v239
    v_mov_b32 v108, v240
    v_mov_b32 v112, v241
    v_mov_b32 v116, v242
    v_mov_b32 v120, v243
    s_cmp_eq_u32 s33, 0
    s_cbranch_scc1 la0_W_p3_go
    s_mov_b32 s91, 0
    v_mov_b32 v2, 0
la0_W_p3:
    buffer_load_dword v3, v2, s[8:11], s45 offen offset:384 sc1
    s_waitcnt vmcnt(0)
    v_cmp_eq_u32 vcc, 0, v3
    s_cbranch_vccz la0_W_p3_go
    s_sleep 2
    s_add_u32 s91, s91, 1
    s_cmp_lt_u32 s91, s90
    s_cbranch_scc1 la0_W_p3
    s_mov_b32 s90, 0
    s_branch la0_W_p3_go
la0_W_p3_go:
    s_waitcnt vmcnt(50)
    buffer_load_dwordx4 v[80:83], v12, s[8:11], s42 offen offset:0 sc1
    buffer_load_dwordx4 v[84:87], v12, s[8:11], s42 offen offset:64 sc1
    buffer_load_dwordx4 v[88:91], v12, s[8:11], s42 offen offset:128 sc1
    buffer_load_dwordx4 v[92:95], v13, s[8:11], s42 offen sc1
    s_waitcnt vmcnt(3)
    v_mfma_f32_16x16x32_bf16 v[124:127], v[80:83], a[208:211], 0
    v_mfma_f32_16x16x32_bf16 v[128:131], v[80:83], a[224:227], 0
    s_waitcnt vmcnt(2)
    v_mfma_f32_16x16x32_bf16 v[124:127], v[84:87], a[212:215], v[124:127]
    v_mfma_f32_16x16x32_bf16 v[128:131], v[84:87], a[228:231], v[128:131]
    s_waitcnt vmcnt(1)
    v_mfma_f32_16x16x32_bf16 v[124:127], v[88:91], a[216:219], v[124:127]
    v_mfma_f32_16x16x32_bf16 v[128:131], v[88:91], a[232:235], v[128:131]
    s_waitcnt vmcnt(0)
    v_mfma_f32_16x16x32_bf16 v[124:127], v[92:95], a[220:223], v[124:127]
    v_mfma_f32_16x16x32_bf16 v[128:131], v[92:95], a[236:239], v[128:131]
    s_nop 7
    v_mov_b32 v126, v128
    v_mov_b32 v127, v129
    ds_write_b128 v17, v[124:127] offset:53248
    s_waitcnt lgkmcnt(0)
    s_barrier
    ds_read_b128 v[160:163], v7 offset:53248
    ds_read_b128 v[164:167], v7 offset:54272
    ds_read_b128 v[168:171], v7 offset:55296
    ds_read_b128 v[172:175], v7 offset:56320
    s_waitcnt lgkmcnt(0)
    v_pk_add_f32 v[160:161], v[160:161], v[164:165]
    v_pk_add_f32 v[168:169], v[168:169], v[172:173]
    v_pk_add_f32 v[124:125], v[160:161], v[168:169]
    v_pk_add_f32 v[162:163], v[162:163], v[166:167]
    v_pk_add_f32 v[170:171], v[170:171], v[174:175]
    v_pk_add_f32 v[126:127], v[162:163], v[170:171]
    v_max_f32 v148, v124, v125
    v_max3_f32 v148, v148, v68, v69
    v_max3_f32 v148, v148, v70, v71
    v_mov_b32 v149, v148
    s_nop 1
    v_permlane16_swap_b32 v148, v149
    v_max_f32 v148, v148, v149
    v_mov_b32 v149, v148
    s_nop 1
    v_permlane32_swap_b32 v148, v149
    v_max_f32 v148, v148, v149
    v_sub_f32 v124, v124, v148
    v_sub_f32 v125, v125, v148
    v_sub_f32 v68, v68, v148
    v_sub_f32 v69, v69, v148
    v_sub_f32 v70, v70, v148
    v_sub_f32 v71, v71, v148
    v_exp_f32 v124, v124
    v_exp_f32 v125, v125
    v_exp_f32 v68, v68
    v_exp_f32 v69, v69
    v_exp_f32 v70, v70
    v_exp_f32 v71, v71
    v_add_f32 v148, v124, v125
    v_add_f32 v148, v148, v68
    v_add_f32 v148, v148, v69
    v_add_f32 v148, v148, v70
    v_add_f32 v148, v148, v71
    v_mov_b32 v149, v148
    s_nop 1
    v_permlane16_swap_b32 v148, v149
    v_add_f32 v148, v148, v149
    v_mov_b32 v149, v148
    s_nop 1
    v_permlane32_swap_b32 v148, v149
    v_add_f32 v148, v148, v149
    v_rcp_f32 v148, v148
    s_nop 0
    v_mul_f32 v124, v124, v148
    v_mul_f32 v125, v125, v148
    v_mul_f32 v68, v68, v148
    v_mul_f32 v69, v69, v148
    v_mul_f32 v70, v70, v148
    v_mul_f32 v71, v71, v148
    v_cvt_pk_bf16_f32 v140, v124, v125
    v_cvt_pk_bf16_f32 v132, v68, v69
    v_cvt_pk_bf16_f32 v134, v70, v71
    v_mov_b32 v133, 0
    v_mov_b32 v135, 0
    v_max_f32 v150, v126, v127
    v_max3_f32 v150, v150, v72, v73
    v_max3_f32 v150, v150, v74, v75
    v_max3_f32 v150, v150, v76, v77
    v_max3_f32 v150, v150, v78, v79
    v_mov_b32 v151, v150
    s_nop 1
    v_permlane16_swap_b32 v150, v151
    v_max_f32 v150, v150, v151
    v_mov_b32 v151, v150
    s_nop 1
    v_permlane32_swap_b32 v150, v151
    v_max_f32 v150, v150, v151
    v_sub_f32 v126, v126, v150
    v_sub_f32 v127, v127, v150
    v_sub_f32 v72, v72, v150
    v_sub_f32 v73, v73, v150
    v_sub_f32 v74, v74, v150
    v_sub_f32 v75, v75, v150
    v_sub_f32 v76, v76, v150
    v_sub_f32 v77, v77, v150
    v_sub_f32 v78, v78, v150
    v_sub_f32 v79, v79, v150
    v_exp_f32 v126, v126
    v_exp_f32 v127, v127
    v_exp_f32 v72, v72
    v_exp_f32 v73, v73
    v_exp_f32 v74, v74
    v_exp_f32 v75, v75
    v_exp_f32 v76, v76
    v_exp_f32 v77, v77
    v_exp_f32 v78, v78
    v_exp_f32 v79, v79
    v_add_f32 v150, v126, v127
    v_add_f32 v150, v150, v72
    v_add_f32 v150, v150, v73
    v_add_f32 v150, v150, v74
    v_add_f32 v150, v150, v75
    v_add_f32 v150, v150, v76
    v_add_f32 v150, v150, v77
    v_add_f32 v150, v150, v78
    v_add_f32 v150, v150, v79
    v_mov_b32 v151, v150
    s_nop 1
    v_permlane16_swap_b32 v150, v151
    v_add_f32 v150, v150, v151
    v_mov_b32 v151, v150
    s_nop 1
    v_permlane32_swap_b32 v150, v151
    v_add_f32 v150, v150, v151
    v_rcp_f32 v150, v150
    s_nop 0
    v_mul_f32 v126, v126, v150
    v_mul_f32 v127, v127, v150
    v_mul_f32 v72, v72, v150
    v_mul_f32 v73, v73, v150
    v_mul_f32 v74, v74, v150
    v_mul_f32 v75, v75, v150
    v_mul_f32 v76, v76, v150
    v_mul_f32 v77, v77, v150
    v_mul_f32 v78, v78, v150
    v_mul_f32 v79, v79, v150
    v_cvt_pk_bf16_f32 v144, v126, v127
    v_cvt_pk_bf16_f32 v136, v72, v73
    v_cvt_pk_bf16_f32 v138, v74, v75
    v_cvt_pk_bf16_f32 v137, v76, v77
    v_cvt_pk_bf16_f32 v139, v78, v79
    v_mfma_f32_16x16x32_bf16 v[160:163], v[132:135], a[84:87], 0
    v_mfma_f32_16x16x32_bf16 v[164:167], v[132:135], a[88:91], 0
    v_mfma_f32_16x16x32_bf16 v[168:171], v[132:135], a[92:95], 0
    v_mfma_f32_16x16x32_bf16 v[172:175], v[132:135], a[96:99], 0
    v_mfma_f32_16x16x32_bf16 v[176:179], v[132:135], a[100:103], 0
    v_mfma_f32_16x16x32_bf16 v[180:183], v[132:135], a[104:107], 0
    v_mfma_f32_16x16x32_bf16 v[184:187], v[132:135], a[108:111], 0
    v_mfma_f32_16x16x32_bf16 v[188:191], v[136:139], a[84:87], 0
    v_mfma_f32_16x16x32_bf16 v[192:195], v[136:139], a[88:91], 0
    v_mfma_f32_16x16x32_bf16 v[196:199], v[136:139], a[92:95], 0
    v_mfma_f32_16x16x32_bf16 v[200:203], v[136:139], a[96:99], 0
    v_mfma_f32_16x16x32_bf16 v[204:207], v[136:139], a[100:103], 0
    v_mfma_f32_16x16x32_bf16 v[208:211], v[136:139], a[104:107], 0
    v_mfma_f32_16x16x32_bf16 v[212:215], v[136:139], a[108:111], 0
    s_cmp_eq_u32 s33, 0
    s_cbranch_scc1 la0_W_p3_wok
    s_mov_b32 s91, 0
la0_W_p3_w:
    buffer_load_dword v3, v15, s[8:11], s41 offen offset:2048 sc1
    s_waitcnt vmcnt(0)
    v_cmp_eq_u32 vcc, 0, v3
    s_cbranch_vccz la0_W_p3_wl
    s_sleep 1
    s_add_u32 s91, s91, 1
    s_cmp_lt_u32 s91, s90
    s_cbranch_scc1 la0_W_p3_w
    s_mov_b32 s90, 0
    s_branch la0_W_p3_wl
la0_W_p3_wl:
    s_add_u32 s22, s43, 4096
    buffer_load_dword v96, v14, s[8:11], s43 offen offset:0 sc1
    buffer_load_dword v100, v14, s[8:11], s43 offen offset:1024 sc1
    buffer_load_dword v104, v14, s[8:11], s43 offen offset:2048 sc1
    buffer_load_dword v108, v14, s[8:11], s43 offen offset:3072 sc1
    buffer_load_dword v112, v14, s[8:11], s22 offen offset:0 sc1
    buffer_load_dword v116, v14, s[8:11], s22 offen offset:1024 sc1
    buffer_load_dword v120, v14, s[8:11], s22 offen offset:2048 sc1
    s_waitcnt vmcnt(0)
la0_W_p3_wok:
    v_mfma_f32_16x16x32_bf16 v[160:163], v[140:143], v[96:99], v[160:163]
    v_mfma_f32_16x16x32_bf16 v[164:167], v[140:143], v[100:103], v[164:167]
    v_mfma_f32_16x16x32_bf16 v[168:171], v[140:143], v[104:107], v[168:171]
    v_mfma_f32_16x16x32_bf16 v[172:175], v[140:143], v[108:111], v[172:175]
    v_mfma_f32_16x16x32_bf16 v[176:179], v[140:143], v[112:115], v[176:179]
    v_mfma_f32_16x16x32_bf16 v[180:183], v[140:143], v[116:119], v[180:183]
    v_mfma_f32_16x16x32_bf16 v[184:187], v[140:143], v[120:123], v[184:187]
    v_mfma_f32_16x16x32_bf16 v[188:191], v[144:147], v[96:99], v[188:191]
    v_mfma_f32_16x16x32_bf16 v[192:195], v[144:147], v[100:103], v[192:195]
    v_mfma_f32_16x16x32_bf16 v[196:199], v[144:147], v[104:107], v[196:199]
    v_mfma_f32_16x16x32_bf16 v[200:203], v[144:147], v[108:111], v[200:203]
    v_mfma_f32_16x16x32_bf16 v[204:207], v[144:147], v[112:115], v[204:207]
    v_mfma_f32_16x16x32_bf16 v[208:211], v[144:147], v[116:119], v[208:211]
    v_mfma_f32_16x16x32_bf16 v[212:215], v[144:147], v[120:123], v[212:215]
    s_add_u32 s22, s44, 0
    buffer_atomic_add_f32 v160, v16, s[8:11], s22 offen offset:0
    buffer_atomic_add_f32 v164, v16, s[8:11], s22 offen offset:64
    buffer_atomic_add_f32 v168, v16, s[8:11], s22 offen offset:128
    buffer_atomic_add_f32 v172, v16, s[8:11], s22 offen offset:192
    buffer_atomic_add_f32 v176, v16, s[8:11], s22 offen offset:256
    buffer_atomic_add_f32 v180, v16, s[8:11], s22 offen offset:320
    buffer_atomic_add_f32 v184, v16, s[8:11], s22 offen offset:384
    s_add_u32 s22, s44, 1792
    buffer_atomic_add_f32 v161, v16, s[8:11], s22 offen offset:0
    buffer_atomic_add_f32 v165, v16, s[8:11], s22 offen offset:64
    buffer_atomic_add_f32 v169, v16, s[8:11], s22 offen offset:128
    buffer_atomic_add_f32 v173, v16, s[8:11], s22 offen offset:192
    buffer_atomic_add_f32 v177, v16, s[8:11], s22 offen offset:256
    buffer_atomic_add_f32 v181, v16, s[8:11], s22 offen offset:320
    buffer_atomic_add_f32 v185, v16, s[8:11], s22 offen offset:384
    s_add_u32 s22, s44, 3584
    buffer_atomic_add_f32 v162, v16, s[8:11], s22 offen offset:0
    buffer_atomic_add_f32 v166, v16, s[8:11], s22 offen offset:64
    buffer_atomic_add_f32 v170, v16, s[8:11], s22 offen offset:128
    buffer_atomic_add_f32 v174, v16, s[8:11], s22 offen offset:192
    buffer_atomic_add_f32 v178, v16, s[8:11], s22 offen offset:256
    buffer_atomic_add_f32 v182, v16, s[8:11], s22 offen offset:320
    buffer_atomic_add_f32 v186, v16, s[8:11], s22 offen offset:384
    s_add_u32 s22, s44, 5376
    buffer_atomic_add_f32 v163, v16, s[8:11], s22 offen offset:0
    buffer_atomic_add_f32 v167, v16, s[8:11], s22 offen offset:64
    buffer_atomic_add_f32 v171, v16, s[8:11], s22 offen offset:128
    buffer_atomic_add_f32 v175, v16, s[8:11], s22 offen offset:192
    buffer_atomic_add_f32 v179, v16, s[8:11], s22 offen offset:256
    buffer_atomic_add_f32 v183, v16, s[8:11], s22 offen offset:320
    buffer_atomic_add_f32 v187, v16, s[8:11], s22 offen offset:384
    s_add_u32 s22, s44, 28672
    buffer_atomic_add_f32 v188, v16, s[8:11], s22 offen offset:0
    buffer_atomic_add_f32 v192, v16, s[8:11], s22 offen offset:64
    buffer_atomic_add_f32 v196, v16, s[8:11], s22 offen offset:128
    buffer_atomic_add_f32 v200, v16, s[8:11], s22 offen offset:192
    buffer_atomic_add_f32 v204, v16, s[8:11], s22 offen offset:256
    buffer_atomic_add_f32 v208, v16, s[8:11], s22 offen offset:320
    buffer_atomic_add_f32 v212, v16, s[8:11], s22 offen offset:384
    s_add_u32 s22, s44, 30464
    buffer_atomic_add_f32 v189, v16, s[8:11], s22 offen offset:0
    buffer_atomic_add_f32 v193, v16, s[8:11], s22 offen offset:64
    buffer_atomic_add_f32 v197, v16, s[8:11], s22 offen offset:128
    buffer_atomic_add_f32 v201, v16, s[8:11], s22 offen offset:192
    buffer_atomic_add_f32 v205, v16, s[8:11], s22 offen offset:256
    buffer_atomic_add_f32 v209, v16, s[8:11], s22 offen offset:320
    buffer_atomic_add_f32 v213, v16, s[8:11], s22 offen offset:384
    s_add_u32 s22, s44, 32256
    buffer_atomic_add_f32 v190, v16, s[8:11], s22 offen offset:0
    buffer_atomic_add_f32 v194, v16, s[8:11], s22 offen offset:64
    buffer_atomic_add_f32 v198, v16, s[8:11], s22 offen offset:128
    buffer_atomic_add_f32 v202, v16, s[8:11], s22 offen offset:192
    buffer_atomic_add_f32 v206, v16, s[8:11], s22 offen offset:256
    buffer_atomic_add_f32 v210, v16, s[8:11], s22 offen offset:320
    buffer_atomic_add_f32 v214, v16, s[8:11], s22 offen offset:384
    s_add_u32 s22, s44, 34048
    buffer_atomic_add_f32 v191, v16, s[8:11], s22 offen offset:0
    buffer_atomic_add_f32 v195, v16, s[8:11], s22 offen offset:64
    buffer_atomic_add_f32 v199, v16, s[8:11], s22 offen offset:128
    buffer_atomic_add_f32 v203, v16, s[8:11], s22 offen offset:192
    buffer_atomic_add_f32 v207, v16, s[8:11], s22 offen offset:256
    buffer_atomic_add_f32 v211, v16, s[8:11], s22 offen offset:320
    buffer_atomic_add_f32 v215, v16, s[8:11], s22 offen offset:384
la0_W_p3_skip:
    s_add_u32 s42, s42, 7168
    s_add_u32 s43, s43, 114688
    s_add_u32 s44, s44, 57344
    s_waitcnt vmcnt(0)
    s_barrier
    s_cmp_lg_u32 s3, 0
    s_cbranch_scc1 la0_W_cnt
    s_lshl_b32 s22, s30, 9
    s_add_u32 s22, s22, 0x4298000
    s_add_u32 s22, s22, s84
    v_lshlrev_b32 v3, 7, v1
    v_mov_b32 v2, 1
    s_mov_b32 exec_lo, s37
    s_mov_b32 exec_hi, 0
    buffer_atomic_add v2, v3, s[8:11], s22 offen
    s_mov_b64 exec, -1
la0_W_cnt:
    s_mov_b32 s86, -1
    s_cmp_ge_u32 s30, 9
    s_cbranch_scc1 la0_W_scan0
    s_cmp_gt_u32 s30, 6
    s_cselect_b32 s22, 1, 0
    s_sub_u32 s22, s30, s22
    s_lshl_b32 s22, s22, 2
    s_lshr_b32 s22, 0x76532140, s22
    s_and_b32 s22, s22, 7
    s_cmp_eq_u32 s30, 6
    s_cselect_b32 s22, 8, s22
    s_add_u32 s22, s22, 14
    s_lshl_b32 s22, s22, 4
    s_add_u32 s86, s22, s31
    s_branch la0_W_scan0
la0_W_scan:
    s_barrier
la0_W_scan0:
    s_cmp_lg_u32 s3, 0
    s_cbranch_scc1 la0_W_scan_w
    v_lshlrev_b32 v2, 5, v1
    s_mov_b32 s22, 0x4283000
    s_add_u32 s22, s22, s84
    buffer_load_dword v12, v2, s[8:11], s22 offen sc1
    s_add_u32 s22, s22, 2048
    buffer_load_dword v13, v2, s[8:11], s22 offen sc1
    s_add_u32 s22, s22, 2048
    buffer_load_dword v14, v2, s[8:11], s22 offen sc1
    s_add_u32 s22, s22, 2048
    buffer_load_dword v15, v2, s[8:11], s22 offen sc1
    s_add_u32 s22, s22, 2048
    buffer_load_dword v16, v2, s[8:11], s22 offen sc1
    s_add_u32 s22, s22, 2048
    buffer_load_dword v17, v2, s[8:11], s22 offen sc1
    s_add_u32 s22, s22, 2048
    s_waitcnt vmcnt(0)
    s_mov_b32 s23, -1
    v_cmp_eq_u32 vcc, 0, v17
    s_nop 1
    s_and_b32 vcc_hi, vcc_hi, 0x1ffff
    s_ff1_i32_b64 s22, vcc
    s_cmp_lt_i32 s22, 0
    s_cbranch_scc1 la0_W_sc5
    s_add_u32 s23, s22, 320
la0_W_sc5:
    v_cmp_eq_u32 vcc, 0, v16
    s_nop 0
    s_ff1_i32_b64 s22, vcc
    s_cmp_lt_i32 s22, 0
    s_cbranch_scc1 la0_W_sc4
    s_add_u32 s23, s22, 256
la0_W_sc4:
    v_cmp_eq_u32 vcc, 0, v15
    s_nop 0
    s_ff1_i32_b64 s22, vcc
    s_cmp_lt_i32 s22, 0
    s_cbranch_scc1 la0_W_sc3
    s_add_u32 s23, s22, 192
la0_W_sc3:
    v_cmp_eq_u32 vcc, 0, v14
    s_nop 0
    s_ff1_i32_b64 s22, vcc
    s_cmp_lt_i32 s22, 0
    s_cbranch_scc1 la0_W_sc2
    s_add_u32 s23, s22, 128
la0_W_sc2:
    v_cmp_eq_u32 vcc, 0, v13
    s_nop 0
    s_ff1_i32_b64 s22, vcc
    s_cmp_lt_i32 s22, 0
    s_cbranch_scc1 la0_W_sc1
    s_add_u32 s23, s22, 64
la0_W_sc1:
    v_cmp_eq_u32 vcc, 0, v12
    s_nop 0
    s_ff1_i32_b64 s22, vcc
    s_cmp_lt_i32 s22, 0
    s_cbranch_scc1 la0_W_sc0
    s_add_u32 s23, s22, 0
la0_W_sc0:
    v_mov_b32 v2, s23
    v_mov_b32 v3, 0x27ff4
    ds_write_b32 v3, v2
    s_waitcnt lgkmcnt(0)
la0_W_scan_w:
    s_barrier
    v_mov_b32 v3, 0x27ff4
    ds_read_b32 v2, v3
    s_waitcnt lgkmcnt(0)
    v_readfirstlane_b32 s22, v2
    s_nop 0
    s_cmp_lt_i32 s22, 0
    s_cbranch_scc1 la0_job
    s_cmp_lt_u32 s22, 224
    s_cbranch_scc1 la0_W_pick
    s_cmp_lt_i32 s86, 0
    s_cselect_b32 s22, s22, s86
    s_mov_b32 s86, -1
la0_W_pick:
    s_cmp_eq_u32 s22, 368
    s_cbranch_scc1 la0_tr
    s_lshr_b32 s30, s22, 4
    s_and_b32 s31, s22, 15
    s_mov_b32 s32, -1
    s_cmp_lt_u32 s30, 14
    s_cbranch_scc1 la0_W_item
    s_cmp_lg_u32 s30, 22
    s_cbranch_scc1 la0_W_dec
    s_mov_b32 s30, 13
    s_mov_b32 s32, 12
    s_branch la0_W_item
la0_W_dec:
    s_sub_u32 s30, s30, 14
    s_and_b32 s32, s30, 3
    s_lshr_b32 s30, s30, 2
    s_add_u32 s30, s30, 14
    s_branch la0_W_item
la0_tr:
    s_load_dwordx4 s[36:39], s[0:1], 64
    s_load_dwordx4 s[40:43], s[0:1], 80
    s_cmp_lg_u32 s3, 0
    s_cbranch_scc1 la0_tr_c
    s_mov_b32 s22, 0x4285e00
    s_add_u32 s22, s22, s84
    v_mov_b32 v2, 1
    v_mov_b32 v3, 0
    s_mov_b64 exec, 1
    buffer_atomic_add v2, v3, s[8:11], s22 offen sc0
    v_mov_b32 v3, 0x27ff8
    s_waitcnt vmcnt(0)
    ds_write_b32 v3, v2
    s_mov_b64 exec, -1
la0_tr_c:
    s_waitcnt lgkmcnt(0)
    s_barrier
    v_mov_b32 v3, 0x27ff8
    ds_read_b32 v2, v3
    s_waitcnt lgkmcnt(0)
    v_readfirstlane_b32 s22, v2
    s_nop 0
    s_or_b32 s22, s22, s89
    s_cmp_lg_u32 s22, 0
    s_cbranch_scc1 la0_tr_done
    s_lshl_b32 s22, s3, 6
    v_add_u32 v8, s22, v1
    v_and_b32 v4, 31, v8
    v_lshrrev_b32 v5, 5, v8
    v_bfe_u32 v9, v8, 2, 1
    v_mul_u32_u24 v9, 0x3800, v9
    v_bfe_u32 v2, v8, 3, 2
    v_lshlrev_b32 v2, 6, v2
    v_add_u32 v9, v9, v2
    v_bfe_u32 v2, v8, 0, 2
    v_lshlrev_b32 v2, 4, v2
    v_add_u32 v9, v9, v2
    v_bfe_u32 v2, v8, 7, 1
    v_lshlrev_b32 v2, 10, v2
    v_add_u32 v9, v9, v2
    v_bfe_u32 v2, v8, 5, 2
    v_lshlrev_b32 v2, 8, v2
    v_add_u32 v9, v9, v2
    v_bfe_u32 v10, v8, 4, 1
    v_mul_u32_u24 v10, 0x3800, v10
    v_bfe_u32 v2, v8, 0, 4
    v_lshlrev_b32 v2, 4, v2
    v_add_u32 v10, v10, v2
    v_bfe_u32 v2, v8, 7, 1
    v_lshlrev_b32 v2, 10, v2
    v_add_u32 v10, v10, v2
    v_bfe_u32 v2, v8, 5, 2
    v_lshlrev_b32 v2, 8, v2
    v_add_u32 v10, v10, v2
    s_mov_b32 s44, 0
la0_tr_loop:
    s_cmp_lt_u32 s44, 16
    s_cbranch_scc1 la0_tr_q
    s_cmp_lt_u32 s44, 18
    s_cbranch_scc1 la0_tr_kv
    s_mov_b32 s16, s42
    s_and_b32 s17, s43, 0xffff
    s_mov_b32 s18, 401408
    s_mov_b32 s53, 896
    s_sub_u32 s45, s44, 18
    s_lshl_b32 s54, s45, 6
    s_mov_b32 s55, 32
    s_mul_i32 s56, s45, 28672
    s_add_u32 s56, s56, 0xcc0000
    s_branch la0_tr_go
la0_tr_q:
    s_mov_b32 s16, s36
    s_and_b32 s17, s37, 0xffff
    s_mov_b32 s18, 401408
    s_mov_b32 s53, 896
    s_mul_i32 s54, s44, 56
    s_mov_b32 s55, 28
    s_mul_i32 s56, s44, 28672
    s_add_u32 s56, s56, 0xc40000
    s_branch la0_tr_go
la0_tr_kv:
    s_cmp_eq_u32 s44, 16
    s_cselect_b32 s16, s38, s40
    s_cselect_b32 s17, s39, s41
    s_and_b32 s17, s17, 0xffff
    s_mov_b32 s18, 25088
    s_mov_b32 s53, 56
    s_mov_b32 s54, 0
    s_mov_b32 s55, 28
    s_mul_i32 s56, s44, 28672
    s_add_u32 s56, s56, 0xc40000
la0_tr_go:
    s_mov_b32 s19, 0x20000
    s_lshl_b32 s57, s53, 3
    v_mul_lo_u32 v6, v5, s57
    v_lshl_add_u32 v6, v4, 1, v6
    v_add_u32 v6, s54, v6
    v_cmp_gt_u32 vcc, s55, v4
    v_mov_b32 v2, 0x40000000
    s_nop 0
    v_cndmask_b32 v6, v2, v6, vcc
    s_cmp_eq_u32 s44, 17
    s_cselect_b64 vcc, -1, 0
    v_cndmask_b32 v7, v9, v10, vcc
    s_mul_i32 s58, s53, 0
    buffer_load_ushort v16, v6, s[16:19], s58 offen
    s_mul_i32 s58, s53, 1
    buffer_load_ushort v17, v6, s[16:19], s58 offen
    s_mul_i32 s58, s53, 2
    buffer_load_ushort v18, v6, s[16:19], s58 offen
    s_mul_i32 s58, s53, 3
    buffer_load_ushort v19, v6, s[16:19], s58 offen
    s_mul_i32 s58, s53, 4
    buffer_load_ushort v20, v6, s[16:19], s58 offen
    s_mul_i32 s58, s53, 5
    buffer_load_ushort v21, v6, s[16:19], s58 offen
    s_mul_i32 s58, s53, 6
    buffer_load_ushort v22, v6, s[16:19], s58 offen
    s_mul_i32 s58, s53, 7
    buffer_load_ushort v23, v6, s[16:19], s58 offen
    s_mul_i32 s58, s53, 64
    buffer_load_ushort v24, v6, s[16:19], s58 offen
    s_mul_i32 s58, s53, 65
    buffer_load_ushort v25, v6, s[16:19], s58 offen
    s_mul_i32 s58, s53, 66
    buffer_load_ushort v26, v6, s[16:19], s58 offen
    s_mul_i32 s58, s53, 67
    buffer_load_ushort v27, v6, s[16:19], s58 offen
    s_mul_i32 s58, s53, 68
    buffer_load_ushort v28, v6, s[16:19], s58 offen
    s_mul_i32 s58, s53, 69
    buffer_load_ushort v29, v6, s[16:19], s58 offen
    s_mul_i32 s58, s53, 70
    buffer_load_ushort v30, v6, s[16:19], s58 offen
    s_mul_i32 s58, s53, 71
    buffer_load_ushort v31, v6, s[16:19], s58 offen
    s_mul_i32 s58, s53, 128
    buffer_load_ushort v32, v6, s[16:19], s58 offen
    s_mul_i32 s58, s53, 129
    buffer_load_ushort v33, v6, s[16:19], s58 offen
    s_mul_i32 s58, s53, 130
    buffer_load_ushort v34, v6, s[16:19], s58 offen
    s_mul_i32 s58, s53, 131
    buffer_load_ushort v35, v6, s[16:19], s58 offen
    s_mul_i32 s58, s53, 132
    buffer_load_ushort v36, v6, s[16:19], s58 offen
    s_mul_i32 s58, s53, 133
    buffer_load_ushort v37, v6, s[16:19], s58 offen
    s_mul_i32 s58, s53, 134
    buffer_load_ushort v38, v6, s[16:19], s58 offen
    s_mul_i32 s58, s53, 135
    buffer_load_ushort v39, v6, s[16:19], s58 offen
    s_mul_i32 s58, s53, 192
    buffer_load_ushort v40, v6, s[16:19], s58 offen
    s_mul_i32 s58, s53, 193
    buffer_load_ushort v41, v6, s[16:19], s58 offen
    s_mul_i32 s58, s53, 194
    buffer_load_ushort v42, v6, s[16:19], s58 offen
    s_mul_i32 s58, s53, 195
    buffer_load_ushort v43, v6, s[16:19], s58 offen
    s_mul_i32 s58, s53, 196
    buffer_load_ushort v44, v6, s[16:19], s58 offen
    s_mul_i32 s58, s53, 197
    buffer_load_ushort v45, v6, s[16:19], s58 offen
    s_mul_i32 s58, s53, 198
    buffer_load_ushort v46, v6, s[16:19], s58 offen
    s_mul_i32 s58, s53, 199
    buffer_load_ushort v47, v6, s[16:19], s58 offen
    s_mul_i32 s58, s53, 256
    buffer_load_ushort v48, v6, s[16:19], s58 offen
    s_mul_i32 s58, s53, 257
    buffer_load_ushort v49, v6, s[16:19], s58 offen
    s_mul_i32 s58, s53, 258
    buffer_load_ushort v50, v6, s[16:19], s58 offen
    s_mul_i32 s58, s53, 259
    buffer_load_ushort v51, v6, s[16:19], s58 offen
    s_mul_i32 s58, s53, 260
    buffer_load_ushort v52, v6, s[16:19], s58 offen
    s_mul_i32 s58, s53, 261
    buffer_load_ushort v53, v6, s[16:19], s58 offen
    s_mul_i32 s58, s53, 262
    buffer_load_ushort v54, v6, s[16:19], s58 offen
    s_mul_i32 s58, s53, 263
    buffer_load_ushort v55, v6, s[16:19], s58 offen
    s_mul_i32 s58, s53, 320
    buffer_load_ushort v56, v6, s[16:19], s58 offen
    s_mul_i32 s58, s53, 321
    buffer_load_ushort v57, v6, s[16:19], s58 offen
    s_mul_i32 s58, s53, 322
    buffer_load_ushort v58, v6, s[16:19], s58 offen
    s_mul_i32 s58, s53, 323
    buffer_load_ushort v59, v6, s[16:19], s58 offen
    s_mul_i32 s58, s53, 324
    buffer_load_ushort v60, v6, s[16:19], s58 offen
    s_mul_i32 s58, s53, 325
    buffer_load_ushort v61, v6, s[16:19], s58 offen
    s_mul_i32 s58, s53, 326
    buffer_load_ushort v62, v6, s[16:19], s58 offen
    s_mul_i32 s58, s53, 327
    buffer_load_ushort v63, v6, s[16:19], s58 offen
    s_mul_i32 s58, s53, 384
    buffer_load_ushort v64, v6, s[16:19], s58 offen
    s_mul_i32 s58, s53, 385
    buffer_load_ushort v65, v6, s[16:19], s58 offen
    s_mul_i32 s58, s53, 386
    buffer_load_ushort v66, v6, s[16:19], s58 offen
    s_mul_i32 s58, s53, 387
    buffer_load_ushort v67, v6, s[16:19], s58 offen
    s_mul_i32 s58, s53, 388
    buffer_load_ushort v68, v6, s[16:19], s58 offen
    s_mul_i32 s58, s53, 389
    buffer_load_ushort v69, v6, s[16:19], s58 offen
    s_mul_i32 s58, s53, 390
    buffer_load_ushort v70, v6, s[16:19], s58 offen
    s_mul_i32 s58, s53, 391
    buffer_load_ushort v71, v6, s[16:19], s58 offen
    s_waitcnt vmcnt(48)
    v_lshl_or_b32 v80, v17, 16, v16
    v_lshl_or_b32 v81, v19, 16, v18
    v_lshl_or_b32 v82, v21, 16, v20
    v_lshl_or_b32 v83, v23, 16, v22
    buffer_store_dwordx4 v[80:83], v7, s[8:11], s56 offen offset:0 sc1
    s_waitcnt vmcnt(41)
    v_lshl_or_b32 v84, v25, 16, v24
    v_lshl_or_b32 v85, v27, 16, v26
    v_lshl_or_b32 v86, v29, 16, v28
    v_lshl_or_b32 v87, v31, 16, v30
    buffer_store_dwordx4 v[84:87], v7, s[8:11], s56 offen offset:2048 sc1
    s_add_u32 s56, s56, 4096
    s_waitcnt vmcnt(34)
    v_lshl_or_b32 v88, v33, 16, v32
    v_lshl_or_b32 v89, v35, 16, v34
    v_lshl_or_b32 v90, v37, 16, v36
    v_lshl_or_b32 v91, v39, 16, v38
    buffer_store_dwordx4 v[88:91], v7, s[8:11], s56 offen offset:0 sc1
    s_waitcnt vmcnt(27)
    v_lshl_or_b32 v92, v41, 16, v40
    v_lshl_or_b32 v93, v43, 16, v42
    v_lshl_or_b32 v94, v45, 16, v44
    v_lshl_or_b32 v95, v47, 16, v46
    buffer_store_dwordx4 v[92:95], v7, s[8:11], s56 offen offset:2048 sc1
    s_add_u32 s56, s56, 4096
    s_waitcnt vmcnt(20)
    v_lshl_or_b32 v96, v49, 16, v48
    v_lshl_or_b32 v97, v51, 16, v50
    v_lshl_or_b32 v98, v53, 16, v52
    v_lshl_or_b32 v99, v55, 16, v54
    buffer_store_dwordx4 v[96:99], v7, s[8:11], s56 offen offset:0 sc1
    s_waitcnt vmcnt(13)
    v_lshl_or_b32 v100, v57, 16, v56
    v_lshl_or_b32 v101, v59, 16, v58
    v_lshl_or_b32 v102, v61, 16, v60
    v_lshl_or_b32 v103, v63, 16, v62
    buffer_store_dwordx4 v[100:103], v7, s[8:11], s56 offen offset:2048 sc1
    s_add_u32 s56, s56, 4096
    s_waitcnt vmcnt(6)
    v_lshl_or_b32 v104, v65, 16, v64
    v_lshl_or_b32 v105, v67, 16, v66
    v_lshl_or_b32 v106, v69, 16, v68
    v_lshl_or_b32 v107, v71, 16, v70
    buffer_store_dwordx4 v[104:107], v7, s[8:11], s56 offen offset:0 sc1
    s_waitcnt vmcnt(0)
    s_cmp_lg_u32 s44, 17
    s_cbranch_scc1 la0_tr_nf
    s_barrier
    s_cmp_lg_u32 s3, 0
    s_cbranch_scc1 la0_tr_nf
    s_mov_b32 s22, 0x1180880
    v_mov_b32 v2, 1
    v_mov_b32 v3, 0
    s_mov_b64 exec, 1
    buffer_store_dword v2, v3, s[8:11], s22 offen sc1
    s_mov_b64 exec, -1
la0_tr_nf:
    s_add_u32 s44, s44, 1
    s_cmp_lt_u32 s44, 18
    s_cbranch_scc1 la0_tr_loop
    s_mov_b32 s16, s42
    s_and_b32 s17, s43, 0xffff
    s_mov_b32 s18, 401408
    s_mov_b32 s44, 0
    v_mul_u32_u24 v11, 7168, v5
    v_lshl_add_u32 v11, v4, 1, v11
    v_cmp_gt_u32 vcc, 6, v5
    v_mov_b32 v2, 0x40000000
    s_nop 0
    v_cndmask_b32 v12, v2, v11, vcc
    v_bfe_u32 v9, v8, 2, 1
    v_lshlrev_b32 v9, 14, v9
    v_bfe_u32 v2, v8, 3, 2
    v_lshlrev_b32 v2, 6, v2
    v_add_u32 v9, v9, v2
    v_bfe_u32 v2, v8, 0, 2
    v_lshlrev_b32 v2, 4, v2
    v_add_u32 v9, v9, v2
    v_bfe_u32 v2, v8, 7, 1
    v_lshlrev_b32 v2, 10, v2
    v_add_u32 v9, v9, v2
    v_bfe_u32 v2, v8, 5, 2
    v_lshlrev_b32 v2, 8, v2
    v_add_u32 v9, v9, v2
    v_bfe_u32 v10, v8, 4, 1
    v_lshlrev_b32 v10, 14, v10
    v_bfe_u32 v2, v8, 0, 4
    v_lshlrev_b32 v2, 4, v2
    v_add_u32 v10, v10, v2
    v_bfe_u32 v2, v8, 7, 1
    v_lshlrev_b32 v2, 10, v2
    v_add_u32 v10, v10, v2
    v_bfe_u32 v2, v8, 5, 2
    v_lshlrev_b32 v2, 8, v2
    v_add_u32 v10, v10, v2
la0_tr2_loop:
    s_lshl_b32 s54, s44, 6
    s_lshl_b32 s56, s44, 15
    s_add_u32 s55, s56, 0xcc0000
    s_add_u32 s56, s56, 0xd30000
    s_add_u32 s58, s54, 0
    buffer_load_ushort v16, v11, s[16:19], s58 offen
    s_add_u32 s58, s54, 896
    buffer_load_ushort v17, v11, s[16:19], s58 offen
    s_add_u32 s58, s54, 1792
    buffer_load_ushort v18, v11, s[16:19], s58 offen
    s_add_u32 s58, s54, 2688
    buffer_load_ushort v19, v11, s[16:19], s58 offen
    s_add_u32 s58, s54, 3584
    buffer_load_ushort v20, v11, s[16:19], s58 offen
    s_add_u32 s58, s54, 4480
    buffer_load_ushort v21, v11, s[16:19], s58 offen
    s_add_u32 s58, s54, 5376
    buffer_load_ushort v22, v11, s[16:19], s58 offen
    s_add_u32 s58, s54, 6272
    buffer_load_ushort v23, v11, s[16:19], s58 offen
    s_add_u32 s58, s54, 57344
    buffer_load_ushort v24, v12, s[16:19], s58 offen
    s_add_u32 s58, s54, 58240
    buffer_load_ushort v25, v12, s[16:19], s58 offen
    s_add_u32 s58, s54, 59136
    buffer_load_ushort v26, v12, s[16:19], s58 offen
    s_add_u32 s58, s54, 60032
    buffer_load_ushort v27, v12, s[16:19], s58 offen
    s_add_u32 s58, s54, 60928
    buffer_load_ushort v28, v12, s[16:19], s58 offen
    s_add_u32 s58, s54, 61824
    buffer_load_ushort v29, v12, s[16:19], s58 offen
    s_add_u32 s58, s54, 62720
    buffer_load_ushort v30, v12, s[16:19], s58 offen
    s_add_u32 s58, s54, 63616
    buffer_load_ushort v31, v12, s[16:19], s58 offen
    s_add_u32 s58, s54, 100352
    buffer_load_ushort v32, v11, s[16:19], s58 offen
    s_add_u32 s58, s54, 101248
    buffer_load_ushort v33, v11, s[16:19], s58 offen
    s_add_u32 s58, s54, 102144
    buffer_load_ushort v34, v11, s[16:19], s58 offen
    s_add_u32 s58, s54, 103040
    buffer_load_ushort v35, v11, s[16:19], s58 offen
    s_add_u32 s58, s54, 103936
    buffer_load_ushort v36, v11, s[16:19], s58 offen
    s_add_u32 s58, s54, 104832
    buffer_load_ushort v37, v11, s[16:19], s58 offen
    s_add_u32 s58, s54, 105728
    buffer_load_ushort v38, v11, s[16:19], s58 offen
    s_add_u32 s58, s54, 106624
    buffer_load_ushort v39, v11, s[16:19], s58 offen
    s_add_u32 s58, s54, 157696
    buffer_load_ushort v40, v12, s[16:19], s58 offen
    s_add_u32 s58, s54, 158592
    buffer_load_ushort v41, v12, s[16:19], s58 offen
    s_add_u32 s58, s54, 159488
    buffer_load_ushort v42, v12, s[16:19], s58 offen
    s_add_u32 s58, s54, 160384
    buffer_load_ushort v43, v12, s[16:19], s58 offen
    s_add_u32 s58, s54, 161280
    buffer_load_ushort v44, v12, s[16:19], s58 offen
    s_add_u32 s58, s54, 162176
    buffer_load_ushort v45, v12, s[16:19], s58 offen
    s_add_u32 s58, s54, 163072
    buffer_load_ushort v46, v12, s[16:19], s58 offen
    s_add_u32 s58, s54, 163968
    buffer_load_ushort v47, v12, s[16:19], s58 offen
    s_waitcnt vmcnt(24)
    v_lshl_or_b32 v80, v17, 16, v16
    v_lshl_or_b32 v81, v19, 16, v18
    v_lshl_or_b32 v82, v21, 16, v20
    v_lshl_or_b32 v83, v23, 16, v22
    buffer_store_dwordx4 v[80:83], v10, s[8:11], s56 offen offset:0 sc1
    buffer_store_dwordx4 v[80:83], v9, s[8:11], s55 offen offset:0 sc1
    s_waitcnt vmcnt(18)
    v_lshl_or_b32 v84, v25, 16, v24
    v_lshl_or_b32 v85, v27, 16, v26
    v_lshl_or_b32 v86, v29, 16, v28
    v_lshl_or_b32 v87, v31, 16, v30
    buffer_store_dwordx4 v[84:87], v10, s[8:11], s56 offen offset:2048 sc1
    buffer_store_dwordx4 v[84:87], v9, s[8:11], s55 offen offset:2048 sc1
    s_add_u32 s56, s56, 4096
    s_add_u32 s55, s55, 4096
    s_waitcnt vmcnt(12)
    v_lshl_or_b32 v88, v33, 16, v32
    v_lshl_or_b32 v89, v35, 16, v34
    v_lshl_or_b32 v90, v37, 16, v36
    v_lshl_or_b32 v91, v39, 16, v38
    buffer_store_dwordx4 v[88:91], v10, s[8:11], s56 offen offset:0 sc1
    buffer_store_dwordx4 v[88:91], v9, s[8:11], s55 offen offset:0 sc1
    s_waitcnt vmcnt(6)
    v_lshl_or_b32 v92, v41, 16, v40
    v_lshl_or_b32 v93, v43, 16, v42
    v_lshl_or_b32 v94, v45, 16, v44
    v_lshl_or_b32 v95, v47, 16, v46
    buffer_store_dwordx4 v[92:95], v10, s[8:11], s56 offen offset:2048 sc1
    buffer_store_dwordx4 v[92:95], v9, s[8:11], s55 offen offset:2048 sc1
    s_add_u32 s56, s56, 4096
    s_add_u32 s55, s55, 4096
    s_waitcnt vmcnt(0)
    s_add_u32 s58, s54, 200704
    buffer_load_ushort v16, v11, s[16:19], s58 offen
    s_add_u32 s58, s54, 201600
    buffer_load_ushort v17, v11, s[16:19], s58 offen
    s_add_u32 s58, s54, 202496
    buffer_load_ushort v18, v11, s[16:19], s58 offen
    s_add_u32 s58, s54, 203392
    buffer_load_ushort v19, v11, s[16:19], s58 offen
    s_add_u32 s58, s54, 204288
    buffer_load_ushort v20, v11, s[16:19], s58 offen
    s_add_u32 s58, s54, 205184
    buffer_load_ushort v21, v11, s[16:19], s58 offen
    s_add_u32 s58, s54, 206080
    buffer_load_ushort v22, v11, s[16:19], s58 offen
    s_add_u32 s58, s54, 206976
    buffer_load_ushort v23, v11, s[16:19], s58 offen
    s_add_u32 s58, s54, 258048
    buffer_load_ushort v24, v12, s[16:19], s58 offen
    s_add_u32 s58, s54, 258944
    buffer_load_ushort v25, v12, s[16:19], s58 offen
    s_add_u32 s58, s54, 259840
    buffer_load_ushort v26, v12, s[16:19], s58 offen
    s_add_u32 s58, s54, 260736
    buffer_load_ushort v27, v12, s[16:19], s58 offen
    s_add_u32 s58, s54, 261632
    buffer_load_ushort v28, v12, s[16:19], s58 offen
    s_add_u32 s58, s54, 262528
    buffer_load_ushort v29, v12, s[16:19], s58 offen
    s_add_u32 s58, s54, 263424
    buffer_load_ushort v30, v12, s[16:19], s58 offen
    s_add_u32 s58, s54, 264320
    buffer_load_ushort v31, v12, s[16:19], s58 offen
    s_add_u32 s58, s54, 301056
    buffer_load_ushort v32, v11, s[16:19], s58 offen
    s_add_u32 s58, s54, 301952
    buffer_load_ushort v33, v11, s[16:19], s58 offen
    s_add_u32 s58, s54, 302848
    buffer_load_ushort v34, v11, s[16:19], s58 offen
    s_add_u32 s58, s54, 303744
    buffer_load_ushort v35, v11, s[16:19], s58 offen
    s_add_u32 s58, s54, 304640
    buffer_load_ushort v36, v11, s[16:19], s58 offen
    s_add_u32 s58, s54, 305536
    buffer_load_ushort v37, v11, s[16:19], s58 offen
    s_add_u32 s58, s54, 306432
    buffer_load_ushort v38, v11, s[16:19], s58 offen
    s_add_u32 s58, s54, 307328
    buffer_load_ushort v39, v11, s[16:19], s58 offen
    s_add_u32 s58, s54, 358400
    buffer_load_ushort v40, v12, s[16:19], s58 offen
    s_add_u32 s58, s54, 359296
    buffer_load_ushort v41, v12, s[16:19], s58 offen
    s_add_u32 s58, s54, 360192
    buffer_load_ushort v42, v12, s[16:19], s58 offen
    s_add_u32 s58, s54, 361088
    buffer_load_ushort v43, v12, s[16:19], s58 offen
    s_add_u32 s58, s54, 361984
    buffer_load_ushort v44, v12, s[16:19], s58 offen
    s_add_u32 s58, s54, 362880
    buffer_load_ushort v45, v12, s[16:19], s58 offen
    s_add_u32 s58, s54, 363776
    buffer_load_ushort v46, v12, s[16:19], s58 offen
    s_add_u32 s58, s54, 364672
    buffer_load_ushort v47, v12, s[16:19], s58 offen
    s_waitcnt vmcnt(24)
    v_lshl_or_b32 v80, v17, 16, v16
    v_lshl_or_b32 v81, v19, 16, v18
    v_lshl_or_b32 v82, v21, 16, v20
    v_lshl_or_b32 v83, v23, 16, v22
    buffer_store_dwordx4 v[80:83], v10, s[8:11], s56 offen offset:0 sc1
    buffer_store_dwordx4 v[80:83], v9, s[8:11], s55 offen offset:0 sc1
    s_waitcnt vmcnt(18)
    v_lshl_or_b32 v84, v25, 16, v24
    v_lshl_or_b32 v85, v27, 16, v26
    v_lshl_or_b32 v86, v29, 16, v28
    v_lshl_or_b32 v87, v31, 16, v30
    buffer_store_dwordx4 v[84:87], v10, s[8:11], s56 offen offset:2048 sc1
    buffer_store_dwordx4 v[84:87], v9, s[8:11], s55 offen offset:2048 sc1
    s_add_u32 s56, s56, 4096
    s_add_u32 s55, s55, 4096
    s_waitcnt vmcnt(12)
    v_lshl_or_b32 v88, v33, 16, v32
    v_lshl_or_b32 v89, v35, 16, v34
    v_lshl_or_b32 v90, v37, 16, v36
    v_lshl_or_b32 v91, v39, 16, v38
    buffer_store_dwordx4 v[88:91], v10, s[8:11], s56 offen offset:0 sc1
    buffer_store_dwordx4 v[88:91], v9, s[8:11], s55 offen offset:0 sc1
    s_waitcnt vmcnt(6)
    v_lshl_or_b32 v92, v41, 16, v40
    v_lshl_or_b32 v93, v43, 16, v42
    v_lshl_or_b32 v94, v45, 16, v44
    v_lshl_or_b32 v95, v47, 16, v46
    buffer_store_dwordx4 v[92:95], v10, s[8:11], s56 offen offset:2048 sc1
    buffer_store_dwordx4 v[92:95], v9, s[8:11], s55 offen offset:2048 sc1
    s_add_u32 s56, s56, 4096
    s_add_u32 s55, s55, 4096
    s_waitcnt vmcnt(0)
    s_add_u32 s44, s44, 1
    s_cmp_lt_u32 s44, 14
    s_cbranch_scc1 la0_tr2_loop
    s_barrier
    s_cmp_lg_u32 s3, 0
    s_cbranch_scc1 la0_tr_done
    s_mov_b32 s22, 0x1180900
    v_mov_b32 v2, 1
    v_mov_b32 v3, 0
    s_mov_b64 exec, 1
    buffer_store_dword v2, v3, s[8:11], s22 offen sc1
    s_mov_b64 exec, -1
la0_tr_done:
    s_cmp_eq_u32 s21, 0
    s_cbranch_scc1 la0_job
    s_branch la0_W_scan
la0_O_job:
    s_mov_b32 s32, -1
    v_lshlrev_b32 v7, 4, v1
    s_lshr_b32 s23, s35, 1
    s_lshl_b32 s23, s23, 2
    s_add_u32 s23, s23, s3
    s_lshl_b32 s22, s23, 7
    s_add_u32 s22, s22, 69836800
    v_mov_b32 v2, s22
    v_mov_b32 v3, 18352384
    v_cmp_eq_u32 vcc, 0, v1
    s_nop 1
    v_cndmask_b32 v2, v3, v2, vcc
    s_mov_b32 s91, 0
la0_O_w:
    buffer_load_dword v3, v2, s[8:11], 0 offen sc1
    s_waitcnt vmcnt(0)
    v_cmp_eq_u32 vcc, 0, v3
    s_cbranch_vccz la0_O_wok
    s_sleep 2
    s_add_u32 s91, s91, 1
    s_cmp_lt_u32 s91, s90
    s_cbranch_scc1 la0_O_w
    s_mov_b32 s90, 0
    s_branch la0_O_wok
la0_O_wok:
    s_lshl_b32 s40, s3, 2
    s_cmp_eq_u32 s3, 3
    s_cselect_b32 s40, 11, s40
    s_mov_b32 s16, s8
    s_mov_b32 s17, s9
    s_mov_b32 s19, s11
    s_cmp_lt_u32 s3, 2
    s_cselect_b32 s18, s10, 0
    s_cselect_b32 s39, 1.0, 0
    s_lshl_b32 s22, s23, 13
    s_and_b32 s23, s35, 1
    s_lshl_b32 s23, s23, 12
    s_add_u32 s22, s22, s23
    s_add_u32 s22, s22, 67108864
    s_lshl_b32 s23, s3, 12
    s_mov_b32 m0, s23
    s_nop 0
    buffer_load_dwordx4 v7, s[8:11], s22 offen offset:0 sc1 lds
    buffer_load_dwordx4 v7, s[8:11], s22 offen offset:1024 sc1 lds
    buffer_load_dwordx4 v7, s[8:11], s22 offen offset:2048 sc1 lds
    buffer_load_dwordx4 v7, s[8:11], s22 offen offset:3072 sc1 lds
    s_lshl_b32 s22, s40, 15
    s_add_u32 s22, s22, 0xcc0000
    s_add_u32 s50, s22, 0
    s_add_u32 s51, s22, 16384
    s_add_u32 s52, s22, 32768
    s_add_u32 s53, s22, 49152
    s_add_u32 s54, s22, 65536
    s_add_u32 s55, s22, 81920
    s_add_u32 s56, s22, 98304
    s_add_u32 s57, s22, 114688
    v_bfe_u32 v8, v1, 0, 4
    v_mul_u32_u24 v8, 0x700, v8
    v_bfe_u32 v2, v1, 4, 2
    v_lshlrev_b32 v2, 5, v2
    v_add_u32 v8, v8, v2
    s_mul_i32 s41, s35, 28672
    s_lshl_b32 s23, s40, 7
    s_add_u32 s41, s41, s23
    s_add_u32 s41, s41, 0xe00000
    v_add_u32 v10, 4096, v7
    s_cmp_eq_u32 s36, 0
    s_cbranch_scc1 la0_O_pre
    buffer_load_dwordx4 a[168:171], v7, s[8:11], s50 offen offset:0 sc1
    buffer_load_dwordx4 a[172:175], v7, s[8:11], s51 offen offset:0 sc1
    buffer_load_dwordx4 a[176:179], v7, s[8:11], s52 offen offset:0 sc1
    buffer_load_dwordx4 a[180:183], v7, s[8:11], s53 offen offset:0 sc1
    buffer_load_dwordx4 a[184:187], v7, s[8:11], s54 offen offset:0 sc1
    buffer_load_dwordx4 a[188:191], v7, s[8:11], s55 offen offset:0 sc1
    buffer_load_dwordx4 a[192:195], v7, s[16:19], s56 offen offset:0 sc1
    buffer_load_dwordx4 a[196:199], v7, s[16:19], s57 offen offset:0 sc1
    buffer_load_dwordx4 a[200:203], v7, s[8:11], s50 offen offset:1024 sc1
    buffer_load_dwordx4 a[204:207], v7, s[8:11], s51 offen offset:1024 sc1
    buffer_load_dwordx4 a[208:211], v7, s[8:11], s52 offen offset:1024 sc1
    buffer_load_dwordx4 a[212:215], v7, s[8:11], s53 offen offset:1024 sc1
    buffer_load_dwordx4 a[216:219], v7, s[8:11], s54 offen offset:1024 sc1
    buffer_load_dwordx4 a[220:223], v7, s[8:11], s55 offen offset:1024 sc1
    buffer_load_dwordx4 a[224:227], v7, s[16:19], s56 offen offset:1024 sc1
    buffer_load_dwordx4 a[228:231], v7, s[16:19], s57 offen offset:1024 sc1
    buffer_load_dwordx4 a[232:235], v7, s[8:11], s50 offen offset:2048 sc1
    buffer_load_dwordx4 a[236:239], v7, s[8:11], s51 offen offset:2048 sc1
    buffer_load_dwordx4 a[240:243], v7, s[8:11], s52 offen offset:2048 sc1
    buffer_load_dwordx4 a[244:247], v7, s[8:11], s53 offen offset:2048 sc1
    buffer_load_dwordx4 a[248:251], v7, s[8:11], s54 offen offset:2048 sc1
    buffer_load_dwordx4 a[252:255], v7, s[8:11], s55 offen offset:2048 sc1
    buffer_load_dwordx4 v[200:203], v7, s[16:19], s56 offen offset:2048 sc1
    buffer_load_dwordx4 v[204:207], v7, s[16:19], s57 offen offset:2048 sc1
    buffer_load_dwordx4 v[208:211], v7, s[8:11], s50 offen offset:3072 sc1
    buffer_load_dwordx4 v[212:215], v7, s[8:11], s51 offen offset:3072 sc1
    buffer_load_dwordx4 v[216:219], v7, s[8:11], s52 offen offset:3072 sc1
    buffer_load_dwordx4 v[220:223], v7, s[8:11], s53 offen offset:3072 sc1
    buffer_load_dwordx4 v[224:227], v7, s[8:11], s54 offen offset:3072 sc1
    buffer_load_dwordx4 v[228:231], v7, s[8:11], s55 offen offset:3072 sc1
    buffer_load_dwordx4 v[232:235], v7, s[16:19], s56 offen offset:3072 sc1
    buffer_load_dwordx4 v[236:239], v7, s[16:19], s57 offen offset:3072 sc1
    s_waitcnt vmcnt(0)
la0_O_pre:
    buffer_load_dwordx4 a[128:131], v10, s[8:11], s50 offen offset:0 sc1
    buffer_load_dwordx4 a[132:135], v10, s[8:11], s51 offen offset:0 sc1
    buffer_load_dwordx4 a[136:139], v10, s[8:11], s52 offen offset:0 sc1
    buffer_load_dwordx4 a[140:143], v10, s[8:11], s53 offen offset:0 sc1
    buffer_load_dwordx4 a[144:147], v10, s[8:11], s54 offen offset:0 sc1
    buffer_load_dwordx4 a[148:151], v10, s[8:11], s55 offen offset:0 sc1
    buffer_load_dwordx4 a[152:155], v10, s[16:19], s56 offen offset:0 sc1
    buffer_load_dwordx4 a[156:159], v10, s[16:19], s57 offen offset:0 sc1
    buffer_load_dwordx4 a[0:3], v10, s[8:11], s50 offen offset:1024 sc1
    buffer_load_dwordx4 a[4:7], v10, s[8:11], s51 offen offset:1024 sc1
    buffer_load_dwordx4 a[8:11], v10, s[8:11], s52 offen offset:1024 sc1
    buffer_load_dwordx4 a[12:15], v10, s[8:11], s53 offen offset:1024 sc1
    buffer_load_dwordx4 a[16:19], v10, s[8:11], s54 offen offset:1024 sc1
    buffer_load_dwordx4 a[20:23], v10, s[8:11], s55 offen offset:1024 sc1
    buffer_load_dwordx4 a[24:27], v10, s[16:19], s56 offen offset:1024 sc1
    buffer_load_dwordx4 a[28:31], v10, s[16:19], s57 offen offset:1024 sc1
    buffer_load_dwordx4 a[32:35], v10, s[8:11], s50 offen offset:2048 sc1
    buffer_load_dwordx4 a[36:39], v10, s[8:11], s51 offen offset:2048 sc1
    buffer_load_dwordx4 a[40:43], v10, s[8:11], s52 offen offset:2048 sc1
    buffer_load_dwordx4 a[44:47], v10, s[8:11], s53 offen offset:2048 sc1
    buffer_load_dwordx4 a[48:51], v10, s[8:11], s54 offen offset:2048 sc1
    buffer_load_dwordx4 a[52:55], v10, s[8:11], s55 offen offset:2048 sc1
    buffer_load_dwordx4 a[56:59], v10, s[16:19], s56 offen offset:2048 sc1
    buffer_load_dwordx4 a[60:63], v10, s[16:19], s57 offen offset:2048 sc1
    buffer_load_dwordx4 a[64:67], v10, s[8:11], s50 offen offset:3072 sc1
    buffer_load_dwordx4 a[68:71], v10, s[8:11], s51 offen offset:3072 sc1
    buffer_load_dwordx4 a[72:75], v10, s[8:11], s52 offen offset:3072 sc1
    buffer_load_dwordx4 a[76:79], v10, s[8:11], s53 offen offset:3072 sc1
    buffer_load_dwordx4 a[80:83], v10, s[8:11], s54 offen offset:3072 sc1
    buffer_load_dwordx4 a[84:87], v10, s[8:11], s55 offen offset:3072 sc1
    buffer_load_dwordx4 a[88:91], v10, s[16:19], s56 offen offset:3072 sc1
    buffer_load_dwordx4 a[92:95], v10, s[16:19], s57 offen offset:3072 sc1
    v_add_u32 v10, 4096, v10
    buffer_load_dwordx4 a[96:99], v10, s[8:11], s50 offen offset:0 sc1
    buffer_load_dwordx4 a[100:103], v10, s[8:11], s51 offen offset:0 sc1
    buffer_load_dwordx4 a[104:107], v10, s[8:11], s52 offen offset:0 sc1
    buffer_load_dwordx4 a[108:111], v10, s[8:11], s53 offen offset:0 sc1
    buffer_load_dwordx4 a[112:115], v10, s[8:11], s54 offen offset:0 sc1
    buffer_load_dwordx4 a[116:119], v10, s[8:11], s55 offen offset:0 sc1
    buffer_load_dwordx4 a[120:123], v10, s[16:19], s56 offen offset:0 sc1
    buffer_load_dwordx4 a[124:127], v10, s[16:19], s57 offen offset:0 sc1
    buffer_load_dwordx4 v[64:67], v8, s[8:11], s41 offen offset:0 sc1
    buffer_load_dwordx4 v[68:71], v8, s[8:11], s41 offen offset:16 sc1
    buffer_load_dwordx4 v[72:75], v8, s[8:11], s41 offen offset:128 sc1
    buffer_load_dwordx4 v[76:79], v8, s[8:11], s41 offen offset:144 sc1
    buffer_load_dwordx4 v[80:83], v8, s[8:11], s41 offen offset:256 sc1
    buffer_load_dwordx4 v[84:87], v8, s[8:11], s41 offen offset:272 sc1
    buffer_load_dwordx4 v[88:91], v8, s[16:19], s41 offen offset:384 sc1
    buffer_load_dwordx4 v[92:95], v8, s[16:19], s41 offen offset:400 sc1
    s_waitcnt vmcnt(48)
    s_barrier
    ds_read_b128 v[24:27], v7
    ds_read_b128 v[28:31], v7 offset:1024
    s_waitcnt lgkmcnt(1)
    v_mfma_f32_16x16x32_bf16 v[32:35], a[168:171], v[24:27], 0
    v_mfma_f32_16x16x32_bf16 v[36:39], a[172:175], v[24:27], 0
    v_mfma_f32_16x16x32_bf16 v[40:43], a[176:179], v[24:27], 0
    v_mfma_f32_16x16x32_bf16 v[44:47], a[180:183], v[24:27], 0
    v_mfma_f32_16x16x32_bf16 v[48:51], a[184:187], v[24:27], 0
    v_mfma_f32_16x16x32_bf16 v[52:55], a[188:191], v[24:27], 0
    v_mfma_f32_16x16x32_bf16 v[56:59], a[192:195], v[24:27], 0
    v_mfma_f32_16x16x32_bf16 v[60:63], a[196:199], v[24:27], 0
    ds_read_b128 v[24:27], v7 offset:2048
    s_waitcnt lgkmcnt(1)
    v_mfma_f32_16x16x32_bf16 v[32:35], a[200:203], v[28:31], v[32:35]
    v_mfma_f32_16x16x32_bf16 v[36:39], a[204:207], v[28:31], v[36:39]
    v_mfma_f32_16x16x32_bf16 v[40:43], a[208:211], v[28:31], v[40:43]
    v_mfma_f32_16x16x32_bf16 v[44:47], a[212:215], v[28:31], v[44:47]
    v_mfma_f32_16x16x32_bf16 v[48:51], a[216:219], v[28:31], v[48:51]
    v_mfma_f32_16x16x32_bf16 v[52:55], a[220:223], v[28:31], v[52:55]
    v_mfma_f32_16x16x32_bf16 v[56:59], a[224:227], v[28:31], v[56:59]
    v_mfma_f32_16x16x32_bf16 v[60:63], a[228:231], v[28:31], v[60:63]
    ds_read_b128 v[28:31], v7 offset:3072
    s_waitcnt lgkmcnt(1)
    v_mfma_f32_16x16x32_bf16 v[32:35], a[232:235], v[24:27], v[32:35]
    v_mfma_f32_16x16x32_bf16 v[36:39], a[236:239], v[24:27], v[36:39]
    v_mfma_f32_16x16x32_bf16 v[40:43], a[240:243], v[24:27], v[40:43]
    v_mfma_f32_16x16x32_bf16 v[44:47], a[244:247], v[24:27], v[44:47]
    v_mfma_f32_16x16x32_bf16 v[48:51], a[248:251], v[24:27], v[48:51]
    v_mfma_f32_16x16x32_bf16 v[52:55], a[252:255], v[24:27], v[52:55]
    v_mfma_f32_16x16x32_bf16 v[56:59], v[200:203], v[24:27], v[56:59]
    v_mfma_f32_16x16x32_bf16 v[60:63], v[204:207], v[24:27], v[60:63]
    ds_read_b128 v[24:27], v7 offset:4096
    s_waitcnt lgkmcnt(1)
    v_mfma_f32_16x16x32_bf16 v[32:35], v[208:211], v[28:31], v[32:35]
    v_mfma_f32_16x16x32_bf16 v[36:39], v[212:215], v[28:31], v[36:39]
    v_mfma_f32_16x16x32_bf16 v[40:43], v[216:219], v[28:31], v[40:43]
    v_mfma_f32_16x16x32_bf16 v[44:47], v[220:223], v[28:31], v[44:47]
    v_mfma_f32_16x16x32_bf16 v[48:51], v[224:227], v[28:31], v[48:51]
    v_mfma_f32_16x16x32_bf16 v[52:55], v[228:231], v[28:31], v[52:55]
    v_mfma_f32_16x16x32_bf16 v[56:59], v[232:235], v[28:31], v[56:59]
    v_mfma_f32_16x16x32_bf16 v[60:63], v[236:239], v[28:31], v[60:63]
    ds_read_b128 v[28:31], v7 offset:5120
    s_waitcnt vmcnt(40)
    s_waitcnt lgkmcnt(1)
    v_mfma_f32_16x16x32_bf16 v[32:35], a[128:131], v[24:27], v[32:35]
    v_mfma_f32_16x16x32_bf16 v[36:39], a[132:135], v[24:27], v[36:39]
    v_mfma_f32_16x16x32_bf16 v[40:43], a[136:139], v[24:27], v[40:43]
    v_mfma_f32_16x16x32_bf16 v[44:47], a[140:143], v[24:27], v[44:47]
    v_mfma_f32_16x16x32_bf16 v[48:51], a[144:147], v[24:27], v[48:51]
    v_mfma_f32_16x16x32_bf16 v[52:55], a[148:151], v[24:27], v[52:55]
    v_mfma_f32_16x16x32_bf16 v[56:59], a[152:155], v[24:27], v[56:59]
    v_mfma_f32_16x16x32_bf16 v[60:63], a[156:159], v[24:27], v[60:63]
    buffer_load_dwordx4 a[128:131], v10, s[8:11], s50 offen offset:1024 sc1
    buffer_load_dwordx4 a[132:135], v10, s[8:11], s51 offen offset:1024 sc1
    buffer_load_dwordx4 a[136:139], v10, s[8:11], s52 offen offset:1024 sc1
    buffer_load_dwordx4 a[140:143], v10, s[8:11], s53 offen offset:1024 sc1
    buffer_load_dwordx4 a[144:147], v10, s[8:11], s54 offen offset:1024 sc1
    buffer_load_dwordx4 a[148:151], v10, s[8:11], s55 offen offset:1024 sc1
    buffer_load_dwordx4 a[152:155], v10, s[16:19], s56 offen offset:1024 sc1
    buffer_load_dwordx4 a[156:159], v10, s[16:19], s57 offen offset:1024 sc1
    ds_read_b128 v[24:27], v7 offset:6144
    s_waitcnt vmcnt(40)
    s_waitcnt lgkmcnt(1)
    v_mfma_f32_16x16x32_bf16 v[32:35], a[0:3], v[28:31], v[32:35]
    v_mfma_f32_16x16x32_bf16 v[36:39], a[4:7], v[28:31], v[36:39]
    v_mfma_f32_16x16x32_bf16 v[40:43], a[8:11], v[28:31], v[40:43]
    v_mfma_f32_16x16x32_bf16 v[44:47], a[12:15], v[28:31], v[44:47]
    v_mfma_f32_16x16x32_bf16 v[48:51], a[16:19], v[28:31], v[48:51]
    v_mfma_f32_16x16x32_bf16 v[52:55], a[20:23], v[28:31], v[52:55]
    v_mfma_f32_16x16x32_bf16 v[56:59], a[24:27], v[28:31], v[56:59]
    v_mfma_f32_16x16x32_bf16 v[60:63], a[28:31], v[28:31], v[60:63]
    buffer_load_dwordx4 a[0:3], v10, s[8:11], s50 offen offset:2048 sc1
    buffer_load_dwordx4 a[4:7], v10, s[8:11], s51 offen offset:2048 sc1
    buffer_load_dwordx4 a[8:11], v10, s[8:11], s52 offen offset:2048 sc1
    buffer_load_dwordx4 a[12:15], v10, s[8:11], s53 offen offset:2048 sc1
    buffer_load_dwordx4 a[16:19], v10, s[8:11], s54 offen offset:2048 sc1
    buffer_load_dwordx4 a[20:23], v10, s[8:11], s55 offen offset:2048 sc1
    buffer_load_dwordx4 a[24:27], v10, s[16:19], s56 offen offset:2048 sc1
    buffer_load_dwordx4 a[28:31], v10, s[16:19], s57 offen offset:2048 sc1
    ds_read_b128 v[28:31], v7 offset:7168
    s_waitcnt vmcnt(40)
    s_waitcnt lgkmcnt(1)
    v_mfma_f32_16x16x32_bf16 v[32:35], a[32:35], v[24:27], v[32:35]
    v_mfma_f32_16x16x32_bf16 v[36:39], a[36:39], v[24:27], v[36:39]
    v_mfma_f32_16x16x32_bf16 v[40:43], a[40:43], v[24:27], v[40:43]
    v_mfma_f32_16x16x32_bf16 v[44:47], a[44:47], v[24:27], v[44:47]
    v_mfma_f32_16x16x32_bf16 v[48:51], a[48:51], v[24:27], v[48:51]
    v_mfma_f32_16x16x32_bf16 v[52:55], a[52:55], v[24:27], v[52:55]
    v_mfma_f32_16x16x32_bf16 v[56:59], a[56:59], v[24:27], v[56:59]
    v_mfma_f32_16x16x32_bf16 v[60:63], a[60:63], v[24:27], v[60:63]
    buffer_load_dwordx4 a[32:35], v10, s[8:11], s50 offen offset:3072 sc1
    buffer_load_dwordx4 a[36:39], v10, s[8:11], s51 offen offset:3072 sc1
    buffer_load_dwordx4 a[40:43], v10, s[8:11], s52 offen offset:3072 sc1
    buffer_load_dwordx4 a[44:47], v10, s[8:11], s53 offen offset:3072 sc1
    buffer_load_dwordx4 a[48:51], v10, s[8:11], s54 offen offset:3072 sc1
    buffer_load_dwordx4 a[52:55], v10, s[8:11], s55 offen offset:3072 sc1
    buffer_load_dwordx4 a[56:59], v10, s[16:19], s56 offen offset:3072 sc1
    buffer_load_dwordx4 a[60:63], v10, s[16:19], s57 offen offset:3072 sc1
    ds_read_b128 v[24:27], v7 offset:8192
    s_waitcnt vmcnt(40)
    s_waitcnt lgkmcnt(1)
    v_mfma_f32_16x16x32_bf16 v[32:35], a[64:67], v[28:31], v[32:35]
    v_mfma_f32_16x16x32_bf16 v[36:39], a[68:71], v[28:31], v[36:39]
    v_mfma_f32_16x16x32_bf16 v[40:43], a[72:75], v[28:31], v[40:43]
    v_mfma_f32_16x16x32_bf16 v[44:47], a[76:79], v[28:31], v[44:47]
    v_mfma_f32_16x16x32_bf16 v[48:51], a[80:83], v[28:31], v[48:51]
    v_mfma_f32_16x16x32_bf16 v[52:55], a[84:87], v[28:31], v[52:55]
    v_mfma_f32_16x16x32_bf16 v[56:59], a[88:91], v[28:31], v[56:59]
    v_mfma_f32_16x16x32_bf16 v[60:63], a[92:95], v[28:31], v[60:63]
    v_add_u32 v10, 4096, v10
    buffer_load_dwordx4 a[64:67], v10, s[8:11], s50 offen offset:0 sc1
    buffer_load_dwordx4 a[68:71], v10, s[8:11], s51 offen offset:0 sc1
    buffer_load_dwordx4 a[72:75], v10, s[8:11], s52 offen offset:0 sc1
    buffer_load_dwordx4 a[76:79], v10, s[8:11], s53 offen offset:0 sc1
    buffer_load_dwordx4 a[80:83], v10, s[8:11], s54 offen offset:0 sc1
    buffer_load_dwordx4 a[84:87], v10, s[8:11], s55 offen offset:0 sc1
    buffer_load_dwordx4 a[88:91], v10, s[16:19], s56 offen offset:0 sc1
    buffer_load_dwordx4 a[92:95], v10, s[16:19], s57 offen offset:0 sc1
    ds_read_b128 v[28:31], v7 offset:9216
    s_waitcnt vmcnt(40)
    s_waitcnt lgkmcnt(1)
    v_mfma_f32_16x16x32_bf16 v[32:35], a[96:99], v[24:27], v[32:35]
    v_mfma_f32_16x16x32_bf16 v[36:39], a[100:103], v[24:27], v[36:39]
    v_mfma_f32_16x16x32_bf16 v[40:43], a[104:107], v[24:27], v[40:43]
    v_mfma_f32_16x16x32_bf16 v[44:47], a[108:111], v[24:27], v[44:47]
    v_mfma_f32_16x16x32_bf16 v[48:51], a[112:115], v[24:27], v[48:51]
    v_mfma_f32_16x16x32_bf16 v[52:55], a[116:119], v[24:27], v[52:55]
    v_mfma_f32_16x16x32_bf16 v[56:59], a[120:123], v[24:27], v[56:59]
    v_mfma_f32_16x16x32_bf16 v[60:63], a[124:127], v[24:27], v[60:63]
    buffer_load_dwordx4 a[96:99], v10, s[8:11], s50 offen offset:1024 sc1
    buffer_load_dwordx4 a[100:103], v10, s[8:11], s51 offen offset:1024 sc1
    buffer_load_dwordx4 a[104:107], v10, s[8:11], s52 offen offset:1024 sc1
    buffer_load_dwordx4 a[108:111], v10, s[8:11], s53 offen offset:1024 sc1
    buffer_load_dwordx4 a[112:115], v10, s[8:11], s54 offen offset:1024 sc1
    buffer_load_dwordx4 a[116:119], v10, s[8:11], s55 offen offset:1024 sc1
    buffer_load_dwordx4 a[120:123], v10, s[16:19], s56 offen offset:1024 sc1
    buffer_load_dwordx4 a[124:127], v10, s[16:19], s57 offen offset:1024 sc1
    ds_read_b128 v[24:27], v7 offset:10240
    s_waitcnt vmcnt(32)
    s_waitcnt lgkmcnt(1)
    v_mfma_f32_16x16x32_bf16 v[32:35], a[128:131], v[28:31], v[32:35]
    v_mfma_f32_16x16x32_bf16 v[36:39], a[132:135], v[28:31], v[36:39]
    v_mfma_f32_16x16x32_bf16 v[40:43], a[136:139], v[28:31], v[40:43]
    v_mfma_f32_16x16x32_bf16 v[44:47], a[140:143], v[28:31], v[44:47]
    v_mfma_f32_16x16x32_bf16 v[48:51], a[144:147], v[28:31], v[48:51]
    v_mfma_f32_16x16x32_bf16 v[52:55], a[148:151], v[28:31], v[52:55]
    v_mfma_f32_16x16x32_bf16 v[56:59], a[152:155], v[28:31], v[56:59]
    v_mfma_f32_16x16x32_bf16 v[60:63], a[156:159], v[28:31], v[60:63]
    buffer_load_dwordx4 a[128:131], v10, s[8:11], s50 offen offset:2048 sc1
    buffer_load_dwordx4 a[132:135], v10, s[8:11], s51 offen offset:2048 sc1
    buffer_load_dwordx4 a[136:139], v10, s[8:11], s52 offen offset:2048 sc1
    buffer_load_dwordx4 a[140:143], v10, s[8:11], s53 offen offset:2048 sc1
    buffer_load_dwordx4 a[144:147], v10, s[8:11], s54 offen offset:2048 sc1
    buffer_load_dwordx4 a[148:151], v10, s[8:11], s55 offen offset:2048 sc1
    buffer_load_dwordx4 a[152:155], v10, s[16:19], s56 offen offset:2048 sc1
    buffer_load_dwordx4 a[156:159], v10, s[16:19], s57 offen offset:2048 sc1
    ds_read_b128 v[28:31], v7 offset:11264
    s_waitcnt vmcnt(32)
    s_waitcnt lgkmcnt(1)
    v_mfma_f32_16x16x32_bf16 v[32:35], a[0:3], v[24:27], v[32:35]
    v_mfma_f32_16x16x32_bf16 v[36:39], a[4:7], v[24:27], v[36:39]
    v_mfma_f32_16x16x32_bf16 v[40:43], a[8:11], v[24:27], v[40:43]
    v_mfma_f32_16x16x32_bf16 v[44:47], a[12:15], v[24:27], v[44:47]
    v_mfma_f32_16x16x32_bf16 v[48:51], a[16:19], v[24:27], v[48:51]
    v_mfma_f32_16x16x32_bf16 v[52:55], a[20:23], v[24:27], v[52:55]
    v_mfma_f32_16x16x32_bf16 v[56:59], a[24:27], v[24:27], v[56:59]
    v_mfma_f32_16x16x32_bf16 v[60:63], a[28:31], v[24:27], v[60:63]
    buffer_load_dwordx4 a[0:3], v10, s[8:11], s50 offen offset:3072 sc1
    buffer_load_dwordx4 a[4:7], v10, s[8:11], s51 offen offset:3072 sc1
    buffer_load_dwordx4 a[8:11], v10, s[8:11], s52 offen offset:3072 sc1
    buffer_load_dwordx4 a[12:15], v10, s[8:11], s53 offen offset:3072 sc1
    buffer_load_dwordx4 a[16:19], v10, s[8:11], s54 offen offset:3072 sc1
    buffer_load_dwordx4 a[20:23], v10, s[8:11], s55 offen offset:3072 sc1
    buffer_load_dwordx4 a[24:27], v10, s[16:19], s56 offen offset:3072 sc1
    buffer_load_dwordx4 a[28:31], v10, s[16:19], s57 offen offset:3072 sc1
    ds_read_b128 v[24:27], v7 offset:12288
    s_waitcnt vmcnt(32)
    s_waitcnt lgkmcnt(1)
    v_mfma_f32_16x16x32_bf16 v[32:35], a[32:35], v[28:31], v[32:35]
    v_mfma_f32_16x16x32_bf16 v[36:39], a[36:39], v[28:31], v[36:39]
    v_mfma_f32_16x16x32_bf16 v[40:43], a[40:43], v[28:31], v[40:43]
    v_mfma_f32_16x16x32_bf16 v[44:47], a[44:47], v[28:31], v[44:47]
    v_mfma_f32_16x16x32_bf16 v[48:51], a[48:51], v[28:31], v[48:51]
    v_mfma_f32_16x16x32_bf16 v[52:55], a[52:55], v[28:31], v[52:55]
    v_mfma_f32_16x16x32_bf16 v[56:59], a[56:59], v[28:31], v[56:59]
    v_mfma_f32_16x16x32_bf16 v[60:63], a[60:63], v[28:31], v[60:63]
    ds_read_b128 v[28:31], v7 offset:13312
    s_waitcnt vmcnt(24)
    s_waitcnt lgkmcnt(1)
    v_mfma_f32_16x16x32_bf16 v[32:35], a[64:67], v[24:27], v[32:35]
    v_mfma_f32_16x16x32_bf16 v[36:39], a[68:71], v[24:27], v[36:39]
    v_mfma_f32_16x16x32_bf16 v[40:43], a[72:75], v[24:27], v[40:43]
    v_mfma_f32_16x16x32_bf16 v[44:47], a[76:79], v[24:27], v[44:47]
    v_mfma_f32_16x16x32_bf16 v[48:51], a[80:83], v[24:27], v[48:51]
    v_mfma_f32_16x16x32_bf16 v[52:55], a[84:87], v[24:27], v[52:55]
    v_mfma_f32_16x16x32_bf16 v[56:59], a[88:91], v[24:27], v[56:59]
    v_mfma_f32_16x16x32_bf16 v[60:63], a[92:95], v[24:27], v[60:63]
    ds_read_b128 v[24:27], v7 offset:14336
    s_waitcnt vmcnt(16)
    s_waitcnt lgkmcnt(1)
    v_mfma_f32_16x16x32_bf16 v[32:35], a[96:99], v[28:31], v[32:35]
    v_mfma_f32_16x16x32_bf16 v[36:39], a[100:103], v[28:31], v[36:39]
    v_mfma_f32_16x16x32_bf16 v[40:43], a[104:107], v[28:31], v[40:43]
    v_mfma_f32_16x16x32_bf16 v[44:47], a[108:111], v[28:31], v[44:47]
    v_mfma_f32_16x16x32_bf16 v[48:51], a[112:115], v[28:31], v[48:51]
    v_mfma_f32_16x16x32_bf16 v[52:55], a[116:119], v[28:31], v[52:55]
    v_mfma_f32_16x16x32_bf16 v[56:59], a[120:123], v[28:31], v[56:59]
    v_mfma_f32_16x16x32_bf16 v[60:63], a[124:127], v[28:31], v[60:63]
    ds_read_b128 v[28:31], v7 offset:15360
    s_waitcnt vmcnt(8)
    s_waitcnt lgkmcnt(1)
    v_mfma_f32_16x16x32_bf16 v[32:35], a[128:131], v[24:27], v[32:35]
    v_mfma_f32_16x16x32_bf16 v[36:39], a[132:135], v[24:27], v[36:39]
    v_mfma_f32_16x16x32_bf16 v[40:43], a[136:139], v[24:27], v[40:43]
    v_mfma_f32_16x16x32_bf16 v[44:47], a[140:143], v[24:27], v[44:47]
    v_mfma_f32_16x16x32_bf16 v[48:51], a[144:147], v[24:27], v[48:51]
    v_mfma_f32_16x16x32_bf16 v[52:55], a[148:151], v[24:27], v[52:55]
    v_mfma_f32_16x16x32_bf16 v[56:59], a[152:155], v[24:27], v[56:59]
    v_mfma_f32_16x16x32_bf16 v[60:63], a[156:159], v[24:27], v[60:63]
    s_waitcnt vmcnt(0)
    s_waitcnt lgkmcnt(0)
    v_mfma_f32_16x16x32_bf16 v[32:35], a[0:3], v[28:31], v[32:35]
    v_mfma_f32_16x16x32_bf16 v[36:39], a[4:7], v[28:31], v[36:39]
    v_mfma_f32_16x16x32_bf16 v[40:43], a[8:11], v[28:31], v[40:43]
    v_mfma_f32_16x16x32_bf16 v[44:47], a[12:15], v[28:31], v[44:47]
    v_mfma_f32_16x16x32_bf16 v[48:51], a[16:19], v[28:31], v[48:51]
    v_mfma_f32_16x16x32_bf16 v[52:55], a[20:23], v[28:31], v[52:55]
    v_mfma_f32_16x16x32_bf16 v[56:59], a[24:27], v[28:31], v[56:59]
    v_mfma_f32_16x16x32_bf16 v[60:63], a[28:31], v[28:31], v[60:63]
    v_accvgpr_write_b32 a160, v32
    v_accvgpr_write_b32 a161, v33
    v_accvgpr_write_b32 a162, v34
    v_accvgpr_write_b32 a163, v35
    v_accvgpr_write_b32 a164, v36
    v_accvgpr_write_b32 a165, v37
    v_accvgpr_write_b32 a166, v38
    v_accvgpr_write_b32 a167, v39
    v_accvgpr_write_b32 a168, v40
    v_accvgpr_write_b32 a169, v41
    v_accvgpr_write_b32 a170, v42
    v_accvgpr_write_b32 a171, v43
    v_accvgpr_write_b32 a172, v44
    v_accvgpr_write_b32 a173, v45
    v_accvgpr_write_b32 a174, v46
    v_accvgpr_write_b32 a175, v47
    v_accvgpr_write_b32 a176, v48
    v_accvgpr_write_b32 a177, v49
    v_accvgpr_write_b32 a178, v50
    v_accvgpr_write_b32 a179, v51
    v_accvgpr_write_b32 a180, v52
    v_accvgpr_write_b32 a181, v53
    v_accvgpr_write_b32 a182, v54
    v_accvgpr_write_b32 a183, v55
    v_accvgpr_write_b32 a184, v56
    v_accvgpr_write_b32 a185, v57
    v_accvgpr_write_b32 a186, v58
    v_accvgpr_write_b32 a187, v59
    v_accvgpr_write_b32 a188, v60
    v_accvgpr_write_b32 a189, v61
    v_accvgpr_write_b32 a190, v62
    v_accvgpr_write_b32 a191, v63
    v_add_f32 v64, v64, v32
    v_add_f32 v65, v65, v33
    v_add_f32 v66, v66, v34
    v_add_f32 v67, v67, v35
    v_add_f32 v68, v68, v36
    v_add_f32 v69, v69, v37
    v_add_f32 v70, v70, v38
    v_add_f32 v71, v71, v39
    v_add_f32 v72, v72, v40
    v_add_f32 v73, v73, v41
    v_add_f32 v74, v74, v42
    v_add_f32 v75, v75, v43
    v_add_f32 v76, v76, v44
    v_add_f32 v77, v77, v45
    v_add_f32 v78, v78, v46
    v_add_f32 v79, v79, v47
    v_add_f32 v80, v80, v48
    v_add_f32 v81, v81, v49
    v_add_f32 v82, v82, v50
    v_add_f32 v83, v83, v51
    v_add_f32 v84, v84, v52
    v_add_f32 v85, v85, v53
    v_add_f32 v86, v86, v54
    v_add_f32 v87, v87, v55
    v_add_f32 v88, v88, v56
    v_add_f32 v89, v89, v57
    v_add_f32 v90, v90, v58
    v_add_f32 v91, v91, v59
    v_add_f32 v92, v92, v60
    v_add_f32 v93, v93, v61
    v_add_f32 v94, v94, v62
    v_add_f32 v95, v95, v63
    v_bfe_u32 v12, v1, 0, 4
    v_lshlrev_b32 v12, 4, v12
    v_add_u32 v12, 0x4000, v12
    s_lshl_b32 s22, s3, 2
    v_add_u32 v13, s22, v12
    v_add_f32 v14, v64, v65
    v_add_f32 v15, v66, v67
    v_add_f32 v14, v14, v68
    v_add_f32 v15, v15, v69
    v_add_f32 v14, v14, v70
    v_add_f32 v15, v15, v71
    v_add_f32 v14, v14, v72
    v_add_f32 v15, v15, v73
    v_add_f32 v14, v14, v74
    v_add_f32 v15, v15, v75
    v_add_f32 v14, v14, v76
    v_add_f32 v15, v15, v77
    v_add_f32 v14, v14, v78
    v_add_f32 v15, v15, v79
    v_add_f32 v14, v14, v80
    v_add_f32 v15, v15, v81
    v_add_f32 v14, v14, v82
    v_add_f32 v15, v15, v83
    v_add_f32 v14, v14, v84
    v_add_f32 v15, v15, v85
    v_add_f32 v14, v14, v86
    v_add_f32 v15, v15, v87
    v_add_f32 v20, v88, v89
    v_add_f32 v20, v20, v90
    v_add_f32 v20, v20, v91
    v_add_f32 v20, v20, v92
    v_add_f32 v20, v20, v93
    v_add_f32 v20, v20, v94
    v_add_f32 v20, v20, v95
    v_add_f32 v14, v14, v15
    v_fmac_f32 v14, s39, v20
    v_mov_b32 v3, v14
    s_nop 1
    v_permlane16_swap_b32 v14, v3
    v_add_f32 v14, v14, v3
    v_mov_b32 v3, v14
    s_nop 1
    v_permlane32_swap_b32 v14, v3
    v_add_f32 v14, v14, v3
    ds_write_b32 v13, v14 offset:0
    s_waitcnt lgkmcnt(0)
    s_barrier
    ds_read_b128 v[16:19], v12 offset:0
    s_waitcnt lgkmcnt(0)
    v_add_f32 v16, v16, v17
    v_add_f32 v18, v18, v19
    v_add_f32 v14, v16, v18
    v_mul_f32 v14, 0x3b124925, v14
    v_sub_f32 v96, v64, v14
    v_sub_f32 v97, v65, v14
    v_sub_f32 v98, v66, v14
    v_sub_f32 v99, v67, v14
    v_sub_f32 v100, v68, v14
    v_sub_f32 v101, v69, v14
    v_sub_f32 v102, v70, v14
    v_sub_f32 v103, v71, v14
    v_sub_f32 v104, v72, v14
    v_sub_f32 v105, v73, v14
    v_sub_f32 v106, v74, v14
    v_sub_f32 v107, v75, v14
    v_sub_f32 v108, v76, v14
    v_sub_f32 v109, v77, v14
    v_sub_f32 v110, v78, v14
    v_sub_f32 v111, v79, v14
    v_sub_f32 v112, v80, v14
    v_sub_f32 v113, v81, v14
    v_sub_f32 v114, v82, v14
    v_sub_f32 v115, v83, v14
    v_sub_f32 v116, v84, v14
    v_sub_f32 v117, v85, v14
    v_sub_f32 v118, v86, v14
    v_sub_f32 v119, v87, v14
    v_sub_f32 v120, v88, v14
    v_sub_f32 v121, v89, v14
    v_sub_f32 v122, v90, v14
    v_sub_f32 v123, v91, v14
    v_sub_f32 v124, v92, v14
    v_sub_f32 v125, v93, v14
    v_sub_f32 v126, v94, v14
    v_sub_f32 v127, v95, v14
    v_mul_f32 v15, v96, v96
    v_mul_f32 v20, v120, v120
    v_fmac_f32 v15, v97, v97
    v_fmac_f32 v15, v98, v98
    v_fmac_f32 v15, v99, v99
    v_fmac_f32 v15, v100, v100
    v_fmac_f32 v15, v101, v101
    v_fmac_f32 v15, v102, v102
    v_fmac_f32 v15, v103, v103
    v_fmac_f32 v15, v104, v104
    v_fmac_f32 v15, v105, v105
    v_fmac_f32 v15, v106, v106
    v_fmac_f32 v15, v107, v107
    v_fmac_f32 v15, v108, v108
    v_fmac_f32 v15, v109, v109
    v_fmac_f32 v15, v110, v110
    v_fmac_f32 v15, v111, v111
    v_fmac_f32 v15, v112, v112
    v_fmac_f32 v15, v113, v113
    v_fmac_f32 v15, v114, v114
    v_fmac_f32 v15, v115, v115
    v_fmac_f32 v15, v116, v116
    v_fmac_f32 v15, v117, v117
    v_fmac_f32 v15, v118, v118
    v_fmac_f32 v15, v119, v119
    v_fmac_f32 v20, v121, v121
    v_fmac_f32 v20, v122, v122
    v_fmac_f32 v20, v123, v123
    v_fmac_f32 v20, v124, v124
    v_fmac_f32 v20, v125, v125
    v_fmac_f32 v20, v126, v126
    v_fmac_f32 v20, v127, v127
    v_fmac_f32 v15, s39, v20
    v_mov_b32 v3, v15
    s_nop 1
    v_permlane16_swap_b32 v15, v3
    v_add_f32 v15, v15, v3
    v_mov_b32 v3, v15
    s_nop 1
    v_permlane32_swap_b32 v15, v3
    v_add_f32 v15, v15, v3
    ds_write_b32 v13, v15 offset:256
    s_waitcnt lgkmcnt(0)
    s_barrier
    ds_read_b128 v[16:19], v12 offset:256
    s_waitcnt lgkmcnt(0)
    v_add_f32 v16, v16, v17
    v_add_f32 v18, v18, v19
    v_add_f32 v15, v16, v18
    v_mov_b32 v14, 0x3727c5ac
    v_fmac_f32 v14, 0x3b124925, v15
    v_rsq_f32 v14, v14
    s_nop 0
    v_mul_f32 v96, v96, v14
    v_mul_f32 v97, v97, v14
    v_mul_f32 v98, v98, v14
    v_mul_f32 v99, v99, v14
    v_mul_f32 v100, v100, v14
    v_mul_f32 v101, v101, v14
    v_mul_f32 v102, v102, v14
    v_mul_f32 v103, v103, v14
    v_mul_f32 v104, v104, v14
    v_mul_f32 v105, v105, v14
    v_mul_f32 v106, v106, v14
    v_mul_f32 v107, v107, v14
    v_mul_f32 v108, v108, v14
    v_mul_f32 v109, v109, v14
    v_mul_f32 v110, v110, v14
    v_mul_f32 v111, v111, v14
    v_mul_f32 v112, v112, v14
    v_mul_f32 v113, v113, v14
    v_mul_f32 v114, v114, v14
    v_mul_f32 v115, v115, v14
    v_mul_f32 v116, v116, v14
    v_mul_f32 v117, v117, v14
    v_mul_f32 v118, v118, v14
    v_mul_f32 v119, v119, v14
    v_mul_f32 v120, v120, v14
    v_mul_f32 v121, v121, v14
    v_mul_f32 v122, v122, v14
    v_mul_f32 v123, v123, v14
    v_mul_f32 v124, v124, v14
    v_mul_f32 v125, v125, v14
    v_mul_f32 v126, v126, v14
    v_mul_f32 v127, v127, v14
    v_cvt_pk_bf16_f32 v96, v96, v97
    v_cvt_pk_bf16_f32 v97, v98, v99
    v_cvt_pk_bf16_f32 v98, v100, v101
    v_cvt_pk_bf16_f32 v99, v102, v103
    v_cvt_pk_bf16_f32 v100, v104, v105
    v_cvt_pk_bf16_f32 v101, v106, v107
    v_cvt_pk_bf16_f32 v102, v108, v109
    v_cvt_pk_bf16_f32 v103, v110, v111
    v_cvt_pk_bf16_f32 v104, v112, v113
    v_cvt_pk_bf16_f32 v105, v114, v115
    v_cvt_pk_bf16_f32 v106, v116, v117
    v_cvt_pk_bf16_f32 v107, v118, v119
    v_cvt_pk_bf16_f32 v108, v120, v121
    v_cvt_pk_bf16_f32 v109, v122, v123
    v_cvt_pk_bf16_f32 v110, v124, v125
    v_cvt_pk_bf16_f32 v111, v126, v127
    s_mul_i32 s22, s35, 14
    s_add_u32 s22, s22, s40
    s_lshl_b32 s22, s22, 10
    s_add_u32 s22, s22, 0x1800000
    s_add_u32 s22, s22, s84
    buffer_store_dwordx4 v[96:99], v7, s[8:11], s22 offen offset:0 sc1
    buffer_store_dwordx4 v[100:103], v7, s[8:11], s22 offen offset:1024 sc1
    buffer_store_dwordx4 v[104:107], v7, s[8:11], s22 offen offset:2048 sc1
    buffer_store_dwordx4 v[108:111], v7, s[16:19], s22 offen offset:3072 sc1
    v_bfe_u32 v9, v1, 0, 1
    v_mul_u32_u24 v9, 0x3800, v9
    v_bfe_u32 v2, v1, 4, 2
    v_lshlrev_b32 v2, 8, v2
    v_add_u32 v9, v9, v2
    v_bfe_u32 v2, v1, 1, 3
    v_lshlrev_b32 v2, 4, v2
    v_add_u32 v9, v9, v2
    s_lshr_b32 s22, s35, 1
    s_mul_i32 s22, s22, 28672
    s_lshl_b32 s23, s40, 10
    s_add_u32 s22, s22, s23
    s_and_b32 s23, s35, 1
    s_lshl_b32 s23, s23, 7
    s_add_u32 s22, s22, s23
    s_add_u32 s42, s22, 0x1a00000
    s_add_u32 s42, s42, s84
    buffer_store_dwordx4 v[96:99], v9, s[8:11], s42 offen offset:0 sc1
    buffer_store_dwordx4 v[100:103], v9, s[8:11], s42 offen offset:1024 sc1
    buffer_store_dwordx4 v[104:107], v9, s[8:11], s42 offen offset:2048 sc1
    buffer_store_dwordx4 v[108:111], v9, s[16:19], s42 offen offset:3072 sc1
    s_waitcnt vmcnt(0)
    s_barrier
    s_cmp_lg_u32 s3, 0
    s_cbranch_scc1 la0_O_f1
    s_lshl_b32 s22, s35, 7
    s_add_u32 s22, s22, 0x428a000
    s_add_u32 s22, s22, s84
    v_mov_b32 v2, 1
    v_mov_b32 v3, 0
    s_mov_b64 exec, 1
    buffer_store_dword v2, v3, s[8:11], s22 offen sc1
    s_mov_b64 exec, -1
la0_O_f1:
    s_mov_b32 s83, s35
    s_cmp_eq_u32 s36, 0
    s_cbranch_scc1 la0_W_fast
    s_cmp_lt_i32 s83, 0
    s_cbranch_scc1 la0_oaddx
    s_lshl_b32 s22, s3, 2
    s_cmp_eq_u32 s3, 3
    s_cselect_b32 s22, 11, s22
    s_lshl_b32 s22, s22, 7
    v_bfe_u32 v12, v1, 0, 4
    v_mul_u32_u24 v12, 0x700, v12
    v_bfe_u32 v2, v1, 4, 2
    v_lshlrev_b32 v2, 5, v2
    v_add_u32 v12, v12, v2
    v_add_u32 v12, s22, v12
    ds_write_b128 v12, a[160:163] offset:0
    ds_write_b128 v12, a[164:167] offset:16
    ds_write_b128 v12, a[168:171] offset:128
    ds_write_b128 v12, a[172:175] offset:144
    ds_write_b128 v12, a[176:179] offset:256
    ds_write_b128 v12, a[180:183] offset:272
    s_cmp_ge_u32 s3, 2
    s_cbranch_scc1 la0_oaddx_w
    ds_write_b128 v12, a[184:187] offset:384
    ds_write_b128 v12, a[188:191] offset:400
la0_oaddx_w:
    s_mul_i32 s23, s3, 7168
    v_lshlrev_b32 v13, 2, v1
    v_add_u32 v12, s23, v13
    s_mul_i32 s22, s83, 28672
    s_add_u32 s22, s22, s23
    s_add_u32 s22, s22, 0xe00000
    s_add_u32 s23, s22, 4096
    s_waitcnt lgkmcnt(0)
    s_barrier
    ds_read_b32 v32, v12 offset:0
    ds_read_b32 v33, v12 offset:256
    ds_read_b32 v34, v12 offset:512
    ds_read_b32 v35, v12 offset:768
    ds_read_b32 v36, v12 offset:1024
    ds_read_b32 v37, v12 offset:1280
    ds_read_b32 v38, v12 offset:1536
    ds_read_b32 v39, v12 offset:1792
    ds_read_b32 v40, v12 offset:2048
    ds_read_b32 v41, v12 offset:2304
    ds_read_b32 v42, v12 offset:2560
    ds_read_b32 v43, v12 offset:2816
    ds_read_b32 v44, v12 offset:3072
    ds_read_b32 v45, v12 offset:3328
    s_waitcnt lgkmcnt(13)
    buffer_atomic_add_f32 v32, v13, s[8:11], s22 offen offset:0
    s_waitcnt lgkmcnt(12)
    buffer_atomic_add_f32 v33, v13, s[8:11], s22 offen offset:256
    s_waitcnt lgkmcnt(11)
    buffer_atomic_add_f32 v34, v13, s[8:11], s22 offen offset:512
    s_waitcnt lgkmcnt(10)
    buffer_atomic_add_f32 v35, v13, s[8:11], s22 offen offset:768
    s_waitcnt lgkmcnt(9)
    buffer_atomic_add_f32 v36, v13, s[8:11], s22 offen offset:1024
    s_waitcnt lgkmcnt(8)
    buffer_atomic_add_f32 v37, v13, s[8:11], s22 offen offset:1280
    s_waitcnt lgkmcnt(7)
    buffer_atomic_add_f32 v38, v13, s[8:11], s22 offen offset:1536
    s_waitcnt lgkmcnt(6)
    buffer_atomic_add_f32 v39, v13, s[8:11], s22 offen offset:1792
    s_waitcnt lgkmcnt(5)
    buffer_atomic_add_f32 v40, v13, s[8:11], s22 offen offset:2048
    s_waitcnt lgkmcnt(4)
    buffer_atomic_add_f32 v41, v13, s[8:11], s22 offen offset:2304
    s_waitcnt lgkmcnt(3)
    buffer_atomic_add_f32 v42, v13, s[8:11], s22 offen offset:2560
    s_waitcnt lgkmcnt(2)
    buffer_atomic_add_f32 v43, v13, s[8:11], s22 offen offset:2816
    s_waitcnt lgkmcnt(1)
    buffer_atomic_add_f32 v44, v13, s[8:11], s22 offen offset:3072
    s_waitcnt lgkmcnt(0)
    buffer_atomic_add_f32 v45, v13, s[8:11], s22 offen offset:3328
    ds_read_b32 v46, v12 offset:3584
    ds_read_b32 v47, v12 offset:3840
    ds_read_b32 v48, v12 offset:4096
    ds_read_b32 v49, v12 offset:4352
    ds_read_b32 v50, v12 offset:4608
    ds_read_b32 v51, v12 offset:4864
    ds_read_b32 v52, v12 offset:5120
    ds_read_b32 v53, v12 offset:5376
    ds_read_b32 v54, v12 offset:5632
    ds_read_b32 v55, v12 offset:5888
    ds_read_b32 v56, v12 offset:6144
    ds_read_b32 v57, v12 offset:6400
    ds_read_b32 v58, v12 offset:6656
    ds_read_b32 v59, v12 offset:6912
    s_waitcnt lgkmcnt(13)
    buffer_atomic_add_f32 v46, v13, s[8:11], s22 offen offset:3584
    s_waitcnt lgkmcnt(12)
    buffer_atomic_add_f32 v47, v13, s[8:11], s22 offen offset:3840
    s_waitcnt lgkmcnt(11)
    buffer_atomic_add_f32 v48, v13, s[8:11], s23 offen offset:0
    s_waitcnt lgkmcnt(10)
    buffer_atomic_add_f32 v49, v13, s[8:11], s23 offen offset:256
    s_waitcnt lgkmcnt(9)
    buffer_atomic_add_f32 v50, v13, s[8:11], s23 offen offset:512
    s_waitcnt lgkmcnt(8)
    buffer_atomic_add_f32 v51, v13, s[8:11], s23 offen offset:768
    s_waitcnt lgkmcnt(7)
    buffer_atomic_add_f32 v52, v13, s[8:11], s23 offen offset:1024
    s_waitcnt lgkmcnt(6)
    buffer_atomic_add_f32 v53, v13, s[8:11], s23 offen offset:1280
    s_waitcnt lgkmcnt(5)
    buffer_atomic_add_f32 v54, v13, s[8:11], s23 offen offset:1536
    s_waitcnt lgkmcnt(4)
    buffer_atomic_add_f32 v55, v13, s[8:11], s23 offen offset:1792
    s_waitcnt lgkmcnt(3)
    buffer_atomic_add_f32 v56, v13, s[8:11], s23 offen offset:2048
    s_waitcnt lgkmcnt(2)
    buffer_atomic_add_f32 v57, v13, s[8:11], s23 offen offset:2304
    s_waitcnt lgkmcnt(1)
    buffer_atomic_add_f32 v58, v13, s[8:11], s23 offen offset:2560
    s_waitcnt lgkmcnt(0)
    buffer_atomic_add_f32 v59, v13, s[8:11], s23 offen offset:2816
    s_waitcnt vmcnt(0)
    s_barrier
    s_cmp_lg_u32 s3, 0
    s_cbranch_scc1 la0_oaddx_c
    s_lshr_b32 s22, s83, 1
    s_lshl_b32 s22, s22, 7
    s_add_u32 s22, s22, 0x4298000
    s_add_u32 s22, s22, s84
    v_mov_b32 v2, 1
    v_mov_b32 v3, 0
    s_mov_b64 exec, 1
    buffer_atomic_add v2, v3, s[8:11], s22 offen
    s_mov_b64 exec, -1
la0_oaddx_c:
    s_mov_b32 s83, -1
la0_oaddx:
    s_branch la0_O_pull
la0_job:
    s_mov_b64 exec, -1
    v_mbcnt_lo_u32_b32 v1, -1, 0
    v_mbcnt_hi_u32_b32 v1, -1, v1
    s_waitcnt vmcnt(0) lgkmcnt(0)
    s_load_dwordx2 s[6:7], s[0:1], 96
    s_mov_b32 s42, s89
    s_cmp_le_u32 s100, 30
    s_cselect_b32 s43, s77, 0
    s_cmp_lg_u32 s3, 0
    s_cbranch_scc1 at_jw
    s_mov_b32 s22, 0x4282000
    s_add_u32 s22, s22, s84
    v_mov_b32 v2, 1
    v_mov_b32 v3, 0
    s_mov_b64 exec, 1
    s_cmp_lg_u32 s43, 0
    s_cbranch_scc1 at_nodraw
    buffer_atomic_add v2, v3, s[8:11], s22 offen sc0
at_nodraw:
    s_mov_b32 s40, 0
at_trw:
    s_mov_b32 s23, 0x1180900
    buffer_load_dword v5, v3, s[8:11], s23 offen sc1
    s_waitcnt vmcnt(0)
    v_cmp_eq_u32 vcc, 0, v5
    s_cbranch_vccz at_trok
    s_sleep 8
    s_add_u32 s40, s40, 1
    s_cmp_lt_u32 s40, 0x8000
    s_cbranch_scc1 at_trw
at_trok:
    v_mov_b32 v3, 0x27ffc
    s_waitcnt vmcnt(0)
    ds_write_b32 v3, v2
    s_mov_b64 exec, -1
at_jw:
    s_waitcnt lgkmcnt(0)
    s_barrier
    v_mov_b32 v3, 0x27ffc
    ds_read_b32 v2, v3
    s_waitcnt lgkmcnt(0)
    v_readfirstlane_b32 s2, v2
    s_mov_b32 s12, s6
    s_and_b32 s13, s7, 0xffff
    s_mov_b32 s14, 0x1c0000
    s_mov_b32 s15, 0x20000
    s_cmp_ge_u32 s2, 225
    s_cbranch_scc1 la0_end
    s_sub_u32 s22, s2, 126
    s_mul_i32 s21, s22, 21846
    s_lshr_b32 s21, s21, 16
    s_mul_i32 s23, s21, 3
    s_sub_u32 s20, s22, s23
    s_add_u32 s20, s20, 1
    s_add_u32 s21, s21, 31
    s_sub_u32 s22, s2, 64
    s_lshr_b32 s23, s22, 1
    s_and_b32 s22, s22, 1
    s_add_u32 s22, s22, 2
    s_cmp_lt_u32 s2, 126
    s_cselect_b32 s21, s23, s21
    s_cselect_b32 s20, s22, s20
    s_cmp_lt_u32 s2, 64
    s_cselect_b32 s21, s2, s21
    s_cselect_b32 s20, 0, s20
    s_cmp_lg_u32 s43, 0
    s_cselect_b32 s21, s100, s21
    s_cselect_b32 s20, 1, s20
    v_lshlrev_b32 v4, 4, v1
    v_bfe_u32 v6, v1, 5, 1
    v_mul_u32_u24 v6, 0x700, v6
    v_bfe_u32 v2, v1, 0, 5
    v_lshlrev_b32 v2, 4, v2
    v_add_u32 v6, v6, v2
    v_and_b32 v7, 31, v1
    v_cmp_gt_u32 s[30:31], 28, v7
    v_mov_b32 v3, 0x40000000
    s_nop 0
    v_cndmask_b32 v6, v3, v6, s[30:31]
    s_lshl_b32 s27, s21, 2
    s_add_u32 s27, s27, s3
    s_mul_i32 s27, s27, 14336
    s_add_u32 s27, s27, 0xe00000
    s_lshl_b32 s22, s20, 2
    s_add_u32 s22, s22, s3
    s_lshr_b32 s23, s3, 1
    s_add_u32 s23, s23, 16
    s_cmp_eq_u32 s20, 0
    s_cselect_b32 s24, s23, s22
    s_mov_b32 s16, s8
    s_mov_b32 s17, s9
    s_mov_b32 s19, s11
    s_cmp_lg_u32 s42, 0
    s_cselect_b32 s18, s10, 0
    s_lshl_b32 s22, s21, 7
    s_add_u32 s22, s22, 0x4298000
    s_add_u32 s22, s22, s84
    s_lshl_b32 s23, s42, 1
    s_add_u32 s23, s23, 16
    v_mov_b32 v3, 0
    s_mov_b32 s40, 0
    buffer_load_dword v2, v3, s[8:11], s22 offen sc1
    s_waitcnt vmcnt(0)
    v_cmp_gt_u32 vcc, s23, v2
    s_cbranch_vccnz at_snot
    buffer_load_dwordx4 v[16:19], v6, s[8:11], s27 offen offset:0 sc1
    buffer_load_dwordx4 v[20:23], v6, s[8:11], s27 offen offset:448 sc1
    buffer_load_dwordx4 v[24:27], v6, s[8:11], s27 offen offset:896 sc1
    buffer_load_dwordx4 v[28:31], v6, s[8:11], s27 offen offset:1344 sc1
    s_add_u32 s27, s27, 3584
    buffer_load_dwordx4 v[32:35], v6, s[8:11], s27 offen offset:0 sc1
    buffer_load_dwordx4 v[36:39], v6, s[8:11], s27 offen offset:448 sc1
    buffer_load_dwordx4 v[40:43], v6, s[8:11], s27 offen offset:896 sc1
    buffer_load_dwordx4 v[44:47], v6, s[8:11], s27 offen offset:1344 sc1
    s_add_u32 s27, s27, 3584
    buffer_load_dwordx4 v[48:51], v6, s[8:11], s27 offen offset:0 sc1
    buffer_load_dwordx4 v[52:55], v6, s[8:11], s27 offen offset:448 sc1
    buffer_load_dwordx4 v[56:59], v6, s[8:11], s27 offen offset:896 sc1
    buffer_load_dwordx4 v[60:63], v6, s[8:11], s27 offen offset:1344 sc1
    s_add_u32 s27, s27, 3584
    buffer_load_dwordx4 v[64:67], v6, s[8:11], s27 offen offset:0 sc1
    buffer_load_dwordx4 v[68:71], v6, s[8:11], s27 offen offset:448 sc1
    buffer_load_dwordx4 v[72:75], v6, s[8:11], s27 offen offset:896 sc1
    buffer_load_dwordx4 v[76:79], v6, s[8:11], s27 offen offset:1344 sc1
    s_mul_i32 s25, s24, 28672
    s_add_u32 s25, s25, 0xc40000
    s_add_u32 s26, s25, 14336
    buffer_load_dwordx4 a[0:3], v4, s[8:11], s25 offen offset:0 sc1
    buffer_load_dwordx4 a[4:7], v4, s[8:11], s26 offen offset:0 sc1
    buffer_load_dwordx4 a[8:11], v4, s[8:11], s25 offen offset:1024 sc1
    buffer_load_dwordx4 a[12:15], v4, s[8:11], s26 offen offset:1024 sc1
    buffer_load_dwordx4 a[16:19], v4, s[8:11], s25 offen offset:2048 sc1
    buffer_load_dwordx4 a[20:23], v4, s[8:11], s26 offen offset:2048 sc1
    buffer_load_dwordx4 a[24:27], v4, s[8:11], s25 offen offset:3072 sc1
    buffer_load_dwordx4 a[28:31], v4, s[8:11], s26 offen offset:3072 sc1
    s_add_u32 s25, s25, 4096
    s_add_u32 s26, s26, 4096
    buffer_load_dwordx4 a[32:35], v4, s[8:11], s25 offen offset:0 sc1
    buffer_load_dwordx4 a[36:39], v4, s[8:11], s26 offen offset:0 sc1
    buffer_load_dwordx4 a[40:43], v4, s[8:11], s25 offen offset:1024 sc1
    buffer_load_dwordx4 a[44:47], v4, s[8:11], s26 offen offset:1024 sc1
    buffer_load_dwordx4 a[48:51], v4, s[8:11], s25 offen offset:2048 sc1
    buffer_load_dwordx4 a[52:55], v4, s[8:11], s26 offen offset:2048 sc1
    buffer_load_dwordx4 a[56:59], v4, s[8:11], s25 offen offset:3072 sc1
    buffer_load_dwordx4 a[60:63], v4, s[8:11], s26 offen offset:3072 sc1
    s_add_u32 s25, s25, 4096
    s_add_u32 s26, s26, 4096
    buffer_load_dwordx4 a[64:67], v4, s[8:11], s25 offen offset:0 sc1
    buffer_load_dwordx4 a[68:71], v4, s[8:11], s26 offen offset:0 sc1
    buffer_load_dwordx4 a[72:75], v4, s[8:11], s25 offen offset:1024 sc1
    buffer_load_dwordx4 a[76:79], v4, s[8:11], s26 offen offset:1024 sc1
    buffer_load_dwordx4 a[80:83], v4, s[8:11], s25 offen offset:2048 sc1
    buffer_load_dwordx4 a[84:87], v4, s[8:11], s26 offen offset:2048 sc1
    buffer_load_dwordx4 a[88:91], v4, s[8:11], s25 offen offset:3072 sc1
    buffer_load_dwordx4 a[92:95], v4, s[8:11], s26 offen offset:3072 sc1
    s_add_u32 s25, s25, 4096
    s_add_u32 s26, s26, 4096
    buffer_load_dwordx4 a[96:99], v4, s[8:11], s25 offen offset:0 sc1
    buffer_load_dwordx4 a[100:103], v4, s[8:11], s26 offen offset:0 sc1
    buffer_load_dwordx4 a[104:107], v4, s[8:11], s25 offen offset:1024 sc1
    buffer_load_dwordx4 a[108:111], v4, s[8:11], s26 offen offset:1024 sc1
    s_waitcnt vmcnt(28)
    s_branch at_sgo
at_snot:
    s_mul_i32 s25, s24, 28672
    s_add_u32 s25, s25, 0xc40000
    s_add_u32 s26, s25, 14336
    buffer_load_dwordx4 a[0:3], v4, s[8:11], s25 offen offset:0 sc1
    buffer_load_dwordx4 a[4:7], v4, s[8:11], s26 offen offset:0 sc1
    buffer_load_dwordx4 a[8:11], v4, s[8:11], s25 offen offset:1024 sc1
    buffer_load_dwordx4 a[12:15], v4, s[8:11], s26 offen offset:1024 sc1
    buffer_load_dwordx4 a[16:19], v4, s[8:11], s25 offen offset:2048 sc1
    buffer_load_dwordx4 a[20:23], v4, s[8:11], s26 offen offset:2048 sc1
    buffer_load_dwordx4 a[24:27], v4, s[8:11], s25 offen offset:3072 sc1
    buffer_load_dwordx4 a[28:31], v4, s[8:11], s26 offen offset:3072 sc1
    s_add_u32 s25, s25, 4096
    s_add_u32 s26, s26, 4096
    buffer_load_dwordx4 a[32:35], v4, s[8:11], s25 offen offset:0 sc1
    buffer_load_dwordx4 a[36:39], v4, s[8:11], s26 offen offset:0 sc1
    buffer_load_dwordx4 a[40:43], v4, s[8:11], s25 offen offset:1024 sc1
    buffer_load_dwordx4 a[44:47], v4, s[8:11], s26 offen offset:1024 sc1
    buffer_load_dwordx4 a[48:51], v4, s[8:11], s25 offen offset:2048 sc1
    buffer_load_dwordx4 a[52:55], v4, s[8:11], s26 offen offset:2048 sc1
    buffer_load_dwordx4 a[56:59], v4, s[8:11], s25 offen offset:3072 sc1
    buffer_load_dwordx4 a[60:63], v4, s[8:11], s26 offen offset:3072 sc1
    s_add_u32 s25, s25, 4096
    s_add_u32 s26, s26, 4096
    buffer_load_dwordx4 a[64:67], v4, s[8:11], s25 offen offset:0 sc1
    buffer_load_dwordx4 a[68:71], v4, s[8:11], s26 offen offset:0 sc1
    buffer_load_dwordx4 a[72:75], v4, s[8:11], s25 offen offset:1024 sc1
    buffer_load_dwordx4 a[76:79], v4, s[8:11], s26 offen offset:1024 sc1
    buffer_load_dwordx4 a[80:83], v4, s[8:11], s25 offen offset:2048 sc1
    buffer_load_dwordx4 a[84:87], v4, s[8:11], s26 offen offset:2048 sc1
    buffer_load_dwordx4 a[88:91], v4, s[8:11], s25 offen offset:3072 sc1
    buffer_load_dwordx4 a[92:95], v4, s[8:11], s26 offen offset:3072 sc1
    s_add_u32 s25, s25, 4096
    s_add_u32 s26, s26, 4096
    buffer_load_dwordx4 a[96:99], v4, s[8:11], s25 offen offset:0 sc1
    buffer_load_dwordx4 a[100:103], v4, s[8:11], s26 offen offset:0 sc1
    buffer_load_dwordx4 a[104:107], v4, s[8:11], s25 offen offset:1024 sc1
    buffer_load_dwordx4 a[108:111], v4, s[8:11], s26 offen offset:1024 sc1
at_sw:
    buffer_load_dword v2, v3, s[8:11], s22 offen sc1
    s_waitcnt vmcnt(0)
    v_cmp_gt_u32 vcc, s23, v2
    s_cbranch_vccz at_sok
    s_sleep 2
    s_add_u32 s40, s40, 1
    s_cmp_lt_u32 s40, 0x10000
    s_cbranch_scc1 at_sw
at_sok:
    buffer_load_dwordx4 v[16:19], v6, s[8:11], s27 offen offset:0 sc1
    buffer_load_dwordx4 v[20:23], v6, s[8:11], s27 offen offset:448 sc1
    buffer_load_dwordx4 v[24:27], v6, s[8:11], s27 offen offset:896 sc1
    buffer_load_dwordx4 v[28:31], v6, s[8:11], s27 offen offset:1344 sc1
    s_add_u32 s27, s27, 3584
    buffer_load_dwordx4 v[32:35], v6, s[8:11], s27 offen offset:0 sc1
    buffer_load_dwordx4 v[36:39], v6, s[8:11], s27 offen offset:448 sc1
    buffer_load_dwordx4 v[40:43], v6, s[8:11], s27 offen offset:896 sc1
    buffer_load_dwordx4 v[44:47], v6, s[8:11], s27 offen offset:1344 sc1
    s_add_u32 s27, s27, 3584
    buffer_load_dwordx4 v[48:51], v6, s[8:11], s27 offen offset:0 sc1
    buffer_load_dwordx4 v[52:55], v6, s[8:11], s27 offen offset:448 sc1
    buffer_load_dwordx4 v[56:59], v6, s[8:11], s27 offen offset:896 sc1
    buffer_load_dwordx4 v[60:63], v6, s[8:11], s27 offen offset:1344 sc1
    s_add_u32 s27, s27, 3584
    buffer_load_dwordx4 v[64:67], v6, s[8:11], s27 offen offset:0 sc1
    buffer_load_dwordx4 v[68:71], v6, s[8:11], s27 offen offset:448 sc1
    buffer_load_dwordx4 v[72:75], v6, s[8:11], s27 offen offset:896 sc1
    buffer_load_dwordx4 v[76:79], v6, s[8:11], s27 offen offset:1344 sc1
    s_waitcnt vmcnt(0)
at_sgo:
    s_lshr_b32 s28, s3, 1
    s_mul_i32 s28, s28, 14336
    s_and_b32 s29, s3, 1
    s_lshl_b32 s29, s29, 7
    s_add_u32 s28, s28, s29
    v_bfe_u32 v8, v1, 1, 4
    v_lshlrev_b32 v8, 8, v8
    v_bfe_u32 v2, v1, 0, 1
    v_lshlrev_b32 v2, 3, v2
    v_add_u32 v8, v8, v2
    v_bfe_u32 v2, v1, 5, 1
    v_lshlrev_b32 v2, 4, v2
    v_add_u32 v8, v8, v2
    v_add_u32 v8, s28, v8
    v_mov_b32 v3, 28672
    v_cndmask_b32 v8, v3, v8, s[30:31]
    v_pk_add_f32 v[88:89], v[16:17], v[18:19]
    v_pk_add_f32 v[90:91], v[20:21], v[22:23]
    v_pk_add_f32 v[92:93], v[24:25], v[26:27]
    v_pk_add_f32 v[94:95], v[28:29], v[30:31]
    v_pk_add_f32 v[88:89], v[88:89], v[90:91]
    v_pk_add_f32 v[92:93], v[92:93], v[94:95]
    v_pk_add_f32 v[88:89], v[88:89], v[92:93]
    v_pk_add_f32 v[104:105], v[32:33], v[34:35]
    v_pk_add_f32 v[106:107], v[36:37], v[38:39]
    v_pk_add_f32 v[108:109], v[40:41], v[42:43]
    v_pk_add_f32 v[110:111], v[44:45], v[46:47]
    v_pk_add_f32 v[104:105], v[104:105], v[106:107]
    v_pk_add_f32 v[108:109], v[108:109], v[110:111]
    v_pk_add_f32 v[104:105], v[104:105], v[108:109]
    v_pk_add_f32 v[120:121], v[48:49], v[50:51]
    v_pk_add_f32 v[122:123], v[52:53], v[54:55]
    v_pk_add_f32 v[124:125], v[56:57], v[58:59]
    v_pk_add_f32 v[126:127], v[60:61], v[62:63]
    v_pk_add_f32 v[120:121], v[120:121], v[122:123]
    v_pk_add_f32 v[124:125], v[124:125], v[126:127]
    v_pk_add_f32 v[120:121], v[120:121], v[124:125]
    v_pk_add_f32 v[136:137], v[64:65], v[66:67]
    v_pk_add_f32 v[138:139], v[68:69], v[70:71]
    v_pk_add_f32 v[140:141], v[72:73], v[74:75]
    v_pk_add_f32 v[142:143], v[76:77], v[78:79]
    v_pk_add_f32 v[136:137], v[136:137], v[138:139]
    v_pk_add_f32 v[140:141], v[140:141], v[142:143]
    v_pk_add_f32 v[136:137], v[136:137], v[140:141]
    v_add_f32 v80, v88, v89
    v_add_f32 v83, v104, v105
    v_add_f32 v86, v120, v121
    v_add_f32 v89, v136, v137
    v_add_f32_dpp v80, v80, v80 quad_perm:[1,0,3,2] row_mask:0xf bank_mask:0xf
    v_add_f32_dpp v83, v83, v83 quad_perm:[1,0,3,2] row_mask:0xf bank_mask:0xf
    v_add_f32_dpp v86, v86, v86 quad_perm:[1,0,3,2] row_mask:0xf bank_mask:0xf
    v_add_f32_dpp v89, v89, v89 quad_perm:[1,0,3,2] row_mask:0xf bank_mask:0xf
    v_add_f32_dpp v80, v80, v80 quad_perm:[2,3,0,1] row_mask:0xf bank_mask:0xf
    v_add_f32_dpp v83, v83, v83 quad_perm:[2,3,0,1] row_mask:0xf bank_mask:0xf
    v_add_f32_dpp v86, v86, v86 quad_perm:[2,3,0,1] row_mask:0xf bank_mask:0xf
    v_add_f32_dpp v89, v89, v89 quad_perm:[2,3,0,1] row_mask:0xf bank_mask:0xf
    v_add_f32_dpp v80, v80, v80 row_half_mirror row_mask:0xf bank_mask:0xf
    v_add_f32_dpp v83, v83, v83 row_half_mirror row_mask:0xf bank_mask:0xf
    v_add_f32_dpp v86, v86, v86 row_half_mirror row_mask:0xf bank_mask:0xf
    v_add_f32_dpp v89, v89, v89 row_half_mirror row_mask:0xf bank_mask:0xf
    v_add_f32_dpp v80, v80, v80 row_mirror row_mask:0xf bank_mask:0xf
    v_add_f32_dpp v83, v83, v83 row_mirror row_mask:0xf bank_mask:0xf
    v_add_f32_dpp v86, v86, v86 row_mirror row_mask:0xf bank_mask:0xf
    v_add_f32_dpp v89, v89, v89 row_mirror row_mask:0xf bank_mask:0xf
    v_mov_b32 v81, v80
    v_mov_b32 v84, v83
    v_mov_b32 v87, v86
    v_mov_b32 v90, v89
    v_permlane16_swap_b32 v80, v81
    v_permlane16_swap_b32 v83, v84
    v_permlane16_swap_b32 v86, v87
    v_permlane16_swap_b32 v89, v90
    v_add_f32 v80, v80, v81
    v_add_f32 v83, v83, v84
    v_add_f32 v86, v86, v87
    v_add_f32 v89, v89, v90
    v_mul_f32 v80, 0x3b124925, v80
    v_mul_f32 v83, 0x3b124925, v83
    v_mul_f32 v86, 0x3b124925, v86
    v_mul_f32 v89, 0x3b124925, v89
    v_sub_f32 v16, v16, v80
    v_sub_f32 v17, v17, v80
    v_sub_f32 v18, v18, v80
    v_sub_f32 v19, v19, v80
    v_sub_f32 v20, v20, v80
    v_sub_f32 v21, v21, v80
    v_sub_f32 v22, v22, v80
    v_sub_f32 v23, v23, v80
    v_sub_f32 v24, v24, v80
    v_sub_f32 v25, v25, v80
    v_sub_f32 v26, v26, v80
    v_sub_f32 v27, v27, v80
    v_sub_f32 v28, v28, v80
    v_sub_f32 v29, v29, v80
    v_sub_f32 v30, v30, v80
    v_sub_f32 v31, v31, v80
    v_sub_f32 v32, v32, v83
    v_sub_f32 v33, v33, v83
    v_sub_f32 v34, v34, v83
    v_sub_f32 v35, v35, v83
    v_sub_f32 v36, v36, v83
    v_sub_f32 v37, v37, v83
    v_sub_f32 v38, v38, v83
    v_sub_f32 v39, v39, v83
    v_sub_f32 v40, v40, v83
    v_sub_f32 v41, v41, v83
    v_sub_f32 v42, v42, v83
    v_sub_f32 v43, v43, v83
    v_sub_f32 v44, v44, v83
    v_sub_f32 v45, v45, v83
    v_sub_f32 v46, v46, v83
    v_sub_f32 v47, v47, v83
    v_sub_f32 v48, v48, v86
    v_sub_f32 v49, v49, v86
    v_sub_f32 v50, v50, v86
    v_sub_f32 v51, v51, v86
    v_sub_f32 v52, v52, v86
    v_sub_f32 v53, v53, v86
    v_sub_f32 v54, v54, v86
    v_sub_f32 v55, v55, v86
    v_sub_f32 v56, v56, v86
    v_sub_f32 v57, v57, v86
    v_sub_f32 v58, v58, v86
    v_sub_f32 v59, v59, v86
    v_sub_f32 v60, v60, v86
    v_sub_f32 v61, v61, v86
    v_sub_f32 v62, v62, v86
    v_sub_f32 v63, v63, v86
    v_sub_f32 v64, v64, v89
    v_sub_f32 v65, v65, v89
    v_sub_f32 v66, v66, v89
    v_sub_f32 v67, v67, v89
    v_sub_f32 v68, v68, v89
    v_sub_f32 v69, v69, v89
    v_sub_f32 v70, v70, v89
    v_sub_f32 v71, v71, v89
    v_sub_f32 v72, v72, v89
    v_sub_f32 v73, v73, v89
    v_sub_f32 v74, v74, v89
    v_sub_f32 v75, v75, v89
    v_sub_f32 v76, v76, v89
    v_sub_f32 v77, v77, v89
    v_sub_f32 v78, v78, v89
    v_sub_f32 v79, v79, v89
    v_mul_f32 v82, v16, v16
    v_mul_f32 v85, v32, v32
    v_mul_f32 v88, v48, v48
    v_mul_f32 v91, v64, v64
    v_fmac_f32 v82, v17, v17
    v_fmac_f32 v85, v33, v33
    v_fmac_f32 v88, v49, v49
    v_fmac_f32 v91, v65, v65
    v_fmac_f32 v82, v18, v18
    v_fmac_f32 v85, v34, v34
    v_fmac_f32 v88, v50, v50
    v_fmac_f32 v91, v66, v66
    v_fmac_f32 v82, v19, v19
    v_fmac_f32 v85, v35, v35
    v_fmac_f32 v88, v51, v51
    v_fmac_f32 v91, v67, v67
    v_fmac_f32 v82, v20, v20
    v_fmac_f32 v85, v36, v36
    v_fmac_f32 v88, v52, v52
    v_fmac_f32 v91, v68, v68
    v_fmac_f32 v82, v21, v21
    v_fmac_f32 v85, v37, v37
    v_fmac_f32 v88, v53, v53
    v_fmac_f32 v91, v69, v69
    v_fmac_f32 v82, v22, v22
    v_fmac_f32 v85, v38, v38
    v_fmac_f32 v88, v54, v54
    v_fmac_f32 v91, v70, v70
    v_fmac_f32 v82, v23, v23
    v_fmac_f32 v85, v39, v39
    v_fmac_f32 v88, v55, v55
    v_fmac_f32 v91, v71, v71
    v_fmac_f32 v82, v24, v24
    v_fmac_f32 v85, v40, v40
    v_fmac_f32 v88, v56, v56
    v_fmac_f32 v91, v72, v72
    v_fmac_f32 v82, v25, v25
    v_fmac_f32 v85, v41, v41
    v_fmac_f32 v88, v57, v57
    v_fmac_f32 v91, v73, v73
    v_fmac_f32 v82, v26, v26
    v_fmac_f32 v85, v42, v42
    v_fmac_f32 v88, v58, v58
    v_fmac_f32 v91, v74, v74
    v_fmac_f32 v82, v27, v27
    v_fmac_f32 v85, v43, v43
    v_fmac_f32 v88, v59, v59
    v_fmac_f32 v91, v75, v75
    v_fmac_f32 v82, v28, v28
    v_fmac_f32 v85, v44, v44
    v_fmac_f32 v88, v60, v60
    v_fmac_f32 v91, v76, v76
    v_fmac_f32 v82, v29, v29
    v_fmac_f32 v85, v45, v45
    v_fmac_f32 v88, v61, v61
    v_fmac_f32 v91, v77, v77
    v_fmac_f32 v82, v30, v30
    v_fmac_f32 v85, v46, v46
    v_fmac_f32 v88, v62, v62
    v_fmac_f32 v91, v78, v78
    v_fmac_f32 v82, v31, v31
    v_fmac_f32 v85, v47, v47
    v_fmac_f32 v88, v63, v63
    v_fmac_f32 v91, v79, v79
    v_cndmask_b32 v82, 0, v82, s[30:31]
    v_cndmask_b32 v85, 0, v85, s[30:31]
    v_cndmask_b32 v88, 0, v88, s[30:31]
    v_cndmask_b32 v91, 0, v91, s[30:31]
    v_add_f32_dpp v82, v82, v82 quad_perm:[1,0,3,2] row_mask:0xf bank_mask:0xf
    v_add_f32_dpp v85, v85, v85 quad_perm:[1,0,3,2] row_mask:0xf bank_mask:0xf
    v_add_f32_dpp v88, v88, v88 quad_perm:[1,0,3,2] row_mask:0xf bank_mask:0xf
    v_add_f32_dpp v91, v91, v91 quad_perm:[1,0,3,2] row_mask:0xf bank_mask:0xf
    v_add_f32_dpp v82, v82, v82 quad_perm:[2,3,0,1] row_mask:0xf bank_mask:0xf
    v_add_f32_dpp v85, v85, v85 quad_perm:[2,3,0,1] row_mask:0xf bank_mask:0xf
    v_add_f32_dpp v88, v88, v88 quad_perm:[2,3,0,1] row_mask:0xf bank_mask:0xf
    v_add_f32_dpp v91, v91, v91 quad_perm:[2,3,0,1] row_mask:0xf bank_mask:0xf
    v_add_f32_dpp v82, v82, v82 row_half_mirror row_mask:0xf bank_mask:0xf
    v_add_f32_dpp v85, v85, v85 row_half_mirror row_mask:0xf bank_mask:0xf
    v_add_f32_dpp v88, v88, v88 row_half_mirror row_mask:0xf bank_mask:0xf
    v_add_f32_dpp v91, v91, v91 row_half_mirror row_mask:0xf bank_mask:0xf
    v_add_f32_dpp v82, v82, v82 row_mirror row_mask:0xf bank_mask:0xf
    v_add_f32_dpp v85, v85, v85 row_mirror row_mask:0xf bank_mask:0xf
    v_add_f32_dpp v88, v88, v88 row_mirror row_mask:0xf bank_mask:0xf
    v_add_f32_dpp v91, v91, v91 row_mirror row_mask:0xf bank_mask:0xf
    v_mov_b32 v81, v82
    v_mov_b32 v84, v85
    v_mov_b32 v87, v88
    v_mov_b32 v90, v91
    v_permlane16_swap_b32 v82, v81
    v_permlane16_swap_b32 v85, v84
    v_permlane16_swap_b32 v88, v87
    v_permlane16_swap_b32 v91, v90
    v_add_f32 v82, v82, v81
    v_add_f32 v85, v85, v84
    v_add_f32 v88, v88, v87
    v_add_f32 v91, v91, v90
    v_mov_b32 v81, 0x3727c5ac
    v_fmac_f32 v81, 0x3b124925, v82
    v_mov_b32 v84, 0x3727c5ac
    v_fmac_f32 v84, 0x3b124925, v85
    v_mov_b32 v87, 0x3727c5ac
    v_fmac_f32 v87, 0x3b124925, v88
    v_mov_b32 v90, 0x3727c5ac
    v_fmac_f32 v90, 0x3b124925, v91
    v_rsq_f32 v80, v81
    v_rsq_f32 v83, v84
    v_rsq_f32 v86, v87
    v_rsq_f32 v89, v90
    v_mul_f32 v16, v16, v80
    v_mul_f32 v17, v17, v80
    v_mul_f32 v18, v18, v80
    v_mul_f32 v19, v19, v80
    v_mul_f32 v20, v20, v80
    v_mul_f32 v21, v21, v80
    v_mul_f32 v22, v22, v80
    v_mul_f32 v23, v23, v80
    v_mul_f32 v24, v24, v80
    v_mul_f32 v25, v25, v80
    v_mul_f32 v26, v26, v80
    v_mul_f32 v27, v27, v80
    v_mul_f32 v28, v28, v80
    v_mul_f32 v29, v29, v80
    v_mul_f32 v30, v30, v80
    v_mul_f32 v31, v31, v80
    v_cvt_pk_bf16_f32 v96, v16, v17
    v_cvt_pk_bf16_f32 v97, v18, v19
    v_cvt_pk_bf16_f32 v98, v20, v21
    v_cvt_pk_bf16_f32 v99, v22, v23
    v_cvt_pk_bf16_f32 v100, v24, v25
    v_cvt_pk_bf16_f32 v101, v26, v27
    v_cvt_pk_bf16_f32 v102, v28, v29
    v_cvt_pk_bf16_f32 v103, v30, v31
    ds_write_b64 v8, v[96:97] offset:0
    ds_write_b64 v8, v[98:99] offset:3584
    ds_write_b64 v8, v[100:101] offset:7168
    ds_write_b64 v8, v[102:103] offset:10752
    v_mul_f32 v32, v32, v83
    v_mul_f32 v33, v33, v83
    v_mul_f32 v34, v34, v83
    v_mul_f32 v35, v35, v83
    v_mul_f32 v36, v36, v83
    v_mul_f32 v37, v37, v83
    v_mul_f32 v38, v38, v83
    v_mul_f32 v39, v39, v83
    v_mul_f32 v40, v40, v83
    v_mul_f32 v41, v41, v83
    v_mul_f32 v42, v42, v83
    v_mul_f32 v43, v43, v83
    v_mul_f32 v44, v44, v83
    v_mul_f32 v45, v45, v83
    v_mul_f32 v46, v46, v83
    v_mul_f32 v47, v47, v83
    v_cvt_pk_bf16_f32 v104, v32, v33
    v_cvt_pk_bf16_f32 v105, v34, v35
    v_cvt_pk_bf16_f32 v106, v36, v37
    v_cvt_pk_bf16_f32 v107, v38, v39
    v_cvt_pk_bf16_f32 v108, v40, v41
    v_cvt_pk_bf16_f32 v109, v42, v43
    v_cvt_pk_bf16_f32 v110, v44, v45
    v_cvt_pk_bf16_f32 v111, v46, v47
    ds_write_b64 v8, v[104:105] offset:32
    ds_write_b64 v8, v[106:107] offset:3616
    ds_write_b64 v8, v[108:109] offset:7200
    ds_write_b64 v8, v[110:111] offset:10784
    v_mul_f32 v48, v48, v86
    v_mul_f32 v49, v49, v86
    v_mul_f32 v50, v50, v86
    v_mul_f32 v51, v51, v86
    v_mul_f32 v52, v52, v86
    v_mul_f32 v53, v53, v86
    v_mul_f32 v54, v54, v86
    v_mul_f32 v55, v55, v86
    v_mul_f32 v56, v56, v86
    v_mul_f32 v57, v57, v86
    v_mul_f32 v58, v58, v86
    v_mul_f32 v59, v59, v86
    v_mul_f32 v60, v60, v86
    v_mul_f32 v61, v61, v86
    v_mul_f32 v62, v62, v86
    v_mul_f32 v63, v63, v86
    v_cvt_pk_bf16_f32 v112, v48, v49
    v_cvt_pk_bf16_f32 v113, v50, v51
    v_cvt_pk_bf16_f32 v114, v52, v53
    v_cvt_pk_bf16_f32 v115, v54, v55
    v_cvt_pk_bf16_f32 v116, v56, v57
    v_cvt_pk_bf16_f32 v117, v58, v59
    v_cvt_pk_bf16_f32 v118, v60, v61
    v_cvt_pk_bf16_f32 v119, v62, v63
    ds_write_b64 v8, v[112:113] offset:64
    ds_write_b64 v8, v[114:115] offset:3648
    ds_write_b64 v8, v[116:117] offset:7232
    ds_write_b64 v8, v[118:119] offset:10816
    v_mul_f32 v64, v64, v89
    v_mul_f32 v65, v65, v89
    v_mul_f32 v66, v66, v89
    v_mul_f32 v67, v67, v89
    v_mul_f32 v68, v68, v89
    v_mul_f32 v69, v69, v89
    v_mul_f32 v70, v70, v89
    v_mul_f32 v71, v71, v89
    v_mul_f32 v72, v72, v89
    v_mul_f32 v73, v73, v89
    v_mul_f32 v74, v74, v89
    v_mul_f32 v75, v75, v89
    v_mul_f32 v76, v76, v89
    v_mul_f32 v77, v77, v89
    v_mul_f32 v78, v78, v89
    v_mul_f32 v79, v79, v89
    v_cvt_pk_bf16_f32 v120, v64, v65
    v_cvt_pk_bf16_f32 v121, v66, v67
    v_cvt_pk_bf16_f32 v122, v68, v69
    v_cvt_pk_bf16_f32 v123, v70, v71
    v_cvt_pk_bf16_f32 v124, v72, v73
    v_cvt_pk_bf16_f32 v125, v74, v75
    v_cvt_pk_bf16_f32 v126, v76, v77
    v_cvt_pk_bf16_f32 v127, v78, v79
    ds_write_b64 v8, v[120:121] offset:96
    ds_write_b64 v8, v[122:123] offset:3680
    ds_write_b64 v8, v[124:125] offset:7264
    ds_write_b64 v8, v[126:127] offset:10848
    s_waitcnt lgkmcnt(0)
    s_barrier
    s_cmp_lg_u32 s20, 0
    s_cbranch_scc1 at_q
    s_and_b32 s22, s3, 1
    s_mul_i32 s23, s22, 14336
    v_add_u32 v9, s23, v4
    s_waitcnt vmcnt(0)
    s_cmp_ge_u32 s3, 2
    s_cbranch_scc1 at_v
    ds_read_b128 v[16:19], v9 offset:0
    ds_read_b128 v[24:27], v9 offset:1024
    ds_read_b128 v[32:35], v9 offset:2048
    ds_read_b128 v[40:43], v9 offset:3072
    ds_read_b128 v[48:51], v9 offset:4096
    ds_read_b128 v[56:59], v9 offset:5120
    s_waitcnt lgkmcnt(5)
    v_mfma_f32_16x16x32_bf16 v[96:99], a[0:3], v[16:19], 0
    v_mfma_f32_16x16x32_bf16 v[104:107], a[4:7], v[16:19], 0
    ds_read_b128 v[64:67], v9 offset:6144
    s_waitcnt lgkmcnt(5)
    v_mfma_f32_16x16x32_bf16 v[96:99], a[8:11], v[24:27], v[96:99]
    v_mfma_f32_16x16x32_bf16 v[104:107], a[12:15], v[24:27], v[104:107]
    ds_read_b128 v[72:75], v9 offset:7168
    s_waitcnt lgkmcnt(5)
    v_mfma_f32_16x16x32_bf16 v[96:99], a[16:19], v[32:35], v[96:99]
    v_mfma_f32_16x16x32_bf16 v[104:107], a[20:23], v[32:35], v[104:107]
    ds_read_b128 v[16:19], v9 offset:8192
    s_waitcnt lgkmcnt(5)
    v_mfma_f32_16x16x32_bf16 v[96:99], a[24:27], v[40:43], v[96:99]
    v_mfma_f32_16x16x32_bf16 v[104:107], a[28:31], v[40:43], v[104:107]
    ds_read_b128 v[24:27], v9 offset:9216
    s_waitcnt lgkmcnt(5)
    v_mfma_f32_16x16x32_bf16 v[96:99], a[32:35], v[48:51], v[96:99]
    v_mfma_f32_16x16x32_bf16 v[104:107], a[36:39], v[48:51], v[104:107]
    ds_read_b128 v[32:35], v9 offset:10240
    s_waitcnt lgkmcnt(5)
    v_mfma_f32_16x16x32_bf16 v[96:99], a[40:43], v[56:59], v[96:99]
    v_mfma_f32_16x16x32_bf16 v[104:107], a[44:47], v[56:59], v[104:107]
    ds_read_b128 v[40:43], v9 offset:11264
    s_waitcnt lgkmcnt(5)
    v_mfma_f32_16x16x32_bf16 v[96:99], a[48:51], v[64:67], v[96:99]
    v_mfma_f32_16x16x32_bf16 v[104:107], a[52:55], v[64:67], v[104:107]
    ds_read_b128 v[48:51], v9 offset:12288
    s_waitcnt lgkmcnt(5)
    v_mfma_f32_16x16x32_bf16 v[96:99], a[56:59], v[72:75], v[96:99]
    v_mfma_f32_16x16x32_bf16 v[104:107], a[60:63], v[72:75], v[104:107]
    ds_read_b128 v[56:59], v9 offset:13312
    s_waitcnt lgkmcnt(5)
    v_mfma_f32_16x16x32_bf16 v[96:99], a[64:67], v[16:19], v[96:99]
    v_mfma_f32_16x16x32_bf16 v[104:107], a[68:71], v[16:19], v[104:107]
    s_waitcnt lgkmcnt(4)
    v_mfma_f32_16x16x32_bf16 v[96:99], a[72:75], v[24:27], v[96:99]
    v_mfma_f32_16x16x32_bf16 v[104:107], a[76:79], v[24:27], v[104:107]
    s_waitcnt lgkmcnt(3)
    v_mfma_f32_16x16x32_bf16 v[96:99], a[80:83], v[32:35], v[96:99]
    v_mfma_f32_16x16x32_bf16 v[104:107], a[84:87], v[32:35], v[104:107]
    s_waitcnt lgkmcnt(2)
    v_mfma_f32_16x16x32_bf16 v[96:99], a[88:91], v[40:43], v[96:99]
    v_mfma_f32_16x16x32_bf16 v[104:107], a[92:95], v[40:43], v[104:107]
    s_waitcnt lgkmcnt(1)
    v_mfma_f32_16x16x32_bf16 v[96:99], a[96:99], v[48:51], v[96:99]
    v_mfma_f32_16x16x32_bf16 v[104:107], a[100:103], v[48:51], v[104:107]
    s_waitcnt lgkmcnt(0)
    v_mfma_f32_16x16x32_bf16 v[96:99], a[104:107], v[56:59], v[96:99]
    v_mfma_f32_16x16x32_bf16 v[104:107], a[108:111], v[56:59], v[104:107]
    s_lshl_b32 s22, s22, 8
    v_bfe_u32 v5, v1, 5, 1
    v_lshlrev_b32 v5, 10, v5
    v_bfe_u32 v2, v1, 4, 1
    v_lshlrev_b32 v2, 9, v2
    v_add_u32 v5, v5, v2
    v_bfe_u32 v2, v1, 0, 2
    v_lshlrev_b32 v2, 4, v2
    v_add_u32 v5, v5, v2
    v_bfe_u32 v2, v1, 2, 1
    v_lshlrev_b32 v2, 7, v2
    v_add_u32 v5, v5, v2
    v_bfe_u32 v2, v1, 3, 1
    v_lshlrev_b32 v2, 6, v2
    v_add_u32 v5, v5, v2
    v_add_u32 v5, 0x12400, v5
    v_add_u32 v5, s22, v5
    v_cvt_pk_bf16_f32 v120, v96, v97
    v_cvt_pk_bf16_f32 v121, v98, v99
    v_cvt_pk_bf16_f32 v122, v104, v105
    v_cvt_pk_bf16_f32 v123, v106, v107
    ds_write_b128 v5, v[120:123]
    s_branch at_q0
at_v:
    ds_read_b128 v[16:19], v9 offset:0
    ds_read_b128 v[24:27], v9 offset:1024
    ds_read_b128 v[32:35], v9 offset:2048
    ds_read_b128 v[40:43], v9 offset:3072
    ds_read_b128 v[48:51], v9 offset:4096
    ds_read_b128 v[56:59], v9 offset:5120
    s_waitcnt lgkmcnt(5)
    v_mfma_f32_16x16x32_bf16 v[96:99], v[16:19], a[0:3], 0
    v_mfma_f32_16x16x32_bf16 v[104:107], v[16:19], a[4:7], 0
    ds_read_b128 v[64:67], v9 offset:6144
    s_waitcnt lgkmcnt(5)
    v_mfma_f32_16x16x32_bf16 v[96:99], v[24:27], a[8:11], v[96:99]
    v_mfma_f32_16x16x32_bf16 v[104:107], v[24:27], a[12:15], v[104:107]
    ds_read_b128 v[72:75], v9 offset:7168
    s_waitcnt lgkmcnt(5)
    v_mfma_f32_16x16x32_bf16 v[96:99], v[32:35], a[16:19], v[96:99]
    v_mfma_f32_16x16x32_bf16 v[104:107], v[32:35], a[20:23], v[104:107]
    ds_read_b128 v[16:19], v9 offset:8192
    s_waitcnt lgkmcnt(5)
    v_mfma_f32_16x16x32_bf16 v[96:99], v[40:43], a[24:27], v[96:99]
    v_mfma_f32_16x16x32_bf16 v[104:107], v[40:43], a[28:31], v[104:107]
    ds_read_b128 v[24:27], v9 offset:9216
    s_waitcnt lgkmcnt(5)
    v_mfma_f32_16x16x32_bf16 v[96:99], v[48:51], a[32:35], v[96:99]
    v_mfma_f32_16x16x32_bf16 v[104:107], v[48:51], a[36:39], v[104:107]
    ds_read_b128 v[32:35], v9 offset:10240
    s_waitcnt lgkmcnt(5)
    v_mfma_f32_16x16x32_bf16 v[96:99], v[56:59], a[40:43], v[96:99]
    v_mfma_f32_16x16x32_bf16 v[104:107], v[56:59], a[44:47], v[104:107]
    ds_read_b128 v[40:43], v9 offset:11264
    s_waitcnt lgkmcnt(5)
    v_mfma_f32_16x16x32_bf16 v[96:99], v[64:67], a[48:51], v[96:99]
    v_mfma_f32_16x16x32_bf16 v[104:107], v[64:67], a[52:55], v[104:107]
    ds_read_b128 v[48:51], v9 offset:12288
    s_waitcnt lgkmcnt(5)
    v_mfma_f32_16x16x32_bf16 v[96:99], v[72:75], a[56:59], v[96:99]
    v_mfma_f32_16x16x32_bf16 v[104:107], v[72:75], a[60:63], v[104:107]
    ds_read_b128 v[56:59], v9 offset:13312
    s_waitcnt lgkmcnt(5)
    v_mfma_f32_16x16x32_bf16 v[96:99], v[16:19], a[64:67], v[96:99]
    v_mfma_f32_16x16x32_bf16 v[104:107], v[16:19], a[68:71], v[104:107]
    s_waitcnt lgkmcnt(4)
    v_mfma_f32_16x16x32_bf16 v[96:99], v[24:27], a[72:75], v[96:99]
    v_mfma_f32_16x16x32_bf16 v[104:107], v[24:27], a[76:79], v[104:107]
    s_waitcnt lgkmcnt(3)
    v_mfma_f32_16x16x32_bf16 v[96:99], v[32:35], a[80:83], v[96:99]
    v_mfma_f32_16x16x32_bf16 v[104:107], v[32:35], a[84:87], v[104:107]
    s_waitcnt lgkmcnt(2)
    v_mfma_f32_16x16x32_bf16 v[96:99], v[40:43], a[88:91], v[96:99]
    v_mfma_f32_16x16x32_bf16 v[104:107], v[40:43], a[92:95], v[104:107]
    s_waitcnt lgkmcnt(1)
    v_mfma_f32_16x16x32_bf16 v[96:99], v[48:51], a[96:99], v[96:99]
    v_mfma_f32_16x16x32_bf16 v[104:107], v[48:51], a[100:103], v[104:107]
    s_waitcnt lgkmcnt(0)
    v_mfma_f32_16x16x32_bf16 v[96:99], v[56:59], a[104:107], v[96:99]
    v_mfma_f32_16x16x32_bf16 v[104:107], v[56:59], a[108:111], v[104:107]
    s_lshl_b32 s22, s22, 10
    v_bfe_u32 v5, v1, 5, 1
    v_lshlrev_b32 v5, 9, v5
    v_bfe_u32 v2, v1, 0, 4
    v_lshlrev_b32 v2, 4, v2
    v_add_u32 v5, v5, v2
    v_bfe_u32 v2, v1, 4, 1
    v_lshlrev_b32 v2, 3, v2
    v_add_u32 v5, v5, v2
    v_add_u32 v5, 0x12c00, v5
    v_add_u32 v5, s22, v5
    v_and_b32 v10, 15, v1
    v_cmp_eq_u32 vcc, 12, v10
    v_mov_b32 v11, 0x3f803f80
    v_cvt_pk_bf16_f32 v120, v96, v97
    v_cvt_pk_bf16_f32 v121, v98, v99
    ds_write_b64 v5, v[120:121] offset:0
    v_cvt_pk_bf16_f32 v122, v104, v105
    v_cvt_pk_bf16_f32 v123, v106, v107
    v_cndmask_b32 v122, v122, v11, vcc
    v_cndmask_b32 v123, v123, v11, vcc
    ds_write_b64 v5, v[122:123] offset:256
at_q0:
    s_lshl_b32 s22, s3, 10
    s_add_u32 s22, s22, 0x12400
    v_add_u32 v5, s22, v4
    s_waitcnt lgkmcnt(0)
    s_barrier
    ds_read_b128 v[120:123], v5
    s_lshl_b32 s33, s21, 11
    s_and_b32 s22, s3, 1
    s_lshl_b32 s22, s22, 10
    s_add_u32 s33, s33, s22
    s_lshr_b32 s22, s3, 1
    s_mul_i32 s22, s22, 0x20000
    s_add_u32 s33, s33, s22
    s_add_u32 s33, s33, 0x3f80000
    s_add_u32 s33, s33, s84
    s_waitcnt lgkmcnt(0)
    buffer_store_dwordx4 v[120:123], v4, s[8:11], s33 offen sc1
    s_mul_i32 s25, s3, 28672
    s_add_u32 s25, s25, 0xc40000
    s_add_u32 s26, s25, 14336
    buffer_load_dwordx4 a[0:3], v4, s[8:11], s25 offen offset:0 sc1
    buffer_load_dwordx4 a[4:7], v4, s[8:11], s26 offen offset:0 sc1
    buffer_load_dwordx4 a[8:11], v4, s[8:11], s25 offen offset:1024 sc1
    buffer_load_dwordx4 a[12:15], v4, s[8:11], s26 offen offset:1024 sc1
    buffer_load_dwordx4 a[16:19], v4, s[8:11], s25 offen offset:2048 sc1
    buffer_load_dwordx4 a[20:23], v4, s[8:11], s26 offen offset:2048 sc1
    buffer_load_dwordx4 a[24:27], v4, s[8:11], s25 offen offset:3072 sc1
    buffer_load_dwordx4 a[28:31], v4, s[8:11], s26 offen offset:3072 sc1
    s_add_u32 s25, s25, 4096
    s_add_u32 s26, s26, 4096
    buffer_load_dwordx4 a[32:35], v4, s[8:11], s25 offen offset:0 sc1
    buffer_load_dwordx4 a[36:39], v4, s[8:11], s26 offen offset:0 sc1
    buffer_load_dwordx4 a[40:43], v4, s[8:11], s25 offen offset:1024 sc1
    buffer_load_dwordx4 a[44:47], v4, s[8:11], s26 offen offset:1024 sc1
    buffer_load_dwordx4 a[48:51], v4, s[8:11], s25 offen offset:2048 sc1
    buffer_load_dwordx4 a[52:55], v4, s[8:11], s26 offen offset:2048 sc1
    buffer_load_dwordx4 a[56:59], v4, s[8:11], s25 offen offset:3072 sc1
    buffer_load_dwordx4 a[60:63], v4, s[8:11], s26 offen offset:3072 sc1
    s_add_u32 s25, s25, 4096
    s_add_u32 s26, s26, 4096
    buffer_load_dwordx4 a[64:67], v4, s[8:11], s25 offen offset:0 sc1
    buffer_load_dwordx4 a[68:71], v4, s[8:11], s26 offen offset:0 sc1
    buffer_load_dwordx4 a[72:75], v4, s[8:11], s25 offen offset:1024 sc1
    buffer_load_dwordx4 a[76:79], v4, s[8:11], s26 offen offset:1024 sc1
    buffer_load_dwordx4 a[80:83], v4, s[8:11], s25 offen offset:2048 sc1
    buffer_load_dwordx4 a[84:87], v4, s[8:11], s26 offen offset:2048 sc1
    buffer_load_dwordx4 a[88:91], v4, s[8:11], s25 offen offset:3072 sc1
    buffer_load_dwordx4 a[92:95], v4, s[8:11], s26 offen offset:3072 sc1
    s_add_u32 s25, s25, 4096
    s_add_u32 s26, s26, 4096
    buffer_load_dwordx4 a[96:99], v4, s[8:11], s25 offen offset:0 sc1
    buffer_load_dwordx4 a[100:103], v4, s[8:11], s26 offen offset:0 sc1
    buffer_load_dwordx4 a[104:107], v4, s[8:11], s25 offen offset:1024 sc1
    buffer_load_dwordx4 a[108:111], v4, s[8:11], s26 offen offset:1024 sc1
    s_waitcnt vmcnt(28)
    s_barrier
    s_cmp_lg_u32 s3, 0
    s_cbranch_scc1 at_q
    s_lshl_b32 s22, s21, 7
    s_add_u32 s22, s22, 0x4296000
    s_add_u32 s22, s22, s84
    v_mov_b32 v2, 1
    v_mov_b32 v3, 0
    s_mov_b64 exec, 1
    buffer_store_dword v2, v3, s[8:11], s22 offen sc1
    s_mov_b64 exec, -1
at_q:
    s_waitcnt vmcnt(0)
    ds_read_b128 v[16:19], v4 offset:0
    ds_read_b128 v[20:23], v4 offset:14336
    ds_read_b128 v[24:27], v4 offset:1024
    ds_read_b128 v[28:31], v4 offset:15360
    ds_read_b128 v[32:35], v4 offset:2048
    ds_read_b128 v[36:39], v4 offset:16384
    ds_read_b128 v[40:43], v4 offset:3072
    ds_read_b128 v[44:47], v4 offset:17408
    ds_read_b128 v[48:51], v4 offset:4096
    ds_read_b128 v[52:55], v4 offset:18432
    ds_read_b128 v[56:59], v4 offset:5120
    ds_read_b128 v[60:63], v4 offset:19456
    s_waitcnt lgkmcnt(10)
    v_mfma_f32_16x16x32_bf16 v[96:99], a[0:3], v[16:19], 0
    v_mfma_f32_16x16x32_bf16 v[100:103], a[0:3], v[20:23], 0
    v_mfma_f32_16x16x32_bf16 v[104:107], a[4:7], v[16:19], 0
    v_mfma_f32_16x16x32_bf16 v[108:111], a[4:7], v[20:23], 0
    ds_read_b128 v[64:67], v4 offset:6144
    ds_read_b128 v[68:71], v4 offset:20480
    s_waitcnt lgkmcnt(10)
    v_mfma_f32_16x16x32_bf16 v[96:99], a[8:11], v[24:27], v[96:99]
    v_mfma_f32_16x16x32_bf16 v[100:103], a[8:11], v[28:31], v[100:103]
    v_mfma_f32_16x16x32_bf16 v[104:107], a[12:15], v[24:27], v[104:107]
    v_mfma_f32_16x16x32_bf16 v[108:111], a[12:15], v[28:31], v[108:111]
    ds_read_b128 v[72:75], v4 offset:7168
    ds_read_b128 v[76:79], v4 offset:21504
    s_waitcnt lgkmcnt(10)
    v_mfma_f32_16x16x32_bf16 v[96:99], a[16:19], v[32:35], v[96:99]
    v_mfma_f32_16x16x32_bf16 v[100:103], a[16:19], v[36:39], v[100:103]
    v_mfma_f32_16x16x32_bf16 v[104:107], a[20:23], v[32:35], v[104:107]
    v_mfma_f32_16x16x32_bf16 v[108:111], a[20:23], v[36:39], v[108:111]
    ds_read_b128 v[16:19], v4 offset:8192
    ds_read_b128 v[20:23], v4 offset:22528
    s_waitcnt lgkmcnt(10)
    v_mfma_f32_16x16x32_bf16 v[96:99], a[24:27], v[40:43], v[96:99]
    v_mfma_f32_16x16x32_bf16 v[100:103], a[24:27], v[44:47], v[100:103]
    v_mfma_f32_16x16x32_bf16 v[104:107], a[28:31], v[40:43], v[104:107]
    v_mfma_f32_16x16x32_bf16 v[108:111], a[28:31], v[44:47], v[108:111]
    ds_read_b128 v[24:27], v4 offset:9216
    ds_read_b128 v[28:31], v4 offset:23552
    s_waitcnt lgkmcnt(10)
    v_mfma_f32_16x16x32_bf16 v[96:99], a[32:35], v[48:51], v[96:99]
    v_mfma_f32_16x16x32_bf16 v[100:103], a[32:35], v[52:55], v[100:103]
    v_mfma_f32_16x16x32_bf16 v[104:107], a[36:39], v[48:51], v[104:107]
    v_mfma_f32_16x16x32_bf16 v[108:111], a[36:39], v[52:55], v[108:111]
    ds_read_b128 v[32:35], v4 offset:10240
    ds_read_b128 v[36:39], v4 offset:24576
    s_waitcnt lgkmcnt(10)
    v_mfma_f32_16x16x32_bf16 v[96:99], a[40:43], v[56:59], v[96:99]
    v_mfma_f32_16x16x32_bf16 v[100:103], a[40:43], v[60:63], v[100:103]
    v_mfma_f32_16x16x32_bf16 v[104:107], a[44:47], v[56:59], v[104:107]
    v_mfma_f32_16x16x32_bf16 v[108:111], a[44:47], v[60:63], v[108:111]
    ds_read_b128 v[40:43], v4 offset:11264
    ds_read_b128 v[44:47], v4 offset:25600
    s_waitcnt lgkmcnt(10)
    v_mfma_f32_16x16x32_bf16 v[96:99], a[48:51], v[64:67], v[96:99]
    v_mfma_f32_16x16x32_bf16 v[100:103], a[48:51], v[68:71], v[100:103]
    v_mfma_f32_16x16x32_bf16 v[104:107], a[52:55], v[64:67], v[104:107]
    v_mfma_f32_16x16x32_bf16 v[108:111], a[52:55], v[68:71], v[108:111]
    ds_read_b128 v[48:51], v4 offset:12288
    ds_read_b128 v[52:55], v4 offset:26624
    s_waitcnt lgkmcnt(10)
    v_mfma_f32_16x16x32_bf16 v[96:99], a[56:59], v[72:75], v[96:99]
    v_mfma_f32_16x16x32_bf16 v[100:103], a[56:59], v[76:79], v[100:103]
    v_mfma_f32_16x16x32_bf16 v[104:107], a[60:63], v[72:75], v[104:107]
    v_mfma_f32_16x16x32_bf16 v[108:111], a[60:63], v[76:79], v[108:111]
    ds_read_b128 v[56:59], v4 offset:13312
    ds_read_b128 v[60:63], v4 offset:27648
    s_waitcnt lgkmcnt(10)
    v_mfma_f32_16x16x32_bf16 v[96:99], a[64:67], v[16:19], v[96:99]
    v_mfma_f32_16x16x32_bf16 v[100:103], a[64:67], v[20:23], v[100:103]
    v_mfma_f32_16x16x32_bf16 v[104:107], a[68:71], v[16:19], v[104:107]
    v_mfma_f32_16x16x32_bf16 v[108:111], a[68:71], v[20:23], v[108:111]
    s_waitcnt lgkmcnt(8)
    v_mfma_f32_16x16x32_bf16 v[96:99], a[72:75], v[24:27], v[96:99]
    v_mfma_f32_16x16x32_bf16 v[100:103], a[72:75], v[28:31], v[100:103]
    v_mfma_f32_16x16x32_bf16 v[104:107], a[76:79], v[24:27], v[104:107]
    v_mfma_f32_16x16x32_bf16 v[108:111], a[76:79], v[28:31], v[108:111]
    s_waitcnt lgkmcnt(6)
    v_mfma_f32_16x16x32_bf16 v[96:99], a[80:83], v[32:35], v[96:99]
    v_mfma_f32_16x16x32_bf16 v[100:103], a[80:83], v[36:39], v[100:103]
    v_mfma_f32_16x16x32_bf16 v[104:107], a[84:87], v[32:35], v[104:107]
    v_mfma_f32_16x16x32_bf16 v[108:111], a[84:87], v[36:39], v[108:111]
    s_waitcnt lgkmcnt(4)
    v_mfma_f32_16x16x32_bf16 v[96:99], a[88:91], v[40:43], v[96:99]
    v_mfma_f32_16x16x32_bf16 v[100:103], a[88:91], v[44:47], v[100:103]
    v_mfma_f32_16x16x32_bf16 v[104:107], a[92:95], v[40:43], v[104:107]
    v_mfma_f32_16x16x32_bf16 v[108:111], a[92:95], v[44:47], v[108:111]
    s_waitcnt lgkmcnt(2)
    v_mfma_f32_16x16x32_bf16 v[96:99], a[96:99], v[48:51], v[96:99]
    v_mfma_f32_16x16x32_bf16 v[100:103], a[96:99], v[52:55], v[100:103]
    v_mfma_f32_16x16x32_bf16 v[104:107], a[100:103], v[48:51], v[104:107]
    v_mfma_f32_16x16x32_bf16 v[108:111], a[100:103], v[52:55], v[108:111]
    s_waitcnt lgkmcnt(0)
    v_mfma_f32_16x16x32_bf16 v[96:99], a[104:107], v[56:59], v[96:99]
    v_mfma_f32_16x16x32_bf16 v[100:103], a[104:107], v[60:63], v[100:103]
    v_mfma_f32_16x16x32_bf16 v[104:107], a[108:111], v[56:59], v[104:107]
    v_mfma_f32_16x16x32_bf16 v[108:111], a[108:111], v[60:63], v[108:111]
    s_mov_b32 s32, 0x3e8b97f6
    s_lshl_b32 s22, s3, 11
    v_bfe_u32 v5, v1, 5, 1
    v_lshlrev_b32 v5, 10, v5
    v_bfe_u32 v2, v1, 4, 1
    v_lshlrev_b32 v2, 9, v2
    v_add_u32 v5, v5, v2
    v_bfe_u32 v2, v1, 0, 4
    v_lshlrev_b32 v2, 4, v2
    v_add_u32 v5, v5, v2
    v_add_u32 v5, 0x10400, v5
    v_add_u32 v5, s22, v5
    v_mul_f32 v96, s32, v96
    v_mul_f32 v97, s32, v97
    v_mul_f32 v98, s32, v98
    v_mul_f32 v99, s32, v99
    v_cvt_pk_bf16_f32 v112, v96, v97
    v_cvt_pk_bf16_f32 v113, v98, v99
    v_mul_f32 v104, s32, v104
    v_mul_f32 v105, s32, v105
    v_mul_f32 v106, s32, v106
    v_mul_f32 v107, s32, v107
    v_cvt_pk_bf16_f32 v114, v104, v105
    v_cvt_pk_bf16_f32 v115, v106, v107
    ds_write_b128 v5, v[112:115] offset:0
    v_mul_f32 v100, s32, v100
    v_mul_f32 v101, s32, v101
    v_mul_f32 v102, s32, v102
    v_mul_f32 v103, s32, v103
    v_cvt_pk_bf16_f32 v116, v100, v101
    v_cvt_pk_bf16_f32 v117, v102, v103
    v_mul_f32 v108, s32, v108
    v_mul_f32 v109, s32, v109
    v_mul_f32 v110, s32, v110
    v_mul_f32 v111, s32, v111
    v_cvt_pk_bf16_f32 v118, v108, v109
    v_cvt_pk_bf16_f32 v119, v110, v111
    ds_write_b128 v5, v[116:119] offset:256
    s_waitcnt lgkmcnt(0)
    s_barrier
at_qd:
    v_add_u32 v9, 0x10400, v4
    ds_read_b128 a[0:3], v9 offset:0
    ds_read_b128 a[4:7], v9 offset:1024
    ds_read_b128 a[8:11], v9 offset:2048
    ds_read_b128 a[12:15], v9 offset:3072
    ds_read_b128 a[16:19], v9 offset:4096
    ds_read_b128 a[20:23], v9 offset:5120
    ds_read_b128 a[24:27], v9 offset:6144
    ds_read_b128 a[28:31], v9 offset:7168
    v_accvgpr_write_b32 a32, 0
    v_accvgpr_write_b32 a33, 0
    v_accvgpr_write_b32 a34, 0
    v_accvgpr_write_b32 a35, 0
    v_accvgpr_write_b32 a36, 0
    v_accvgpr_write_b32 a37, 0
    v_accvgpr_write_b32 a38, 0
    v_accvgpr_write_b32 a39, 0
    v_accvgpr_write_b32 a40, 0
    v_accvgpr_write_b32 a41, 0
    v_accvgpr_write_b32 a42, 0
    v_accvgpr_write_b32 a43, 0
    v_accvgpr_write_b32 a44, 0
    v_accvgpr_write_b32 a45, 0
    v_accvgpr_write_b32 a46, 0
    v_accvgpr_write_b32 a47, 0
    v_accvgpr_write_b32 a48, 0
    v_accvgpr_write_b32 a49, 0
    v_accvgpr_write_b32 a50, 0
    v_accvgpr_write_b32 a51, 0
    v_accvgpr_write_b32 a52, 0
    v_accvgpr_write_b32 a53, 0
    v_accvgpr_write_b32 a54, 0
    v_accvgpr_write_b32 a55, 0
    v_accvgpr_write_b32 a56, 0
    v_accvgpr_write_b32 a57, 0
    v_accvgpr_write_b32 a58, 0
    v_accvgpr_write_b32 a59, 0
    v_accvgpr_write_b32 a60, 0
    v_accvgpr_write_b32 a61, 0
    v_accvgpr_write_b32 a62, 0
    v_accvgpr_write_b32 a63, 0
    v_accvgpr_write_b32 a64, 0
    v_accvgpr_write_b32 a65, 0
    v_accvgpr_write_b32 a66, 0
    v_accvgpr_write_b32 a67, 0
    v_accvgpr_write_b32 a68, 0
    v_accvgpr_write_b32 a69, 0
    v_accvgpr_write_b32 a70, 0
    v_accvgpr_write_b32 a71, 0
    v_accvgpr_write_b32 a72, 0
    v_accvgpr_write_b32 a73, 0
    v_accvgpr_write_b32 a74, 0
    v_accvgpr_write_b32 a75, 0
    v_accvgpr_write_b32 a76, 0
    v_accvgpr_write_b32 a77, 0
    v_accvgpr_write_b32 a78, 0
    v_accvgpr_write_b32 a79, 0
    v_accvgpr_write_b32 a80, 0
    v_accvgpr_write_b32 a81, 0
    v_accvgpr_write_b32 a82, 0
    v_accvgpr_write_b32 a83, 0
    v_accvgpr_write_b32 a84, 0
    v_accvgpr_write_b32 a85, 0
    v_accvgpr_write_b32 a86, 0
    v_accvgpr_write_b32 a87, 0
    v_accvgpr_write_b32 a88, 0
    v_accvgpr_write_b32 a89, 0
    v_accvgpr_write_b32 a90, 0
    v_accvgpr_write_b32 a91, 0
    v_accvgpr_write_b32 a92, 0
    v_accvgpr_write_b32 a93, 0
    v_accvgpr_write_b32 a94, 0
    v_accvgpr_write_b32 a95, 0
    s_add_u32 s22, s3, 0
    v_lshlrev_b32 v5, 2, v1
    v_add_u32 v5, s22, v5
    v_cmp_gt_u32 vcc, 11, v1
    s_nop 1
    v_cndmask_b32 v5, 0, v5, vcc
    v_lshlrev_b32 v5, 7, v5
    v_add_u32 v5, 0x14000, v5
    v_mov_b32 v6, 0x6f80
    v_cmp_lt_u32 vcc, 31, v1
    s_nop 1
    v_cndmask_b32 v5, v5, v6, vcc
    s_mov_b32 s22, 0x4282000
    s_add_u32 s22, s22, s84
    s_mov_b32 s40, 0
at_kvwa:
    buffer_load_dword v6, v5, s[8:11], s22 offen sc1
    s_waitcnt vmcnt(0)
    v_cmp_eq_u32 vcc, 0, v6
    s_cbranch_vccz at_kvoka
    s_sleep 2
    s_add_u32 s40, s40, 1
    s_cmp_lt_u32 s40, 0x10000
    s_cbranch_scc1 at_kvwa
at_kvoka:
    s_mov_b32 s22, 0x3f80000
    s_add_u32 s22, s22, s84
    buffer_load_dwordx4 a[160:163], v4, s[8:11], s22 offen offset:0 sc1
    buffer_load_dwordx4 a[164:167], v4, s[8:11], s22 offen offset:1024 sc1
    s_lshl_b32 s24, s3, 11
    s_add_u32 s25, s24, 0x3fa0000
    s_add_u32 s25, s25, s84
    s_add_u32 s24, s24, 0x3f80000
    s_add_u32 s24, s24, s84
    buffer_load_dwordx4 a[96:99], v4, s[8:11], s24 offen offset:0 sc1
    buffer_load_dwordx4 a[100:103], v4, s[8:11], s24 offen offset:1024 sc1
    buffer_load_dwordx4 a[104:107], v4, s[8:11], s25 offen offset:0 sc1
    buffer_load_dwordx4 a[108:111], v4, s[8:11], s25 offen offset:1024 sc1
    s_add_u32 s24, s24, 8192
    s_add_u32 s25, s25, 8192
    buffer_load_dwordx4 a[112:115], v4, s[8:11], s24 offen offset:0 sc1
    buffer_load_dwordx4 a[116:119], v4, s[8:11], s24 offen offset:1024 sc1
    buffer_load_dwordx4 a[120:123], v4, s[8:11], s25 offen offset:0 sc1
    buffer_load_dwordx4 a[124:127], v4, s[8:11], s25 offen offset:1024 sc1
    s_add_u32 s24, s24, 8192
    s_add_u32 s25, s25, 8192
    buffer_load_dwordx4 a[128:131], v4, s[8:11], s24 offen offset:0 sc1
    buffer_load_dwordx4 a[132:135], v4, s[8:11], s24 offen offset:1024 sc1
    buffer_load_dwordx4 a[136:139], v4, s[8:11], s25 offen offset:0 sc1
    buffer_load_dwordx4 a[140:143], v4, s[8:11], s25 offen offset:1024 sc1
    s_add_u32 s24, s24, 8192
    s_add_u32 s25, s25, 8192
    s_mov_b32 s36, s8
    s_mov_b32 s37, s9
    s_mov_b32 s38, s10
    s_mov_b32 s39, s11
    s_mov_b32 s48, 0
    s_cmp_eq_u32 s42, 0
    s_cbranch_scc1 sl_9_0
    s_mul_i32 s34, s20, 7
    s_lshl_b32 s35, s3, 1
    s_add_u32 s34, s34, s35
    s_lshl_b32 s34, s34, 14
    s_add_u32 s34, s34, 0xd30000
    s_movk_i32 s44, 1024
    s_mov_b32 s45, -1
    s_movk_i32 s47, 16384
    s_cmp_lt_u32 s3, 3
    s_cselect_b32 s38, s10, 0
    s_branch sl_9_d
sl_9_0:
    s_cmp_eq_u32 s43, 0
    s_cbranch_scc1 sl_9_w
    s_cmp_ge_u32 s100, 30
    s_cbranch_scc1 sl_9_w
    s_cmp_ge_u32 s100, 16
    s_cbranch_scc1 sl_9_b
    s_lshr_b32 s34, s3, 1
    s_mul_i32 s34, s34, 14
    s_and_b32 s35, s3, 1
    s_lshl_b32 s35, s35, 3
    s_add_u32 s34, s34, s35
    s_mul_i32 s35, s100, 28
    s_add_u32 s34, s34, s35
    s_mul_i32 s34, s34, 14336
    s_add_u32 s34, s34, 0x620000
    s_branch sl_9_t
sl_9_b:
    s_mul_i32 s34, s3, 112
    s_sub_u32 s35, s100, 16
    s_lshl_b32 s35, s35, 1
    s_add_u32 s34, s34, s35
    s_mul_i32 s34, s34, 14336
    s_add_u32 s34, s34, 0x0
sl_9_t:
    s_add_u32 s45, s34, 14336
    s_lshl_b32 s35, s3, 12
    s_add_u32 s34, s34, s35
    s_movk_i32 s44, 2048
    s_movk_i32 s46, -14336
    s_movk_i32 s47, 1024
    s_movk_i32 s48, 14336
    s_branch sl_9_d
sl_9_w:
    s_lshl_b32 s34, s3, 2
    s_cmp_eq_u32 s3, 3
    s_cselect_b32 s34, 11, s34
    s_lshl_b32 s34, s34, 15
    s_add_u32 s34, s34, 0xcc0000
    s_add_u32 s45, s34, 131072
    s_mov_b32 s44, 32768
    s_mov_b32 s46, -130048
    s_movk_i32 s47, 16384
sl_9_d:
    s_add_u32 s35, s34, s47
    v_accvgpr_write_b32 a152, 0
    v_mov_b32 v120, 0
    v_accvgpr_write_b32 a153, 0
    v_mov_b32 v121, 0
    v_accvgpr_write_b32 a154, 0
    v_mov_b32 v122, 0
    v_accvgpr_write_b32 a155, 0
    v_mov_b32 v123, 0
    v_accvgpr_write_b32 a156, 0
    v_mov_b32 v124, 0
    v_accvgpr_write_b32 a157, 0
    v_mov_b32 v125, 0
    v_accvgpr_write_b32 a158, 0
    v_mov_b32 v126, 0
    v_accvgpr_write_b32 a159, 0
    v_mov_b32 v127, 0
    s_mov_b32 s30, 0x5f800000
    s_mov_b32 s41, 0
    s_waitcnt vmcnt(12) lgkmcnt(0)
    v_mfma_f32_32x32x16_bf16 v[16:31], a[160:163], a[0:3], 0
    v_mfma_f32_32x32x16_bf16 v[16:31], a[164:167], a[4:7], v[16:31]
    v_mfma_f32_32x32x16_bf16 v[32:47], a[160:163], a[8:11], 0
    v_mfma_f32_32x32x16_bf16 v[32:47], a[164:167], a[12:15], v[32:47]
    v_mfma_f32_32x32x16_bf16 v[48:63], a[160:163], a[16:19], 0
    v_mfma_f32_32x32x16_bf16 v[48:63], a[164:167], a[20:23], v[48:63]
    v_mfma_f32_32x32x16_bf16 v[64:79], a[160:163], a[24:27], 0
    v_mfma_f32_32x32x16_bf16 v[64:79], a[164:167], a[28:31], v[64:79]
    v_max3_f32 v8, v16, v17, v18
    v_max3_f32 v8, v8, v19, v20
    v_max3_f32 v8, v8, v21, v22
    v_max3_f32 v8, v8, v23, v24
    v_max3_f32 v8, v8, v25, v26
    v_max3_f32 v8, v8, v27, v28
    v_max3_f32 v8, v8, v29, v30
    v_max_f32 v8, v8, v31
    v_max3_f32 v9, v32, v33, v34
    v_max3_f32 v9, v9, v35, v36
    v_max3_f32 v9, v9, v37, v38
    v_max3_f32 v9, v9, v39, v40
    v_max3_f32 v9, v9, v41, v42
    v_max3_f32 v9, v9, v43, v44
    v_max3_f32 v9, v9, v45, v46
    v_max_f32 v9, v9, v47
    v_max3_f32 v10, v48, v49, v50
    v_max3_f32 v10, v10, v51, v52
    v_max3_f32 v10, v10, v53, v54
    v_max3_f32 v10, v10, v55, v56
    v_max3_f32 v10, v10, v57, v58
    v_max3_f32 v10, v10, v59, v60
    v_max3_f32 v10, v10, v61, v62
    v_max_f32 v10, v10, v63
    v_max3_f32 v11, v64, v65, v66
    v_max3_f32 v11, v11, v67, v68
    v_max3_f32 v11, v11, v69, v70
    v_max3_f32 v11, v11, v71, v72
    v_max3_f32 v11, v11, v73, v74
    v_max3_f32 v11, v11, v75, v76
    v_max3_f32 v11, v11, v77, v78
    v_max_f32 v11, v11, v79
    v_mov_b32 v12, v8
    v_mov_b32 v13, v9
    v_mov_b32 v14, v10
    v_mov_b32 v15, v11
    v_permlane32_swap_b32 v8, v12
    v_permlane32_swap_b32 v9, v13
    v_permlane32_swap_b32 v10, v14
    v_permlane32_swap_b32 v11, v15
    v_max_f32 v8, v8, v12
    v_max_f32 v9, v9, v13
    v_max_f32 v10, v10, v14
    v_max_f32 v11, v11, v15
    v_sub_f32 v16, 0, v8
    v_sub_f32 v17, 0, v8
    v_sub_f32 v18, 0, v8
    v_sub_f32 v19, 0, v8
    v_sub_f32 v20, 0, v8
    v_sub_f32 v21, 0, v8
    v_sub_f32 v22, 0, v8
    v_sub_f32 v23, 0, v8
    v_sub_f32 v24, 0, v8
    v_sub_f32 v25, 0, v8
    v_sub_f32 v26, 0, v8
    v_sub_f32 v27, 0, v8
    v_sub_f32 v28, 0, v8
    v_sub_f32 v29, 0, v8
    v_sub_f32 v30, 0, v8
    v_sub_f32 v31, 0, v8
    v_sub_f32 v32, 0, v9
    v_sub_f32 v33, 0, v9
    v_sub_f32 v34, 0, v9
    v_sub_f32 v35, 0, v9
    v_sub_f32 v36, 0, v9
    v_sub_f32 v37, 0, v9
    v_sub_f32 v38, 0, v9
    v_sub_f32 v39, 0, v9
    v_sub_f32 v40, 0, v9
    v_sub_f32 v41, 0, v9
    v_sub_f32 v42, 0, v9
    v_sub_f32 v43, 0, v9
    v_sub_f32 v44, 0, v9
    v_sub_f32 v45, 0, v9
    v_sub_f32 v46, 0, v9
    v_sub_f32 v47, 0, v9
    v_sub_f32 v48, 0, v10
    v_sub_f32 v49, 0, v10
    v_sub_f32 v50, 0, v10
    v_sub_f32 v51, 0, v10
    v_sub_f32 v52, 0, v10
    v_sub_f32 v53, 0, v10
    v_sub_f32 v54, 0, v10
    v_sub_f32 v55, 0, v10
    v_sub_f32 v56, 0, v10
    v_sub_f32 v57, 0, v10
    v_sub_f32 v58, 0, v10
    v_sub_f32 v59, 0, v10
    v_sub_f32 v60, 0, v10
    v_sub_f32 v61, 0, v10
    v_sub_f32 v62, 0, v10
    v_sub_f32 v63, 0, v10
    v_sub_f32 v64, 0, v11
    v_sub_f32 v65, 0, v11
    v_sub_f32 v66, 0, v11
    v_sub_f32 v67, 0, v11
    v_sub_f32 v68, 0, v11
    v_sub_f32 v69, 0, v11
    v_sub_f32 v70, 0, v11
    v_sub_f32 v71, 0, v11
    v_sub_f32 v72, 0, v11
    v_sub_f32 v73, 0, v11
    v_sub_f32 v74, 0, v11
    v_sub_f32 v75, 0, v11
    v_sub_f32 v76, 0, v11
    v_sub_f32 v77, 0, v11
    v_sub_f32 v78, 0, v11
    v_sub_f32 v79, 0, v11
at_pass:
    s_waitcnt vmcnt(8)
    v_mfma_f32_32x32x16_bf16 v[80:95], a[96:99], a[0:3], v[16:31]
    v_mfma_f32_32x32x16_bf16 v[80:95], a[100:103], a[4:7], v[80:95]
at_loop:
    s_nop 11
    v_exp_f32 v80, v80
    v_mfma_f32_32x32x16_bf16 v[96:111], a[96:99], a[8:11], v[32:47]
    v_exp_f32 v81, v81
    v_exp_f32 v82, v82
    v_exp_f32 v83, v83
    v_exp_f32 v84, v84
    v_cvt_pk_bf16_f32 v112, v80, v81
    v_mfma_f32_32x32x16_bf16 v[96:111], a[100:103], a[12:15], v[96:111]
    v_exp_f32 v85, v85
    v_exp_f32 v86, v86
    v_exp_f32 v87, v87
    v_exp_f32 v88, v88
    v_cvt_pk_bf16_f32 v113, v82, v83
    v_cvt_pk_bf16_f32 v114, v84, v85
    v_mfma_f32_32x32x16_bf16 a[80:95], a[152:155], v[120:123], a[80:95]
    v_exp_f32 v89, v89
    v_exp_f32 v90, v90
    v_exp_f32 v91, v91
    v_exp_f32 v92, v92
    v_cvt_pk_bf16_f32 v115, v86, v87
    v_cvt_pk_bf16_f32 v116, v88, v89
    v_mfma_f32_32x32x16_bf16 a[80:95], a[156:159], v[124:127], a[80:95]
    v_exp_f32 v93, v93
    buffer_load_dwordx4 a[144:147], v4, s[8:11], s24 offen offset:0 sc1
    buffer_load_dwordx4 a[148:151], v4, s[8:11], s24 offen offset:1024 sc1
    buffer_load_dwordx4 a[152:155], v4, s[8:11], s25 offen offset:0 sc1
    buffer_load_dwordx4 a[156:159], v4, s[8:11], s25 offen offset:1024 sc1
    s_add_u32 s24, s24, 8192
    s_add_u32 s25, s25, 8192
    buffer_load_dwordx4 a[168:171], v4, s[8:11], s34 offen sc1
    buffer_load_dwordx4 a[172:175], v4, s[36:39], s35 offen sc1
    s_add_u32 s34, s34, s44
    s_cmp_ge_u32 s34, s45
    s_cselect_b32 s35, s46, 0
    s_add_u32 s34, s34, s35
    s_add_u32 s35, s34, s47
    v_exp_f32 v94, v94
    v_exp_f32 v95, v95
    v_cvt_pk_bf16_f32 v117, v90, v91
    v_cvt_pk_bf16_f32 v118, v92, v93
    v_cvt_pk_bf16_f32 v119, v94, v95
    v_exp_f32 v96, v96
    v_mfma_f32_32x32x16_bf16 v[80:95], a[96:99], a[16:19], v[48:63]
    v_exp_f32 v97, v97
    v_exp_f32 v98, v98
    v_exp_f32 v99, v99
    v_exp_f32 v100, v100
    v_cvt_pk_bf16_f32 v120, v96, v97
    v_mfma_f32_32x32x16_bf16 v[80:95], a[100:103], a[20:23], v[80:95]
    v_exp_f32 v101, v101
    v_exp_f32 v102, v102
    v_exp_f32 v103, v103
    v_exp_f32 v104, v104
    v_cvt_pk_bf16_f32 v121, v98, v99
    v_cvt_pk_bf16_f32 v122, v100, v101
    v_mfma_f32_32x32x16_bf16 a[32:47], a[104:107], v[112:115], a[32:47]
    v_exp_f32 v105, v105
    v_exp_f32 v106, v106
    v_exp_f32 v107, v107
    v_exp_f32 v108, v108
    v_cvt_pk_bf16_f32 v123, v102, v103
    v_cvt_pk_bf16_f32 v124, v104, v105
    v_mfma_f32_32x32x16_bf16 a[32:47], a[108:111], v[116:119], a[32:47]
    v_exp_f32 v109, v109
    v_exp_f32 v110, v110
    v_exp_f32 v111, v111
    v_cvt_pk_bf16_f32 v125, v106, v107
    v_cvt_pk_bf16_f32 v126, v108, v109
    v_cvt_pk_bf16_f32 v127, v110, v111
    v_exp_f32 v80, v80
    v_mfma_f32_32x32x16_bf16 v[96:111], a[96:99], a[24:27], v[64:79]
    v_exp_f32 v81, v81
    v_exp_f32 v82, v82
    v_exp_f32 v83, v83
    v_exp_f32 v84, v84
    v_cvt_pk_bf16_f32 v112, v80, v81
    v_mfma_f32_32x32x16_bf16 v[96:111], a[100:103], a[28:31], v[96:111]
    v_exp_f32 v85, v85
    v_exp_f32 v86, v86
    v_exp_f32 v87, v87
    v_exp_f32 v88, v88
    v_cvt_pk_bf16_f32 v113, v82, v83
    v_cvt_pk_bf16_f32 v114, v84, v85
    v_mfma_f32_32x32x16_bf16 a[48:63], a[104:107], v[120:123], a[48:63]
    v_exp_f32 v89, v89
    v_exp_f32 v90, v90
    v_exp_f32 v91, v91
    v_exp_f32 v92, v92
    v_cvt_pk_bf16_f32 v115, v86, v87
    v_cvt_pk_bf16_f32 v116, v88, v89
    v_mfma_f32_32x32x16_bf16 a[48:63], a[108:111], v[124:127], a[48:63]
    v_exp_f32 v93, v93
    v_exp_f32 v94, v94
    v_exp_f32 v95, v95
    v_cvt_pk_bf16_f32 v117, v90, v91
    v_cvt_pk_bf16_f32 v118, v92, v93
    v_cvt_pk_bf16_f32 v119, v94, v95
    s_waitcnt vmcnt(10)
    v_exp_f32 v96, v96
    v_mfma_f32_32x32x16_bf16 v[80:95], a[112:115], a[0:3], v[16:31]
    v_exp_f32 v97, v97
    v_exp_f32 v98, v98
    v_exp_f32 v99, v99
    v_exp_f32 v100, v100
    v_cvt_pk_bf16_f32 v120, v96, v97
    v_mfma_f32_32x32x16_bf16 v[80:95], a[116:119], a[4:7], v[80:95]
    v_exp_f32 v101, v101
    v_exp_f32 v102, v102
    v_exp_f32 v103, v103
    v_exp_f32 v104, v104
    v_cvt_pk_bf16_f32 v121, v98, v99
    v_cvt_pk_bf16_f32 v122, v100, v101
    v_mfma_f32_32x32x16_bf16 a[64:79], a[104:107], v[112:115], a[64:79]
    v_exp_f32 v105, v105
    v_exp_f32 v106, v106
    v_exp_f32 v107, v107
    v_exp_f32 v108, v108
    v_cvt_pk_bf16_f32 v123, v102, v103
    v_cvt_pk_bf16_f32 v124, v104, v105
    v_mfma_f32_32x32x16_bf16 a[64:79], a[108:111], v[116:119], a[64:79]
    v_exp_f32 v109, v109
    v_exp_f32 v110, v110
    v_exp_f32 v111, v111
    v_cvt_pk_bf16_f32 v125, v106, v107
    v_cvt_pk_bf16_f32 v126, v108, v109
    v_cvt_pk_bf16_f32 v127, v110, v111
    v_exp_f32 v80, v80
    v_mfma_f32_32x32x16_bf16 v[96:111], a[112:115], a[8:11], v[32:47]
    v_exp_f32 v81, v81
    v_exp_f32 v82, v82
    v_exp_f32 v83, v83
    v_exp_f32 v84, v84
    v_cvt_pk_bf16_f32 v112, v80, v81
    v_mfma_f32_32x32x16_bf16 v[96:111], a[116:119], a[12:15], v[96:111]
    v_exp_f32 v85, v85
    v_exp_f32 v86, v86
    v_exp_f32 v87, v87
    v_exp_f32 v88, v88
    v_cvt_pk_bf16_f32 v113, v82, v83
    v_cvt_pk_bf16_f32 v114, v84, v85
    v_mfma_f32_32x32x16_bf16 a[80:95], a[104:107], v[120:123], a[80:95]
    v_exp_f32 v89, v89
    v_exp_f32 v90, v90
    v_exp_f32 v91, v91
    v_exp_f32 v92, v92
    v_cvt_pk_bf16_f32 v115, v86, v87
    v_cvt_pk_bf16_f32 v116, v88, v89
    v_mfma_f32_32x32x16_bf16 a[80:95], a[108:111], v[124:127], a[80:95]
    v_exp_f32 v93, v93
    buffer_load_dwordx4 a[96:99], v4, s[8:11], s24 offen offset:0 sc1
    buffer_load_dwordx4 a[100:103], v4, s[8:11], s24 offen offset:1024 sc1
    buffer_load_dwordx4 a[104:107], v4, s[8:11], s25 offen offset:0 sc1
    buffer_load_dwordx4 a[108:111], v4, s[8:11], s25 offen offset:1024 sc1
    s_add_u32 s24, s24, 8192
    s_add_u32 s25, s25, 8192
    buffer_load_dwordx4 a[176:179], v4, s[8:11], s34 offen sc1
    buffer_load_dwordx4 a[180:183], v4, s[36:39], s35 offen sc1
    s_add_u32 s34, s34, s44
    s_cmp_ge_u32 s34, s45
    s_cselect_b32 s35, s46, 0
    s_add_u32 s34, s34, s35
    s_add_u32 s35, s34, s47
    v_exp_f32 v94, v94
    v_exp_f32 v95, v95
    v_cvt_pk_bf16_f32 v117, v90, v91
    v_cvt_pk_bf16_f32 v118, v92, v93
    v_cvt_pk_bf16_f32 v119, v94, v95
    v_exp_f32 v96, v96
    v_mfma_f32_32x32x16_bf16 v[80:95], a[112:115], a[16:19], v[48:63]
    v_exp_f32 v97, v97
    v_exp_f32 v98, v98
    v_exp_f32 v99, v99
    v_exp_f32 v100, v100
    v_cvt_pk_bf16_f32 v120, v96, v97
    v_mfma_f32_32x32x16_bf16 v[80:95], a[116:119], a[20:23], v[80:95]
    v_exp_f32 v101, v101
    v_exp_f32 v102, v102
    v_exp_f32 v103, v103
    v_exp_f32 v104, v104
    v_cvt_pk_bf16_f32 v121, v98, v99
    v_cvt_pk_bf16_f32 v122, v100, v101
    v_mfma_f32_32x32x16_bf16 a[32:47], a[120:123], v[112:115], a[32:47]
    v_exp_f32 v105, v105
    v_exp_f32 v106, v106
    v_exp_f32 v107, v107
    v_exp_f32 v108, v108
    v_cvt_pk_bf16_f32 v123, v102, v103
    v_cvt_pk_bf16_f32 v124, v104, v105
    v_mfma_f32_32x32x16_bf16 a[32:47], a[124:127], v[116:119], a[32:47]
    v_exp_f32 v109, v109
    v_exp_f32 v110, v110
    v_exp_f32 v111, v111
    v_cvt_pk_bf16_f32 v125, v106, v107
    v_cvt_pk_bf16_f32 v126, v108, v109
    v_cvt_pk_bf16_f32 v127, v110, v111
    v_exp_f32 v80, v80
    v_mfma_f32_32x32x16_bf16 v[96:111], a[112:115], a[24:27], v[64:79]
    v_exp_f32 v81, v81
    v_exp_f32 v82, v82
    v_exp_f32 v83, v83
    v_exp_f32 v84, v84
    v_cvt_pk_bf16_f32 v112, v80, v81
    v_mfma_f32_32x32x16_bf16 v[96:111], a[116:119], a[28:31], v[96:111]
    v_exp_f32 v85, v85
    v_exp_f32 v86, v86
    v_exp_f32 v87, v87
    v_exp_f32 v88, v88
    v_cvt_pk_bf16_f32 v113, v82, v83
    v_cvt_pk_bf16_f32 v114, v84, v85
    v_mfma_f32_32x32x16_bf16 a[48:63], a[120:123], v[120:123], a[48:63]
    v_exp_f32 v89, v89
    v_exp_f32 v90, v90
    v_exp_f32 v91, v91
    v_exp_f32 v92, v92
    v_cvt_pk_bf16_f32 v115, v86, v87
    v_cvt_pk_bf16_f32 v116, v88, v89
    v_mfma_f32_32x32x16_bf16 a[48:63], a[124:127], v[124:127], a[48:63]
    v_exp_f32 v93, v93
    v_exp_f32 v94, v94
    v_exp_f32 v95, v95
    v_cvt_pk_bf16_f32 v117, v90, v91
    v_cvt_pk_bf16_f32 v118, v92, v93
    v_cvt_pk_bf16_f32 v119, v94, v95
    s_waitcnt vmcnt(12)
    v_exp_f32 v96, v96
    v_mfma_f32_32x32x16_bf16 v[80:95], a[128:131], a[0:3], v[16:31]
    v_exp_f32 v97, v97
    v_exp_f32 v98, v98
    v_exp_f32 v99, v99
    v_exp_f32 v100, v100
    v_cvt_pk_bf16_f32 v120, v96, v97
    v_mfma_f32_32x32x16_bf16 v[80:95], a[132:135], a[4:7], v[80:95]
    v_exp_f32 v101, v101
    v_exp_f32 v102, v102
    v_exp_f32 v103, v103
    v_exp_f32 v104, v104
    v_cvt_pk_bf16_f32 v121, v98, v99
    v_cvt_pk_bf16_f32 v122, v100, v101
    v_mfma_f32_32x32x16_bf16 a[64:79], a[120:123], v[112:115], a[64:79]
    v_exp_f32 v105, v105
    v_exp_f32 v106, v106
    v_exp_f32 v107, v107
    v_exp_f32 v108, v108
    v_cvt_pk_bf16_f32 v123, v102, v103
    v_cvt_pk_bf16_f32 v124, v104, v105
    v_mfma_f32_32x32x16_bf16 a[64:79], a[124:127], v[116:119], a[64:79]
    v_exp_f32 v109, v109
    v_exp_f32 v110, v110
    v_exp_f32 v111, v111
    v_cvt_pk_bf16_f32 v125, v106, v107
    v_cvt_pk_bf16_f32 v126, v108, v109
    v_cvt_pk_bf16_f32 v127, v110, v111
    v_exp_f32 v80, v80
    v_mfma_f32_32x32x16_bf16 v[96:111], a[128:131], a[8:11], v[32:47]
    v_exp_f32 v81, v81
    v_exp_f32 v82, v82
    v_exp_f32 v83, v83
    v_exp_f32 v84, v84
    v_cvt_pk_bf16_f32 v112, v80, v81
    v_mfma_f32_32x32x16_bf16 v[96:111], a[132:135], a[12:15], v[96:111]
    v_exp_f32 v85, v85
    v_exp_f32 v86, v86
    v_exp_f32 v87, v87
    v_exp_f32 v88, v88
    v_cvt_pk_bf16_f32 v113, v82, v83
    v_cvt_pk_bf16_f32 v114, v84, v85
    v_mfma_f32_32x32x16_bf16 a[80:95], a[120:123], v[120:123], a[80:95]
    v_exp_f32 v89, v89
    v_exp_f32 v90, v90
    v_exp_f32 v91, v91
    v_exp_f32 v92, v92
    v_cvt_pk_bf16_f32 v115, v86, v87
    v_cvt_pk_bf16_f32 v116, v88, v89
    v_mfma_f32_32x32x16_bf16 a[80:95], a[124:127], v[124:127], a[80:95]
    v_exp_f32 v93, v93
    buffer_load_dwordx4 a[112:115], v4, s[8:11], s24 offen offset:0 sc1
    buffer_load_dwordx4 a[116:119], v4, s[8:11], s24 offen offset:1024 sc1
    buffer_load_dwordx4 a[120:123], v4, s[8:11], s25 offen offset:0 sc1
    buffer_load_dwordx4 a[124:127], v4, s[8:11], s25 offen offset:1024 sc1
    s_add_u32 s24, s24, 8192
    s_add_u32 s25, s25, 8192
    buffer_load_dwordx4 a[184:187], v4, s[8:11], s34 offen sc1
    buffer_load_dwordx4 a[188:191], v4, s[36:39], s35 offen sc1
    s_add_u32 s34, s34, s44
    s_cmp_ge_u32 s34, s45
    s_cselect_b32 s35, s46, 0
    s_add_u32 s34, s34, s35
    s_add_u32 s35, s34, s47
    v_exp_f32 v94, v94
    v_exp_f32 v95, v95
    v_cvt_pk_bf16_f32 v117, v90, v91
    v_cvt_pk_bf16_f32 v118, v92, v93
    v_cvt_pk_bf16_f32 v119, v94, v95
    v_exp_f32 v96, v96
    v_mfma_f32_32x32x16_bf16 v[80:95], a[128:131], a[16:19], v[48:63]
    v_exp_f32 v97, v97
    v_exp_f32 v98, v98
    v_exp_f32 v99, v99
    v_exp_f32 v100, v100
    v_cvt_pk_bf16_f32 v120, v96, v97
    v_mfma_f32_32x32x16_bf16 v[80:95], a[132:135], a[20:23], v[80:95]
    v_exp_f32 v101, v101
    v_exp_f32 v102, v102
    v_exp_f32 v103, v103
    v_exp_f32 v104, v104
    v_cvt_pk_bf16_f32 v121, v98, v99
    v_cvt_pk_bf16_f32 v122, v100, v101
    v_mfma_f32_32x32x16_bf16 a[32:47], a[136:139], v[112:115], a[32:47]
    v_exp_f32 v105, v105
    v_exp_f32 v106, v106
    v_exp_f32 v107, v107
    v_exp_f32 v108, v108
    v_cvt_pk_bf16_f32 v123, v102, v103
    v_cvt_pk_bf16_f32 v124, v104, v105
    v_mfma_f32_32x32x16_bf16 a[32:47], a[140:143], v[116:119], a[32:47]
    v_exp_f32 v109, v109
    v_exp_f32 v110, v110
    v_exp_f32 v111, v111
    v_cvt_pk_bf16_f32 v125, v106, v107
    v_cvt_pk_bf16_f32 v126, v108, v109
    v_cvt_pk_bf16_f32 v127, v110, v111
    v_exp_f32 v80, v80
    v_mfma_f32_32x32x16_bf16 v[96:111], a[128:131], a[24:27], v[64:79]
    v_exp_f32 v81, v81
    v_exp_f32 v82, v82
    v_exp_f32 v83, v83
    v_exp_f32 v84, v84
    v_cvt_pk_bf16_f32 v112, v80, v81
    v_mfma_f32_32x32x16_bf16 v[96:111], a[132:135], a[28:31], v[96:111]
    v_exp_f32 v85, v85
    v_exp_f32 v86, v86
    v_exp_f32 v87, v87
    v_exp_f32 v88, v88
    v_cvt_pk_bf16_f32 v113, v82, v83
    v_cvt_pk_bf16_f32 v114, v84, v85
    v_mfma_f32_32x32x16_bf16 a[48:63], a[136:139], v[120:123], a[48:63]
    v_exp_f32 v89, v89
    v_exp_f32 v90, v90
    v_exp_f32 v91, v91
    v_exp_f32 v92, v92
    v_cvt_pk_bf16_f32 v115, v86, v87
    v_cvt_pk_bf16_f32 v116, v88, v89
    v_mfma_f32_32x32x16_bf16 a[48:63], a[140:143], v[124:127], a[48:63]
    v_exp_f32 v93, v93
    v_exp_f32 v94, v94
    v_exp_f32 v95, v95
    v_cvt_pk_bf16_f32 v117, v90, v91
    v_cvt_pk_bf16_f32 v118, v92, v93
    v_cvt_pk_bf16_f32 v119, v94, v95
    s_waitcnt vmcnt(12)
    v_exp_f32 v96, v96
    v_mfma_f32_32x32x16_bf16 v[80:95], a[144:147], a[0:3], v[16:31]
    v_exp_f32 v97, v97
    v_exp_f32 v98, v98
    v_exp_f32 v99, v99
    v_exp_f32 v100, v100
    v_cvt_pk_bf16_f32 v120, v96, v97
    v_mfma_f32_32x32x16_bf16 v[80:95], a[148:151], a[4:7], v[80:95]
    v_exp_f32 v101, v101
    v_exp_f32 v102, v102
    v_exp_f32 v103, v103
    v_exp_f32 v104, v104
    v_cvt_pk_bf16_f32 v121, v98, v99
    v_cvt_pk_bf16_f32 v122, v100, v101
    v_mfma_f32_32x32x16_bf16 a[64:79], a[136:139], v[112:115], a[64:79]
    v_exp_f32 v105, v105
    v_exp_f32 v106, v106
    v_exp_f32 v107, v107
    v_exp_f32 v108, v108
    v_cvt_pk_bf16_f32 v123, v102, v103
    v_cvt_pk_bf16_f32 v124, v104, v105
    v_mfma_f32_32x32x16_bf16 a[64:79], a[140:143], v[116:119], a[64:79]
    v_exp_f32 v109, v109
    v_exp_f32 v110, v110
    v_exp_f32 v111, v111
    v_cvt_pk_bf16_f32 v125, v106, v107
    v_cvt_pk_bf16_f32 v126, v108, v109
    v_cvt_pk_bf16_f32 v127, v110, v111
    v_exp_f32 v80, v80
    v_mfma_f32_32x32x16_bf16 v[96:111], a[144:147], a[8:11], v[32:47]
    v_exp_f32 v81, v81
    v_exp_f32 v82, v82
    v_exp_f32 v83, v83
    v_exp_f32 v84, v84
    v_cvt_pk_bf16_f32 v112, v80, v81
    v_mfma_f32_32x32x16_bf16 v[96:111], a[148:151], a[12:15], v[96:111]
    v_exp_f32 v85, v85
    v_exp_f32 v86, v86
    v_exp_f32 v87, v87
    v_exp_f32 v88, v88
    v_cvt_pk_bf16_f32 v113, v82, v83
    v_cvt_pk_bf16_f32 v114, v84, v85
    v_mfma_f32_32x32x16_bf16 a[80:95], a[136:139], v[120:123], a[80:95]
    v_exp_f32 v89, v89
    v_exp_f32 v90, v90
    v_exp_f32 v91, v91
    v_exp_f32 v92, v92
    v_cvt_pk_bf16_f32 v115, v86, v87
    v_cvt_pk_bf16_f32 v116, v88, v89
    v_mfma_f32_32x32x16_bf16 a[80:95], a[140:143], v[124:127], a[80:95]
    v_exp_f32 v93, v93
    buffer_load_dwordx4 a[128:131], v4, s[8:11], s24 offen offset:0 sc1
    buffer_load_dwordx4 a[132:135], v4, s[8:11], s24 offen offset:1024 sc1
    buffer_load_dwordx4 a[136:139], v4, s[8:11], s25 offen offset:0 sc1
    buffer_load_dwordx4 a[140:143], v4, s[8:11], s25 offen offset:1024 sc1
    s_add_u32 s24, s24, 8192
    s_add_u32 s25, s25, 8192
    buffer_load_dwordx4 a[192:195], v4, s[8:11], s34 offen sc1
    buffer_load_dwordx4 a[196:199], v4, s[36:39], s35 offen sc1
    s_add_u32 s34, s34, s44
    s_cmp_ge_u32 s34, s45
    s_cselect_b32 s35, s46, 0
    s_add_u32 s34, s34, s35
    s_add_u32 s35, s34, s47
    v_exp_f32 v94, v94
    v_exp_f32 v95, v95
    v_cvt_pk_bf16_f32 v117, v90, v91
    v_cvt_pk_bf16_f32 v118, v92, v93
    v_cvt_pk_bf16_f32 v119, v94, v95
    v_exp_f32 v96, v96
    v_mfma_f32_32x32x16_bf16 v[80:95], a[144:147], a[16:19], v[48:63]
    v_exp_f32 v97, v97
    v_exp_f32 v98, v98
    v_exp_f32 v99, v99
    v_exp_f32 v100, v100
    v_cvt_pk_bf16_f32 v120, v96, v97
    v_mfma_f32_32x32x16_bf16 v[80:95], a[148:151], a[20:23], v[80:95]
    v_exp_f32 v101, v101
    v_exp_f32 v102, v102
    v_exp_f32 v103, v103
    v_exp_f32 v104, v104
    v_cvt_pk_bf16_f32 v121, v98, v99
    v_cvt_pk_bf16_f32 v122, v100, v101
    v_mfma_f32_32x32x16_bf16 a[32:47], a[152:155], v[112:115], a[32:47]
    v_exp_f32 v105, v105
    v_exp_f32 v106, v106
    v_exp_f32 v107, v107
    v_exp_f32 v108, v108
    v_cvt_pk_bf16_f32 v123, v102, v103
    v_cvt_pk_bf16_f32 v124, v104, v105
    v_mfma_f32_32x32x16_bf16 a[32:47], a[156:159], v[116:119], a[32:47]
    v_exp_f32 v109, v109
    v_exp_f32 v110, v110
    v_exp_f32 v111, v111
    v_cvt_pk_bf16_f32 v125, v106, v107
    v_cvt_pk_bf16_f32 v126, v108, v109
    v_cvt_pk_bf16_f32 v127, v110, v111
    v_exp_f32 v80, v80
    v_mfma_f32_32x32x16_bf16 v[96:111], a[144:147], a[24:27], v[64:79]
    v_exp_f32 v81, v81
    v_exp_f32 v82, v82
    v_exp_f32 v83, v83
    v_exp_f32 v84, v84
    v_cvt_pk_bf16_f32 v112, v80, v81
    v_mfma_f32_32x32x16_bf16 v[96:111], a[148:151], a[28:31], v[96:111]
    v_exp_f32 v85, v85
    v_exp_f32 v86, v86
    v_exp_f32 v87, v87
    v_exp_f32 v88, v88
    v_cvt_pk_bf16_f32 v113, v82, v83
    v_cvt_pk_bf16_f32 v114, v84, v85
    v_mfma_f32_32x32x16_bf16 a[48:63], a[152:155], v[120:123], a[48:63]
    v_exp_f32 v89, v89
    v_exp_f32 v90, v90
    v_exp_f32 v91, v91
    v_exp_f32 v92, v92
    v_cvt_pk_bf16_f32 v115, v86, v87
    v_cvt_pk_bf16_f32 v116, v88, v89
    v_mfma_f32_32x32x16_bf16 a[48:63], a[156:159], v[124:127], a[48:63]
    v_exp_f32 v93, v93
    v_exp_f32 v94, v94
    v_exp_f32 v95, v95
    v_cvt_pk_bf16_f32 v117, v90, v91
    v_cvt_pk_bf16_f32 v118, v92, v93
    v_cvt_pk_bf16_f32 v119, v94, v95
    s_waitcnt vmcnt(12)
    v_exp_f32 v96, v96
    v_mfma_f32_32x32x16_bf16 v[80:95], a[96:99], a[0:3], v[16:31]
    v_exp_f32 v97, v97
    v_exp_f32 v98, v98
    v_exp_f32 v99, v99
    v_exp_f32 v100, v100
    v_cvt_pk_bf16_f32 v120, v96, v97
    v_mfma_f32_32x32x16_bf16 v[80:95], a[100:103], a[4:7], v[80:95]
    v_exp_f32 v101, v101
    v_exp_f32 v102, v102
    v_exp_f32 v103, v103
    v_exp_f32 v104, v104
    v_cvt_pk_bf16_f32 v121, v98, v99
    v_cvt_pk_bf16_f32 v122, v100, v101
    v_mfma_f32_32x32x16_bf16 a[64:79], a[152:155], v[112:115], a[64:79]
    v_exp_f32 v105, v105
    v_exp_f32 v106, v106
    v_exp_f32 v107, v107
    v_exp_f32 v108, v108
    v_cvt_pk_bf16_f32 v123, v102, v103
    v_cvt_pk_bf16_f32 v124, v104, v105
    v_mfma_f32_32x32x16_bf16 a[64:79], a[156:159], v[116:119], a[64:79]
    v_exp_f32 v109, v109
    v_exp_f32 v110, v110
    v_exp_f32 v111, v111
    v_cvt_pk_bf16_f32 v125, v106, v107
    v_cvt_pk_bf16_f32 v126, v108, v109
    v_cvt_pk_bf16_f32 v127, v110, v111
    v_exp_f32 v80, v80
    v_mfma_f32_32x32x16_bf16 v[96:111], a[96:99], a[8:11], v[32:47]
    v_exp_f32 v81, v81
    v_exp_f32 v82, v82
    v_exp_f32 v83, v83
    v_exp_f32 v84, v84
    v_cvt_pk_bf16_f32 v112, v80, v81
    v_mfma_f32_32x32x16_bf16 v[96:111], a[100:103], a[12:15], v[96:111]
    v_exp_f32 v85, v85
    v_exp_f32 v86, v86
    v_exp_f32 v87, v87
    v_exp_f32 v88, v88
    v_cvt_pk_bf16_f32 v113, v82, v83
    v_cvt_pk_bf16_f32 v114, v84, v85
    v_mfma_f32_32x32x16_bf16 a[80:95], a[152:155], v[120:123], a[80:95]
    v_exp_f32 v89, v89
    v_exp_f32 v90, v90
    v_exp_f32 v91, v91
    v_exp_f32 v92, v92
    v_cvt_pk_bf16_f32 v115, v86, v87
    v_cvt_pk_bf16_f32 v116, v88, v89
    v_mfma_f32_32x32x16_bf16 a[80:95], a[156:159], v[124:127], a[80:95]
    v_exp_f32 v93, v93
    buffer_load_dwordx4 a[144:147], v4, s[8:11], s24 offen offset:0 sc1
    buffer_load_dwordx4 a[148:151], v4, s[8:11], s24 offen offset:1024 sc1
    buffer_load_dwordx4 a[152:155], v4, s[8:11], s25 offen offset:0 sc1
    buffer_load_dwordx4 a[156:159], v4, s[8:11], s25 offen offset:1024 sc1
    s_add_u32 s24, s24, 8192
    s_add_u32 s25, s25, 8192
    buffer_load_dwordx4 a[200:203], v4, s[8:11], s34 offen sc1
    buffer_load_dwordx4 a[204:207], v4, s[36:39], s35 offen sc1
    s_add_u32 s34, s34, s44
    s_cmp_ge_u32 s34, s45
    s_cselect_b32 s35, s46, 0
    s_add_u32 s34, s34, s35
    s_add_u32 s35, s34, s47
    v_exp_f32 v94, v94
    v_exp_f32 v95, v95
    v_cvt_pk_bf16_f32 v117, v90, v91
    v_cvt_pk_bf16_f32 v118, v92, v93
    v_cvt_pk_bf16_f32 v119, v94, v95
    v_exp_f32 v96, v96
    v_mfma_f32_32x32x16_bf16 v[80:95], a[96:99], a[16:19], v[48:63]
    v_exp_f32 v97, v97
    v_exp_f32 v98, v98
    v_exp_f32 v99, v99
    v_exp_f32 v100, v100
    v_cvt_pk_bf16_f32 v120, v96, v97
    v_mfma_f32_32x32x16_bf16 v[80:95], a[100:103], a[20:23], v[80:95]
    v_exp_f32 v101, v101
    v_exp_f32 v102, v102
    v_exp_f32 v103, v103
    v_exp_f32 v104, v104
    v_cvt_pk_bf16_f32 v121, v98, v99
    v_cvt_pk_bf16_f32 v122, v100, v101
    v_mfma_f32_32x32x16_bf16 a[32:47], a[104:107], v[112:115], a[32:47]
    v_exp_f32 v105, v105
    v_exp_f32 v106, v106
    v_exp_f32 v107, v107
    v_exp_f32 v108, v108
    v_cvt_pk_bf16_f32 v123, v102, v103
    v_cvt_pk_bf16_f32 v124, v104, v105
    v_mfma_f32_32x32x16_bf16 a[32:47], a[108:111], v[116:119], a[32:47]
    v_exp_f32 v109, v109
    v_exp_f32 v110, v110
    v_exp_f32 v111, v111
    v_cvt_pk_bf16_f32 v125, v106, v107
    v_cvt_pk_bf16_f32 v126, v108, v109
    v_cvt_pk_bf16_f32 v127, v110, v111
    v_exp_f32 v80, v80
    v_mfma_f32_32x32x16_bf16 v[96:111], a[96:99], a[24:27], v[64:79]
    v_exp_f32 v81, v81
    v_exp_f32 v82, v82
    v_exp_f32 v83, v83
    v_exp_f32 v84, v84
    v_cvt_pk_bf16_f32 v112, v80, v81
    v_mfma_f32_32x32x16_bf16 v[96:111], a[100:103], a[28:31], v[96:111]
    v_exp_f32 v85, v85
    v_exp_f32 v86, v86
    v_exp_f32 v87, v87
    v_exp_f32 v88, v88
    v_cvt_pk_bf16_f32 v113, v82, v83
    v_cvt_pk_bf16_f32 v114, v84, v85
    v_mfma_f32_32x32x16_bf16 a[48:63], a[104:107], v[120:123], a[48:63]
    v_exp_f32 v89, v89
    v_exp_f32 v90, v90
    v_exp_f32 v91, v91
    v_exp_f32 v92, v92
    v_cvt_pk_bf16_f32 v115, v86, v87
    v_cvt_pk_bf16_f32 v116, v88, v89
    v_mfma_f32_32x32x16_bf16 a[48:63], a[108:111], v[124:127], a[48:63]
    v_exp_f32 v93, v93
    v_exp_f32 v94, v94
    v_exp_f32 v95, v95
    v_cvt_pk_bf16_f32 v117, v90, v91
    v_cvt_pk_bf16_f32 v118, v92, v93
    v_cvt_pk_bf16_f32 v119, v94, v95
    s_waitcnt vmcnt(12)
    v_exp_f32 v96, v96
    v_mfma_f32_32x32x16_bf16 v[80:95], a[112:115], a[0:3], v[16:31]
    v_exp_f32 v97, v97
    v_exp_f32 v98, v98
    v_exp_f32 v99, v99
    v_exp_f32 v100, v100
    v_cvt_pk_bf16_f32 v120, v96, v97
    v_mfma_f32_32x32x16_bf16 v[80:95], a[116:119], a[4:7], v[80:95]
    v_exp_f32 v101, v101
    v_exp_f32 v102, v102
    v_exp_f32 v103, v103
    v_exp_f32 v104, v104
    v_cvt_pk_bf16_f32 v121, v98, v99
    v_cvt_pk_bf16_f32 v122, v100, v101
    v_mfma_f32_32x32x16_bf16 a[64:79], a[104:107], v[112:115], a[64:79]
    v_exp_f32 v105, v105
    v_exp_f32 v106, v106
    v_exp_f32 v107, v107
    v_exp_f32 v108, v108
    v_cvt_pk_bf16_f32 v123, v102, v103
    v_cvt_pk_bf16_f32 v124, v104, v105
    v_mfma_f32_32x32x16_bf16 a[64:79], a[108:111], v[116:119], a[64:79]
    v_exp_f32 v109, v109
    v_exp_f32 v110, v110
    v_exp_f32 v111, v111
    v_cvt_pk_bf16_f32 v125, v106, v107
    v_cvt_pk_bf16_f32 v126, v108, v109
    v_cvt_pk_bf16_f32 v127, v110, v111
    v_exp_f32 v80, v80
    v_mfma_f32_32x32x16_bf16 v[96:111], a[112:115], a[8:11], v[32:47]
    v_exp_f32 v81, v81
    v_exp_f32 v82, v82
    v_exp_f32 v83, v83
    v_exp_f32 v84, v84
    v_cvt_pk_bf16_f32 v112, v80, v81
    v_mfma_f32_32x32x16_bf16 v[96:111], a[116:119], a[12:15], v[96:111]
    v_exp_f32 v85, v85
    v_exp_f32 v86, v86
    v_exp_f32 v87, v87
    v_exp_f32 v88, v88
    v_cvt_pk_bf16_f32 v113, v82, v83
    v_cvt_pk_bf16_f32 v114, v84, v85
    v_mfma_f32_32x32x16_bf16 a[80:95], a[104:107], v[120:123], a[80:95]
    v_exp_f32 v89, v89
    v_exp_f32 v90, v90
    v_exp_f32 v91, v91
    v_exp_f32 v92, v92
    v_cvt_pk_bf16_f32 v115, v86, v87
    v_cvt_pk_bf16_f32 v116, v88, v89
    v_mfma_f32_32x32x16_bf16 a[80:95], a[108:111], v[124:127], a[80:95]
    v_exp_f32 v93, v93
    buffer_load_dwordx4 a[96:99], v4, s[8:11], s24 offen offset:0 sc1
    buffer_load_dwordx4 a[100:103], v4, s[8:11], s24 offen offset:1024 sc1
    buffer_load_dwordx4 a[104:107], v4, s[8:11], s25 offen offset:0 sc1
    buffer_load_dwordx4 a[108:111], v4, s[8:11], s25 offen offset:1024 sc1
    s_add_u32 s24, s24, 8192
    s_add_u32 s25, s25, 8192
    buffer_load_dwordx4 a[208:211], v4, s[8:11], s34 offen sc1
    buffer_load_dwordx4 a[212:215], v4, s[36:39], s35 offen sc1
    s_add_u32 s34, s34, s44
    s_cmp_ge_u32 s34, s45
    s_cselect_b32 s35, s46, 0
    s_add_u32 s34, s34, s35
    s_add_u32 s35, s34, s47
    v_exp_f32 v94, v94
    v_exp_f32 v95, v95
    v_cvt_pk_bf16_f32 v117, v90, v91
    v_cvt_pk_bf16_f32 v118, v92, v93
    v_cvt_pk_bf16_f32 v119, v94, v95
    v_exp_f32 v96, v96
    v_mfma_f32_32x32x16_bf16 v[80:95], a[112:115], a[16:19], v[48:63]
    v_exp_f32 v97, v97
    v_exp_f32 v98, v98
    v_exp_f32 v99, v99
    v_exp_f32 v100, v100
    v_cvt_pk_bf16_f32 v120, v96, v97
    v_mfma_f32_32x32x16_bf16 v[80:95], a[116:119], a[20:23], v[80:95]
    v_exp_f32 v101, v101
    v_exp_f32 v102, v102
    v_exp_f32 v103, v103
    v_exp_f32 v104, v104
    v_cvt_pk_bf16_f32 v121, v98, v99
    v_cvt_pk_bf16_f32 v122, v100, v101
    v_mfma_f32_32x32x16_bf16 a[32:47], a[120:123], v[112:115], a[32:47]
    v_exp_f32 v105, v105
    v_exp_f32 v106, v106
    v_exp_f32 v107, v107
    v_exp_f32 v108, v108
    v_cvt_pk_bf16_f32 v123, v102, v103
    v_cvt_pk_bf16_f32 v124, v104, v105
    v_mfma_f32_32x32x16_bf16 a[32:47], a[124:127], v[116:119], a[32:47]
    v_exp_f32 v109, v109
    v_exp_f32 v110, v110
    v_exp_f32 v111, v111
    v_cvt_pk_bf16_f32 v125, v106, v107
    v_cvt_pk_bf16_f32 v126, v108, v109
    v_cvt_pk_bf16_f32 v127, v110, v111
    v_exp_f32 v80, v80
    v_mfma_f32_32x32x16_bf16 v[96:111], a[112:115], a[24:27], v[64:79]
    v_exp_f32 v81, v81
    v_exp_f32 v82, v82
    v_exp_f32 v83, v83
    v_exp_f32 v84, v84
    v_cvt_pk_bf16_f32 v112, v80, v81
    v_mfma_f32_32x32x16_bf16 v[96:111], a[116:119], a[28:31], v[96:111]
    v_exp_f32 v85, v85
    v_exp_f32 v86, v86
    v_exp_f32 v87, v87
    v_exp_f32 v88, v88
    v_cvt_pk_bf16_f32 v113, v82, v83
    v_cvt_pk_bf16_f32 v114, v84, v85
    v_mfma_f32_32x32x16_bf16 a[48:63], a[120:123], v[120:123], a[48:63]
    v_exp_f32 v89, v89
    v_exp_f32 v90, v90
    v_exp_f32 v91, v91
    v_exp_f32 v92, v92
    v_cvt_pk_bf16_f32 v115, v86, v87
    v_cvt_pk_bf16_f32 v116, v88, v89
    v_mfma_f32_32x32x16_bf16 a[48:63], a[124:127], v[124:127], a[48:63]
    v_exp_f32 v93, v93
    v_exp_f32 v94, v94
    v_exp_f32 v95, v95
    v_cvt_pk_bf16_f32 v117, v90, v91
    v_cvt_pk_bf16_f32 v118, v92, v93
    v_cvt_pk_bf16_f32 v119, v94, v95
    s_waitcnt vmcnt(12)
    v_exp_f32 v96, v96
    v_mfma_f32_32x32x16_bf16 v[80:95], a[128:131], a[0:3], v[16:31]
    v_exp_f32 v97, v97
    v_exp_f32 v98, v98
    v_exp_f32 v99, v99
    v_exp_f32 v100, v100
    v_cvt_pk_bf16_f32 v120, v96, v97
    v_mfma_f32_32x32x16_bf16 v[80:95], a[132:135], a[4:7], v[80:95]
    v_exp_f32 v101, v101
    v_exp_f32 v102, v102
    v_exp_f32 v103, v103
    v_exp_f32 v104, v104
    v_cvt_pk_bf16_f32 v121, v98, v99
    v_cvt_pk_bf16_f32 v122, v100, v101
    v_mfma_f32_32x32x16_bf16 a[64:79], a[120:123], v[112:115], a[64:79]
    v_exp_f32 v105, v105
    v_exp_f32 v106, v106
    v_exp_f32 v107, v107
    v_exp_f32 v108, v108
    v_cvt_pk_bf16_f32 v123, v102, v103
    v_cvt_pk_bf16_f32 v124, v104, v105
    v_mfma_f32_32x32x16_bf16 a[64:79], a[124:127], v[116:119], a[64:79]
    v_exp_f32 v109, v109
    v_exp_f32 v110, v110
    v_exp_f32 v111, v111
    v_cvt_pk_bf16_f32 v125, v106, v107
    v_cvt_pk_bf16_f32 v126, v108, v109
    v_cvt_pk_bf16_f32 v127, v110, v111
    v_exp_f32 v80, v80
    v_mfma_f32_32x32x16_bf16 v[96:111], a[128:131], a[8:11], v[32:47]
    v_exp_f32 v81, v81
    v_exp_f32 v82, v82
    v_exp_f32 v83, v83
    v_exp_f32 v84, v84
    v_cvt_pk_bf16_f32 v112, v80, v81
    v_mfma_f32_32x32x16_bf16 v[96:111], a[132:135], a[12:15], v[96:111]
    v_exp_f32 v85, v85
    v_exp_f32 v86, v86
    v_exp_f32 v87, v87
    v_exp_f32 v88, v88
    v_cvt_pk_bf16_f32 v113, v82, v83
    v_cvt_pk_bf16_f32 v114, v84, v85
    v_mfma_f32_32x32x16_bf16 a[80:95], a[120:123], v[120:123], a[80:95]
    v_exp_f32 v89, v89
    v_exp_f32 v90, v90
    v_exp_f32 v91, v91
    v_exp_f32 v92, v92
    v_cvt_pk_bf16_f32 v115, v86, v87
    v_cvt_pk_bf16_f32 v116, v88, v89
    v_mfma_f32_32x32x16_bf16 a[80:95], a[124:127], v[124:127], a[80:95]
    v_exp_f32 v93, v93
    buffer_load_dwordx4 a[112:115], v4, s[8:11], s24 offen offset:0 sc1
    buffer_load_dwordx4 a[116:119], v4, s[8:11], s24 offen offset:1024 sc1
    buffer_load_dwordx4 a[120:123], v4, s[8:11], s25 offen offset:0 sc1
    buffer_load_dwordx4 a[124:127], v4, s[8:11], s25 offen offset:1024 sc1
    s_add_u32 s24, s24, 8192
    s_add_u32 s25, s25, 8192
    buffer_load_dwordx4 a[216:219], v4, s[8:11], s34 offen sc1
    buffer_load_dwordx4 a[220:223], v4, s[36:39], s35 offen sc1
    s_add_u32 s34, s34, s44
    s_cmp_ge_u32 s34, s45
    s_cselect_b32 s35, s46, 0
    s_add_u32 s34, s34, s35
    s_add_u32 s34, s34, s48
    s_add_u32 s45, s45, s48
    s_add_u32 s35, s34, s47
    v_exp_f32 v94, v94
    v_exp_f32 v95, v95
    v_cvt_pk_bf16_f32 v117, v90, v91
    v_cvt_pk_bf16_f32 v118, v92, v93
    v_cvt_pk_bf16_f32 v119, v94, v95
    v_exp_f32 v96, v96
    v_mfma_f32_32x32x16_bf16 v[80:95], a[128:131], a[16:19], v[48:63]
    v_exp_f32 v97, v97
    v_exp_f32 v98, v98
    v_exp_f32 v99, v99
    v_exp_f32 v100, v100
    v_cvt_pk_bf16_f32 v120, v96, v97
    v_mfma_f32_32x32x16_bf16 v[80:95], a[132:135], a[20:23], v[80:95]
    v_exp_f32 v101, v101
    v_exp_f32 v102, v102
    v_exp_f32 v103, v103
    v_exp_f32 v104, v104
    v_cvt_pk_bf16_f32 v121, v98, v99
    v_cvt_pk_bf16_f32 v122, v100, v101
    v_mfma_f32_32x32x16_bf16 a[32:47], a[136:139], v[112:115], a[32:47]
    v_exp_f32 v105, v105
    v_exp_f32 v106, v106
    v_exp_f32 v107, v107
    v_exp_f32 v108, v108
    v_cvt_pk_bf16_f32 v123, v102, v103
    v_cvt_pk_bf16_f32 v124, v104, v105
    v_mfma_f32_32x32x16_bf16 a[32:47], a[140:143], v[116:119], a[32:47]
    v_exp_f32 v109, v109
    v_exp_f32 v110, v110
    v_exp_f32 v111, v111
    v_cvt_pk_bf16_f32 v125, v106, v107
    v_cvt_pk_bf16_f32 v126, v108, v109
    v_cvt_pk_bf16_f32 v127, v110, v111
    v_exp_f32 v80, v80
    v_mfma_f32_32x32x16_bf16 v[96:111], a[128:131], a[24:27], v[64:79]
    v_exp_f32 v81, v81
    v_exp_f32 v82, v82
    v_exp_f32 v83, v83
    v_exp_f32 v84, v84
    v_cvt_pk_bf16_f32 v112, v80, v81
    v_mfma_f32_32x32x16_bf16 v[96:111], a[132:135], a[28:31], v[96:111]
    v_exp_f32 v85, v85
    v_exp_f32 v86, v86
    v_exp_f32 v87, v87
    v_exp_f32 v88, v88
    v_cvt_pk_bf16_f32 v113, v82, v83
    v_cvt_pk_bf16_f32 v114, v84, v85
    v_mfma_f32_32x32x16_bf16 a[48:63], a[136:139], v[120:123], a[48:63]
    v_exp_f32 v89, v89
    v_exp_f32 v90, v90
    v_exp_f32 v91, v91
    v_exp_f32 v92, v92
    v_cvt_pk_bf16_f32 v115, v86, v87
    v_cvt_pk_bf16_f32 v116, v88, v89
    v_mfma_f32_32x32x16_bf16 a[48:63], a[140:143], v[124:127], a[48:63]
    v_exp_f32 v93, v93
    v_exp_f32 v94, v94
    v_exp_f32 v95, v95
    v_cvt_pk_bf16_f32 v117, v90, v91
    v_cvt_pk_bf16_f32 v118, v92, v93
    v_cvt_pk_bf16_f32 v119, v94, v95
    s_waitcnt vmcnt(12)
    v_exp_f32 v96, v96
    v_mfma_f32_32x32x16_bf16 v[80:95], a[144:147], a[0:3], v[16:31]
    v_exp_f32 v97, v97
    v_exp_f32 v98, v98
    v_exp_f32 v99, v99
    v_exp_f32 v100, v100
    v_cvt_pk_bf16_f32 v120, v96, v97
    v_mfma_f32_32x32x16_bf16 v[80:95], a[148:151], a[4:7], v[80:95]
    v_exp_f32 v101, v101
    v_exp_f32 v102, v102
    v_exp_f32 v103, v103
    v_exp_f32 v104, v104
    v_cvt_pk_bf16_f32 v121, v98, v99
    v_cvt_pk_bf16_f32 v122, v100, v101
    v_mfma_f32_32x32x16_bf16 a[64:79], a[136:139], v[112:115], a[64:79]
    v_exp_f32 v105, v105
    v_exp_f32 v106, v106
    v_exp_f32 v107, v107
    v_exp_f32 v108, v108
    v_cvt_pk_bf16_f32 v123, v102, v103
    v_cvt_pk_bf16_f32 v124, v104, v105
    v_mfma_f32_32x32x16_bf16 a[64:79], a[140:143], v[116:119], a[64:79]
    v_exp_f32 v109, v109
    v_exp_f32 v110, v110
    v_exp_f32 v111, v111
    v_cvt_pk_bf16_f32 v125, v106, v107
    v_cvt_pk_bf16_f32 v126, v108, v109
    v_cvt_pk_bf16_f32 v127, v110, v111
    v_exp_f32 v80, v80
    v_mfma_f32_32x32x16_bf16 v[96:111], a[144:147], a[8:11], v[32:47]
    v_exp_f32 v81, v81
    v_exp_f32 v82, v82
    v_exp_f32 v83, v83
    v_exp_f32 v84, v84
    v_cvt_pk_bf16_f32 v112, v80, v81
    v_mfma_f32_32x32x16_bf16 v[96:111], a[148:151], a[12:15], v[96:111]
    v_exp_f32 v85, v85
    v_exp_f32 v86, v86
    v_exp_f32 v87, v87
    v_exp_f32 v88, v88
    v_cvt_pk_bf16_f32 v113, v82, v83
    v_cvt_pk_bf16_f32 v114, v84, v85
    v_mfma_f32_32x32x16_bf16 a[80:95], a[136:139], v[120:123], a[80:95]
    v_exp_f32 v89, v89
    v_exp_f32 v90, v90
    v_exp_f32 v91, v91
    v_exp_f32 v92, v92
    v_cvt_pk_bf16_f32 v115, v86, v87
    v_cvt_pk_bf16_f32 v116, v88, v89
    v_mfma_f32_32x32x16_bf16 a[80:95], a[140:143], v[124:127], a[80:95]
    v_exp_f32 v93, v93
    buffer_load_dwordx4 a[128:131], v4, s[8:11], s24 offen offset:0 sc1
    buffer_load_dwordx4 a[132:135], v4, s[8:11], s24 offen offset:1024 sc1
    buffer_load_dwordx4 a[136:139], v4, s[8:11], s25 offen offset:0 sc1
    buffer_load_dwordx4 a[140:143], v4, s[8:11], s25 offen offset:1024 sc1
    s_add_u32 s24, s24, 8192
    s_add_u32 s25, s25, 8192
    buffer_load_dwordx4 a[224:227], v4, s[8:11], s34 offen sc1
    buffer_load_dwordx4 a[228:231], v4, s[36:39], s35 offen sc1
    s_add_u32 s34, s34, s44
    s_cmp_ge_u32 s34, s45
    s_cselect_b32 s35, s46, 0
    s_add_u32 s34, s34, s35
    s_add_u32 s35, s34, s47
    v_exp_f32 v94, v94
    v_exp_f32 v95, v95
    v_cvt_pk_bf16_f32 v117, v90, v91
    v_cvt_pk_bf16_f32 v118, v92, v93
    v_cvt_pk_bf16_f32 v119, v94, v95
    v_exp_f32 v96, v96
    v_mfma_f32_32x32x16_bf16 v[80:95], a[144:147], a[16:19], v[48:63]
    v_exp_f32 v97, v97
    v_exp_f32 v98, v98
    v_exp_f32 v99, v99
    v_exp_f32 v100, v100
    v_cvt_pk_bf16_f32 v120, v96, v97
    v_mfma_f32_32x32x16_bf16 v[80:95], a[148:151], a[20:23], v[80:95]
    v_exp_f32 v101, v101
    v_exp_f32 v102, v102
    v_exp_f32 v103, v103
    v_exp_f32 v104, v104
    v_cvt_pk_bf16_f32 v121, v98, v99
    v_cvt_pk_bf16_f32 v122, v100, v101
    v_mfma_f32_32x32x16_bf16 a[32:47], a[152:155], v[112:115], a[32:47]
    v_exp_f32 v105, v105
    v_exp_f32 v106, v106
    v_exp_f32 v107, v107
    v_exp_f32 v108, v108
    v_cvt_pk_bf16_f32 v123, v102, v103
    v_cvt_pk_bf16_f32 v124, v104, v105
    v_mfma_f32_32x32x16_bf16 a[32:47], a[156:159], v[116:119], a[32:47]
    v_exp_f32 v109, v109
    v_exp_f32 v110, v110
    v_exp_f32 v111, v111
    v_cvt_pk_bf16_f32 v125, v106, v107
    v_cvt_pk_bf16_f32 v126, v108, v109
    v_cvt_pk_bf16_f32 v127, v110, v111
    v_exp_f32 v80, v80
    v_mfma_f32_32x32x16_bf16 v[96:111], a[144:147], a[24:27], v[64:79]
    v_exp_f32 v81, v81
    v_exp_f32 v82, v82
    v_exp_f32 v83, v83
    v_exp_f32 v84, v84
    v_cvt_pk_bf16_f32 v112, v80, v81
    v_mfma_f32_32x32x16_bf16 v[96:111], a[148:151], a[28:31], v[96:111]
    v_exp_f32 v85, v85
    v_exp_f32 v86, v86
    v_exp_f32 v87, v87
    v_exp_f32 v88, v88
    v_cvt_pk_bf16_f32 v113, v82, v83
    v_cvt_pk_bf16_f32 v114, v84, v85
    v_mfma_f32_32x32x16_bf16 a[48:63], a[152:155], v[120:123], a[48:63]
    v_exp_f32 v89, v89
    v_exp_f32 v90, v90
    v_exp_f32 v91, v91
    v_exp_f32 v92, v92
    v_cvt_pk_bf16_f32 v115, v86, v87
    v_cvt_pk_bf16_f32 v116, v88, v89
    v_mfma_f32_32x32x16_bf16 a[48:63], a[156:159], v[124:127], a[48:63]
    v_exp_f32 v93, v93
    v_exp_f32 v94, v94
    v_exp_f32 v95, v95
    v_cvt_pk_bf16_f32 v117, v90, v91
    v_cvt_pk_bf16_f32 v118, v92, v93
    v_cvt_pk_bf16_f32 v119, v94, v95
    s_waitcnt vmcnt(12)
    v_exp_f32 v96, v96
    v_mfma_f32_32x32x16_bf16 v[80:95], a[96:99], a[0:3], v[16:31]
    v_exp_f32 v97, v97
    v_exp_f32 v98, v98
    v_exp_f32 v99, v99
    v_exp_f32 v100, v100
    v_cvt_pk_bf16_f32 v120, v96, v97
    v_mfma_f32_32x32x16_bf16 v[80:95], a[100:103], a[4:7], v[80:95]
    v_exp_f32 v101, v101
    v_exp_f32 v102, v102
    v_exp_f32 v103, v103
    v_exp_f32 v104, v104
    v_cvt_pk_bf16_f32 v121, v98, v99
    v_cvt_pk_bf16_f32 v122, v100, v101
    v_mfma_f32_32x32x16_bf16 a[64:79], a[152:155], v[112:115], a[64:79]
    v_exp_f32 v105, v105
    v_exp_f32 v106, v106
    v_exp_f32 v107, v107
    v_exp_f32 v108, v108
    v_cvt_pk_bf16_f32 v123, v102, v103
    v_cvt_pk_bf16_f32 v124, v104, v105
    v_mfma_f32_32x32x16_bf16 a[64:79], a[156:159], v[116:119], a[64:79]
    v_exp_f32 v109, v109
    v_exp_f32 v110, v110
    v_exp_f32 v111, v111
    v_cvt_pk_bf16_f32 v125, v106, v107
    v_cvt_pk_bf16_f32 v126, v108, v109
    v_cvt_pk_bf16_f32 v127, v110, v111
    v_exp_f32 v80, v80
    v_mfma_f32_32x32x16_bf16 v[96:111], a[96:99], a[8:11], v[32:47]
    v_exp_f32 v81, v81
    v_exp_f32 v82, v82
    v_exp_f32 v83, v83
    v_exp_f32 v84, v84
    v_cvt_pk_bf16_f32 v112, v80, v81
    v_mfma_f32_32x32x16_bf16 v[96:111], a[100:103], a[12:15], v[96:111]
    v_exp_f32 v85, v85
    v_exp_f32 v86, v86
    v_exp_f32 v87, v87
    v_exp_f32 v88, v88
    v_cvt_pk_bf16_f32 v113, v82, v83
    v_cvt_pk_bf16_f32 v114, v84, v85
    v_mfma_f32_32x32x16_bf16 a[80:95], a[152:155], v[120:123], a[80:95]
    v_exp_f32 v89, v89
    v_exp_f32 v90, v90
    v_exp_f32 v91, v91
    v_exp_f32 v92, v92
    v_cvt_pk_bf16_f32 v115, v86, v87
    v_cvt_pk_bf16_f32 v116, v88, v89
    v_mfma_f32_32x32x16_bf16 a[80:95], a[156:159], v[124:127], a[80:95]
    v_exp_f32 v93, v93
    s_add_u32 s22, s3, 44
    v_lshlrev_b32 v5, 2, v1
    v_add_u32 v5, s22, v5
    v_cmp_gt_u32 vcc, 3, v1
    s_nop 1
    v_cndmask_b32 v5, 0, v5, vcc
    v_lshlrev_b32 v5, 7, v5
    v_add_u32 v5, 0x14000, v5
    s_mov_b32 s22, 0x4282000
    s_add_u32 s22, s22, s84
    s_mov_b32 s40, 0
at_kvwc:
    buffer_load_dword v6, v5, s[8:11], s22 offen sc1
    s_waitcnt vmcnt(0)
    v_cmp_eq_u32 vcc, 0, v6
    s_cbranch_vccz at_kvokc
    s_sleep 2
    s_add_u32 s40, s40, 1
    s_cmp_lt_u32 s40, 0x10000
    s_cbranch_scc1 at_kvwc
at_kvokc:
    buffer_load_dwordx4 a[144:147], v4, s[8:11], s24 offen offset:0 sc1
    buffer_load_dwordx4 a[148:151], v4, s[8:11], s24 offen offset:1024 sc1
    buffer_load_dwordx4 a[152:155], v4, s[8:11], s25 offen offset:0 sc1
    buffer_load_dwordx4 a[156:159], v4, s[8:11], s25 offen offset:1024 sc1
    s_add_u32 s24, s24, 8192
    s_add_u32 s25, s25, 8192
    buffer_load_dwordx4 a[232:235], v4, s[8:11], s34 offen sc1
    buffer_load_dwordx4 a[236:239], v4, s[36:39], s35 offen sc1
    s_add_u32 s34, s34, s44
    s_cmp_ge_u32 s34, s45
    s_cselect_b32 s35, s46, 0
    s_add_u32 s34, s34, s35
    s_add_u32 s35, s34, s47
    v_exp_f32 v94, v94
    v_exp_f32 v95, v95
    v_cvt_pk_bf16_f32 v117, v90, v91
    v_cvt_pk_bf16_f32 v118, v92, v93
    v_cvt_pk_bf16_f32 v119, v94, v95
    v_exp_f32 v96, v96
    v_mfma_f32_32x32x16_bf16 v[80:95], a[96:99], a[16:19], v[48:63]
    v_exp_f32 v97, v97
    v_exp_f32 v98, v98
    v_exp_f32 v99, v99
    v_exp_f32 v100, v100
    v_cvt_pk_bf16_f32 v120, v96, v97
    v_mfma_f32_32x32x16_bf16 v[80:95], a[100:103], a[20:23], v[80:95]
    v_exp_f32 v101, v101
    v_exp_f32 v102, v102
    v_exp_f32 v103, v103
    v_exp_f32 v104, v104
    v_cvt_pk_bf16_f32 v121, v98, v99
    v_cvt_pk_bf16_f32 v122, v100, v101
    v_mfma_f32_32x32x16_bf16 a[32:47], a[104:107], v[112:115], a[32:47]
    v_exp_f32 v105, v105
    v_exp_f32 v106, v106
    v_exp_f32 v107, v107
    v_exp_f32 v108, v108
    v_cvt_pk_bf16_f32 v123, v102, v103
    v_cvt_pk_bf16_f32 v124, v104, v105
    v_mfma_f32_32x32x16_bf16 a[32:47], a[108:111], v[116:119], a[32:47]
    v_exp_f32 v109, v109
    v_exp_f32 v110, v110
    v_exp_f32 v111, v111
    v_cvt_pk_bf16_f32 v125, v106, v107
    v_cvt_pk_bf16_f32 v126, v108, v109
    v_cvt_pk_bf16_f32 v127, v110, v111
    v_exp_f32 v80, v80
    v_mfma_f32_32x32x16_bf16 v[96:111], a[96:99], a[24:27], v[64:79]
    v_exp_f32 v81, v81
    v_exp_f32 v82, v82
    v_exp_f32 v83, v83
    v_exp_f32 v84, v84
    v_cvt_pk_bf16_f32 v112, v80, v81
    v_mfma_f32_32x32x16_bf16 v[96:111], a[100:103], a[28:31], v[96:111]
    v_exp_f32 v85, v85
    v_exp_f32 v86, v86
    v_exp_f32 v87, v87
    v_exp_f32 v88, v88
    v_cvt_pk_bf16_f32 v113, v82, v83
    v_cvt_pk_bf16_f32 v114, v84, v85
    v_mfma_f32_32x32x16_bf16 a[48:63], a[104:107], v[120:123], a[48:63]
    v_exp_f32 v89, v89
    v_exp_f32 v90, v90
    v_exp_f32 v91, v91
    v_exp_f32 v92, v92
    v_cvt_pk_bf16_f32 v115, v86, v87
    v_cvt_pk_bf16_f32 v116, v88, v89
    v_mfma_f32_32x32x16_bf16 a[48:63], a[108:111], v[124:127], a[48:63]
    v_exp_f32 v93, v93
    v_exp_f32 v94, v94
    v_exp_f32 v95, v95
    v_cvt_pk_bf16_f32 v117, v90, v91
    v_cvt_pk_bf16_f32 v118, v92, v93
    v_cvt_pk_bf16_f32 v119, v94, v95
    s_waitcnt vmcnt(12)
    v_exp_f32 v96, v96
    v_mfma_f32_32x32x16_bf16 v[80:95], a[112:115], a[0:3], v[16:31]
    v_exp_f32 v97, v97
    v_exp_f32 v98, v98
    v_exp_f32 v99, v99
    v_exp_f32 v100, v100
    v_cvt_pk_bf16_f32 v120, v96, v97
    v_mfma_f32_32x32x16_bf16 v[80:95], a[116:119], a[4:7], v[80:95]
    v_exp_f32 v101, v101
    v_exp_f32 v102, v102
    v_exp_f32 v103, v103
    v_exp_f32 v104, v104
    v_cvt_pk_bf16_f32 v121, v98, v99
    v_cvt_pk_bf16_f32 v122, v100, v101
    v_mfma_f32_32x32x16_bf16 a[64:79], a[104:107], v[112:115], a[64:79]
    v_exp_f32 v105, v105
    v_exp_f32 v106, v106
    v_exp_f32 v107, v107
    v_exp_f32 v108, v108
    v_cvt_pk_bf16_f32 v123, v102, v103
    v_cvt_pk_bf16_f32 v124, v104, v105
    v_mfma_f32_32x32x16_bf16 a[64:79], a[108:111], v[116:119], a[64:79]
    v_exp_f32 v109, v109
    v_exp_f32 v110, v110
    v_exp_f32 v111, v111
    v_cvt_pk_bf16_f32 v125, v106, v107
    v_cvt_pk_bf16_f32 v126, v108, v109
    v_cvt_pk_bf16_f32 v127, v110, v111
    v_exp_f32 v80, v80
    v_mfma_f32_32x32x16_bf16 v[96:111], a[112:115], a[8:11], v[32:47]
    v_exp_f32 v81, v81
    v_exp_f32 v82, v82
    v_exp_f32 v83, v83
    v_exp_f32 v84, v84
    v_cvt_pk_bf16_f32 v112, v80, v81
    v_mfma_f32_32x32x16_bf16 v[96:111], a[116:119], a[12:15], v[96:111]
    v_exp_f32 v85, v85
    v_exp_f32 v86, v86
    v_exp_f32 v87, v87
    v_exp_f32 v88, v88
    v_cvt_pk_bf16_f32 v113, v82, v83
    v_cvt_pk_bf16_f32 v114, v84, v85
    v_mfma_f32_32x32x16_bf16 a[80:95], a[104:107], v[120:123], a[80:95]
    v_exp_f32 v89, v89
    v_exp_f32 v90, v90
    v_exp_f32 v91, v91
    v_exp_f32 v92, v92
    v_cvt_pk_bf16_f32 v115, v86, v87
    v_cvt_pk_bf16_f32 v116, v88, v89
    v_mfma_f32_32x32x16_bf16 a[80:95], a[108:111], v[124:127], a[80:95]
    v_exp_f32 v93, v93
    buffer_load_dwordx4 a[96:99], v4, s[8:11], s24 offen offset:0 sc1
    buffer_load_dwordx4 a[100:103], v4, s[8:11], s24 offen offset:1024 sc1
    buffer_load_dwordx4 a[104:107], v4, s[8:11], s25 offen offset:0 sc1
    buffer_load_dwordx4 a[108:111], v4, s[8:11], s25 offen offset:1024 sc1
    s_add_u32 s24, s24, 8192
    s_add_u32 s25, s25, 8192
    buffer_load_dwordx4 a[240:243], v4, s[8:11], s34 offen sc1
    buffer_load_dwordx4 a[244:247], v4, s[36:39], s35 offen sc1
    s_add_u32 s34, s34, s44
    s_cmp_ge_u32 s34, s45
    s_cselect_b32 s35, s46, 0
    s_add_u32 s34, s34, s35
    s_add_u32 s35, s34, s47
    v_exp_f32 v94, v94
    v_exp_f32 v95, v95
    v_cvt_pk_bf16_f32 v117, v90, v91
    v_cvt_pk_bf16_f32 v118, v92, v93
    v_cvt_pk_bf16_f32 v119, v94, v95
    v_exp_f32 v96, v96
    v_mfma_f32_32x32x16_bf16 v[80:95], a[112:115], a[16:19], v[48:63]
    v_exp_f32 v97, v97
    v_exp_f32 v98, v98
    v_exp_f32 v99, v99
    v_exp_f32 v100, v100
    v_cvt_pk_bf16_f32 v120, v96, v97
    v_mfma_f32_32x32x16_bf16 v[80:95], a[116:119], a[20:23], v[80:95]
    v_exp_f32 v101, v101
    v_exp_f32 v102, v102
    v_exp_f32 v103, v103
    v_exp_f32 v104, v104
    v_cvt_pk_bf16_f32 v121, v98, v99
    v_cvt_pk_bf16_f32 v122, v100, v101
    v_mfma_f32_32x32x16_bf16 a[32:47], a[120:123], v[112:115], a[32:47]
    v_exp_f32 v105, v105
    v_exp_f32 v106, v106
    v_exp_f32 v107, v107
    v_exp_f32 v108, v108
    v_cvt_pk_bf16_f32 v123, v102, v103
    v_cvt_pk_bf16_f32 v124, v104, v105
    v_mfma_f32_32x32x16_bf16 a[32:47], a[124:127], v[116:119], a[32:47]
    v_exp_f32 v109, v109
    v_exp_f32 v110, v110
    v_exp_f32 v111, v111
    v_cvt_pk_bf16_f32 v125, v106, v107
    v_cvt_pk_bf16_f32 v126, v108, v109
    v_cvt_pk_bf16_f32 v127, v110, v111
    v_exp_f32 v80, v80
    v_mfma_f32_32x32x16_bf16 v[96:111], a[112:115], a[24:27], v[64:79]
    v_exp_f32 v81, v81
    v_exp_f32 v82, v82
    v_exp_f32 v83, v83
    v_exp_f32 v84, v84
    v_cvt_pk_bf16_f32 v112, v80, v81
    v_mfma_f32_32x32x16_bf16 v[96:111], a[116:119], a[28:31], v[96:111]
    v_exp_f32 v85, v85
    v_exp_f32 v86, v86
    v_exp_f32 v87, v87
    v_exp_f32 v88, v88
    v_cvt_pk_bf16_f32 v113, v82, v83
    v_cvt_pk_bf16_f32 v114, v84, v85
    v_mfma_f32_32x32x16_bf16 a[48:63], a[120:123], v[120:123], a[48:63]
    v_exp_f32 v89, v89
    v_exp_f32 v90, v90
    v_exp_f32 v91, v91
    v_exp_f32 v92, v92
    v_cvt_pk_bf16_f32 v115, v86, v87
    v_cvt_pk_bf16_f32 v116, v88, v89
    v_mfma_f32_32x32x16_bf16 a[48:63], a[124:127], v[124:127], a[48:63]
    v_exp_f32 v93, v93
    v_exp_f32 v94, v94
    v_exp_f32 v95, v95
    v_cvt_pk_bf16_f32 v117, v90, v91
    v_cvt_pk_bf16_f32 v118, v92, v93
    v_cvt_pk_bf16_f32 v119, v94, v95
    s_waitcnt vmcnt(12)
    v_exp_f32 v96, v96
    v_mfma_f32_32x32x16_bf16 v[80:95], a[128:131], a[0:3], v[16:31]
    v_exp_f32 v97, v97
    v_exp_f32 v98, v98
    v_exp_f32 v99, v99
    v_exp_f32 v100, v100
    v_cvt_pk_bf16_f32 v120, v96, v97
    v_mfma_f32_32x32x16_bf16 v[80:95], a[132:135], a[4:7], v[80:95]
    v_exp_f32 v101, v101
    v_exp_f32 v102, v102
    v_exp_f32 v103, v103
    v_exp_f32 v104, v104
    v_cvt_pk_bf16_f32 v121, v98, v99
    v_cvt_pk_bf16_f32 v122, v100, v101
    v_mfma_f32_32x32x16_bf16 a[64:79], a[120:123], v[112:115], a[64:79]
    v_exp_f32 v105, v105
    v_exp_f32 v106, v106
    v_exp_f32 v107, v107
    v_exp_f32 v108, v108
    v_cvt_pk_bf16_f32 v123, v102, v103
    v_cvt_pk_bf16_f32 v124, v104, v105
    v_mfma_f32_32x32x16_bf16 a[64:79], a[124:127], v[116:119], a[64:79]
    v_exp_f32 v109, v109
    v_exp_f32 v110, v110
    v_exp_f32 v111, v111
    v_cvt_pk_bf16_f32 v125, v106, v107
    v_cvt_pk_bf16_f32 v126, v108, v109
    v_cvt_pk_bf16_f32 v127, v110, v111
    v_exp_f32 v80, v80
    v_mfma_f32_32x32x16_bf16 v[96:111], a[128:131], a[8:11], v[32:47]
    v_exp_f32 v81, v81
    v_exp_f32 v82, v82
    v_exp_f32 v83, v83
    v_exp_f32 v84, v84
    v_cvt_pk_bf16_f32 v112, v80, v81
    v_mfma_f32_32x32x16_bf16 v[96:111], a[132:135], a[12:15], v[96:111]
    v_exp_f32 v85, v85
    v_exp_f32 v86, v86
    v_exp_f32 v87, v87
    v_exp_f32 v88, v88
    v_cvt_pk_bf16_f32 v113, v82, v83
    v_cvt_pk_bf16_f32 v114, v84, v85
    v_mfma_f32_32x32x16_bf16 a[80:95], a[120:123], v[120:123], a[80:95]
    v_exp_f32 v89, v89
    v_exp_f32 v90, v90
    v_exp_f32 v91, v91
    v_exp_f32 v92, v92
    v_cvt_pk_bf16_f32 v115, v86, v87
    v_cvt_pk_bf16_f32 v116, v88, v89
    v_mfma_f32_32x32x16_bf16 a[80:95], a[124:127], v[124:127], a[80:95]
    v_exp_f32 v93, v93
    buffer_load_dwordx4 a[112:115], v4, s[8:11], s24 offen offset:0 sc1
    buffer_load_dwordx4 a[116:119], v4, s[8:11], s24 offen offset:1024 sc1
    buffer_load_dwordx4 a[120:123], v4, s[8:11], s25 offen offset:0 sc1
    buffer_load_dwordx4 a[124:127], v4, s[8:11], s25 offen offset:1024 sc1
    s_add_u32 s24, s24, 8192
    s_add_u32 s25, s25, 8192
    buffer_load_dwordx4 a[248:251], v4, s[8:11], s34 offen sc1
    buffer_load_dwordx4 a[252:255], v4, s[36:39], s35 offen sc1
    s_add_u32 s34, s34, s44
    s_cmp_ge_u32 s34, s45
    s_cselect_b32 s35, s46, 0
    s_add_u32 s34, s34, s35
    s_add_u32 s35, s34, s47
    v_exp_f32 v94, v94
    v_exp_f32 v95, v95
    v_cvt_pk_bf16_f32 v117, v90, v91
    v_cvt_pk_bf16_f32 v118, v92, v93
    v_cvt_pk_bf16_f32 v119, v94, v95
    v_exp_f32 v96, v96
    v_mfma_f32_32x32x16_bf16 v[80:95], a[128:131], a[16:19], v[48:63]
    v_exp_f32 v97, v97
    v_exp_f32 v98, v98
    v_exp_f32 v99, v99
    v_exp_f32 v100, v100
    v_cvt_pk_bf16_f32 v120, v96, v97
    v_mfma_f32_32x32x16_bf16 v[80:95], a[132:135], a[20:23], v[80:95]
    v_exp_f32 v101, v101
    v_exp_f32 v102, v102
    v_exp_f32 v103, v103
    v_exp_f32 v104, v104
    v_cvt_pk_bf16_f32 v121, v98, v99
    v_cvt_pk_bf16_f32 v122, v100, v101
    v_mfma_f32_32x32x16_bf16 a[32:47], a[136:139], v[112:115], a[32:47]
    v_exp_f32 v105, v105
    v_exp_f32 v106, v106
    v_exp_f32 v107, v107
    v_exp_f32 v108, v108
    v_cvt_pk_bf16_f32 v123, v102, v103
    v_cvt_pk_bf16_f32 v124, v104, v105
    v_mfma_f32_32x32x16_bf16 a[32:47], a[140:143], v[116:119], a[32:47]
    v_exp_f32 v109, v109
    v_exp_f32 v110, v110
    v_exp_f32 v111, v111
    v_cvt_pk_bf16_f32 v125, v106, v107
    v_cvt_pk_bf16_f32 v126, v108, v109
    v_cvt_pk_bf16_f32 v127, v110, v111
    v_exp_f32 v80, v80
    v_mfma_f32_32x32x16_bf16 v[96:111], a[128:131], a[24:27], v[64:79]
    v_exp_f32 v81, v81
    v_exp_f32 v82, v82
    v_exp_f32 v83, v83
    v_exp_f32 v84, v84
    v_cvt_pk_bf16_f32 v112, v80, v81
    v_mfma_f32_32x32x16_bf16 v[96:111], a[132:135], a[28:31], v[96:111]
    v_exp_f32 v85, v85
    v_exp_f32 v86, v86
    v_exp_f32 v87, v87
    v_exp_f32 v88, v88
    v_cvt_pk_bf16_f32 v113, v82, v83
    v_cvt_pk_bf16_f32 v114, v84, v85
    v_mfma_f32_32x32x16_bf16 a[48:63], a[136:139], v[120:123], a[48:63]
    v_exp_f32 v89, v89
    v_exp_f32 v90, v90
    v_exp_f32 v91, v91
    v_exp_f32 v92, v92
    v_cvt_pk_bf16_f32 v115, v86, v87
    v_cvt_pk_bf16_f32 v116, v88, v89
    v_mfma_f32_32x32x16_bf16 a[48:63], a[140:143], v[124:127], a[48:63]
    v_exp_f32 v93, v93
    v_exp_f32 v94, v94
    v_exp_f32 v95, v95
    v_cvt_pk_bf16_f32 v117, v90, v91
    v_cvt_pk_bf16_f32 v118, v92, v93
    v_cvt_pk_bf16_f32 v119, v94, v95
    s_waitcnt vmcnt(12)
    v_exp_f32 v96, v96
    v_mfma_f32_32x32x16_bf16 v[80:95], a[144:147], a[0:3], v[16:31]
    v_exp_f32 v97, v97
    v_exp_f32 v98, v98
    v_exp_f32 v99, v99
    v_exp_f32 v100, v100
    v_cvt_pk_bf16_f32 v120, v96, v97
    v_mfma_f32_32x32x16_bf16 v[80:95], a[148:151], a[4:7], v[80:95]
    v_exp_f32 v101, v101
    v_exp_f32 v102, v102
    v_exp_f32 v103, v103
    v_exp_f32 v104, v104
    v_cvt_pk_bf16_f32 v121, v98, v99
    v_cvt_pk_bf16_f32 v122, v100, v101
    v_mfma_f32_32x32x16_bf16 a[64:79], a[136:139], v[112:115], a[64:79]
    v_exp_f32 v105, v105
    v_exp_f32 v106, v106
    v_exp_f32 v107, v107
    v_exp_f32 v108, v108
    v_cvt_pk_bf16_f32 v123, v102, v103
    v_cvt_pk_bf16_f32 v124, v104, v105
    v_mfma_f32_32x32x16_bf16 a[64:79], a[140:143], v[116:119], a[64:79]
    v_exp_f32 v109, v109
    v_exp_f32 v110, v110
    v_exp_f32 v111, v111
    v_cvt_pk_bf16_f32 v125, v106, v107
    v_cvt_pk_bf16_f32 v126, v108, v109
    v_cvt_pk_bf16_f32 v127, v110, v111
    v_exp_f32 v80, v80
    v_mfma_f32_32x32x16_bf16 v[96:111], a[144:147], a[8:11], v[32:47]
    v_exp_f32 v81, v81
    v_exp_f32 v82, v82
    v_exp_f32 v83, v83
    v_exp_f32 v84, v84
    v_cvt_pk_bf16_f32 v112, v80, v81
    v_mfma_f32_32x32x16_bf16 v[96:111], a[148:151], a[12:15], v[96:111]
    v_exp_f32 v85, v85
    v_exp_f32 v86, v86
    v_exp_f32 v87, v87
    v_exp_f32 v88, v88
    v_cvt_pk_bf16_f32 v113, v82, v83
    v_cvt_pk_bf16_f32 v114, v84, v85
    v_mfma_f32_32x32x16_bf16 a[80:95], a[136:139], v[120:123], a[80:95]
    v_exp_f32 v89, v89
    v_exp_f32 v90, v90
    v_exp_f32 v91, v91
    v_exp_f32 v92, v92
    v_cvt_pk_bf16_f32 v115, v86, v87
    v_cvt_pk_bf16_f32 v116, v88, v89
    v_mfma_f32_32x32x16_bf16 a[80:95], a[140:143], v[124:127], a[80:95]
    v_exp_f32 v93, v93
    s_add_u32 s22, s3, 56
    v_lshlrev_b32 v5, 2, v1
    v_add_u32 v5, s22, v5
    v_cmp_gt_u32 vcc, 1, v1
    s_nop 1
    v_cndmask_b32 v5, 0, v5, vcc
    v_lshlrev_b32 v5, 7, v5
    v_add_u32 v5, 0x14000, v5
    s_mov_b32 s22, 0x4282000
    s_add_u32 s22, s22, s84
    s_mov_b32 s40, 0
at_kvwd:
    buffer_load_dword v6, v5, s[8:11], s22 offen sc1
    s_waitcnt vmcnt(0)
    v_cmp_eq_u32 vcc, 0, v6
    s_cbranch_vccz at_kvokd
    s_sleep 2
    s_add_u32 s40, s40, 1
    s_cmp_lt_u32 s40, 0x10000
    s_cbranch_scc1 at_kvwd
at_kvokd:
    buffer_load_dwordx4 a[128:131], v4, s[8:11], s24 offen offset:0 sc1
    buffer_load_dwordx4 a[132:135], v4, s[8:11], s24 offen offset:1024 sc1
    buffer_load_dwordx4 a[136:139], v4, s[8:11], s25 offen offset:0 sc1
    buffer_load_dwordx4 a[140:143], v4, s[8:11], s25 offen offset:1024 sc1
    s_add_u32 s24, s24, 8192
    s_add_u32 s25, s25, 8192
    buffer_load_dwordx4 v[200:203], v4, s[8:11], s34 offen sc1
    buffer_load_dwordx4 v[204:207], v4, s[36:39], s35 offen sc1
    s_add_u32 s34, s34, s44
    s_cmp_ge_u32 s34, s45
    s_cselect_b32 s35, s46, 0
    s_add_u32 s34, s34, s35
    s_add_u32 s35, s34, s47
    v_exp_f32 v94, v94
    v_exp_f32 v95, v95
    v_cvt_pk_bf16_f32 v117, v90, v91
    v_cvt_pk_bf16_f32 v118, v92, v93
    v_cvt_pk_bf16_f32 v119, v94, v95
    v_exp_f32 v96, v96
    v_mfma_f32_32x32x16_bf16 v[80:95], a[144:147], a[16:19], v[48:63]
    v_exp_f32 v97, v97
    v_exp_f32 v98, v98
    v_exp_f32 v99, v99
    v_exp_f32 v100, v100
    v_cvt_pk_bf16_f32 v120, v96, v97
    v_mfma_f32_32x32x16_bf16 v[80:95], a[148:151], a[20:23], v[80:95]
    v_exp_f32 v101, v101
    v_exp_f32 v102, v102
    v_exp_f32 v103, v103
    v_exp_f32 v104, v104
    v_cvt_pk_bf16_f32 v121, v98, v99
    v_cvt_pk_bf16_f32 v122, v100, v101
    v_mfma_f32_32x32x16_bf16 a[32:47], a[152:155], v[112:115], a[32:47]
    v_exp_f32 v105, v105
    v_exp_f32 v106, v106
    v_exp_f32 v107, v107
    v_exp_f32 v108, v108
    v_cvt_pk_bf16_f32 v123, v102, v103
    v_cvt_pk_bf16_f32 v124, v104, v105
    v_mfma_f32_32x32x16_bf16 a[32:47], a[156:159], v[116:119], a[32:47]
    v_exp_f32 v109, v109
    v_exp_f32 v110, v110
    v_exp_f32 v111, v111
    v_cvt_pk_bf16_f32 v125, v106, v107
    v_cvt_pk_bf16_f32 v126, v108, v109
    v_cvt_pk_bf16_f32 v127, v110, v111
    v_exp_f32 v80, v80
    v_mfma_f32_32x32x16_bf16 v[96:111], a[144:147], a[24:27], v[64:79]
    v_exp_f32 v81, v81
    v_exp_f32 v82, v82
    v_exp_f32 v83, v83
    v_exp_f32 v84, v84
    v_cvt_pk_bf16_f32 v112, v80, v81
    v_mfma_f32_32x32x16_bf16 v[96:111], a[148:151], a[28:31], v[96:111]
    v_exp_f32 v85, v85
    v_exp_f32 v86, v86
    v_exp_f32 v87, v87
    v_exp_f32 v88, v88
    v_cvt_pk_bf16_f32 v113, v82, v83
    v_cvt_pk_bf16_f32 v114, v84, v85
    v_mfma_f32_32x32x16_bf16 a[48:63], a[152:155], v[120:123], a[48:63]
    v_exp_f32 v89, v89
    v_exp_f32 v90, v90
    v_exp_f32 v91, v91
    v_exp_f32 v92, v92
    v_cvt_pk_bf16_f32 v115, v86, v87
    v_cvt_pk_bf16_f32 v116, v88, v89
    v_mfma_f32_32x32x16_bf16 a[48:63], a[156:159], v[124:127], a[48:63]
    v_exp_f32 v93, v93
    v_exp_f32 v94, v94
    v_exp_f32 v95, v95
    v_cvt_pk_bf16_f32 v117, v90, v91
    v_cvt_pk_bf16_f32 v118, v92, v93
    v_cvt_pk_bf16_f32 v119, v94, v95
    s_waitcnt vmcnt(12)
    v_exp_f32 v96, v96
    v_mfma_f32_32x32x16_bf16 v[80:95], a[96:99], a[0:3], v[16:31]
    v_exp_f32 v97, v97
    v_exp_f32 v98, v98
    v_exp_f32 v99, v99
    v_exp_f32 v100, v100
    v_cvt_pk_bf16_f32 v120, v96, v97
    v_mfma_f32_32x32x16_bf16 v[80:95], a[100:103], a[4:7], v[80:95]
    v_exp_f32 v101, v101
    v_exp_f32 v102, v102
    v_exp_f32 v103, v103
    v_exp_f32 v104, v104
    v_cvt_pk_bf16_f32 v121, v98, v99
    v_cvt_pk_bf16_f32 v122, v100, v101
    v_mfma_f32_32x32x16_bf16 a[64:79], a[152:155], v[112:115], a[64:79]
    v_exp_f32 v105, v105
    v_exp_f32 v106, v106
    v_exp_f32 v107, v107
    v_exp_f32 v108, v108
    v_cvt_pk_bf16_f32 v123, v102, v103
    v_cvt_pk_bf16_f32 v124, v104, v105
    v_mfma_f32_32x32x16_bf16 a[64:79], a[156:159], v[116:119], a[64:79]
    v_exp_f32 v109, v109
    v_exp_f32 v110, v110
    v_exp_f32 v111, v111
    v_cvt_pk_bf16_f32 v125, v106, v107
    v_cvt_pk_bf16_f32 v126, v108, v109
    v_cvt_pk_bf16_f32 v127, v110, v111
    v_exp_f32 v80, v80
    v_mfma_f32_32x32x16_bf16 v[96:111], a[96:99], a[8:11], v[32:47]
    v_exp_f32 v81, v81
    v_exp_f32 v82, v82
    v_exp_f32 v83, v83
    v_exp_f32 v84, v84
    v_cvt_pk_bf16_f32 v112, v80, v81
    v_mfma_f32_32x32x16_bf16 v[96:111], a[100:103], a[12:15], v[96:111]
    v_exp_f32 v85, v85
    v_exp_f32 v86, v86
    v_exp_f32 v87, v87
    v_exp_f32 v88, v88
    v_cvt_pk_bf16_f32 v113, v82, v83
    v_cvt_pk_bf16_f32 v114, v84, v85
    v_mfma_f32_32x32x16_bf16 a[80:95], a[152:155], v[120:123], a[80:95]
    v_exp_f32 v89, v89
    v_exp_f32 v90, v90
    v_exp_f32 v91, v91
    v_exp_f32 v92, v92
    v_cvt_pk_bf16_f32 v115, v86, v87
    v_cvt_pk_bf16_f32 v116, v88, v89
    v_mfma_f32_32x32x16_bf16 a[80:95], a[156:159], v[124:127], a[80:95]
    v_exp_f32 v93, v93
    buffer_load_dwordx4 v[208:211], v4, s[8:11], s34 offen sc1
    buffer_load_dwordx4 v[212:215], v4, s[36:39], s35 offen sc1
    s_add_u32 s34, s34, s44
    s_cmp_ge_u32 s34, s45
    s_cselect_b32 s35, s46, 0
    s_add_u32 s34, s34, s35
    s_add_u32 s35, s34, s47
    v_exp_f32 v94, v94
    v_exp_f32 v95, v95
    v_cvt_pk_bf16_f32 v117, v90, v91
    v_cvt_pk_bf16_f32 v118, v92, v93
    v_cvt_pk_bf16_f32 v119, v94, v95
    v_exp_f32 v96, v96
    v_mfma_f32_32x32x16_bf16 v[80:95], a[96:99], a[16:19], v[48:63]
    v_exp_f32 v97, v97
    v_exp_f32 v98, v98
    v_exp_f32 v99, v99
    v_exp_f32 v100, v100
    v_cvt_pk_bf16_f32 v120, v96, v97
    v_mfma_f32_32x32x16_bf16 v[80:95], a[100:103], a[20:23], v[80:95]
    v_exp_f32 v101, v101
    v_exp_f32 v102, v102
    v_exp_f32 v103, v103
    v_exp_f32 v104, v104
    v_cvt_pk_bf16_f32 v121, v98, v99
    v_cvt_pk_bf16_f32 v122, v100, v101
    v_mfma_f32_32x32x16_bf16 a[32:47], a[104:107], v[112:115], a[32:47]
    v_exp_f32 v105, v105
    v_exp_f32 v106, v106
    v_exp_f32 v107, v107
    v_exp_f32 v108, v108
    v_cvt_pk_bf16_f32 v123, v102, v103
    v_cvt_pk_bf16_f32 v124, v104, v105
    v_mfma_f32_32x32x16_bf16 a[32:47], a[108:111], v[116:119], a[32:47]
    v_exp_f32 v109, v109
    v_exp_f32 v110, v110
    v_exp_f32 v111, v111
    v_cvt_pk_bf16_f32 v125, v106, v107
    v_cvt_pk_bf16_f32 v126, v108, v109
    v_cvt_pk_bf16_f32 v127, v110, v111
    v_exp_f32 v80, v80
    v_mfma_f32_32x32x16_bf16 v[96:111], a[96:99], a[24:27], v[64:79]
    v_exp_f32 v81, v81
    v_exp_f32 v82, v82
    v_exp_f32 v83, v83
    v_exp_f32 v84, v84
    v_cvt_pk_bf16_f32 v112, v80, v81
    v_mfma_f32_32x32x16_bf16 v[96:111], a[100:103], a[28:31], v[96:111]
    v_exp_f32 v85, v85
    v_exp_f32 v86, v86
    v_exp_f32 v87, v87
    v_exp_f32 v88, v88
    v_cvt_pk_bf16_f32 v113, v82, v83
    v_cvt_pk_bf16_f32 v114, v84, v85
    v_mfma_f32_32x32x16_bf16 a[48:63], a[104:107], v[120:123], a[48:63]
    v_exp_f32 v89, v89
    v_exp_f32 v90, v90
    v_exp_f32 v91, v91
    v_exp_f32 v92, v92
    v_cvt_pk_bf16_f32 v115, v86, v87
    v_cvt_pk_bf16_f32 v116, v88, v89
    v_mfma_f32_32x32x16_bf16 a[48:63], a[108:111], v[124:127], a[48:63]
    v_exp_f32 v93, v93
    v_exp_f32 v94, v94
    v_exp_f32 v95, v95
    v_cvt_pk_bf16_f32 v117, v90, v91
    v_cvt_pk_bf16_f32 v118, v92, v93
    v_cvt_pk_bf16_f32 v119, v94, v95
    s_waitcnt vmcnt(4)
    v_exp_f32 v96, v96
    v_mfma_f32_32x32x16_bf16 v[80:95], a[112:115], a[0:3], v[16:31]
    v_exp_f32 v97, v97
    v_exp_f32 v98, v98
    v_exp_f32 v99, v99
    v_exp_f32 v100, v100
    v_cvt_pk_bf16_f32 v120, v96, v97
    v_mfma_f32_32x32x16_bf16 v[80:95], a[116:119], a[4:7], v[80:95]
    v_exp_f32 v101, v101
    v_exp_f32 v102, v102
    v_exp_f32 v103, v103
    v_exp_f32 v104, v104
    v_cvt_pk_bf16_f32 v121, v98, v99
    v_cvt_pk_bf16_f32 v122, v100, v101
    v_mfma_f32_32x32x16_bf16 a[64:79], a[104:107], v[112:115], a[64:79]
    v_exp_f32 v105, v105
    v_exp_f32 v106, v106
    v_exp_f32 v107, v107
    v_exp_f32 v108, v108
    v_cvt_pk_bf16_f32 v123, v102, v103
    v_cvt_pk_bf16_f32 v124, v104, v105
    v_mfma_f32_32x32x16_bf16 a[64:79], a[108:111], v[116:119], a[64:79]
    v_exp_f32 v109, v109
    v_exp_f32 v110, v110
    v_exp_f32 v111, v111
    v_cvt_pk_bf16_f32 v125, v106, v107
    v_cvt_pk_bf16_f32 v126, v108, v109
    v_cvt_pk_bf16_f32 v127, v110, v111
    v_exp_f32 v80, v80
    v_mfma_f32_32x32x16_bf16 v[96:111], a[112:115], a[8:11], v[32:47]
    v_exp_f32 v81, v81
    v_exp_f32 v82, v82
    v_exp_f32 v83, v83
    v_exp_f32 v84, v84
    v_cvt_pk_bf16_f32 v112, v80, v81
    v_mfma_f32_32x32x16_bf16 v[96:111], a[116:119], a[12:15], v[96:111]
    v_exp_f32 v85, v85
    v_exp_f32 v86, v86
    v_exp_f32 v87, v87
    v_exp_f32 v88, v88
    v_cvt_pk_bf16_f32 v113, v82, v83
    v_cvt_pk_bf16_f32 v114, v84, v85
    v_mfma_f32_32x32x16_bf16 a[80:95], a[104:107], v[120:123], a[80:95]
    v_exp_f32 v89, v89
    v_exp_f32 v90, v90
    v_exp_f32 v91, v91
    v_exp_f32 v92, v92
    v_cvt_pk_bf16_f32 v115, v86, v87
    v_cvt_pk_bf16_f32 v116, v88, v89
    v_mfma_f32_32x32x16_bf16 a[80:95], a[108:111], v[124:127], a[80:95]
    v_exp_f32 v93, v93
    buffer_load_dwordx4 v[216:219], v4, s[8:11], s34 offen sc1
    buffer_load_dwordx4 v[220:223], v4, s[36:39], s35 offen sc1
    s_add_u32 s34, s34, s44
    s_cmp_ge_u32 s34, s45
    s_cselect_b32 s35, s46, 0
    s_add_u32 s34, s34, s35
    s_add_u32 s35, s34, s47
    v_exp_f32 v94, v94
    v_exp_f32 v95, v95
    v_cvt_pk_bf16_f32 v117, v90, v91
    v_cvt_pk_bf16_f32 v118, v92, v93
    v_cvt_pk_bf16_f32 v119, v94, v95
    v_exp_f32 v96, v96
    v_mfma_f32_32x32x16_bf16 v[80:95], a[112:115], a[16:19], v[48:63]
    v_exp_f32 v97, v97
    v_exp_f32 v98, v98
    v_exp_f32 v99, v99
    v_exp_f32 v100, v100
    v_cvt_pk_bf16_f32 v120, v96, v97
    v_mfma_f32_32x32x16_bf16 v[80:95], a[116:119], a[20:23], v[80:95]
    v_exp_f32 v101, v101
    v_exp_f32 v102, v102
    v_exp_f32 v103, v103
    v_exp_f32 v104, v104
    v_cvt_pk_bf16_f32 v121, v98, v99
    v_cvt_pk_bf16_f32 v122, v100, v101
    v_mfma_f32_32x32x16_bf16 a[32:47], a[120:123], v[112:115], a[32:47]
    v_exp_f32 v105, v105
    v_exp_f32 v106, v106
    v_exp_f32 v107, v107
    v_exp_f32 v108, v108
    v_cvt_pk_bf16_f32 v123, v102, v103
    v_cvt_pk_bf16_f32 v124, v104, v105
    v_mfma_f32_32x32x16_bf16 a[32:47], a[124:127], v[116:119], a[32:47]
    v_exp_f32 v109, v109
    v_exp_f32 v110, v110
    v_exp_f32 v111, v111
    v_cvt_pk_bf16_f32 v125, v106, v107
    v_cvt_pk_bf16_f32 v126, v108, v109
    v_cvt_pk_bf16_f32 v127, v110, v111
    v_exp_f32 v80, v80
    v_mfma_f32_32x32x16_bf16 v[96:111], a[112:115], a[24:27], v[64:79]
    v_exp_f32 v81, v81
    v_exp_f32 v82, v82
    v_exp_f32 v83, v83
    v_exp_f32 v84, v84
    v_cvt_pk_bf16_f32 v112, v80, v81
    v_mfma_f32_32x32x16_bf16 v[96:111], a[116:119], a[28:31], v[96:111]
    v_exp_f32 v85, v85
    v_exp_f32 v86, v86
    v_exp_f32 v87, v87
    v_exp_f32 v88, v88
    v_cvt_pk_bf16_f32 v113, v82, v83
    v_cvt_pk_bf16_f32 v114, v84, v85
    v_mfma_f32_32x32x16_bf16 a[48:63], a[120:123], v[120:123], a[48:63]
    v_exp_f32 v89, v89
    v_exp_f32 v90, v90
    v_exp_f32 v91, v91
    v_exp_f32 v92, v92
    v_cvt_pk_bf16_f32 v115, v86, v87
    v_cvt_pk_bf16_f32 v116, v88, v89
    v_mfma_f32_32x32x16_bf16 a[48:63], a[124:127], v[124:127], a[48:63]
    v_exp_f32 v93, v93
    s_add_u32 s22, s3, 60
    v_lshlrev_b32 v5, 2, v1
    v_add_u32 v5, s22, v5
    v_cmp_gt_u32 vcc, 1, v1
    s_nop 1
    v_cndmask_b32 v5, 0, v5, vcc
    v_lshlrev_b32 v5, 7, v5
    v_add_u32 v5, 0x14000, v5
    s_mov_b32 s22, 0x4282000
    s_add_u32 s22, s22, s84
    s_mov_b32 s40, 0
at_kvwb:
    buffer_load_dword v6, v5, s[8:11], s22 offen sc1
    s_waitcnt vmcnt(0)
    v_cmp_eq_u32 vcc, 0, v6
    s_cbranch_vccz at_kvokb
    s_sleep 2
    s_add_u32 s40, s40, 1
    s_cmp_lt_u32 s40, 0x10000
    s_cbranch_scc1 at_kvwb
at_kvokb:
    buffer_load_dwordx4 a[144:147], v4, s[8:11], s24 offen offset:0 sc1
    buffer_load_dwordx4 a[148:151], v4, s[8:11], s24 offen offset:1024 sc1
    buffer_load_dwordx4 a[152:155], v4, s[8:11], s25 offen offset:0 sc1
    buffer_load_dwordx4 a[156:159], v4, s[8:11], s25 offen offset:1024 sc1
    s_add_u32 s24, s24, 8192
    s_add_u32 s25, s25, 8192
    v_exp_f32 v94, v94
    v_exp_f32 v95, v95
    v_cvt_pk_bf16_f32 v117, v90, v91
    v_cvt_pk_bf16_f32 v118, v92, v93
    v_cvt_pk_bf16_f32 v119, v94, v95
    s_waitcnt vmcnt(4)
    v_exp_f32 v96, v96
    v_mfma_f32_32x32x16_bf16 v[80:95], a[128:131], a[0:3], v[16:31]
    v_exp_f32 v97, v97
    v_exp_f32 v98, v98
    v_exp_f32 v99, v99
    v_exp_f32 v100, v100
    v_cvt_pk_bf16_f32 v120, v96, v97
    v_mfma_f32_32x32x16_bf16 v[80:95], a[132:135], a[4:7], v[80:95]
    v_exp_f32 v101, v101
    v_exp_f32 v102, v102
    v_exp_f32 v103, v103
    v_exp_f32 v104, v104
    v_cvt_pk_bf16_f32 v121, v98, v99
    v_cvt_pk_bf16_f32 v122, v100, v101
    v_mfma_f32_32x32x16_bf16 a[64:79], a[120:123], v[112:115], a[64:79]
    v_exp_f32 v105, v105
    v_exp_f32 v106, v106
    v_exp_f32 v107, v107
    v_exp_f32 v108, v108
    v_cvt_pk_bf16_f32 v123, v102, v103
    v_cvt_pk_bf16_f32 v124, v104, v105
    v_mfma_f32_32x32x16_bf16 a[64:79], a[124:127], v[116:119], a[64:79]
    v_exp_f32 v109, v109
    v_exp_f32 v110, v110
    v_exp_f32 v111, v111
    v_cvt_pk_bf16_f32 v125, v106, v107
    v_cvt_pk_bf16_f32 v126, v108, v109
    v_cvt_pk_bf16_f32 v127, v110, v111
    v_exp_f32 v80, v80
    v_mfma_f32_32x32x16_bf16 v[96:111], a[128:131], a[8:11], v[32:47]
    v_exp_f32 v81, v81
    v_exp_f32 v82, v82
    v_exp_f32 v83, v83
    v_exp_f32 v84, v84
    v_cvt_pk_bf16_f32 v112, v80, v81
    v_mfma_f32_32x32x16_bf16 v[96:111], a[132:135], a[12:15], v[96:111]
    v_exp_f32 v85, v85
    v_exp_f32 v86, v86
    v_exp_f32 v87, v87
    v_exp_f32 v88, v88
    v_cvt_pk_bf16_f32 v113, v82, v83
    v_cvt_pk_bf16_f32 v114, v84, v85
    v_mfma_f32_32x32x16_bf16 a[80:95], a[120:123], v[120:123], a[80:95]
    v_exp_f32 v89, v89
    v_exp_f32 v90, v90
    v_exp_f32 v91, v91
    v_exp_f32 v92, v92
    v_cvt_pk_bf16_f32 v115, v86, v87
    v_cvt_pk_bf16_f32 v116, v88, v89
    v_mfma_f32_32x32x16_bf16 a[80:95], a[124:127], v[124:127], a[80:95]
    v_exp_f32 v93, v93
    buffer_load_dwordx4 v[224:227], v4, s[8:11], s34 offen sc1
    buffer_load_dwordx4 v[228:231], v4, s[36:39], s35 offen sc1
    s_add_u32 s34, s34, s44
    s_cmp_ge_u32 s34, s45
    s_cselect_b32 s35, s46, 0
    s_add_u32 s34, s34, s35
    s_add_u32 s35, s34, s47
    v_exp_f32 v94, v94
    v_exp_f32 v95, v95
    v_cvt_pk_bf16_f32 v117, v90, v91
    v_cvt_pk_bf16_f32 v118, v92, v93
    v_cvt_pk_bf16_f32 v119, v94, v95
    v_exp_f32 v96, v96
    v_mfma_f32_32x32x16_bf16 v[80:95], a[128:131], a[16:19], v[48:63]
    v_exp_f32 v97, v97
    v_exp_f32 v98, v98
    v_exp_f32 v99, v99
    v_exp_f32 v100, v100
    v_cvt_pk_bf16_f32 v120, v96, v97
    v_mfma_f32_32x32x16_bf16 v[80:95], a[132:135], a[20:23], v[80:95]
    v_exp_f32 v101, v101
    v_exp_f32 v102, v102
    v_exp_f32 v103, v103
    v_exp_f32 v104, v104
    v_cvt_pk_bf16_f32 v121, v98, v99
    v_cvt_pk_bf16_f32 v122, v100, v101
    v_mfma_f32_32x32x16_bf16 a[32:47], a[136:139], v[112:115], a[32:47]
    v_exp_f32 v105, v105
    v_exp_f32 v106, v106
    v_exp_f32 v107, v107
    v_exp_f32 v108, v108
    v_cvt_pk_bf16_f32 v123, v102, v103
    v_cvt_pk_bf16_f32 v124, v104, v105
    v_mfma_f32_32x32x16_bf16 a[32:47], a[140:143], v[116:119], a[32:47]
    v_exp_f32 v109, v109
    v_exp_f32 v110, v110
    v_exp_f32 v111, v111
    v_cvt_pk_bf16_f32 v125, v106, v107
    v_cvt_pk_bf16_f32 v126, v108, v109
    v_cvt_pk_bf16_f32 v127, v110, v111
    v_exp_f32 v80, v80
    v_mfma_f32_32x32x16_bf16 v[96:111], a[128:131], a[24:27], v[64:79]
    v_exp_f32 v81, v81
    v_exp_f32 v82, v82
    v_exp_f32 v83, v83
    v_exp_f32 v84, v84
    v_cvt_pk_bf16_f32 v112, v80, v81
    v_mfma_f32_32x32x16_bf16 v[96:111], a[132:135], a[28:31], v[96:111]
    v_exp_f32 v85, v85
    v_exp_f32 v86, v86
    v_exp_f32 v87, v87
    v_exp_f32 v88, v88
    v_cvt_pk_bf16_f32 v113, v82, v83
    v_cvt_pk_bf16_f32 v114, v84, v85
    v_mfma_f32_32x32x16_bf16 a[48:63], a[136:139], v[120:123], a[48:63]
    v_exp_f32 v89, v89
    v_exp_f32 v90, v90
    v_exp_f32 v91, v91
    v_exp_f32 v92, v92
    v_cvt_pk_bf16_f32 v115, v86, v87
    v_cvt_pk_bf16_f32 v116, v88, v89
    v_mfma_f32_32x32x16_bf16 a[48:63], a[140:143], v[124:127], a[48:63]
    v_exp_f32 v93, v93
    v_exp_f32 v94, v94
    v_exp_f32 v95, v95
    v_cvt_pk_bf16_f32 v117, v90, v91
    v_cvt_pk_bf16_f32 v118, v92, v93
    v_cvt_pk_bf16_f32 v119, v94, v95
    s_waitcnt vmcnt(0)
    v_exp_f32 v96, v96
    v_mfma_f32_32x32x16_bf16 v[80:95], a[144:147], a[0:3], v[16:31]
    v_exp_f32 v97, v97
    v_exp_f32 v98, v98
    v_exp_f32 v99, v99
    v_exp_f32 v100, v100
    v_cvt_pk_bf16_f32 v120, v96, v97
    v_mfma_f32_32x32x16_bf16 v[80:95], a[148:151], a[4:7], v[80:95]
    v_exp_f32 v101, v101
    v_exp_f32 v102, v102
    v_exp_f32 v103, v103
    v_exp_f32 v104, v104
    v_cvt_pk_bf16_f32 v121, v98, v99
    v_cvt_pk_bf16_f32 v122, v100, v101
    v_mfma_f32_32x32x16_bf16 a[64:79], a[136:139], v[112:115], a[64:79]
    v_exp_f32 v105, v105
    v_exp_f32 v106, v106
    v_exp_f32 v107, v107
    v_exp_f32 v108, v108
    v_cvt_pk_bf16_f32 v123, v102, v103
    v_cvt_pk_bf16_f32 v124, v104, v105
    v_mfma_f32_32x32x16_bf16 a[64:79], a[140:143], v[116:119], a[64:79]
    v_exp_f32 v109, v109
    v_exp_f32 v110, v110
    v_exp_f32 v111, v111
    v_cvt_pk_bf16_f32 v125, v106, v107
    v_cvt_pk_bf16_f32 v126, v108, v109
    v_cvt_pk_bf16_f32 v127, v110, v111
    v_exp_f32 v80, v80
    v_mfma_f32_32x32x16_bf16 v[96:111], a[144:147], a[8:11], v[32:47]
    v_exp_f32 v81, v81
    v_exp_f32 v82, v82
    v_exp_f32 v83, v83
    v_exp_f32 v84, v84
    v_cvt_pk_bf16_f32 v112, v80, v81
    v_mfma_f32_32x32x16_bf16 v[96:111], a[148:151], a[12:15], v[96:111]
    v_exp_f32 v85, v85
    v_exp_f32 v86, v86
    v_exp_f32 v87, v87
    v_exp_f32 v88, v88
    v_cvt_pk_bf16_f32 v113, v82, v83
    v_cvt_pk_bf16_f32 v114, v84, v85
    v_mfma_f32_32x32x16_bf16 a[80:95], a[136:139], v[120:123], a[80:95]
    v_exp_f32 v89, v89
    v_exp_f32 v90, v90
    v_exp_f32 v91, v91
    v_exp_f32 v92, v92
    v_cvt_pk_bf16_f32 v115, v86, v87
    v_cvt_pk_bf16_f32 v116, v88, v89
    v_mfma_f32_32x32x16_bf16 a[80:95], a[140:143], v[124:127], a[80:95]
    v_exp_f32 v93, v93
    buffer_load_dwordx4 v[232:235], v4, s[8:11], s34 offen sc1
    buffer_load_dwordx4 v[236:239], v4, s[36:39], s35 offen sc1
    s_add_u32 s34, s34, s44
    s_cmp_ge_u32 s34, s45
    s_cselect_b32 s35, s46, 0
    s_add_u32 s34, s34, s35
    s_add_u32 s35, s34, s47
    v_exp_f32 v94, v94
    v_exp_f32 v95, v95
    v_cvt_pk_bf16_f32 v117, v90, v91
    v_cvt_pk_bf16_f32 v118, v92, v93
    v_cvt_pk_bf16_f32 v119, v94, v95
    v_exp_f32 v96, v96
    v_mfma_f32_32x32x16_bf16 v[80:95], a[144:147], a[16:19], v[48:63]
    v_exp_f32 v97, v97
    v_exp_f32 v98, v98
    v_exp_f32 v99, v99
    v_exp_f32 v100, v100
    v_cvt_pk_bf16_f32 v120, v96, v97
    v_mfma_f32_32x32x16_bf16 v[80:95], a[148:151], a[20:23], v[80:95]
    v_exp_f32 v101, v101
    v_exp_f32 v102, v102
    v_exp_f32 v103, v103
    v_exp_f32 v104, v104
    v_cvt_pk_bf16_f32 v121, v98, v99
    v_cvt_pk_bf16_f32 v122, v100, v101
    v_mfma_f32_32x32x16_bf16 a[32:47], a[152:155], v[112:115], a[32:47]
    v_exp_f32 v105, v105
    v_exp_f32 v106, v106
    v_exp_f32 v107, v107
    v_exp_f32 v108, v108
    v_cvt_pk_bf16_f32 v123, v102, v103
    v_cvt_pk_bf16_f32 v124, v104, v105
    v_mfma_f32_32x32x16_bf16 a[32:47], a[156:159], v[116:119], a[32:47]
    v_exp_f32 v109, v109
    v_exp_f32 v110, v110
    v_exp_f32 v111, v111
    v_cvt_pk_bf16_f32 v125, v106, v107
    v_cvt_pk_bf16_f32 v126, v108, v109
    v_cvt_pk_bf16_f32 v127, v110, v111
    v_exp_f32 v80, v80
    v_mfma_f32_32x32x16_bf16 v[96:111], a[144:147], a[24:27], v[64:79]
    v_exp_f32 v81, v81
    v_exp_f32 v82, v82
    v_exp_f32 v83, v83
    v_exp_f32 v84, v84
    v_cvt_pk_bf16_f32 v112, v80, v81
    v_mfma_f32_32x32x16_bf16 v[96:111], a[148:151], a[28:31], v[96:111]
    v_exp_f32 v85, v85
    v_exp_f32 v86, v86
    v_exp_f32 v87, v87
    v_exp_f32 v88, v88
    v_cvt_pk_bf16_f32 v113, v82, v83
    v_cvt_pk_bf16_f32 v114, v84, v85
    v_mfma_f32_32x32x16_bf16 a[48:63], a[152:155], v[120:123], a[48:63]
    v_exp_f32 v89, v89
    v_exp_f32 v90, v90
    v_exp_f32 v91, v91
    v_exp_f32 v92, v92
    v_cvt_pk_bf16_f32 v115, v86, v87
    v_cvt_pk_bf16_f32 v116, v88, v89
    v_mfma_f32_32x32x16_bf16 a[48:63], a[156:159], v[124:127], a[48:63]
    v_exp_f32 v93, v93
    v_exp_f32 v94, v94
    v_exp_f32 v95, v95
    v_cvt_pk_bf16_f32 v117, v90, v91
    v_cvt_pk_bf16_f32 v118, v92, v93
    v_cvt_pk_bf16_f32 v119, v94, v95
    v_exp_f32 v96, v96
    v_exp_f32 v97, v97
    v_exp_f32 v98, v98
    v_exp_f32 v99, v99
    v_exp_f32 v100, v100
    v_cvt_pk_bf16_f32 v120, v96, v97
    v_exp_f32 v101, v101
    v_exp_f32 v102, v102
    v_exp_f32 v103, v103
    v_exp_f32 v104, v104
    v_cvt_pk_bf16_f32 v121, v98, v99
    v_cvt_pk_bf16_f32 v122, v100, v101
    v_mfma_f32_32x32x16_bf16 a[64:79], a[152:155], v[112:115], a[64:79]
    v_exp_f32 v105, v105
    v_exp_f32 v106, v106
    v_exp_f32 v107, v107
    v_exp_f32 v108, v108
    v_cvt_pk_bf16_f32 v123, v102, v103
    v_cvt_pk_bf16_f32 v124, v104, v105
    v_mfma_f32_32x32x16_bf16 a[64:79], a[156:159], v[116:119], a[64:79]
    v_exp_f32 v109, v109
    v_exp_f32 v110, v110
    v_exp_f32 v111, v111
    v_cvt_pk_bf16_f32 v125, v106, v107
    v_cvt_pk_bf16_f32 v126, v108, v109
    v_cvt_pk_bf16_f32 v127, v110, v111
    v_mfma_f32_32x32x16_bf16 a[80:95], a[152:155], v[120:123], a[80:95]
    s_nop 0
    v_mfma_f32_32x32x16_bf16 a[80:95], a[156:159], v[124:127], a[80:95]
    s_lshl_b32 s22, s3, 14
    v_add_u32 v6, s22, v4
    s_lshl_b32 s22, s3, 12
    v_add_u32 v7, s22, v4
    ds_write_b128 v6, a[32:35] offset:0
    ds_write_b128 v6, a[36:39] offset:1024
    ds_write_b128 v6, a[40:43] offset:2048
    ds_write_b128 v6, a[44:47] offset:3072
    s_waitcnt lgkmcnt(4)
    ds_write_b128 v6, a[48:51] offset:4096
    ds_write_b128 v6, a[52:55] offset:5120
    ds_write_b128 v6, a[56:59] offset:6144
    ds_write_b128 v6, a[60:63] offset:7168
    s_waitcnt lgkmcnt(4)
    ds_write_b128 v6, a[64:67] offset:8192
    ds_write_b128 v6, a[68:71] offset:9216
    ds_write_b128 v6, a[72:75] offset:10240
    ds_write_b128 v6, a[76:79] offset:11264
    s_waitcnt lgkmcnt(4)
    ds_write_b128 v6, a[80:83] offset:12288
    ds_write_b128 v6, a[84:87] offset:13312
    ds_write_b128 v6, a[88:91] offset:14336
    ds_write_b128 v6, a[92:95] offset:15360
    s_waitcnt lgkmcnt(4)
    s_waitcnt vmcnt(0) lgkmcnt(0)
    s_barrier
    ds_read_b128 v[144:147], v7 offset:3072
    ds_read_b128 v[160:163], v7 offset:19456
    ds_read_b128 v[176:179], v7 offset:35840
    ds_read_b128 v[192:195], v7 offset:52224
    ds_read_b128 v[132:135], v7 offset:0
    ds_read_b128 v[148:151], v7 offset:16384
    ds_read_b128 v[164:167], v7 offset:32768
    ds_read_b128 v[180:183], v7 offset:49152
    ds_read_b128 v[136:139], v7 offset:1024
    ds_read_b128 v[152:155], v7 offset:17408
    ds_read_b128 v[168:171], v7 offset:33792
    ds_read_b128 v[184:187], v7 offset:50176
    s_waitcnt lgkmcnt(8)
    ds_read_b128 v[140:143], v7 offset:2048
    ds_read_b128 v[156:159], v7 offset:18432
    ds_read_b128 v[172:175], v7 offset:34816
    ds_read_b128 v[188:191], v7 offset:51200
    v_pk_add_f32 v[144:145], v[144:145], v[160:161]
    v_pk_add_f32 v[176:177], v[176:177], v[192:193]
    v_pk_add_f32 v[144:145], v[144:145], v[176:177]
    v_pk_add_f32 v[146:147], v[146:147], v[162:163]
    v_pk_add_f32 v[178:179], v[178:179], v[194:195]
    v_pk_add_f32 v[146:147], v[146:147], v[178:179]
    v_mov_b32 v8, v144
    v_mov_b32 v9, v144
    s_nop 1
    v_permlane32_swap_b32 v8, v9
    v_cmp_nlt_f32 vcc, v9, s30
    v_rcp_f32 v9, v9
    s_waitcnt lgkmcnt(0)
    v_pk_add_f32 v[132:133], v[132:133], v[148:149]
    v_pk_add_f32 v[164:165], v[164:165], v[180:181]
    v_pk_add_f32 v[132:133], v[132:133], v[164:165]
    v_pk_add_f32 v[134:135], v[134:135], v[150:151]
    v_pk_add_f32 v[166:167], v[166:167], v[182:183]
    v_pk_add_f32 v[134:135], v[134:135], v[166:167]
    v_pk_add_f32 v[136:137], v[136:137], v[152:153]
    v_pk_add_f32 v[168:169], v[168:169], v[184:185]
    v_pk_add_f32 v[136:137], v[136:137], v[168:169]
    v_pk_add_f32 v[138:139], v[138:139], v[154:155]
    v_pk_add_f32 v[170:171], v[170:171], v[186:187]
    v_pk_add_f32 v[138:139], v[138:139], v[170:171]
    v_pk_add_f32 v[140:141], v[140:141], v[156:157]
    v_pk_add_f32 v[172:173], v[172:173], v[188:189]
    v_pk_add_f32 v[140:141], v[140:141], v[172:173]
    v_pk_add_f32 v[142:143], v[142:143], v[158:159]
    v_pk_add_f32 v[174:175], v[174:175], v[190:191]
    v_pk_add_f32 v[142:143], v[142:143], v[174:175]
    s_cmp_lg_u64 vcc, 0
    s_cselect_b32 s22, 1, 0
    v_mov_b32 v10, s22
    s_lshl_b32 s22, s3, 2
    s_add_u32 s22, s22, 65536
    v_mov_b32 v11, s22
    ds_write_b32 v11, v10
    v_mov_b32 v11, 65536
    v_mul_f32 v132, v132, v9
    v_mul_f32 v133, v133, v9
    v_mul_f32 v134, v134, v9
    v_mul_f32 v135, v135, v9
    v_mul_f32 v136, v136, v9
    v_mul_f32 v137, v137, v9
    v_mul_f32 v138, v138, v9
    v_mul_f32 v139, v139, v9
    v_mul_f32 v140, v140, v9
    v_mul_f32 v141, v141, v9
    v_mul_f32 v142, v142, v9
    v_mul_f32 v143, v143, v9
    v_mul_f32 v144, v144, v9
    v_mul_f32 v145, v145, v9
    v_mul_f32 v146, v146, v9
    v_mul_f32 v147, v147, v9
    v_cvt_pk_bf16_f32 v80, v132, v133
    v_cvt_pk_bf16_f32 v81, v134, v135
    v_cvt_pk_bf16_f32 v82, v136, v137
    v_cvt_pk_bf16_f32 v83, v138, v139
    v_cvt_pk_bf16_f32 v84, v140, v141
    v_cvt_pk_bf16_f32 v85, v142, v143
    v_cvt_pk_bf16_f32 v86, v144, v145
    v_cvt_pk_bf16_f32 v87, v146, v147
    s_mul_i32 s22, s3, 7
    v_lshrrev_b32 v8, 5, v1
    v_add_u32 v8, s22, v8
    v_bfe_u32 v9, v8, 1, 8
    v_lshlrev_b32 v9, 8, v9
    v_bfe_u32 v2, v8, 0, 1
    v_lshlrev_b32 v2, 3, v2
    v_add_u32 v9, v9, v2
    v_bfe_u32 v5, v1, 4, 1
    v_lshlrev_b32 v5, 12, v5
    v_bfe_u32 v2, v1, 0, 4
    v_lshlrev_b32 v2, 4, v2
    v_add_u32 v5, v5, v2
    v_add_u32 v5, 0x10400, v5
    v_add_u32 v5, v5, v9
    ds_write_b64 v5, v[80:81] offset:0
    ds_write_b64 v5, v[82:83] offset:256
    ds_write_b64 v5, v[84:85] offset:512
    s_mov_b32 exec_hi, 0
    ds_write_b64 v5, v[86:87] offset:768
    s_mov_b32 exec_hi, -1
    v_bfe_u32 v5, v1, 5, 1
    v_lshlrev_b32 v5, 12, v5
    v_bfe_u32 v2, v1, 0, 5
    v_lshlrev_b32 v2, 4, v2
    v_add_u32 v5, v5, v2
    v_add_u32 v5, 0x11200, v5
    v_mov_b32 v16, 0
    v_mov_b32 v17, 0
    v_mov_b32 v18, 0
    v_mov_b32 v19, 0
    ds_write_b128 v5, v[16:19]
    s_waitcnt lgkmcnt(0)
    s_barrier
    ds_read_b128 v[12:15], v11
    s_waitcnt lgkmcnt(0)
    v_or3_b32 v12, v12, v13, v14
    v_or_b32 v12, v12, v15
    s_nop 0
    v_readfirstlane_b32 s22, v12
    s_nop 0
    s_cmp_eq_u32 s22, 0
    s_cbranch_scc1 at_fin
    s_cmp_lg_u32 s41, 0
    s_cbranch_scc1 at_fin
    s_mov_b32 s41, 1
    s_mov_b32 s40, 0
    s_lshl_b32 s24, s3, 11
    s_add_u32 s25, s24, 0x3fa0000
    s_add_u32 s25, s25, s84
    s_add_u32 s24, s24, 0x3f80000
    s_add_u32 s24, s24, s84
    v_mov_b32 v8, 0xff61b1e6
    v_mov_b32 v9, 0xff61b1e6
    v_mov_b32 v10, 0xff61b1e6
    v_mov_b32 v11, 0xff61b1e6
at_mx:
    buffer_load_dwordx4 a[96:99], v4, s[8:11], s24 offen offset:0 sc1
    buffer_load_dwordx4 a[100:103], v4, s[8:11], s24 offen offset:1024 sc1
    buffer_load_dwordx4 a[104:107], v4, s[8:11], s25 offen offset:0 sc1
    buffer_load_dwordx4 a[108:111], v4, s[8:11], s25 offen offset:1024 sc1
    s_add_u32 s24, s24, 8192
    s_add_u32 s25, s25, 8192
    s_waitcnt vmcnt(0)
    v_mfma_f32_32x32x16_bf16 v[80:95], a[96:99], a[0:3], 0
    v_mfma_f32_32x32x16_bf16 v[80:95], a[100:103], a[4:7], v[80:95]
    s_nop 11
    v_max3_f32 v8, v8, v80, v81
    v_max_f32 v8, v8, v82
    v_max3_f32 v8, v8, v83, v84
    v_max3_f32 v8, v8, v85, v86
    v_max3_f32 v8, v8, v87, v88
    v_max3_f32 v8, v8, v89, v90
    v_max3_f32 v8, v8, v91, v92
    v_max3_f32 v8, v8, v93, v94
    v_max_f32 v8, v8, v95
    v_mfma_f32_32x32x16_bf16 v[80:95], a[96:99], a[8:11], 0
    v_mfma_f32_32x32x16_bf16 v[80:95], a[100:103], a[12:15], v[80:95]
    s_nop 11
    v_max3_f32 v9, v9, v80, v81
    v_max_f32 v9, v9, v82
    v_max3_f32 v9, v9, v83, v84
    v_max3_f32 v9, v9, v85, v86
    v_max3_f32 v9, v9, v87, v88
    v_max3_f32 v9, v9, v89, v90
    v_max3_f32 v9, v9, v91, v92
    v_max3_f32 v9, v9, v93, v94
    v_max_f32 v9, v9, v95
    v_mfma_f32_32x32x16_bf16 v[80:95], a[96:99], a[16:19], 0
    v_mfma_f32_32x32x16_bf16 v[80:95], a[100:103], a[20:23], v[80:95]
    s_nop 11
    v_max3_f32 v10, v10, v80, v81
    v_max_f32 v10, v10, v82
    v_max3_f32 v10, v10, v83, v84
    v_max3_f32 v10, v10, v85, v86
    v_max3_f32 v10, v10, v87, v88
    v_max3_f32 v10, v10, v89, v90
    v_max3_f32 v10, v10, v91, v92
    v_max3_f32 v10, v10, v93, v94
    v_max_f32 v10, v10, v95
    v_mfma_f32_32x32x16_bf16 v[80:95], a[96:99], a[24:27], 0
    v_mfma_f32_32x32x16_bf16 v[80:95], a[100:103], a[28:31], v[80:95]
    s_nop 11
    v_max3_f32 v11, v11, v80, v81
    v_max_f32 v11, v11, v82
    v_max3_f32 v11, v11, v83, v84
    v_max3_f32 v11, v11, v85, v86
    v_max3_f32 v11, v11, v87, v88
    v_max3_f32 v11, v11, v89, v90
    v_max3_f32 v11, v11, v91, v92
    v_max3_f32 v11, v11, v93, v94
    v_max_f32 v11, v11, v95
    s_add_u32 s40, s40, 1
    s_cmp_lt_u32 s40, 16
    s_cbranch_scc1 at_mx
    s_lshl_b32 s22, s3, 10
    v_add_u32 v12, s22, v4
    ds_write_b128 v12, v[8:11]
    s_waitcnt lgkmcnt(0)
    s_barrier
    ds_read_b128 v[80:83], v4 offset:0
    ds_read_b128 v[84:87], v4 offset:1024
    ds_read_b128 v[88:91], v4 offset:2048
    ds_read_b128 v[92:95], v4 offset:3072
    s_waitcnt lgkmcnt(0)
    s_barrier
    v_max3_f32 v8, v80, v84, v88
    v_max_f32 v8, v8, v92
    v_max3_f32 v9, v81, v85, v89
    v_max_f32 v9, v9, v93
    v_max3_f32 v10, v82, v86, v90
    v_max_f32 v10, v10, v94
    v_max3_f32 v11, v83, v87, v91
    v_max_f32 v11, v11, v95
    v_mov_b32 v12, v8
    v_mov_b32 v13, v9
    v_mov_b32 v14, v10
    v_mov_b32 v15, v11
    v_permlane32_swap_b32 v8, v12
    v_permlane32_swap_b32 v9, v13
    v_permlane32_swap_b32 v10, v14
    v_permlane32_swap_b32 v11, v15
    v_max_f32 v8, v8, v12
    v_max_f32 v9, v9, v13
    v_max_f32 v10, v10, v14
    v_max_f32 v11, v11, v15
    v_sub_f32 v16, 0, v8
    v_sub_f32 v17, 0, v8
    v_sub_f32 v18, 0, v8
    v_sub_f32 v19, 0, v8
    v_sub_f32 v20, 0, v8
    v_sub_f32 v21, 0, v8
    v_sub_f32 v22, 0, v8
    v_sub_f32 v23, 0, v8
    v_sub_f32 v24, 0, v8
    v_sub_f32 v25, 0, v8
    v_sub_f32 v26, 0, v8
    v_sub_f32 v27, 0, v8
    v_sub_f32 v28, 0, v8
    v_sub_f32 v29, 0, v8
    v_sub_f32 v30, 0, v8
    v_sub_f32 v31, 0, v8
    v_sub_f32 v32, 0, v9
    v_sub_f32 v33, 0, v9
    v_sub_f32 v34, 0, v9
    v_sub_f32 v35, 0, v9
    v_sub_f32 v36, 0, v9
    v_sub_f32 v37, 0, v9
    v_sub_f32 v38, 0, v9
    v_sub_f32 v39, 0, v9
    v_sub_f32 v40, 0, v9
    v_sub_f32 v41, 0, v9
    v_sub_f32 v42, 0, v9
    v_sub_f32 v43, 0, v9
    v_sub_f32 v44, 0, v9
    v_sub_f32 v45, 0, v9
    v_sub_f32 v46, 0, v9
    v_sub_f32 v47, 0, v9
    v_sub_f32 v48, 0, v10
    v_sub_f32 v49, 0, v10
    v_sub_f32 v50, 0, v10
    v_sub_f32 v51, 0, v10
    v_sub_f32 v52, 0, v10
    v_sub_f32 v53, 0, v10
    v_sub_f32 v54, 0, v10
    v_sub_f32 v55, 0, v10
    v_sub_f32 v56, 0, v10
    v_sub_f32 v57, 0, v10
    v_sub_f32 v58, 0, v10
    v_sub_f32 v59, 0, v10
    v_sub_f32 v60, 0, v10
    v_sub_f32 v61, 0, v10
    v_sub_f32 v62, 0, v10
    v_sub_f32 v63, 0, v10
    v_sub_f32 v64, 0, v11
    v_sub_f32 v65, 0, v11
    v_sub_f32 v66, 0, v11
    v_sub_f32 v67, 0, v11
    v_sub_f32 v68, 0, v11
    v_sub_f32 v69, 0, v11
    v_sub_f32 v70, 0, v11
    v_sub_f32 v71, 0, v11
    v_sub_f32 v72, 0, v11
    v_sub_f32 v73, 0, v11
    v_sub_f32 v74, 0, v11
    v_sub_f32 v75, 0, v11
    v_sub_f32 v76, 0, v11
    v_sub_f32 v77, 0, v11
    v_sub_f32 v78, 0, v11
    v_sub_f32 v79, 0, v11
    s_lshl_b32 s24, s3, 11
    s_add_u32 s25, s24, 0x3fa0000
    s_add_u32 s25, s25, s84
    s_add_u32 s24, s24, 0x3f80000
    s_add_u32 s24, s24, s84
    buffer_load_dwordx4 a[96:99], v4, s[8:11], s24 offen offset:0 sc1
    buffer_load_dwordx4 a[100:103], v4, s[8:11], s24 offen offset:1024 sc1
    buffer_load_dwordx4 a[104:107], v4, s[8:11], s25 offen offset:0 sc1
    buffer_load_dwordx4 a[108:111], v4, s[8:11], s25 offen offset:1024 sc1
    s_add_u32 s24, s24, 8192
    s_add_u32 s25, s25, 8192
    buffer_load_dwordx4 a[112:115], v4, s[8:11], s24 offen offset:0 sc1
    buffer_load_dwordx4 a[116:119], v4, s[8:11], s24 offen offset:1024 sc1
    buffer_load_dwordx4 a[120:123], v4, s[8:11], s25 offen offset:0 sc1
    buffer_load_dwordx4 a[124:127], v4, s[8:11], s25 offen offset:1024 sc1
    s_add_u32 s24, s24, 8192
    s_add_u32 s25, s25, 8192
    buffer_load_dwordx4 a[128:131], v4, s[8:11], s24 offen offset:0 sc1
    buffer_load_dwordx4 a[132:135], v4, s[8:11], s24 offen offset:1024 sc1
    buffer_load_dwordx4 a[136:139], v4, s[8:11], s25 offen offset:0 sc1
    buffer_load_dwordx4 a[140:143], v4, s[8:11], s25 offen offset:1024 sc1
    s_add_u32 s24, s24, 8192
    s_add_u32 s25, s25, 8192
    s_mov_b32 s36, s8
    s_mov_b32 s37, s9
    s_mov_b32 s38, s10
    s_mov_b32 s39, s11
    s_mov_b32 s48, 0
    s_cmp_eq_u32 s42, 0
    s_cbranch_scc1 sl_10_0
    s_mul_i32 s34, s20, 7
    s_lshl_b32 s35, s3, 1
    s_add_u32 s34, s34, s35
    s_lshl_b32 s34, s34, 14
    s_add_u32 s34, s34, 0xd30000
    s_movk_i32 s44, 1024
    s_mov_b32 s45, -1
    s_movk_i32 s47, 16384
    s_cmp_lt_u32 s3, 3
    s_cselect_b32 s38, s10, 0
    s_branch sl_10_d
sl_10_0:
    s_cmp_eq_u32 s43, 0
    s_cbranch_scc1 sl_10_w
    s_cmp_ge_u32 s100, 30
    s_cbranch_scc1 sl_10_w
    s_cmp_ge_u32 s100, 16
    s_cbranch_scc1 sl_10_b
    s_lshr_b32 s34, s3, 1
    s_mul_i32 s34, s34, 14
    s_and_b32 s35, s3, 1
    s_lshl_b32 s35, s35, 3
    s_add_u32 s34, s34, s35
    s_mul_i32 s35, s100, 28
    s_add_u32 s34, s34, s35
    s_mul_i32 s34, s34, 14336
    s_add_u32 s34, s34, 0x620000
    s_branch sl_10_t
sl_10_b:
    s_mul_i32 s34, s3, 112
    s_sub_u32 s35, s100, 16
    s_lshl_b32 s35, s35, 1
    s_add_u32 s34, s34, s35
    s_mul_i32 s34, s34, 14336
    s_add_u32 s34, s34, 0x0
sl_10_t:
    s_add_u32 s45, s34, 14336
    s_lshl_b32 s35, s3, 12
    s_add_u32 s34, s34, s35
    s_movk_i32 s44, 2048
    s_movk_i32 s46, -14336
    s_movk_i32 s47, 1024
    s_movk_i32 s48, 14336
    s_branch sl_10_d
sl_10_w:
    s_lshl_b32 s34, s3, 2
    s_cmp_eq_u32 s3, 3
    s_cselect_b32 s34, 11, s34
    s_lshl_b32 s34, s34, 15
    s_add_u32 s34, s34, 0xcc0000
    s_add_u32 s45, s34, 131072
    s_mov_b32 s44, 32768
    s_mov_b32 s46, -130048
    s_movk_i32 s47, 16384
sl_10_d:
    s_add_u32 s35, s34, s47
    v_accvgpr_write_b32 a32, 0
    v_accvgpr_write_b32 a33, 0
    v_accvgpr_write_b32 a34, 0
    v_accvgpr_write_b32 a35, 0
    v_accvgpr_write_b32 a36, 0
    v_accvgpr_write_b32 a37, 0
    v_accvgpr_write_b32 a38, 0
    v_accvgpr_write_b32 a39, 0
    v_accvgpr_write_b32 a40, 0
    v_accvgpr_write_b32 a41, 0
    v_accvgpr_write_b32 a42, 0
    v_accvgpr_write_b32 a43, 0
    v_accvgpr_write_b32 a44, 0
    v_accvgpr_write_b32 a45, 0
    v_accvgpr_write_b32 a46, 0
    v_accvgpr_write_b32 a47, 0
    v_accvgpr_write_b32 a48, 0
    v_accvgpr_write_b32 a49, 0
    v_accvgpr_write_b32 a50, 0
    v_accvgpr_write_b32 a51, 0
    v_accvgpr_write_b32 a52, 0
    v_accvgpr_write_b32 a53, 0
    v_accvgpr_write_b32 a54, 0
    v_accvgpr_write_b32 a55, 0
    v_accvgpr_write_b32 a56, 0
    v_accvgpr_write_b32 a57, 0
    v_accvgpr_write_b32 a58, 0
    v_accvgpr_write_b32 a59, 0
    v_accvgpr_write_b32 a60, 0
    v_accvgpr_write_b32 a61, 0
    v_accvgpr_write_b32 a62, 0
    v_accvgpr_write_b32 a63, 0
    v_accvgpr_write_b32 a64, 0
    v_accvgpr_write_b32 a65, 0
    v_accvgpr_write_b32 a66, 0
    v_accvgpr_write_b32 a67, 0
    v_accvgpr_write_b32 a68, 0
    v_accvgpr_write_b32 a69, 0
    v_accvgpr_write_b32 a70, 0
    v_accvgpr_write_b32 a71, 0
    v_accvgpr_write_b32 a72, 0
    v_accvgpr_write_b32 a73, 0
    v_accvgpr_write_b32 a74, 0
    v_accvgpr_write_b32 a75, 0
    v_accvgpr_write_b32 a76, 0
    v_accvgpr_write_b32 a77, 0
    v_accvgpr_write_b32 a78, 0
    v_accvgpr_write_b32 a79, 0
    v_accvgpr_write_b32 a80, 0
    v_accvgpr_write_b32 a81, 0
    v_accvgpr_write_b32 a82, 0
    v_accvgpr_write_b32 a83, 0
    v_accvgpr_write_b32 a84, 0
    v_accvgpr_write_b32 a85, 0
    v_accvgpr_write_b32 a86, 0
    v_accvgpr_write_b32 a87, 0
    v_accvgpr_write_b32 a88, 0
    v_accvgpr_write_b32 a89, 0
    v_accvgpr_write_b32 a90, 0
    v_accvgpr_write_b32 a91, 0
    v_accvgpr_write_b32 a92, 0
    v_accvgpr_write_b32 a93, 0
    v_accvgpr_write_b32 a94, 0
    v_accvgpr_write_b32 a95, 0
    v_accvgpr_write_b32 a152, 0
    v_mov_b32 v120, 0
    v_accvgpr_write_b32 a153, 0
    v_mov_b32 v121, 0
    v_accvgpr_write_b32 a154, 0
    v_mov_b32 v122, 0
    v_accvgpr_write_b32 a155, 0
    v_mov_b32 v123, 0
    v_accvgpr_write_b32 a156, 0
    v_mov_b32 v124, 0
    v_accvgpr_write_b32 a157, 0
    v_mov_b32 v125, 0
    v_accvgpr_write_b32 a158, 0
    v_mov_b32 v126, 0
    v_accvgpr_write_b32 a159, 0
    v_mov_b32 v127, 0
    s_branch at_pass
at_fin:
    s_lshl_b32 s22, s3, 11
    s_add_u32 s23, s22, 0x10400
    v_add_u32 v5, s23, v4
    ds_read_b128 v[16:19], v5
    ds_read_b128 v[20:23], v5 offset:1024
    s_lshl_b32 s26, s21, 2
    s_add_u32 s27, s26, s20
    s_lshl_b32 s23, s27, 13
    s_add_u32 s23, s23, s22
    s_add_u32 s23, s23, 0x4000000
    s_add_u32 s23, s23, s84
    s_waitcnt lgkmcnt(1)
    buffer_store_dwordx4 v[16:19], v4, s[8:11], s23 offen sc1
    s_waitcnt lgkmcnt(0)
    buffer_store_dwordx4 v[20:23], v4, s[8:11], s23 offen offset:1024 sc1
    v_bfe_u32 v6, v1, 0, 4
    v_mul_u32_u24 v6, 0x700, v6
    v_bfe_u32 v2, v1, 4, 2
    v_lshlrev_b32 v2, 4, v2
    v_add_u32 v6, v6, v2
    s_mul_i32 s28, s21, 57344
    s_mul_i32 s29, s20, 448
    s_add_u32 s28, s28, s29
    s_lshl_b32 s29, s3, 7
    s_add_u32 s28, s28, s29
    s_add_u32 s28, s28, 0xe00000
    s_add_u32 s29, s28, 0x0
    buffer_load_dwordx4 v[32:35], v6, s[8:11], s29 offen offset:0 sc1
    buffer_load_dwordx4 v[36:39], v6, s[36:39], s29 offen offset:64 sc1
    s_add_u32 s29, s28, 0x7000
    buffer_load_dwordx4 v[40:43], v6, s[8:11], s29 offen offset:0 sc1
    buffer_load_dwordx4 v[44:47], v6, s[36:39], s29 offen offset:64 sc1
    s_waitcnt vmcnt(4)
    s_barrier
    s_cmp_lg_u32 s3, 0
    s_cbranch_scc1 at_fw
    s_lshl_b32 s22, s27, 7
    s_add_u32 s22, s22, 0x429a000
    s_add_u32 s22, s22, s84
    v_mov_b32 v2, 1
    v_mov_b32 v3, 0
    s_mov_b64 exec, 1
    buffer_store_dword v2, v3, s[8:11], s22 offen sc1
    s_mov_b64 exec, -1
at_fw:
    s_cmp_eq_u32 s42, 0
    s_cbranch_scc1 la0_pass2
    s_add_u32 s27, s26, s3
    s_lshl_b32 s22, s27, 7
    s_add_u32 s22, s22, 0x429a000
    s_add_u32 s22, s22, s84
    v_mov_b32 v3, 0
    s_mov_b32 s40, 0
at_fp:
    buffer_load_dword v2, v3, s[8:11], s22 offen sc1
    s_waitcnt vmcnt(0)
    v_cmp_eq_u32 vcc, 0, v2
    s_cbranch_vccz at_fok
    s_sleep 1
    s_add_u32 s40, s40, 1
    s_cmp_lt_u32 s40, 0x20000
    s_cbranch_scc1 at_fp
at_fok:
    s_lshl_b32 s23, s27, 13
    s_add_u32 s23, s23, 0x4000000
    s_add_u32 s23, s23, s84
    s_lshl_b32 s22, s3, 13
    s_add_u32 m0, s22, 0
    s_nop 0
    buffer_load_dwordx4 v4, s[8:11], s23 offen offset:0 sc1 lds
    buffer_load_dwordx4 v4, s[8:11], s23 offen offset:1024 sc1 lds
    buffer_load_dwordx4 v4, s[8:11], s23 offen offset:2048 sc1 lds
    buffer_load_dwordx4 v4, s[8:11], s23 offen offset:3072 sc1 lds
    s_add_u32 s23, s23, 4096
    s_add_u32 m0, s22, 4096
    s_nop 0
    buffer_load_dwordx4 v4, s[8:11], s23 offen offset:0 sc1 lds
    buffer_load_dwordx4 v4, s[8:11], s23 offen offset:1024 sc1 lds
    buffer_load_dwordx4 v4, s[8:11], s23 offen offset:2048 sc1 lds
    buffer_load_dwordx4 v4, s[8:11], s23 offen offset:3072 sc1 lds
    v_bfe_u32 v7, v1, 0, 4
    v_mul_u32_u24 v7, 0x380, v7
    v_bfe_u32 v2, v1, 4, 2
    v_lshlrev_b32 v2, 3, v2
    v_add_u32 v7, v7, v2
    s_mul_i32 s28, s21, 28672
    s_mul_i32 s29, s20, 224
    s_add_u32 s28, s28, s29
    s_lshl_b32 s29, s3, 6
    s_add_u32 s28, s28, s29
    s_mov_b32 s36, s12
    s_mov_b32 s37, s13
    s_cmp_lt_u32 s3, 3
    s_cselect_b32 s38, s14, 0
    s_waitcnt vmcnt(0)
    s_barrier
    ds_read_b128 v[80:83], v4 offset:0
    ds_read_b128 v[84:87], v4 offset:4096
    ds_read_b128 v[88:91], v4 offset:1024
    ds_read_b128 v[92:95], v4 offset:5120
    ds_read_b128 v[96:99], v4 offset:2048
    ds_read_b128 v[100:103], v4 offset:6144
    ds_read_b128 v[104:107], v4 offset:3072
    ds_read_b128 v[108:111], v4 offset:7168
    ds_read_b128 v[112:115], v4 offset:8192
    ds_read_b128 v[116:119], v4 offset:12288
    s_waitcnt lgkmcnt(8)
    v_mfma_f32_16x16x32_bf16 v[32:35], a[168:171], v[80:83], v[32:35]
    v_mfma_f32_16x16x32_bf16 v[36:39], a[172:175], v[80:83], v[36:39]
    v_mfma_f32_16x16x32_bf16 v[40:43], a[168:171], v[84:87], v[40:43]
    v_mfma_f32_16x16x32_bf16 v[44:47], a[172:175], v[84:87], v[44:47]
    ds_read_b128 v[120:123], v4 offset:9216
    ds_read_b128 v[124:127], v4 offset:13312
    s_waitcnt lgkmcnt(8)
    v_mfma_f32_16x16x32_bf16 v[32:35], a[176:179], v[88:91], v[32:35]
    v_mfma_f32_16x16x32_bf16 v[36:39], a[180:183], v[88:91], v[36:39]
    v_mfma_f32_16x16x32_bf16 v[40:43], a[176:179], v[92:95], v[40:43]
    v_mfma_f32_16x16x32_bf16 v[44:47], a[180:183], v[92:95], v[44:47]
    ds_read_b128 v[80:83], v4 offset:10240
    ds_read_b128 v[84:87], v4 offset:14336
    s_waitcnt lgkmcnt(8)
    v_mfma_f32_16x16x32_bf16 v[32:35], a[184:187], v[96:99], v[32:35]
    v_mfma_f32_16x16x32_bf16 v[36:39], a[188:191], v[96:99], v[36:39]
    v_mfma_f32_16x16x32_bf16 v[40:43], a[184:187], v[100:103], v[40:43]
    v_mfma_f32_16x16x32_bf16 v[44:47], a[188:191], v[100:103], v[44:47]
    ds_read_b128 v[88:91], v4 offset:11264
    ds_read_b128 v[92:95], v4 offset:15360
    s_waitcnt lgkmcnt(8)
    v_mfma_f32_16x16x32_bf16 v[32:35], a[192:195], v[104:107], v[32:35]
    v_mfma_f32_16x16x32_bf16 v[36:39], a[196:199], v[104:107], v[36:39]
    v_mfma_f32_16x16x32_bf16 v[40:43], a[192:195], v[108:111], v[40:43]
    v_mfma_f32_16x16x32_bf16 v[44:47], a[196:199], v[108:111], v[44:47]
    ds_read_b128 v[96:99], v4 offset:16384
    ds_read_b128 v[100:103], v4 offset:20480
    s_waitcnt lgkmcnt(8)
    v_mfma_f32_16x16x32_bf16 v[32:35], a[200:203], v[112:115], v[32:35]
    v_mfma_f32_16x16x32_bf16 v[36:39], a[204:207], v[112:115], v[36:39]
    v_mfma_f32_16x16x32_bf16 v[40:43], a[200:203], v[116:119], v[40:43]
    v_mfma_f32_16x16x32_bf16 v[44:47], a[204:207], v[116:119], v[44:47]
    ds_read_b128 v[104:107], v4 offset:17408
    ds_read_b128 v[108:111], v4 offset:21504
    s_waitcnt lgkmcnt(8)
    v_mfma_f32_16x16x32_bf16 v[32:35], a[208:211], v[120:123], v[32:35]
    v_mfma_f32_16x16x32_bf16 v[36:39], a[212:215], v[120:123], v[36:39]
    v_mfma_f32_16x16x32_bf16 v[40:43], a[208:211], v[124:127], v[40:43]
    v_mfma_f32_16x16x32_bf16 v[44:47], a[212:215], v[124:127], v[44:47]
    ds_read_b128 v[112:115], v4 offset:18432
    ds_read_b128 v[116:119], v4 offset:22528
    s_waitcnt lgkmcnt(8)
    v_mfma_f32_16x16x32_bf16 v[32:35], a[216:219], v[80:83], v[32:35]
    v_mfma_f32_16x16x32_bf16 v[36:39], a[220:223], v[80:83], v[36:39]
    v_mfma_f32_16x16x32_bf16 v[40:43], a[216:219], v[84:87], v[40:43]
    v_mfma_f32_16x16x32_bf16 v[44:47], a[220:223], v[84:87], v[44:47]
    ds_read_b128 v[120:123], v4 offset:19456
    ds_read_b128 v[124:127], v4 offset:23552
    s_waitcnt lgkmcnt(8)
    v_mfma_f32_16x16x32_bf16 v[32:35], a[224:227], v[88:91], v[32:35]
    v_mfma_f32_16x16x32_bf16 v[36:39], a[228:231], v[88:91], v[36:39]
    v_mfma_f32_16x16x32_bf16 v[40:43], a[224:227], v[92:95], v[40:43]
    v_mfma_f32_16x16x32_bf16 v[44:47], a[228:231], v[92:95], v[44:47]
    ds_read_b128 v[80:83], v4 offset:24576
    ds_read_b128 v[84:87], v4 offset:28672
    s_waitcnt lgkmcnt(8)
    v_mfma_f32_16x16x32_bf16 v[32:35], a[232:235], v[96:99], v[32:35]
    v_mfma_f32_16x16x32_bf16 v[36:39], a[236:239], v[96:99], v[36:39]
    v_mfma_f32_16x16x32_bf16 v[40:43], a[232:235], v[100:103], v[40:43]
    v_mfma_f32_16x16x32_bf16 v[44:47], a[236:239], v[100:103], v[44:47]
    ds_read_b128 v[88:91], v4 offset:25600
    ds_read_b128 v[92:95], v4 offset:29696
    s_waitcnt lgkmcnt(8)
    v_mfma_f32_16x16x32_bf16 v[32:35], a[240:243], v[104:107], v[32:35]
    v_mfma_f32_16x16x32_bf16 v[36:39], a[244:247], v[104:107], v[36:39]
    v_mfma_f32_16x16x32_bf16 v[40:43], a[240:243], v[108:111], v[40:43]
    v_mfma_f32_16x16x32_bf16 v[44:47], a[244:247], v[108:111], v[44:47]
    ds_read_b128 v[96:99], v4 offset:26624
    ds_read_b128 v[100:103], v4 offset:30720
    s_waitcnt lgkmcnt(8)
    v_mfma_f32_16x16x32_bf16 v[32:35], a[248:251], v[112:115], v[32:35]
    v_mfma_f32_16x16x32_bf16 v[36:39], a[252:255], v[112:115], v[36:39]
    v_mfma_f32_16x16x32_bf16 v[40:43], a[248:251], v[116:119], v[40:43]
    v_mfma_f32_16x16x32_bf16 v[44:47], a[252:255], v[116:119], v[44:47]
    ds_read_b128 v[104:107], v4 offset:27648
    ds_read_b128 v[108:111], v4 offset:31744
    s_waitcnt lgkmcnt(8)
    v_mfma_f32_16x16x32_bf16 v[32:35], v[200:203], v[120:123], v[32:35]
    v_mfma_f32_16x16x32_bf16 v[36:39], v[204:207], v[120:123], v[36:39]
    v_mfma_f32_16x16x32_bf16 v[40:43], v[200:203], v[124:127], v[40:43]
    v_mfma_f32_16x16x32_bf16 v[44:47], v[204:207], v[124:127], v[44:47]
    s_waitcnt lgkmcnt(6)
    v_mfma_f32_16x16x32_bf16 v[32:35], v[208:211], v[80:83], v[32:35]
    v_mfma_f32_16x16x32_bf16 v[36:39], v[212:215], v[80:83], v[36:39]
    v_mfma_f32_16x16x32_bf16 v[40:43], v[208:211], v[84:87], v[40:43]
    v_mfma_f32_16x16x32_bf16 v[44:47], v[212:215], v[84:87], v[44:47]
    s_waitcnt lgkmcnt(4)
    v_mfma_f32_16x16x32_bf16 v[32:35], v[216:219], v[88:91], v[32:35]
    v_mfma_f32_16x16x32_bf16 v[36:39], v[220:223], v[88:91], v[36:39]
    v_mfma_f32_16x16x32_bf16 v[40:43], v[216:219], v[92:95], v[40:43]
    v_mfma_f32_16x16x32_bf16 v[44:47], v[220:223], v[92:95], v[44:47]
    s_waitcnt lgkmcnt(2)
    v_mfma_f32_16x16x32_bf16 v[32:35], v[224:227], v[96:99], v[32:35]
    v_mfma_f32_16x16x32_bf16 v[36:39], v[228:231], v[96:99], v[36:39]
    v_mfma_f32_16x16x32_bf16 v[40:43], v[224:227], v[100:103], v[40:43]
    v_mfma_f32_16x16x32_bf16 v[44:47], v[228:231], v[100:103], v[44:47]
    s_waitcnt lgkmcnt(0)
    v_mfma_f32_16x16x32_bf16 v[32:35], v[232:235], v[104:107], v[32:35]
    v_mfma_f32_16x16x32_bf16 v[36:39], v[236:239], v[104:107], v[36:39]
    v_mfma_f32_16x16x32_bf16 v[40:43], v[232:235], v[108:111], v[40:43]
    v_mfma_f32_16x16x32_bf16 v[44:47], v[236:239], v[108:111], v[44:47]
    s_add_u32 s29, s28, 0
    v_cvt_pk_bf16_f32 v64, v32, v33
    v_cvt_pk_bf16_f32 v65, v34, v35
    buffer_store_dwordx2 v[64:65], v7, s[12:15], s29 offen offset:0
    v_cvt_pk_bf16_f32 v66, v36, v37
    v_cvt_pk_bf16_f32 v67, v38, v39
    buffer_store_dwordx2 v[66:67], v7, s[36:39], s29 offen offset:32
    s_add_u32 s29, s28, 14336
    v_cvt_pk_bf16_f32 v68, v40, v41
    v_cvt_pk_bf16_f32 v69, v42, v43
    buffer_store_dwordx2 v[68:69], v7, s[12:15], s29 offen offset:0
    v_cvt_pk_bf16_f32 v70, v44, v45
    v_cvt_pk_bf16_f32 v71, v46, v47
    buffer_store_dwordx2 v[70:71], v7, s[36:39], s29 offen offset:32
    s_branch la0_end
la0_end:
la_x:
    s_endpgm
.section .rodata,"a"
.p2align 6
.amdhsa_kernel prep_kernel
  .amdhsa_next_free_vgpr 288
  .amdhsa_next_free_sgpr 102
  .amdhsa_accum_offset 256
  .amdhsa_group_segment_fixed_size 0
  .amdhsa_kernarg_size 120
  .amdhsa_user_sgpr_count 2
  .amdhsa_user_sgpr_kernarg_segment_ptr 1
  .amdhsa_system_sgpr_workgroup_id_x 1
.end_amdhsa_kernel
.p2align 6
.amdhsa_kernel main_kernel
  .amdhsa_next_free_vgpr 512
  .amdhsa_next_free_sgpr 102
  .amdhsa_accum_offset 256
  .amdhsa_group_segment_fixed_size 0
  .amdhsa_kernarg_size 120
  .amdhsa_user_sgpr_count 2
  .amdhsa_user_sgpr_kernarg_segment_ptr 1
  .amdhsa_system_sgpr_workgroup_id_x 1
.end_amdhsa_kernel
```
